```python
import torch

def _softmax(x, axis=-1):
    return torch.softmax(x, dim=axis)

def _gelu(x):
    return torch.nn.functional.gelu(x, approximate='tanh')

def _silu(x):
    return torch.nn.functional.silu(x)

def _sigmoid(x):
    return torch.sigmoid(x)

def _layernorm(x, axis=-1, eps=1e-05):
    m = x.mean(dim=axis, keepdim=True)
    v = x.var(dim=axis, keepdim=True, unbiased=False)
    return (x - m) / torch.sqrt(v + eps)

def _scatter_add(tgt, idx, src, axis=0):
    return tgt.clone().index_add_(axis, idx, src)

def _segment_sum(src, seg, n):
    out = torch.zeros((n,) + src.shape[1:], dtype=src.dtype)
    return out.index_add_(0, seg, src)

def _pad(x, pw):
    flat = tuple((v for pair in reversed(pw) for v in pair))
    return torch.nn.functional.pad(x, flat)
kernel_name = 'concat_heads__memory_aug_recurrent_mem_tr__sliding_block__prompt'

def setup_inputs():

    _w = lambda a: (lambda t: t.to(torch.bfloat16) if t.is_floating_point() else t)(torch.as_tensor(a))

    def _A_setup():
        B, S, Dm = (1, 2048, 640)
        H, Dh = (32, 192)
        M, seg = (8, 32)
        seg = min(seg, S)
        S = S // seg * seg
        return {'x': _w((lambda *s: torch.randn(*s, dtype=torch.bfloat16) * 0.05)(B, S, Dm)), 'mem0': _w((lambda *s: torch.randn(*s, dtype=torch.bfloat16) * 1.6)(B, M, Dm)), 'Wq': _w((lambda *s: torch.randn(*s, dtype=torch.bfloat16) * 0.8)(Dm, H, Dh) * Dm ** (-0.5)), 'Wk': _w((lambda *s: torch.randn(*s, dtype=torch.bfloat16) * 0.8)(Dm, H, Dh) * Dm ** (-0.5)), 'Wv': _w((lambda *s: torch.randn(*s, dtype=torch.bfloat16) * 1.6)(Dm, H, Dh) * Dm ** (-0.5)), 'Wo': _w((lambda *s: torch.randn(*s, dtype=torch.bfloat16) * 1.6)(H, Dh, Dm) * (H * Dh) ** (-0.5)), 'seg_len': seg}
    _A_in = _A_setup()

    def _B_setup():
        B, S, D = (1, 2048, 640)
        return {'x': _w((lambda *s: torch.randn(*s, dtype=torch.bfloat16) * 0.2)(B, S, D)), 'wqkv': _w((lambda *s: torch.randn(*s, dtype=torch.bfloat16) * 0.2)(D, 3 * D)), 'wo': _w((lambda *s: torch.randn(*s, dtype=torch.bfloat16) * 0.05)(D, D))}
    _B_in = _B_setup()
    return {'A_x': _A_in['x'], 'A_mem0': _A_in['mem0'], 'A_Wq': _A_in['Wq'], 'A_Wk': _A_in['Wk'], 'A_Wv': _A_in['Wv'], 'A_Wo': _A_in['Wo'], 'A_seg_len': _A_in['seg_len'], 'B_x': _B_in['x'], 'B_wqkv': _B_in['wqkv'], 'B_wo': _B_in['wo']}

def reference(A_x, A_mem0, A_Wq, A_Wk, A_Wv, A_Wo, A_seg_len, B_x, B_wqkv, B_wo):

    def _A_ref(x, mem0, Wq, Wk, Wv, Wo, seg_len):
        B, S, Dm = x.shape
        H, Dh = (Wq.shape[1], Wq.shape[2])
        M = mem0.shape[1]
        scale = Dh ** (-0.5)
        n_seg = S // seg_len
        L = M + seg_len
        idx = torch.arange(L)
        mask = (idx[:, None] < M) | (idx[:, None] >= idx[None, :])
        mem = mem0
        outs = []
        for s in range(n_seg):
            xs = x[:, s * seg_len:(s + 1) * seg_len, :].clone()
            h = torch.concatenate([mem, xs], axis=1)
            q = torch.einsum('btd,dhe->bhte', h, Wq)
            k = torch.einsum('btd,dhe->bhte', h, Wk)
            v = torch.einsum('btd,dhe->bhte', h, Wv)
            scores = torch.einsum('bhqe,bhke->bhqk', q, k) * scale
            scores = torch.where(mask[None, None], scores, -1000000000.0)
            p = _softmax(scores, axis=-1)
            o = torch.einsum('bhqk,bhke->bhqe', p, v)
            o = torch.einsum('bhte,hed->btd', o, Wo)
            mem = o[:, :M, :].clone()
            outs.append(o[:, M:, :])
        return torch.concatenate(outs, axis=1)

    def _B_ref(x, wqkv, wo):
        B, S, D = x.shape
        H = 32
        Dh = D // H
        W = 256
        qkv = (lambda x, *d: x.permute(*d))((x @ wqkv).reshape(B, S, 3, H, Dh), 2, 0, 3, 1, 4)
        q, k, v = (qkv[0], qkv[1], qkv[2])
        scores = torch.einsum('bhqd,bhkd->bhqk', q, k) * Dh ** (-0.5)
        idx = torch.arange(S)
        mask = (idx[:, None] - idx[None, :] >= 0) & (idx[:, None] - idx[None, :] < W)
        scores = torch.where(mask[None, None], scores, -1000000000.0)
        p = _softmax(scores, axis=-1)
        o = torch.einsum('bhqk,bhkd->bhqd', p, v)
        return (lambda x, *d: x.permute(*d))(o, 0, 2, 1, 3).reshape(B, S, D) @ wo
    a = _A_ref(A_x, A_mem0, A_Wq, A_Wk, A_Wv, A_Wo, A_seg_len)
    b = _B_ref(B_x, B_wqkv, B_wo)
    return torch.concatenate([a, b], axis=-1)
```

```asm
; @launch grid=(256,1,1) block=(256,1,1) lds=163840
.amdgcn_target "amdgcn-amd-amdhsa--gfx950"
.text
.globl concat_heads__memory_aug_recurrent_mem_tr__sliding_block__prompt_kernel
.p2align 8
.type concat_heads__memory_aug_recurrent_mem_tr__sliding_block__prompt_kernel,@function
concat_heads__memory_aug_recurrent_mem_tr__sliding_block__prompt_kernel:
    s_cmp_ge_u32 s2, 256
    s_cbranch_scc1 L_exit
    s_load_dwordx2 s[4:5], s[0:1], 96
    v_lshrrev_b32 v2, 6, v0
    v_and_b32 v1, 63, v0
    v_readfirstlane_b32 s20, v2
    s_load_dwordx2 s[98:99], s[0:1], 88
    s_mov_b32 s100, 60000
    s_waitcnt lgkmcnt(0)
    s_and_b32 s5, s5, 0xffff
    s_mov_b32 s6, 268435456
    s_mov_b32 s7, 0x20000
    s_and_b32 s23, s2, 7
    s_lshr_b32 s24, s2, 3
    s_cmp_ge_u32 s23, 2
    s_cbranch_scc1 L_bulk
    s_cmp_ge_u32 s24, 16
    s_cbranch_scc1 L_chV
    s_load_dwordx2 s[8:9], s[0:1], 16
    s_load_dwordx2 s[16:17], s[0:1], 24
    s_load_dwordx2 s[12:13], s[0:1], 8
    s_and_b32 s21, s24, 15
    s_lshl_b32 s26, s23, 4
    s_add_u32 s21, s21, s26
    s_getreg_b32 s25, hwreg(HW_REG_XCC_ID, 0, 4)
    s_lshl_b32 s26, s23, 5
    s_add_u32 s26, s26, s24
    s_lshl_b32 s26, s26, 2
    s_add_u32 s27, s26, 167809024
    s_waitcnt lgkmcnt(0)
    s_and_b32 s9, s9, 0xffff
    s_mov_b32 s10, 7864320
    s_mov_b32 s11, 0x20000
    s_and_b32 s17, s17, 0xffff
    s_mov_b32 s18, 7864320
    s_mov_b32 s19, 0x20000
    s_and_b32 s13, s13, 0xffff
    s_mov_b32 s14, 10240
    s_mov_b32 s15, 0x20000
    s_mul_i32 s66, s21, 384
    s_waitcnt vmcnt(0)
    v_add_u32 v121, 0, v1
    v_mul_u32_u24 v122, 2731, v121
    v_lshrrev_b32 v122, 16, v122
    v_mul_u32_u24 v123, 24, v122
    v_sub_u32 v123, v121, v123
    v_mul_u32_u24 v122, 12288, v122
    v_lshl_add_u32 v116, v123, 4, v122
    v_add_u32 v121, 64, v1
    v_mul_u32_u24 v122, 2731, v121
    v_lshrrev_b32 v122, 16, v122
    v_mul_u32_u24 v123, 24, v122
    v_sub_u32 v123, v121, v123
    v_mul_u32_u24 v122, 12288, v122
    v_lshl_add_u32 v117, v123, 4, v122
    v_add_u32 v121, 128, v1
    v_mul_u32_u24 v122, 2731, v121
    v_lshrrev_b32 v122, 16, v122
    v_mul_u32_u24 v123, 24, v122
    v_sub_u32 v123, v121, v123
    v_mul_u32_u24 v122, 12288, v122
    v_lshl_add_u32 v118, v123, 4, v122
    s_mul_i32 s41, s20, 196608
    s_add_u32 s40, s66, s41
    s_mul_i32 s42, s20, 6144
    v_lshrrev_b32 v121, 4, v1
    v_bfe_u32 v122, v1, 2, 2
    v_lshrrev_b32 v123, 1, v121
    v_and_b32 v121, 1, v121
    v_lshlrev_b32 v121, 2, v121
    v_lshl_add_u32 v121, v123, 4, v121
    v_lshrrev_b32 v123, 1, v122
    v_lshl_add_u32 v121, v123, 3, v121
    v_and_b32 v122, 1, v122
    v_add_u32 v121, v121, v122
    v_mul_u32_u24 v121, 384, v121
    v_and_b32 v122, 3, v1
    v_lshl_add_u32 v121, v122, 3, v121
    s_mul_i32 s41, s20, 96
    v_add_u32 v119, s41, v121
    v_add_u32 v120, 73728, v119
    s_add_u32 m0, s42, 0
    s_add_u32 s41, s40, 0
    buffer_load_dwordx4 v116, s[8:11], s41 offen lds
    s_add_u32 m0, s42, 1024
    s_add_u32 s41, s40, 0
    buffer_load_dwordx4 v117, s[8:11], s41 offen lds
    s_add_u32 m0, s42, 2048
    s_add_u32 s41, s40, 0
    buffer_load_dwordx4 v118, s[8:11], s41 offen lds
    s_add_u32 m0, s42, 3072
    s_add_u32 s41, s40, 98304
    buffer_load_dwordx4 v116, s[8:11], s41 offen lds
    s_add_u32 m0, s42, 4096
    s_add_u32 s41, s40, 98304
    buffer_load_dwordx4 v117, s[8:11], s41 offen lds
    s_add_u32 m0, s42, 5120
    s_add_u32 s41, s40, 98304
    buffer_load_dwordx4 v118, s[8:11], s41 offen lds
    s_add_u32 m0, s42, 24576
    s_add_u32 s41, s40, 786432
    buffer_load_dwordx4 v116, s[8:11], s41 offen lds
    s_add_u32 m0, s42, 25600
    s_add_u32 s41, s40, 786432
    buffer_load_dwordx4 v117, s[8:11], s41 offen lds
    s_add_u32 m0, s42, 26624
    s_add_u32 s41, s40, 786432
    buffer_load_dwordx4 v118, s[8:11], s41 offen lds
    s_add_u32 m0, s42, 27648
    s_add_u32 s41, s40, 884736
    buffer_load_dwordx4 v116, s[8:11], s41 offen lds
    s_add_u32 m0, s42, 28672
    s_add_u32 s41, s40, 884736
    buffer_load_dwordx4 v117, s[8:11], s41 offen lds
    s_add_u32 m0, s42, 29696
    s_add_u32 s41, s40, 884736
    buffer_load_dwordx4 v118, s[8:11], s41 offen lds
    s_add_u32 m0, s42, 49152
    s_add_u32 s41, s40, 1572864
    buffer_load_dwordx4 v116, s[8:11], s41 offen lds
    s_add_u32 m0, s42, 50176
    s_add_u32 s41, s40, 1572864
    buffer_load_dwordx4 v117, s[8:11], s41 offen lds
    s_add_u32 m0, s42, 51200
    s_add_u32 s41, s40, 1572864
    buffer_load_dwordx4 v118, s[8:11], s41 offen lds
    s_add_u32 m0, s42, 52224
    s_add_u32 s41, s40, 1671168
    buffer_load_dwordx4 v116, s[8:11], s41 offen lds
    s_add_u32 m0, s42, 53248
    s_add_u32 s41, s40, 1671168
    buffer_load_dwordx4 v117, s[8:11], s41 offen lds
    s_add_u32 m0, s42, 54272
    s_add_u32 s41, s40, 1671168
    buffer_load_dwordx4 v118, s[8:11], s41 offen lds
    s_add_u32 m0, s42, 73728
    s_add_u32 s41, s40, 2359296
    buffer_load_dwordx4 v116, s[8:11], s41 offen lds
    s_add_u32 m0, s42, 74752
    s_add_u32 s41, s40, 2359296
    buffer_load_dwordx4 v117, s[8:11], s41 offen lds
    s_add_u32 m0, s42, 75776
    s_add_u32 s41, s40, 2359296
    buffer_load_dwordx4 v118, s[8:11], s41 offen lds
    s_add_u32 m0, s42, 76800
    s_add_u32 s41, s40, 2457600
    buffer_load_dwordx4 v116, s[8:11], s41 offen lds
    s_add_u32 m0, s42, 77824
    s_add_u32 s41, s40, 2457600
    buffer_load_dwordx4 v117, s[8:11], s41 offen lds
    s_add_u32 m0, s42, 78848
    s_add_u32 s41, s40, 2457600
    buffer_load_dwordx4 v118, s[8:11], s41 offen lds
    s_add_u32 m0, s42, 98304
    s_add_u32 s41, s40, 3145728
    buffer_load_dwordx4 v116, s[8:11], s41 offen lds
    s_add_u32 m0, s42, 99328
    s_add_u32 s41, s40, 3145728
    buffer_load_dwordx4 v117, s[8:11], s41 offen lds
    s_add_u32 m0, s42, 100352
    s_add_u32 s41, s40, 3145728
    buffer_load_dwordx4 v118, s[8:11], s41 offen lds
    s_add_u32 m0, s42, 101376
    s_add_u32 s41, s40, 3244032
    buffer_load_dwordx4 v116, s[8:11], s41 offen lds
    s_add_u32 m0, s42, 102400
    s_add_u32 s41, s40, 3244032
    buffer_load_dwordx4 v117, s[8:11], s41 offen lds
    s_add_u32 m0, s42, 103424
    s_add_u32 s41, s40, 3244032
    buffer_load_dwordx4 v118, s[8:11], s41 offen lds
    s_waitcnt vmcnt(24)
    s_barrier
    s_add_u32 m0, s42, 122880
    s_add_u32 s41, s40, 3932160
    buffer_load_dwordx4 v116, s[8:11], s41 offen lds
    s_add_u32 m0, s42, 123904
    s_add_u32 s41, s40, 3932160
    buffer_load_dwordx4 v117, s[8:11], s41 offen lds
    s_add_u32 m0, s42, 124928
    s_add_u32 s41, s40, 3932160
    buffer_load_dwordx4 v118, s[8:11], s41 offen lds
    s_add_u32 m0, s42, 125952
    s_add_u32 s41, s40, 4030464
    buffer_load_dwordx4 v116, s[8:11], s41 offen lds
    s_add_u32 m0, s42, 126976
    s_add_u32 s41, s40, 4030464
    buffer_load_dwordx4 v117, s[8:11], s41 offen lds
    s_add_u32 m0, s42, 128000
    s_add_u32 s41, s40, 4030464
    buffer_load_dwordx4 v118, s[8:11], s41 offen lds
    ds_read_b64_tr_b16 a[0:1], v119 offset:0
    ds_read_b64_tr_b16 a[2:3], v119 offset:768
    ds_read_b64_tr_b16 a[8:9], v119 offset:32
    ds_read_b64_tr_b16 a[10:11], v119 offset:800
    ds_read_b64_tr_b16 a[128:129], v119 offset:64
    ds_read_b64_tr_b16 a[130:131], v119 offset:832
    ds_read_b64_tr_b16 a[4:5], v119 offset:12288
    ds_read_b64_tr_b16 a[6:7], v119 offset:13056
    ds_read_b64_tr_b16 a[12:13], v119 offset:12320
    ds_read_b64_tr_b16 a[14:15], v119 offset:13088
    ds_read_b64_tr_b16 a[132:133], v119 offset:12352
    ds_read_b64_tr_b16 a[134:135], v119 offset:13120
    s_waitcnt lgkmcnt(0)
    s_waitcnt vmcnt(24)
    s_barrier
    s_add_u32 m0, s42, 0
    s_add_u32 s41, s40, 4718592
    buffer_load_dwordx4 v116, s[8:11], s41 offen lds
    s_add_u32 m0, s42, 1024
    s_add_u32 s41, s40, 4718592
    buffer_load_dwordx4 v117, s[8:11], s41 offen lds
    s_add_u32 m0, s42, 2048
    s_add_u32 s41, s40, 4718592
    buffer_load_dwordx4 v118, s[8:11], s41 offen lds
    s_add_u32 m0, s42, 3072
    s_add_u32 s41, s40, 4816896
    buffer_load_dwordx4 v116, s[8:11], s41 offen lds
    s_add_u32 m0, s42, 4096
    s_add_u32 s41, s40, 4816896
    buffer_load_dwordx4 v117, s[8:11], s41 offen lds
    s_add_u32 m0, s42, 5120
    s_add_u32 s41, s40, 4816896
    buffer_load_dwordx4 v118, s[8:11], s41 offen lds
    ds_read_b64_tr_b16 a[16:17], v119 offset:24576
    ds_read_b64_tr_b16 a[18:19], v119 offset:25344
    ds_read_b64_tr_b16 a[24:25], v119 offset:24608
    ds_read_b64_tr_b16 a[26:27], v119 offset:25376
    ds_read_b64_tr_b16 a[136:137], v119 offset:24640
    ds_read_b64_tr_b16 a[138:139], v119 offset:25408
    ds_read_b64_tr_b16 a[20:21], v119 offset:36864
    ds_read_b64_tr_b16 a[22:23], v119 offset:37632
    ds_read_b64_tr_b16 a[28:29], v119 offset:36896
    ds_read_b64_tr_b16 a[30:31], v119 offset:37664
    ds_read_b64_tr_b16 a[140:141], v119 offset:36928
    ds_read_b64_tr_b16 a[142:143], v119 offset:37696
    s_waitcnt lgkmcnt(0)
    s_waitcnt vmcnt(24)
    s_barrier
    s_add_u32 m0, s42, 24576
    s_add_u32 s41, s40, 5505024
    buffer_load_dwordx4 v116, s[8:11], s41 offen lds
    s_add_u32 m0, s42, 25600
    s_add_u32 s41, s40, 5505024
    buffer_load_dwordx4 v117, s[8:11], s41 offen lds
    s_add_u32 m0, s42, 26624
    s_add_u32 s41, s40, 5505024
    buffer_load_dwordx4 v118, s[8:11], s41 offen lds
    s_add_u32 m0, s42, 27648
    s_add_u32 s41, s40, 5603328
    buffer_load_dwordx4 v116, s[8:11], s41 offen lds
    s_add_u32 m0, s42, 28672
    s_add_u32 s41, s40, 5603328
    buffer_load_dwordx4 v117, s[8:11], s41 offen lds
    s_add_u32 m0, s42, 29696
    s_add_u32 s41, s40, 5603328
    buffer_load_dwordx4 v118, s[8:11], s41 offen lds
    ds_read_b64_tr_b16 v[20:21], v119 offset:49152
    ds_read_b64_tr_b16 v[22:23], v119 offset:49920
    ds_read_b64_tr_b16 a[32:33], v119 offset:49184
    ds_read_b64_tr_b16 a[34:35], v119 offset:49952
    ds_read_b64_tr_b16 a[144:145], v119 offset:49216
    ds_read_b64_tr_b16 a[146:147], v119 offset:49984
    ds_read_b64_tr_b16 v[24:25], v119 offset:61440
    ds_read_b64_tr_b16 v[26:27], v119 offset:62208
    ds_read_b64_tr_b16 a[36:37], v119 offset:61472
    ds_read_b64_tr_b16 a[38:39], v119 offset:62240
    ds_read_b64_tr_b16 a[148:149], v119 offset:61504
    ds_read_b64_tr_b16 a[150:151], v119 offset:62272
    s_waitcnt lgkmcnt(0)
    s_waitcnt vmcnt(24)
    s_barrier
    s_add_u32 m0, s42, 49152
    s_add_u32 s41, s40, 6291456
    buffer_load_dwordx4 v116, s[8:11], s41 offen lds
    s_add_u32 m0, s42, 50176
    s_add_u32 s41, s40, 6291456
    buffer_load_dwordx4 v117, s[8:11], s41 offen lds
    s_add_u32 m0, s42, 51200
    s_add_u32 s41, s40, 6291456
    buffer_load_dwordx4 v118, s[8:11], s41 offen lds
    s_add_u32 m0, s42, 52224
    s_add_u32 s41, s40, 6389760
    buffer_load_dwordx4 v116, s[8:11], s41 offen lds
    s_add_u32 m0, s42, 53248
    s_add_u32 s41, s40, 6389760
    buffer_load_dwordx4 v117, s[8:11], s41 offen lds
    s_add_u32 m0, s42, 54272
    s_add_u32 s41, s40, 6389760
    buffer_load_dwordx4 v118, s[8:11], s41 offen lds
    ds_read_b64_tr_b16 a[40:41], v120 offset:0
    ds_read_b64_tr_b16 a[42:43], v120 offset:768
    ds_read_b64_tr_b16 a[48:49], v120 offset:32
    ds_read_b64_tr_b16 a[50:51], v120 offset:800
    ds_read_b64_tr_b16 a[152:153], v120 offset:64
    ds_read_b64_tr_b16 a[154:155], v120 offset:832
    ds_read_b64_tr_b16 a[44:45], v120 offset:12288
    ds_read_b64_tr_b16 a[46:47], v120 offset:13056
    ds_read_b64_tr_b16 a[52:53], v120 offset:12320
    ds_read_b64_tr_b16 a[54:55], v120 offset:13088
    ds_read_b64_tr_b16 a[156:157], v120 offset:12352
    ds_read_b64_tr_b16 a[158:159], v120 offset:13120
    s_waitcnt lgkmcnt(0)
    s_waitcnt vmcnt(24)
    s_barrier
    s_add_u32 m0, s42, 73728
    s_add_u32 s41, s40, 7077888
    buffer_load_dwordx4 v116, s[8:11], s41 offen lds
    s_add_u32 m0, s42, 74752
    s_add_u32 s41, s40, 7077888
    buffer_load_dwordx4 v117, s[8:11], s41 offen lds
    s_add_u32 m0, s42, 75776
    s_add_u32 s41, s40, 7077888
    buffer_load_dwordx4 v118, s[8:11], s41 offen lds
    s_add_u32 m0, s42, 76800
    s_add_u32 s41, s40, 7176192
    buffer_load_dwordx4 v116, s[8:11], s41 offen lds
    s_add_u32 m0, s42, 77824
    s_add_u32 s41, s40, 7176192
    buffer_load_dwordx4 v117, s[8:11], s41 offen lds
    s_add_u32 m0, s42, 78848
    s_add_u32 s41, s40, 7176192
    buffer_load_dwordx4 v118, s[8:11], s41 offen lds
    ds_read_b64_tr_b16 a[56:57], v120 offset:24576
    ds_read_b64_tr_b16 a[58:59], v120 offset:25344
    ds_read_b64_tr_b16 v[28:29], v120 offset:24608
    ds_read_b64_tr_b16 v[30:31], v120 offset:25376
    ds_read_b64_tr_b16 v[52:53], v120 offset:24640
    ds_read_b64_tr_b16 v[54:55], v120 offset:25408
    ds_read_b64_tr_b16 a[60:61], v120 offset:36864
    ds_read_b64_tr_b16 a[62:63], v120 offset:37632
    ds_read_b64_tr_b16 v[32:33], v120 offset:36896
    ds_read_b64_tr_b16 v[34:35], v120 offset:37664
    ds_read_b64_tr_b16 v[56:57], v120 offset:36928
    ds_read_b64_tr_b16 v[58:59], v120 offset:37696
    s_waitcnt lgkmcnt(0)
    s_waitcnt vmcnt(24)
    s_barrier
    s_add_u32 m0, s42, 98304
    s_add_u32 s41, s40, 0
    buffer_load_dwordx4 v116, s[16:19], s41 offen lds
    s_add_u32 m0, s42, 99328
    s_add_u32 s41, s40, 0
    buffer_load_dwordx4 v117, s[16:19], s41 offen lds
    s_add_u32 m0, s42, 100352
    s_add_u32 s41, s40, 0
    buffer_load_dwordx4 v118, s[16:19], s41 offen lds
    s_add_u32 m0, s42, 101376
    s_add_u32 s41, s40, 98304
    buffer_load_dwordx4 v116, s[16:19], s41 offen lds
    s_add_u32 m0, s42, 102400
    s_add_u32 s41, s40, 98304
    buffer_load_dwordx4 v117, s[16:19], s41 offen lds
    s_add_u32 m0, s42, 103424
    s_add_u32 s41, s40, 98304
    buffer_load_dwordx4 v118, s[16:19], s41 offen lds
    ds_read_b64_tr_b16 a[64:65], v120 offset:49152
    ds_read_b64_tr_b16 a[66:67], v120 offset:49920
    ds_read_b64_tr_b16 a[72:73], v120 offset:49184
    ds_read_b64_tr_b16 a[74:75], v120 offset:49952
    ds_read_b64_tr_b16 a[160:161], v120 offset:49216
    ds_read_b64_tr_b16 a[162:163], v120 offset:49984
    ds_read_b64_tr_b16 a[68:69], v120 offset:61440
    ds_read_b64_tr_b16 a[70:71], v120 offset:62208
    ds_read_b64_tr_b16 a[76:77], v120 offset:61472
    ds_read_b64_tr_b16 a[78:79], v120 offset:62240
    ds_read_b64_tr_b16 a[164:165], v120 offset:61504
    ds_read_b64_tr_b16 a[166:167], v120 offset:62272
    s_waitcnt lgkmcnt(0)
    s_waitcnt vmcnt(24)
    s_barrier
    s_add_u32 m0, s42, 122880
    s_add_u32 s41, s40, 786432
    buffer_load_dwordx4 v116, s[16:19], s41 offen lds
    s_add_u32 m0, s42, 123904
    s_add_u32 s41, s40, 786432
    buffer_load_dwordx4 v117, s[16:19], s41 offen lds
    s_add_u32 m0, s42, 124928
    s_add_u32 s41, s40, 786432
    buffer_load_dwordx4 v118, s[16:19], s41 offen lds
    s_add_u32 m0, s42, 125952
    s_add_u32 s41, s40, 884736
    buffer_load_dwordx4 v116, s[16:19], s41 offen lds
    s_add_u32 m0, s42, 126976
    s_add_u32 s41, s40, 884736
    buffer_load_dwordx4 v117, s[16:19], s41 offen lds
    s_add_u32 m0, s42, 128000
    s_add_u32 s41, s40, 884736
    buffer_load_dwordx4 v118, s[16:19], s41 offen lds
    ds_read_b64_tr_b16 a[80:81], v119 offset:0
    ds_read_b64_tr_b16 a[82:83], v119 offset:768
    ds_read_b64_tr_b16 a[88:89], v119 offset:32
    ds_read_b64_tr_b16 a[90:91], v119 offset:800
    ds_read_b64_tr_b16 a[168:169], v119 offset:64
    ds_read_b64_tr_b16 a[170:171], v119 offset:832
    ds_read_b64_tr_b16 a[84:85], v119 offset:12288
    ds_read_b64_tr_b16 a[86:87], v119 offset:13056
    ds_read_b64_tr_b16 a[92:93], v119 offset:12320
    ds_read_b64_tr_b16 a[94:95], v119 offset:13088
    ds_read_b64_tr_b16 a[172:173], v119 offset:12352
    ds_read_b64_tr_b16 a[174:175], v119 offset:13120
    s_waitcnt lgkmcnt(0)
    s_waitcnt vmcnt(24)
    s_barrier
    s_add_u32 m0, s42, 0
    s_add_u32 s41, s40, 1572864
    buffer_load_dwordx4 v116, s[16:19], s41 offen lds
    s_add_u32 m0, s42, 1024
    s_add_u32 s41, s40, 1572864
    buffer_load_dwordx4 v117, s[16:19], s41 offen lds
    s_add_u32 m0, s42, 2048
    s_add_u32 s41, s40, 1572864
    buffer_load_dwordx4 v118, s[16:19], s41 offen lds
    s_add_u32 m0, s42, 3072
    s_add_u32 s41, s40, 1671168
    buffer_load_dwordx4 v116, s[16:19], s41 offen lds
    s_add_u32 m0, s42, 4096
    s_add_u32 s41, s40, 1671168
    buffer_load_dwordx4 v117, s[16:19], s41 offen lds
    s_add_u32 m0, s42, 5120
    s_add_u32 s41, s40, 1671168
    buffer_load_dwordx4 v118, s[16:19], s41 offen lds
    ds_read_b64_tr_b16 v[36:37], v119 offset:24576
    ds_read_b64_tr_b16 v[38:39], v119 offset:25344
    ds_read_b64_tr_b16 a[96:97], v119 offset:24608
    ds_read_b64_tr_b16 a[98:99], v119 offset:25376
    ds_read_b64_tr_b16 a[176:177], v119 offset:24640
    ds_read_b64_tr_b16 a[178:179], v119 offset:25408
    ds_read_b64_tr_b16 v[40:41], v119 offset:36864
    ds_read_b64_tr_b16 v[42:43], v119 offset:37632
    ds_read_b64_tr_b16 a[100:101], v119 offset:36896
    ds_read_b64_tr_b16 a[102:103], v119 offset:37664
    ds_read_b64_tr_b16 a[180:181], v119 offset:36928
    ds_read_b64_tr_b16 a[182:183], v119 offset:37696
    s_waitcnt lgkmcnt(0)
    s_waitcnt vmcnt(24)
    s_barrier
    s_add_u32 m0, s42, 24576
    s_add_u32 s41, s40, 2359296
    buffer_load_dwordx4 v116, s[16:19], s41 offen lds
    s_add_u32 m0, s42, 25600
    s_add_u32 s41, s40, 2359296
    buffer_load_dwordx4 v117, s[16:19], s41 offen lds
    s_add_u32 m0, s42, 26624
    s_add_u32 s41, s40, 2359296
    buffer_load_dwordx4 v118, s[16:19], s41 offen lds
    s_add_u32 m0, s42, 27648
    s_add_u32 s41, s40, 2457600
    buffer_load_dwordx4 v116, s[16:19], s41 offen lds
    s_add_u32 m0, s42, 28672
    s_add_u32 s41, s40, 2457600
    buffer_load_dwordx4 v117, s[16:19], s41 offen lds
    s_add_u32 m0, s42, 29696
    s_add_u32 s41, s40, 2457600
    buffer_load_dwordx4 v118, s[16:19], s41 offen lds
    ds_read_b64_tr_b16 a[104:105], v119 offset:49152
    ds_read_b64_tr_b16 a[106:107], v119 offset:49920
    ds_read_b64_tr_b16 a[112:113], v119 offset:49184
    ds_read_b64_tr_b16 a[114:115], v119 offset:49952
    ds_read_b64_tr_b16 a[184:185], v119 offset:49216
    ds_read_b64_tr_b16 a[186:187], v119 offset:49984
    ds_read_b64_tr_b16 a[108:109], v119 offset:61440
    ds_read_b64_tr_b16 a[110:111], v119 offset:62208
    ds_read_b64_tr_b16 a[116:117], v119 offset:61472
    ds_read_b64_tr_b16 a[118:119], v119 offset:62240
    ds_read_b64_tr_b16 a[188:189], v119 offset:61504
    ds_read_b64_tr_b16 a[190:191], v119 offset:62272
    s_waitcnt lgkmcnt(0)
    v_mov_b32 v125, 0
    global_load_dword v124, v125, s[98:99] sc1
    s_waitcnt vmcnt(24)
    s_barrier
    s_add_u32 m0, s42, 49152
    s_add_u32 s41, s40, 3145728
    buffer_load_dwordx4 v116, s[16:19], s41 offen lds
    s_add_u32 m0, s42, 50176
    s_add_u32 s41, s40, 3145728
    buffer_load_dwordx4 v117, s[16:19], s41 offen lds
    s_add_u32 m0, s42, 51200
    s_add_u32 s41, s40, 3145728
    buffer_load_dwordx4 v118, s[16:19], s41 offen lds
    s_add_u32 m0, s42, 52224
    s_add_u32 s41, s40, 3244032
    buffer_load_dwordx4 v116, s[16:19], s41 offen lds
    s_add_u32 m0, s42, 53248
    s_add_u32 s41, s40, 3244032
    buffer_load_dwordx4 v117, s[16:19], s41 offen lds
    s_add_u32 m0, s42, 54272
    s_add_u32 s41, s40, 3244032
    buffer_load_dwordx4 v118, s[16:19], s41 offen lds
    ds_read_b64_tr_b16 a[120:121], v120 offset:0
    ds_read_b64_tr_b16 a[122:123], v120 offset:768
    ds_read_b64_tr_b16 v[44:45], v120 offset:32
    ds_read_b64_tr_b16 v[46:47], v120 offset:800
    ds_read_b64_tr_b16 v[60:61], v120 offset:64
    ds_read_b64_tr_b16 v[62:63], v120 offset:832
    ds_read_b64_tr_b16 a[124:125], v120 offset:12288
    ds_read_b64_tr_b16 a[126:127], v120 offset:13056
    ds_read_b64_tr_b16 v[48:49], v120 offset:12320
    ds_read_b64_tr_b16 v[50:51], v120 offset:13088
    ds_read_b64_tr_b16 v[64:65], v120 offset:12352
    ds_read_b64_tr_b16 v[66:67], v120 offset:13120
    s_waitcnt lgkmcnt(0)
    s_waitcnt vmcnt(24)
    s_barrier
    s_add_u32 m0, s42, 73728
    s_add_u32 s41, s40, 3932160
    buffer_load_dwordx4 v116, s[16:19], s41 offen lds
    s_add_u32 m0, s42, 74752
    s_add_u32 s41, s40, 3932160
    buffer_load_dwordx4 v117, s[16:19], s41 offen lds
    s_add_u32 m0, s42, 75776
    s_add_u32 s41, s40, 3932160
    buffer_load_dwordx4 v118, s[16:19], s41 offen lds
    s_add_u32 m0, s42, 76800
    s_add_u32 s41, s40, 4030464
    buffer_load_dwordx4 v116, s[16:19], s41 offen lds
    s_add_u32 m0, s42, 77824
    s_add_u32 s41, s40, 4030464
    buffer_load_dwordx4 v117, s[16:19], s41 offen lds
    s_add_u32 m0, s42, 78848
    s_add_u32 s41, s40, 4030464
    buffer_load_dwordx4 v118, s[16:19], s41 offen lds
    ds_read_b64_tr_b16 a[192:193], v120 offset:24576
    ds_read_b64_tr_b16 a[194:195], v120 offset:25344
    ds_read_b64_tr_b16 v[128:129], v120 offset:24608
    ds_read_b64_tr_b16 v[130:131], v120 offset:25376
    ds_read_b64_tr_b16 v[136:137], v120 offset:24640
    ds_read_b64_tr_b16 v[138:139], v120 offset:25408
    ds_read_b64_tr_b16 a[196:197], v120 offset:36864
    ds_read_b64_tr_b16 a[198:199], v120 offset:37632
    ds_read_b64_tr_b16 v[132:133], v120 offset:36896
    ds_read_b64_tr_b16 v[134:135], v120 offset:37664
    ds_read_b64_tr_b16 v[140:141], v120 offset:36928
    ds_read_b64_tr_b16 v[142:143], v120 offset:37696
    s_waitcnt lgkmcnt(0)
    s_waitcnt vmcnt(24)
    s_barrier
    s_add_u32 m0, s42, 98304
    s_add_u32 s41, s40, 4718592
    buffer_load_dwordx4 v116, s[16:19], s41 offen lds
    s_add_u32 m0, s42, 99328
    s_add_u32 s41, s40, 4718592
    buffer_load_dwordx4 v117, s[16:19], s41 offen lds
    s_add_u32 m0, s42, 100352
    s_add_u32 s41, s40, 4718592
    buffer_load_dwordx4 v118, s[16:19], s41 offen lds
    s_add_u32 m0, s42, 101376
    s_add_u32 s41, s40, 4816896
    buffer_load_dwordx4 v116, s[16:19], s41 offen lds
    s_add_u32 m0, s42, 102400
    s_add_u32 s41, s40, 4816896
    buffer_load_dwordx4 v117, s[16:19], s41 offen lds
    s_add_u32 m0, s42, 103424
    s_add_u32 s41, s40, 4816896
    buffer_load_dwordx4 v118, s[16:19], s41 offen lds
    ds_read_b64_tr_b16 a[200:201], v120 offset:49152
    ds_read_b64_tr_b16 a[202:203], v120 offset:49920
    ds_read_b64_tr_b16 v[144:145], v120 offset:49184
    ds_read_b64_tr_b16 v[146:147], v120 offset:49952
    ds_read_b64_tr_b16 v[152:153], v120 offset:49216
    ds_read_b64_tr_b16 v[154:155], v120 offset:49984
    ds_read_b64_tr_b16 a[204:205], v120 offset:61440
    ds_read_b64_tr_b16 a[206:207], v120 offset:62208
    ds_read_b64_tr_b16 v[148:149], v120 offset:61472
    ds_read_b64_tr_b16 v[150:151], v120 offset:62240
    ds_read_b64_tr_b16 v[156:157], v120 offset:61504
    ds_read_b64_tr_b16 v[158:159], v120 offset:62272
    s_waitcnt lgkmcnt(0)
    s_waitcnt vmcnt(24)
    s_barrier
    s_add_u32 m0, s42, 122880
    s_add_u32 s41, s40, 5505024
    buffer_load_dwordx4 v116, s[16:19], s41 offen lds
    s_add_u32 m0, s42, 123904
    s_add_u32 s41, s40, 5505024
    buffer_load_dwordx4 v117, s[16:19], s41 offen lds
    s_add_u32 m0, s42, 124928
    s_add_u32 s41, s40, 5505024
    buffer_load_dwordx4 v118, s[16:19], s41 offen lds
    s_add_u32 m0, s42, 125952
    s_add_u32 s41, s40, 5603328
    buffer_load_dwordx4 v116, s[16:19], s41 offen lds
    s_add_u32 m0, s42, 126976
    s_add_u32 s41, s40, 5603328
    buffer_load_dwordx4 v117, s[16:19], s41 offen lds
    s_add_u32 m0, s42, 128000
    s_add_u32 s41, s40, 5603328
    buffer_load_dwordx4 v118, s[16:19], s41 offen lds
    ds_read_b64_tr_b16 a[208:209], v119 offset:0
    ds_read_b64_tr_b16 a[210:211], v119 offset:768
    ds_read_b64_tr_b16 v[84:85], v119 offset:32
    ds_read_b64_tr_b16 v[86:87], v119 offset:800
    ds_read_b64_tr_b16 v[160:161], v119 offset:64
    ds_read_b64_tr_b16 v[162:163], v119 offset:832
    ds_read_b64_tr_b16 a[212:213], v119 offset:12288
    ds_read_b64_tr_b16 a[214:215], v119 offset:13056
    ds_read_b64_tr_b16 v[88:89], v119 offset:12320
    ds_read_b64_tr_b16 v[90:91], v119 offset:13088
    ds_read_b64_tr_b16 v[164:165], v119 offset:12352
    ds_read_b64_tr_b16 v[166:167], v119 offset:13120
    s_waitcnt lgkmcnt(0)
    s_waitcnt vmcnt(24)
    s_barrier
    s_add_u32 m0, s42, 0
    s_add_u32 s41, s40, 6291456
    buffer_load_dwordx4 v116, s[16:19], s41 offen lds
    s_add_u32 m0, s42, 1024
    s_add_u32 s41, s40, 6291456
    buffer_load_dwordx4 v117, s[16:19], s41 offen lds
    s_add_u32 m0, s42, 2048
    s_add_u32 s41, s40, 6291456
    buffer_load_dwordx4 v118, s[16:19], s41 offen lds
    s_add_u32 m0, s42, 3072
    s_add_u32 s41, s40, 6389760
    buffer_load_dwordx4 v116, s[16:19], s41 offen lds
    s_add_u32 m0, s42, 4096
    s_add_u32 s41, s40, 6389760
    buffer_load_dwordx4 v117, s[16:19], s41 offen lds
    s_add_u32 m0, s42, 5120
    s_add_u32 s41, s40, 6389760
    buffer_load_dwordx4 v118, s[16:19], s41 offen lds
    ds_read_b64_tr_b16 a[216:217], v119 offset:24576
    ds_read_b64_tr_b16 a[218:219], v119 offset:25344
    ds_read_b64_tr_b16 v[168:169], v119 offset:24608
    ds_read_b64_tr_b16 v[170:171], v119 offset:25376
    ds_read_b64_tr_b16 v[176:177], v119 offset:24640
    ds_read_b64_tr_b16 v[178:179], v119 offset:25408
    ds_read_b64_tr_b16 a[220:221], v119 offset:36864
    ds_read_b64_tr_b16 a[222:223], v119 offset:37632
    ds_read_b64_tr_b16 v[172:173], v119 offset:36896
    ds_read_b64_tr_b16 v[174:175], v119 offset:37664
    ds_read_b64_tr_b16 v[180:181], v119 offset:36928
    ds_read_b64_tr_b16 v[182:183], v119 offset:37696
    s_waitcnt lgkmcnt(0)
    s_waitcnt vmcnt(24)
    s_barrier
    s_add_u32 m0, s42, 24576
    s_add_u32 s41, s40, 7077888
    buffer_load_dwordx4 v116, s[16:19], s41 offen lds
    s_add_u32 m0, s42, 25600
    s_add_u32 s41, s40, 7077888
    buffer_load_dwordx4 v117, s[16:19], s41 offen lds
    s_add_u32 m0, s42, 26624
    s_add_u32 s41, s40, 7077888
    buffer_load_dwordx4 v118, s[16:19], s41 offen lds
    s_add_u32 m0, s42, 27648
    s_add_u32 s41, s40, 7176192
    buffer_load_dwordx4 v116, s[16:19], s41 offen lds
    s_add_u32 m0, s42, 28672
    s_add_u32 s41, s40, 7176192
    buffer_load_dwordx4 v117, s[16:19], s41 offen lds
    s_add_u32 m0, s42, 29696
    s_add_u32 s41, s40, 7176192
    buffer_load_dwordx4 v118, s[16:19], s41 offen lds
    ds_read_b64_tr_b16 v[68:69], v119 offset:49152
    ds_read_b64_tr_b16 v[70:71], v119 offset:49920
    ds_read_b64_tr_b16 v[184:185], v119 offset:49184
    ds_read_b64_tr_b16 v[186:187], v119 offset:49952
    ds_read_b64_tr_b16 v[92:93], v119 offset:49216
    ds_read_b64_tr_b16 v[94:95], v119 offset:49984
    ds_read_b64_tr_b16 v[72:73], v119 offset:61440
    ds_read_b64_tr_b16 v[74:75], v119 offset:62208
    ds_read_b64_tr_b16 v[188:189], v119 offset:61472
    ds_read_b64_tr_b16 v[190:191], v119 offset:62240
    ds_read_b64_tr_b16 v[96:97], v119 offset:61504
    ds_read_b64_tr_b16 v[98:99], v119 offset:62272
    s_waitcnt lgkmcnt(0)
iw_lp_102:
    v_cmp_gt_u32 vcc, 27, v124
    s_cbranch_vccz iw_ok_101
    s_cmp_eq_u32 s100, 0
    s_cbranch_scc1 iw_ok_101
    s_sub_u32 s100, s100, 1
    s_sleep 2
    global_load_dword v124, v125, s[98:99] sc1
    s_waitcnt vmcnt(0)
    s_branch iw_lp_102
iw_ok_101:
    s_cmp_lg_u32 s20, 0
    s_cbranch_scc1 pf_103
    v_mov_b32 v126, s25
    v_mov_b32 v127, 0
    s_mov_b64 exec, 1
    buffer_store_dword v126, v127, s[4:7], s27 offen sc0 sc1
    s_mov_b64 exec, -1
pf_103:
    s_waitcnt vmcnt(24)
    s_barrier
    ds_read_b64_tr_b16 a[224:225], v120 offset:0
    ds_read_b64_tr_b16 a[226:227], v120 offset:768
    ds_read_b64_tr_b16 v[192:193], v120 offset:32
    ds_read_b64_tr_b16 v[194:195], v120 offset:800
    ds_read_b64_tr_b16 v[200:201], v120 offset:64
    ds_read_b64_tr_b16 v[202:203], v120 offset:832
    ds_read_b64_tr_b16 a[228:229], v120 offset:12288
    ds_read_b64_tr_b16 a[230:231], v120 offset:13056
    ds_read_b64_tr_b16 v[196:197], v120 offset:12320
    ds_read_b64_tr_b16 v[198:199], v120 offset:13088
    ds_read_b64_tr_b16 v[204:205], v120 offset:12352
    ds_read_b64_tr_b16 v[206:207], v120 offset:13120
    s_waitcnt lgkmcnt(0)
    s_waitcnt vmcnt(18)
    s_barrier
    ds_read_b64_tr_b16 a[232:233], v120 offset:24576
    ds_read_b64_tr_b16 a[234:235], v120 offset:25344
    ds_read_b64_tr_b16 v[208:209], v120 offset:24608
    ds_read_b64_tr_b16 v[210:211], v120 offset:25376
    ds_read_b64_tr_b16 v[216:217], v120 offset:24640
    ds_read_b64_tr_b16 v[218:219], v120 offset:25408
    ds_read_b64_tr_b16 a[236:237], v120 offset:36864
    ds_read_b64_tr_b16 a[238:239], v120 offset:37632
    ds_read_b64_tr_b16 v[212:213], v120 offset:36896
    ds_read_b64_tr_b16 v[214:215], v120 offset:37664
    ds_read_b64_tr_b16 v[220:221], v120 offset:36928
    ds_read_b64_tr_b16 v[222:223], v120 offset:37696
    s_waitcnt lgkmcnt(0)
    s_waitcnt vmcnt(12)
    s_barrier
    ds_read_b64_tr_b16 a[240:241], v120 offset:49152
    ds_read_b64_tr_b16 a[242:243], v120 offset:49920
    ds_read_b64_tr_b16 v[100:101], v120 offset:49184
    ds_read_b64_tr_b16 v[102:103], v120 offset:49952
    ds_read_b64_tr_b16 v[224:225], v120 offset:49216
    ds_read_b64_tr_b16 v[226:227], v120 offset:49984
    ds_read_b64_tr_b16 a[244:245], v120 offset:61440
    ds_read_b64_tr_b16 a[246:247], v120 offset:62208
    ds_read_b64_tr_b16 v[104:105], v120 offset:61472
    ds_read_b64_tr_b16 v[106:107], v120 offset:62240
    ds_read_b64_tr_b16 v[228:229], v120 offset:61504
    ds_read_b64_tr_b16 v[230:231], v120 offset:62272
    s_waitcnt lgkmcnt(0)
    s_waitcnt vmcnt(6)
    s_barrier
    ds_read_b64_tr_b16 a[248:249], v119 offset:0
    ds_read_b64_tr_b16 a[250:251], v119 offset:768
    ds_read_b64_tr_b16 v[232:233], v119 offset:32
    ds_read_b64_tr_b16 v[234:235], v119 offset:800
    ds_read_b64_tr_b16 v[240:241], v119 offset:64
    ds_read_b64_tr_b16 v[242:243], v119 offset:832
    ds_read_b64_tr_b16 a[252:253], v119 offset:12288
    ds_read_b64_tr_b16 a[254:255], v119 offset:13056
    ds_read_b64_tr_b16 v[236:237], v119 offset:12320
    ds_read_b64_tr_b16 v[238:239], v119 offset:13088
    ds_read_b64_tr_b16 v[244:245], v119 offset:12352
    ds_read_b64_tr_b16 v[246:247], v119 offset:13120
    s_waitcnt lgkmcnt(0)
    s_waitcnt vmcnt(0)
    s_barrier
    ds_read_b64_tr_b16 v[76:77], v119 offset:24576
    ds_read_b64_tr_b16 v[78:79], v119 offset:25344
    ds_read_b64_tr_b16 v[248:249], v119 offset:24608
    ds_read_b64_tr_b16 v[250:251], v119 offset:25376
    ds_read_b64_tr_b16 v[108:109], v119 offset:24640
    ds_read_b64_tr_b16 v[110:111], v119 offset:25408
    ds_read_b64_tr_b16 v[80:81], v119 offset:36864
    ds_read_b64_tr_b16 v[82:83], v119 offset:37632
    ds_read_b64_tr_b16 v[252:253], v119 offset:36896
    ds_read_b64_tr_b16 v[254:255], v119 offset:37664
    ds_read_b64_tr_b16 v[112:113], v119 offset:36928
    ds_read_b64_tr_b16 v[114:115], v119 offset:37696
    s_waitcnt lgkmcnt(0)
    s_barrier
    s_mul_i32 s26, s20, 24576
    v_lshl_add_u32 v5, v1, 4, s26
    ds_write_b128 v5, v[20:23] offset:0
    ds_write_b128 v5, v[24:27] offset:1024
    ds_write_b128 v5, v[28:31] offset:2048
    ds_write_b128 v5, v[32:35] offset:3072
    ds_write_b128 v5, v[36:39] offset:4096
    ds_write_b128 v5, v[40:43] offset:5120
    ds_write_b128 v5, v[44:47] offset:6144
    ds_write_b128 v5, v[48:51] offset:7168
    ds_write_b128 v5, v[52:55] offset:8192
    ds_write_b128 v5, v[56:59] offset:9216
    ds_write_b128 v5, v[60:63] offset:10240
    ds_write_b128 v5, v[64:67] offset:11264
    ds_write_b128 v5, v[68:71] offset:12288
    ds_write_b128 v5, v[72:75] offset:13312
    ds_write_b128 v5, v[76:79] offset:14336
    ds_write_b128 v5, v[80:83] offset:15360
    ds_write_b128 v5, v[84:87] offset:16384
    ds_write_b128 v5, v[88:91] offset:17408
    ds_write_b128 v5, v[92:95] offset:18432
    ds_write_b128 v5, v[96:99] offset:19456
    ds_write_b128 v5, v[100:103] offset:20480
    ds_write_b128 v5, v[104:107] offset:21504
    ds_write_b128 v5, v[108:111] offset:22528
    ds_write_b128 v5, v[112:115] offset:23552
    s_waitcnt lgkmcnt(0)
    v_mov_b32 v118, 0
    global_load_dword v119, v118, s[98:99] offset:4 sc1
    v_mov_b32 v0, 0
    v_and_b32 v112, 15, v1
    v_lshrrev_b32 v113, 4, v1
    v_mov_b32 v2, 0x4444
    v_mov_b32 v114, 0xeeee
    v_and_b32 v3, 1, v1
    v_cmp_eq_u32 vcc, 1, v3
    s_nop 1
    v_cndmask_b32 v2, v2, v114, vcc
    v_lshlrev_b32 v3, 4, v1
    v_add_u32 v4, 98304, v3
    s_mul_i32 s26, s20, 24576
    v_add_u32 v5, s26, v3
    v_lshlrev_b32 v114, 2, v113
    v_lshl_add_u32 v114, v112, 4, v114
    s_mul_i32 s26, s20, 768
    s_add_u32 s26, s26, 108544
    v_add_u32 v6, s26, v114
    v_and_b32 v114, 7, v112
    v_lshl_add_u32 v10, v113, 3, v114
    v_lshlrev_b32 v10, 4, v10
    v_lshl_add_u32 v12, v113, 4, v114
    v_lshlrev_b32 v12, 4, v12
    v_add_u32 v12, 126976, v12
    s_mul_i32 s54, s20, 4096
    s_add_u32 s54, s54, 143360
    v_add_u32 v15, s54, v3
    v_lshrrev_b32 v14, 1, v113
    s_lshl_b32 s26, s24, 1
    v_add_u32 v14, s26, v14
    v_lshlrev_b32 v14, 7, v14
    v_lshl_add_u32 v14, v114, 4, v14
    v_and_b32 v114, 1, v113
    v_lshl_add_u32 v14, v114, 3, v14
    s_mov_b32 s50, 0x00ff00ff
    s_mov_b32 s51, 0x00ff00ff
    s_mov_b32 s52, 0x00ff00ff
    s_mov_b32 s53, 0
    s_lshl_b32 s26, s20, 10
    v_add_u32 v7, s26, v3
    v_add_u32 v126, 98304, v7
    s_lshr_b32 s65, s20, 1
    s_add_u32 s65, s65, 8
    s_sub_u32 s65, s65, s20
    s_lshl_b32 s65, s65, 10
    s_and_b32 s27, s20, 1
    s_sub_u32 s68, s27, 1
    s_sub_u32 s69, 0, s27
    v_and_b32 v19, 7, v1
    v_lshlrev_b32 v19, 5, v19
    v_lshl_add_u32 v19, v113, 8, v19
    v_bfe_u32 v115, v1, 3, 1
    v_lshl_add_u32 v19, v115, 4, v19
    s_add_u32 s26, s26, 98304
    v_add_u32 v19, s26, v19
    v_add_u32 v9, s65, v19
    v_mov_b32 v120, -1
    v_mov_b32 v121, -1
    v_mov_b32 v122, -1
    v_mov_b32 v123, -1
    v_bfe_u32 v115, v1, 2, 2
    v_and_b32 v116, 1, v1
    v_lshlrev_b32 v116, 3, v116
    v_add_u32 v116, 108544, v116
    v_lshl_add_u32 v8, v113, 2, v115
    v_lshl_add_u32 v8, v8, 4, v116
    v_lshrrev_b32 v114, 1, v113
    v_mul_u32_u24 v114, 48, v114
    v_and_b32 v18, 1, v113
    v_lshl_add_u32 v18, v18, 3, v114
    v_add_u32 v18, v18, v115
    v_lshl_add_u32 v18, v18, 4, v116
    v_and_b32 v114, 7, v112
    v_lshl_add_u32 v114, v113, 4, v114
    v_lshlrev_b32 v114, 4, v114
    v_lshrrev_b32 v16, 3, v112
    v_lshl_add_u32 v13, v16, 11, v114
    v_add_u32 v13, 159744, v13
    v_lshl_add_u32 v16, v16, 3, v114
    v_lshlrev_b32 v11, 4, v112
    v_lshl_add_u32 v11, v113, 3, v11
    s_sub_u32 s26, s20, 1
    s_and_b32 s26, s26, 3
    s_lshr_b32 s27, s20, 1
    s_mul_i32 s27, s27, 6144
    s_add_u32 s27, s27, 114688
    v_add_u32 v17, s27, v3
    s_mul_i32 s55, s26, 4096
    s_mul_i32 s44, s21, 12288
    s_add_u32 s44, s44, s55
    s_add_u32 s44, s44, 0
    s_add_u32 s55, s55, 114688
    s_lshr_b32 s59, s21, 1
    s_lshl_b32 s59, s59, 10
    s_and_b32 s60, s21, 1
    s_lshl_b32 s60, s60, 7
    s_add_u32 s59, s59, s60
    s_lshl_b32 s60, s21, 7
    s_add_u32 s60, s60, 16384
    s_mov_b32 s30, 166723584
    s_mov_b32 s31, 167051264
    s_mov_b32 s32, 167706624
    s_mov_b32 s33, 167727104
    s_mov_b32 s46, 167378944
    s_mov_b32 s47, 167747584
    s_mul_i32 s26, s23, 10240
    s_add_u32 s34, s26, 167768064
    s_add_u32 s35, s26, 167788544
    s_lshl_b32 s26, s23, 14
    s_add_u32 s37, s26, 171966464
    s_sub_u32 s36, 171982848, s26
    s_mul_i32 s26, s23, 14336
    s_add_u32 s29, s26, 10240
    s_add_u32 s29, s29, s65
    s_mov_b32 s40, 0x00003f80
    s_mov_b32 s41, 0x3f800000
    s_mov_b32 s66, 0
    s_lshl_b32 s26, s23, 2
    s_add_u32 s26, s26, s20
    s_lshl_b32 s61, s26, 11
    s_lshl_b32 s62, s26, 9
    s_add_u32 s62, s62, 16384
    s_lshl_b32 s63, s26, 10
    s_mul_i32 s38, s26, 163840
    s_add_u32 s38, s38, 50331648
    s_lshl_b32 s58, s24, 13
    s_add_u32 s63, s63, s58
    s_lshl_b32 s58, s24, 10
    s_add_u32 s38, s38, s58
    s_mov_b32 s57, 167849728
    s_lshl_b32 s90, s23, 8
    s_add_u32 s90, s90, 167809280
    s_mul_i32 s27, s23, 16256
    s_sub_u32 s100, 36864, s27
    s_add_u32 s99, s27, 20608
    s_lshl_b32 s56, s21, 7
    s_mov_b32 s49, 0
    s_mov_b32 s42, 1
    v_mov_b32 v127, 0
    v_mov_b32 v124, 0
    s_mov_b32 s48, 1037384597
    s_mov_b32 s22, 0
    s_mov_b32 s28, 61000
    s_mov_b32 s45, 134217728
    s_mul_i32 s67, s21, 3072
    s_add_u32 s67, s67, 160431104
    s_mov_b32 s39, 176160768
    v_and_b32 v20, 31, v1
    v_lshlrev_b32 v20, 2, v20
    s_lshl_b32 s26, s23, 7
    s_add_u32 s26, s26, 167809024
XH_104:
    s_sub_u32 s28, s28, 1
    s_cbranch_scc1 XH_104_dead
    buffer_load_dword v21, v20, s[4:7], s26 offen sc1
    s_waitcnt vmcnt(0)
    v_cmp_eq_u32 vcc, -1, v21
    s_cbranch_vccnz XH_104
XH_104_ok:
    s_branch XJ_105
XH_104_dead:
    s_mov_b32 s28, 0
    s_mov_b64 exec, -1
    s_branch XH_104_ok
XJ_105:
    v_cmp_ne_u32 vcc, s25, v21
    s_cmp_eq_u64 vcc, 0
    s_cselect_b32 s25, 1, 0
    s_mov_b32 s26, 167809024
XN_106:
    s_sub_u32 s28, s28, 1
    s_cbranch_scc1 XN_106_dead
    buffer_load_dword v21, v0, s[4:7], s26 offen sc1
    s_waitcnt vmcnt(0)
    v_cmp_eq_u32 vcc, -1, v21
    s_cbranch_vccnz XN_106
XN_106_ok:
    s_branch XJ_107
XN_106_dead:
    s_mov_b32 s28, 0
    s_mov_b64 exec, -1
    s_branch XN_106_ok
XJ_107:
    v_readfirstlane_b32 s26, v21
    v_readfirstlane_b32 s27, v119
    s_bfe_u32 s26, s26, 0x10002
    s_mul_i32 s26, s26, 3
    s_xor_b32 s27, s27, s26
    s_and_b32 s26, s27, 1
    s_lshl_b32 s26, s26, 13
    s_bfe_u32 s27, s27, 0x10001
    s_lshl_b32 s27, s27, 13
    s_add_u32 s36, s36, s26
    s_add_u32 s37, s37, s26
    s_sub_u32 s27, s27, s26
    s_add_u32 s64, s27, 81920
    v_bfe_u32 v20, v1, 1, 3
    v_mul_u32_u24 v20, 1280, v20
    v_lshrrev_b32 v21, 4, v1
    v_lshl_add_u32 v20, v21, 5, v20
    v_and_b32 v21, 1, v1
    v_lshl_add_u32 v20, v21, 4, v20
    s_lshl_b32 s26, s20, 7
    s_lshl_b32 s27, s20, 10
    s_add_u32 m0, s27, 98304
    s_nop 0
    buffer_load_dwordx4 v20, s[12:15], s26 offen offset:0 lds
    s_add_u32 m0, s27, 101888
    s_nop 0
    buffer_load_dwordx4 v20, s[12:15], s26 offen offset:512 lds
    s_cmp_ge_u32 s20, 2
    s_cbranch_scc1 m0s_110
    s_add_u32 m0, s27, 105472
    s_nop 0
    buffer_load_dwordx4 v20, s[12:15], s26 offen offset:1024 lds
m0s_110:
    s_cmp_eq_u32 s20, 0
    s_cbranch_scc1 k0s_111
kc_lp_114:
    v_cmp_gt_u32 vcc, s42, v124
    s_cbranch_vccnz kc_s_112
kc_ok_113:
    s_mov_b32 m0, s55
    s_nop 0
    buffer_load_dwordx4 v3, s[4:7], s44 offen offset:0 sc1 lds
    buffer_load_dwordx4 v3, s[4:7], s44 offen offset:1024 sc1 lds
    buffer_load_dwordx4 v3, s[4:7], s44 offen offset:2048 sc1 lds
    buffer_load_dwordx4 v3, s[4:7], s44 offen offset:3072 sc1 lds
    s_add_u32 s44, s44, 393216
    s_add_u32 s42, s42, 1
    s_min_u32 s42, s42, 64
k0s_111:
    s_add_u32 s26, s30, s63
    buffer_load_dwordx4 v[24:27], v3, s[4:7], s26 offen sc1
    s_add_u32 s26, s32, s61
    buffer_load_dwordx4 v[24:27], v3, s[4:7], s26 offen sc1
    buffer_load_dwordx4 v[24:27], v3, s[4:7], s26 offen offset:1024 sc1
    s_add_u32 s26, s32, s62
    buffer_load_dwordx4 v[24:27], v10, s[4:7], s26 offen sc1
    s_add_u32 s26, s31, s63
    buffer_load_dwordx4 v[24:27], v3, s[4:7], s26 offen sc1
    s_add_u32 s26, s33, s61
    buffer_load_dwordx4 v[24:27], v3, s[4:7], s26 offen sc1
    buffer_load_dwordx4 v[24:27], v3, s[4:7], s26 offen offset:1024 sc1
    s_add_u32 s26, s33, s62
    buffer_load_dwordx4 v[24:27], v10, s[4:7], s26 offen sc1
    s_add_u32 s26, s46, s63
    buffer_load_dwordx4 v[24:27], v3, s[4:7], s26 offen sc1
    s_add_u32 s26, s47, s61
    buffer_load_dwordx4 v[24:27], v3, s[4:7], s26 offen sc1
    buffer_load_dwordx4 v[24:27], v3, s[4:7], s26 offen offset:1024 sc1
    s_add_u32 s26, s47, s62
    buffer_load_dwordx4 v[24:27], v10, s[4:7], s26 offen sc1
    s_add_u32 s26, s34, 0
    buffer_load_dwordx4 v[24:27], v7, s[4:7], s26 offen sc1
    s_add_u32 s26, s34, 4096
    buffer_load_dwordx4 v[24:27], v7, s[4:7], s26 offen sc1
    s_add_u32 s26, s34, 6144
    buffer_load_dwordx4 v[24:27], v7, s[4:7], s26 offen sc1
    s_add_u32 s26, s35, 0
    buffer_load_dwordx4 v[24:27], v7, s[4:7], s26 offen sc1
    s_add_u32 s26, s35, 4096
    buffer_load_dwordx4 v[24:27], v7, s[4:7], s26 offen sc1
    s_add_u32 s26, s35, 6144
    buffer_load_dwordx4 v[24:27], v7, s[4:7], s26 offen sc1
    s_add_u32 s58, s22, 0
    s_cmp_ge_u32 s58, s49
    s_cbranch_scc1 uc_s_115
uc_ok_116:
    s_mov_b32 s66, 1
    s_mov_b32 s26, 167841920
    buffer_load_dword v127, v0, s[4:7], s26 offen sc1
    s_waitcnt vmcnt(0)
    s_branch XJ_119
kc_s_112:
    s_sub_u32 s28, s28, 1
    s_cbranch_scc1 kc_s_112_d
    s_add_u32 s58, s56, 167829504
    buffer_load_dword v124, v0, s[4:7], s58 offen sc1
    s_waitcnt vmcnt(0)
    s_branch kc_lp_114
kc_s_112_d:
    s_mov_b32 s28, 0
    s_branch kc_ok_113
uc_s_115:
    s_add_u32 s49, s58, 0
    s_min_u32 s49, s49, 63
    s_lshl_b32 s43, s49, 7
    s_add_u32 s43, s43, 167841792
    s_add_u32 s49, s49, 1
    buffer_load_dword v127, v0, s[4:7], s43 offen sc1
    s_waitcnt vmcnt(0)
    v_cmp_gt_u32 vcc, 32, v127
    s_cbranch_vccz uc_ok_116
    s_add_u32 s49, s58, 1
    s_min_u32 s58, s58, 63
    s_lshl_b32 s43, s58, 7
    s_add_u32 s43, s43, 167841792
uc_lp_117:
    buffer_load_dword v127, v0, s[4:7], s43 offen sc1
    s_waitcnt vmcnt(0)
    v_cmp_gt_u32 vcc, 32, v127
    s_cbranch_vccz uc_ok_116
    s_sub_u32 s28, s28, 1
    s_cbranch_scc0 uc_lp_117
    s_mov_b32 s28, 0
    s_branch uc_ok_116
XJ_119:
    s_barrier
    s_cmp_eq_u32 s20, 0
    s_cbranch_scc1 CLS_120
    s_cmp_eq_u32 s20, 3
    s_cbranch_scc1 CLS_122
CLS_121:
    ds_read_b128 v[76:79], v5 offset:0
    ds_read_b128 v[80:83], v5 offset:1024
    ds_read_b128 v[84:87], v5 offset:2048
    ds_read_b128 v[88:91], v5 offset:3072
    ds_read_b128 v[92:95], v5 offset:4096
    ds_read_b128 v[96:99], v5 offset:5120
    v_mov_b64 v[60:61], 0
    v_mov_b64 v[62:63], 0
    v_mov_b64 v[64:65], 0
    v_mov_b64 v[66:67], 0
    v_mov_b64 v[68:69], 0
    v_mov_b64 v[70:71], 0
    s_waitcnt lgkmcnt(0)
    s_branch CH_ent_125
CH_top_123:
GA_127:
    s_sub_u32 s28, s28, 1
    s_cbranch_scc1 GA_127_dead
    s_mov_b64 exec, s[12:13]
    buffer_load_dwordx4 v[20:23], v7, s[4:7], s34 offen sc1
    s_mov_b64 exec, s[14:15]
    buffer_load_dwordx4 v[24:27], v7, s[4:7], s10 offen sc1
    s_mov_b64 exec, s[16:17]
    buffer_load_dwordx4 v[28:31], v7, s[4:7], s11 offen sc1
    s_mov_b64 exec, s[18:19]
    buffer_load_dwordx4 v[32:35], v7, s[4:7], s36 offen sc1
    s_mov_b64 exec, s[8:9]
    buffer_load_dwordx4 v[36:39], v7, s[4:7], s3 offen sc1
    s_mov_b64 exec, s[96:97]
    buffer_load_dwordx4 v[40:43], v7, s[4:7], s101 offen sc1
    s_mov_b64 exec, -1
    s_add_u32 s26, s45, s63
    buffer_store_dwordx4 v[48:51], v3, s[4:7], s26 offen sc0 sc1
    s_waitcnt vmcnt(4)
    v_max_u32 v72, v20, v22
    v_max_u32 v73, v24, v26
    v_max_u32 v74, v28, v30
    v_cmp_eq_u32 s[12:13], -1, v72
    v_cmp_eq_u32 s[14:15], -1, v73
    v_cmp_eq_u32 s[16:17], -1, v74
    v_lshlrev_b32 v100, 16, v20
    v_and_b32 v101, 0xffff0000, v20
    v_lshlrev_b32 v102, 16, v21
    v_and_b32 v103, 0xffff0000, v21
    v_lshlrev_b32 v104, 16, v22
    v_and_b32 v105, 0xffff0000, v22
    v_lshlrev_b32 v106, 16, v23
    v_and_b32 v107, 0xffff0000, v23
    v_lshlrev_b32 v108, 16, v24
    v_and_b32 v109, 0xffff0000, v24
    v_lshlrev_b32 v112, 16, v25
    v_and_b32 v113, 0xffff0000, v25
    v_lshlrev_b32 v114, 16, v26
    v_and_b32 v115, 0xffff0000, v26
    v_lshlrev_b32 v116, 16, v27
    v_and_b32 v117, 0xffff0000, v27
    v_lshlrev_b32 v118, 16, v28
    v_and_b32 v119, 0xffff0000, v28
    v_lshlrev_b32 v56, 16, v29
    v_and_b32 v57, 0xffff0000, v29
    v_lshlrev_b32 v58, 16, v30
    v_and_b32 v59, 0xffff0000, v30
    v_lshlrev_b32 v73, 16, v31
    v_and_b32 v74, 0xffff0000, v31
    s_waitcnt vmcnt(3)
    v_max_u32 v72, v32, v34
    v_dot2_f32_bf16 v60, v32, s40, v100
    v_dot2_f32_bf16 v61, v32, s41, v101
    v_dot2_f32_bf16 v62, v33, s40, v102
    v_dot2_f32_bf16 v63, v33, s41, v103
    v_dot2_f32_bf16 v64, v34, s40, v104
    v_dot2_f32_bf16 v65, v34, s41, v105
    v_dot2_f32_bf16 v66, v35, s40, v106
    v_dot2_f32_bf16 v67, v35, s41, v107
    v_cmp_eq_u32 s[18:19], -1, v72
    v_cvt_pk_bf16_f32 v68, v60, v61
    v_cvt_pk_bf16_f32 v69, v62, v63
    v_cvt_pk_bf16_f32 v70, v64, v65
    v_cvt_pk_bf16_f32 v71, v66, v67
    ds_write_b128 v19, v[68:71] offset:0
    s_waitcnt vmcnt(2)
    v_max_u32 v72, v36, v38
    v_dot2_f32_bf16 v60, v36, s40, v108
    v_dot2_f32_bf16 v61, v36, s41, v109
    v_dot2_f32_bf16 v62, v37, s40, v112
    v_dot2_f32_bf16 v63, v37, s41, v113
    v_dot2_f32_bf16 v64, v38, s40, v114
    v_dot2_f32_bf16 v65, v38, s41, v115
    v_dot2_f32_bf16 v66, v39, s40, v116
    v_dot2_f32_bf16 v67, v39, s41, v117
    v_cmp_eq_u32 s[8:9], -1, v72
    v_cvt_pk_bf16_f32 v44, v60, v61
    v_cvt_pk_bf16_f32 v45, v62, v63
    v_cvt_pk_bf16_f32 v46, v64, v65
    v_cvt_pk_bf16_f32 v47, v66, v67
    ds_write_b128 v19, v[44:47] offset:4096
    s_waitcnt vmcnt(1)
    v_max_u32 v72, v40, v42
    v_dot2_f32_bf16 v60, v40, s40, v118
    v_dot2_f32_bf16 v61, v40, s41, v119
    v_dot2_f32_bf16 v62, v41, s40, v56
    v_dot2_f32_bf16 v63, v41, s41, v57
    v_dot2_f32_bf16 v64, v42, s40, v58
    v_dot2_f32_bf16 v65, v42, s41, v59
    v_dot2_f32_bf16 v66, v43, s40, v73
    v_dot2_f32_bf16 v67, v43, s41, v74
    v_cmp_eq_u32 s[96:97], -1, v72
    v_cvt_pk_bf16_f32 v68, v60, v61
    v_cvt_pk_bf16_f32 v69, v62, v63
    v_cvt_pk_bf16_f32 v70, v64, v65
    v_cvt_pk_bf16_f32 v71, v66, v67
    s_mov_b64 exec, s[68:69]
    ds_write_b128 v9, v[68:71] offset:0
    s_mov_b64 exec, -1
    s_or_b64 vcc, s[12:13], s[14:15]
    s_or_b64 vcc, vcc, s[16:17]
    s_or_b64 vcc, vcc, s[18:19]
    s_or_b64 vcc, vcc, s[8:9]
    s_or_b64 vcc, vcc, s[96:97]
    s_cbranch_scc1 GA_127
GA_127_ok:
    v_mov_b64 v[60:61], 0
    v_mov_b64 v[62:63], 0
    v_mov_b64 v[64:65], 0
    v_mov_b64 v[66:67], 0
    v_mov_b64 v[68:69], 0
    v_mov_b64 v[70:71], 0
    s_add_u32 s45, s45, 327680
    s_cmp_eq_u32 s22, 42
    s_cselect_b32 s26, s64, 49152
    s_add_u32 s36, s36, s26
    s_add_u32 s37, s37, s26
    s_waitcnt lgkmcnt(0)
CH_ent_125:
    s_barrier
    ds_read_b128 v[20:23], v4 offset:0
    ds_read_b128 v[24:27], v4 offset:1024
    ds_read_b128 v[28:31], v4 offset:2048
    s_waitcnt lgkmcnt(2)
    v_smfmac_f32_16x16x64_bf16 v[60:63], v[20:23], a[0:7], v2
    ds_read_b128 v[32:35], v4 offset:3072
    v_mov_b64 v[72:73], 0
    v_smfmac_f32_16x16x64_bf16 v[64:67], v[20:23], a[8:15], v2
    s_waitcnt lgkmcnt(2)
    ds_read_b128 v[36:39], v4 offset:4096
    v_mov_b64 v[74:75], 0
    v_smfmac_f32_16x16x64_bf16 v[60:63], v[24:27], a[16:23], v2
    ds_read_b128 v[40:43], v4 offset:5120
    v_smfmac_f32_16x16x64_bf16 v[64:67], v[24:27], a[24:31], v2
    s_waitcnt lgkmcnt(3)
    ds_read_b128 v[44:47], v4 offset:6144
    s_mov_b32 m0, s54
    v_smfmac_f32_16x16x64_bf16 v[60:63], v[28:31], v[76:83], v2
    ds_read_b128 v[48:51], v4 offset:7168
    s_add_u32 s43, s38, 0
    v_smfmac_f32_16x16x64_bf16 v[64:67], v[28:31], a[32:39], v2
    s_waitcnt lgkmcnt(4)
    buffer_load_dwordx4 v3, s[4:7], s43 offen offset:0 sc1 lds
    v_smfmac_f32_16x16x64_bf16 v[60:63], v[32:35], a[40:47], v2
    ds_read_b128 v[52:55], v4 offset:8192
    v_smfmac_f32_16x16x64_bf16 v[64:67], v[32:35], a[48:55], v2
    s_waitcnt lgkmcnt(4)
    ds_read_b128 v[56:59], v4 offset:9216
    s_add_u32 s43, s38, 39936
    v_smfmac_f32_16x16x64_bf16 v[60:63], v[36:39], a[56:63], v2
    buffer_load_dwordx4 v3, s[4:7], s43 offen offset:1024 sc1 lds
    v_smfmac_f32_16x16x64_bf16 v[64:67], v[36:39], v[84:91], v2
    s_waitcnt lgkmcnt(4)
    ds_read_b128 v[76:79], v5 offset:6144
    v_smfmac_f32_16x16x64_bf16 v[60:63], v[40:43], a[64:71], v2
    ds_read_b128 v[80:83], v5 offset:7168
    v_smfmac_f32_16x16x64_bf16 v[64:67], v[40:43], a[72:79], v2
    s_waitcnt lgkmcnt(5)
    ds_read_b128 v[84:87], v5 offset:8192
    s_add_u32 s43, s38, 79872
    v_smfmac_f32_16x16x64_bf16 v[60:63], v[44:47], a[80:87], v2
    buffer_load_dwordx4 v3, s[4:7], s43 offen offset:2048 sc1 lds
    v_smfmac_f32_16x16x64_bf16 v[64:67], v[44:47], a[88:95], v2
    s_waitcnt lgkmcnt(5)
    ds_read_b128 v[88:91], v5 offset:9216
    v_smfmac_f32_16x16x64_bf16 v[60:63], v[48:51], v[92:99], v2
    ds_read_b128 v[92:95], v5 offset:10240
    v_smfmac_f32_16x16x64_bf16 v[64:67], v[48:51], a[96:103], v2
    s_waitcnt lgkmcnt(6)
    ds_read_b128 v[96:99], v5 offset:11264
    s_add_u32 s43, s38, 119808
    v_smfmac_f32_16x16x64_bf16 v[60:63], v[52:55], a[104:111], v2
    buffer_load_dwordx4 v3, s[4:7], s43 offen offset:3072 sc1 lds
    v_smfmac_f32_16x16x64_bf16 v[64:67], v[52:55], a[112:119], v2
    s_waitcnt lgkmcnt(6)
    v_smfmac_f32_16x16x64_bf16 v[60:63], v[56:59], a[120:127], v2
    s_waitcnt lgkmcnt(4)
    v_smfmac_f32_16x16x64_bf16 v[64:67], v[56:59], v[76:83], v2
    ds_read_b128 v[76:79], v5 offset:12288
    v_smfmac_f32_16x16x64_bf16 v[68:71], v[20:23], a[128:135], v2
    ds_read_b128 v[80:83], v5 offset:13312
    v_smfmac_f32_16x16x64_bf16 v[68:71], v[24:27], a[136:143], v2
    v_add_f32 v60, v60, v61
    v_smfmac_f32_16x16x64_bf16 v[68:71], v[28:31], a[144:151], v2
    v_add_f32 v62, v62, v63
    v_smfmac_f32_16x16x64_bf16 v[68:71], v[32:35], a[152:159], v2
    s_waitcnt lgkmcnt(4)
    v_cvt_pk_bf16_f32 v60, v60, v62
    v_smfmac_f32_16x16x64_bf16 v[68:71], v[36:39], v[84:91], v2
    ds_write_b32 v6, v60 offset:0
    v_add_f32 v64, v64, v65
    v_smfmac_f32_16x16x64_bf16 v[68:71], v[40:43], a[160:167], v2
    ds_read_b128 v[84:87], v5 offset:14336
    v_add_f32 v66, v66, v67
    v_smfmac_f32_16x16x64_bf16 v[68:71], v[44:47], a[168:175], v2
    ds_read_b128 v[88:91], v5 offset:15360
    v_cvt_pk_bf16_f32 v64, v64, v66
    v_smfmac_f32_16x16x64_bf16 v[68:71], v[48:51], a[176:183], v2
    ds_write_b32 v6, v64 offset:256
    v_mov_b64 v[60:61], 0
    v_smfmac_f32_16x16x64_bf16 v[68:71], v[52:55], a[184:191], v2
    s_waitcnt lgkmcnt(6)
    v_mov_b64 v[62:63], 0
    v_smfmac_f32_16x16x64_bf16 v[68:71], v[56:59], v[92:99], v2
    ds_read_b128 v[92:95], v5 offset:16384
    v_mov_b64 v[64:65], 0
    v_smfmac_f32_16x16x64_bf16 v[72:75], v[20:23], a[192:199], v2
    ds_read_b128 v[96:99], v5 offset:17408
    v_mov_b64 v[66:67], 0
    v_smfmac_f32_16x16x64_bf16 v[72:75], v[24:27], a[200:207], v2
    v_smfmac_f32_16x16x64_bf16 v[72:75], v[28:31], a[208:215], v2
    v_add_f32 v68, v68, v69
    v_smfmac_f32_16x16x64_bf16 v[72:75], v[32:35], a[216:223], v2
    s_waitcnt lgkmcnt(6)
    v_add_f32 v70, v70, v71
    v_smfmac_f32_16x16x64_bf16 v[72:75], v[36:39], v[76:83], v2
    ds_read_b128 v[76:79], v5 offset:18432
    v_cvt_pk_bf16_f32 v68, v68, v70
    v_smfmac_f32_16x16x64_bf16 v[72:75], v[40:43], a[224:231], v2
    ds_write_b32 v6, v68 offset:512
    v_smfmac_f32_16x16x64_bf16 v[72:75], v[44:47], a[232:239], v2
    ds_read_b128 v[80:83], v5 offset:19456
    v_smfmac_f32_16x16x64_bf16 v[72:75], v[48:51], a[240:247], v2
    s_waitcnt lgkmcnt(1)
    s_barrier
    v_smfmac_f32_16x16x64_bf16 v[72:75], v[52:55], a[248:255], v2
    ds_read_b64_tr_b16 v[100:101], v8 offset:2304
    v_smfmac_f32_16x16x64_bf16 v[72:75], v[56:59], v[84:91], v2
    ds_read_b64_tr_b16 v[102:103], v8 offset:2560
    v_smfmac_f32_16x16x64_bf16 v[60:63], v[20:23], v[128:135], v2
    ds_read_b128 v[104:107], v17 offset:3072
    v_smfmac_f32_16x16x64_bf16 v[64:67], v[20:23], v[136:143], v2
    ds_read_b64_tr_b16 v[108:109], v18 offset:512
    v_smfmac_f32_16x16x64_bf16 v[60:63], v[24:27], v[144:151], v2
    ds_read_b64_tr_b16 v[110:111], v18 offset:576
    v_add_f32 v72, v72, v73
    v_smfmac_f32_16x16x64_bf16 v[64:67], v[24:27], v[152:159], v2
    ds_read_b128 v[112:115], v17 offset:4096
    v_add_f32 v74, v74, v75
    v_smfmac_f32_16x16x64_bf16 v[60:63], v[28:31], v[92:99], v2
    ds_read_b64_tr_b16 v[116:117], v18 offset:2048
    v_cvt_pk_bf16_f32 v72, v72, v74
    v_smfmac_f32_16x16x64_bf16 v[64:67], v[28:31], v[160:167], v2
    ds_read_b64_tr_b16 v[118:119], v18 offset:2112
    v_smfmac_f32_16x16x64_bf16 v[60:63], v[32:35], v[168:175], v2
    ds_read_b128 v[20:23], v17 offset:5120
    v_smfmac_f32_16x16x64_bf16 v[64:67], v[32:35], v[176:183], v2
    ds_read_b128 v[84:87], v5 offset:20480
    v_smfmac_f32_16x16x64_bf16 v[60:63], v[36:39], v[184:191], v2
    s_waitcnt lgkmcnt(10)
    s_waitcnt lgkmcnt(7)
    v_mfma_f32_16x16x32_bf16 v[68:71], v[104:107], v[100:103], 0
    ds_read_b128 v[88:91], v5 offset:21504
    v_smfmac_f32_16x16x64_bf16 v[64:67], v[36:39], v[76:83], v2
    ds_read_b128 v[92:95], v5 offset:22528
    v_smfmac_f32_16x16x64_bf16 v[60:63], v[40:43], v[192:199], v2
    ds_read_b128 v[96:99], v5 offset:23552
    v_smfmac_f32_16x16x64_bf16 v[64:67], v[40:43], v[200:207], v2
    s_waitcnt lgkmcnt(7)
    v_mfma_f32_16x16x32_bf16 v[68:71], v[112:115], v[108:111], v[68:71]
    ds_write_b32 v6, v72 offset:3072
    v_smfmac_f32_16x16x64_bf16 v[60:63], v[44:47], v[208:215], v2
    v_smfmac_f32_16x16x64_bf16 v[64:67], v[44:47], v[216:223], v2
    s_waitcnt lgkmcnt(3)
    v_smfmac_f32_16x16x64_bf16 v[60:63], v[48:51], v[84:91], v2
    v_mfma_f32_16x16x32_bf16 v[68:71], v[20:23], v[116:119], v[68:71]
    v_smfmac_f32_16x16x64_bf16 v[64:67], v[48:51], v[224:231], v2
    v_smfmac_f32_16x16x64_bf16 v[60:63], v[52:55], v[232:239], v2
    v_smfmac_f32_16x16x64_bf16 v[64:67], v[52:55], v[240:247], v2
    v_smfmac_f32_16x16x64_bf16 v[60:63], v[56:59], v[248:255], v2
    s_waitcnt lgkmcnt(1)
    v_smfmac_f32_16x16x64_bf16 v[64:67], v[56:59], v[92:99], v2
    ds_write_b128 v126, v[68:71] offset:61440
    v_xor_b32 v17, 245760, v17
    s_nop 2
    v_add_f32 v60, v60, v61
    v_add_f32 v62, v62, v63
    v_cvt_pk_bf16_f32 v60, v60, v62
    ds_write_b32 v6, v60 offset:3328
    v_add_f32 v64, v64, v65
    v_add_f32 v66, v66, v67
    v_cvt_pk_bf16_f32 v64, v64, v66
    ds_write_b32 v6, v64 offset:3584
    s_waitcnt lgkmcnt(0)
    s_barrier
    s_cmp_eq_u32 s22, 63
    s_cbranch_scc1 CH_fin_124
    s_add_u32 s26, s32, s61
    s_add_u32 s27, s32, s62
    s_add_u32 s58, s30, s63
    v_mov_b64 v[28:29], 0
    v_mov_b64 v[30:31], 0
    s_xor_b32 s55, s55, 245760
    s_mov_b64 s[12:13], -1
    s_mov_b64 s[14:15], -1
    s_mov_b64 s[16:17], s[50:51]
    s_mov_b64 s[18:19], -1
    s_barrier
GB_128:
    s_sub_u32 s28, s28, 1
    s_cbranch_scc1 GB_128_dead
    s_mov_b64 exec, s[12:13]
    buffer_load_dwordx4 v[20:23], v3, s[4:7], s26 offen offset:0 sc1
    s_mov_b64 exec, s[14:15]
    buffer_load_dwordx4 v[24:27], v3, s[4:7], s26 offen offset:1024 sc1
    s_mov_b64 exec, s[16:17]
    buffer_load_dwordx4 v[28:31], v10, s[4:7], s27 offen sc1
    s_mov_b64 exec, s[18:19]
    buffer_load_dwordx4 v[48:51], v3, s[4:7], s58 offen sc1
    s_mov_b64 exec, -1
    s_waitcnt vmcnt(4)
    ds_read_b128 v[100:103], v15 offset:0
    ds_read_b128 v[104:107], v15 offset:1024
    ds_read_b128 v[108:111], v15 offset:2048
    ds_read_b128 v[112:115], v15 offset:3072
    s_mov_b32 m0, s55
    s_nop 0
    buffer_load_dwordx4 v3, s[4:7], s44 offen offset:0 sc1 lds
    buffer_load_dwordx4 v3, s[4:7], s44 offen offset:1024 sc1 lds
    buffer_load_dwordx4 v3, s[4:7], s44 offen offset:2048 sc1 lds
    buffer_load_dwordx4 v3, s[4:7], s44 offen offset:3072 sc1 lds
    s_waitcnt vmcnt(6) lgkmcnt(0)
    v_mfma_f32_16x16x32_bf16 v[40:43], v[104:107], v[20:23], 0
    v_max_u32 v32, v20, v22
    v_mfma_f32_16x16x32_bf16 v[68:71], v[100:103], v[20:23], 0
    v_max_u32 v33, v24, v26
    v_mfma_f32_16x16x32_bf16 v[40:43], v[112:115], v[24:27], v[40:43]
    v_cmp_eq_u32 s[12:13], -1, v32
    v_mfma_f32_16x16x32_bf16 v[68:71], v[108:111], v[24:27], v[68:71]
    v_cmp_eq_u32 s[14:15], -1, v33
    s_waitcnt vmcnt(4)
    v_mfma_f32_16x16x32_bf16 v[68:71], v[48:51], v[28:31], v[68:71]
    v_max_u32 v34, v28, v30
    v_max_u32 v35, v48, v50
    v_cmp_eq_u32 s[16:17], -1, v34
    v_cmp_eq_u32 s[18:19], -1, v35
    s_or_b64 vcc, s[12:13], s[14:15]
    s_or_b64 vcc, vcc, s[16:17]
    s_or_b64 vcc, vcc, s[18:19]
    s_cbranch_scc1 GB_128
GB_128_ok:
    s_add_u32 s44, s44, 393216
    s_add_u32 s42, s42, 1
    s_min_u32 s42, s42, 64
    s_nop 0
    v_add_f32_dpp v68, v40, v68 row_ror:8 row_mask:0xf bank_mask:0xf
    v_add_f32_dpp v69, v41, v69 row_ror:8 row_mask:0xf bank_mask:0xf
    v_add_f32_dpp v70, v42, v70 row_ror:8 row_mask:0xf bank_mask:0xf
    v_add_f32_dpp v71, v43, v71 row_ror:8 row_mask:0xf bank_mask:0xf
    ds_write_b128 v126, v[68:71] offset:28672
    s_waitcnt lgkmcnt(0)
    s_barrier
    s_sleep 4
    ds_read_b128 v[44:47], v126 offset:12288
    s_waitcnt lgkmcnt(0)
    buffer_store_dwordx4 v[44:47], v7, s[4:7], s67 offen sc0 sc1
    s_add_u32 s67, s67, 98304
    s_add_u32 s22, s22, 1
    s_mov_b32 s26, s30
    s_mov_b32 s30, s31
    s_mov_b32 s31, s46
    s_mov_b32 s46, s26
    s_mov_b32 s26, s32
    s_mov_b32 s32, s33
    s_mov_b32 s33, s47
    s_mov_b32 s47, s26
    s_mov_b32 s26, s34
    s_mov_b32 s34, s35
    s_mov_b32 s35, s26
    s_add_u32 s38, s38, 1310720
    s_add_u32 s57, s57, 128
    ds_read_b128 v[76:79], v5 offset:0
    ds_read_b128 v[80:83], v5 offset:1024
    ds_read_b128 v[84:87], v5 offset:2048
    ds_read_b128 v[88:91], v5 offset:3072
    ds_read_b128 v[92:95], v5 offset:4096
    ds_read_b128 v[96:99], v5 offset:5120
    v_mov_b64 v[28:29], 0
    v_mov_b64 v[30:31], 0
    v_mov_b64 v[40:41], 0
    v_mov_b64 v[42:43], 0
    s_add_u32 s10, s34, 4096
    s_add_u32 s11, s34, s65
    s_mov_b64 s[12:13], -1
    s_mov_b64 s[14:15], -1
    s_mov_b64 s[16:17], s[68:69]
    s_mov_b64 s[18:19], -1
    s_mov_b64 s[8:9], -1
    s_mov_b64 s[96:97], s[68:69]
    s_add_u32 s3, s36, 4096
    s_add_u32 s101, s36, s29
    s_barrier
    s_branch CH_top_123
GA_127_dead:
    s_mov_b32 s28, 0
    s_branch GA_127_ok
GB_128_dead:
    s_mov_b32 s28, 0
    s_branch GB_128_ok
CH_fin_124:
    ds_read_b128 v[100:103], v126 offset:12288
    s_waitcnt lgkmcnt(0)
    buffer_store_dwordx4 v[100:103], v7, s[4:7], s67 offen sc0 sc1
    s_waitcnt vmcnt(0)
    s_barrier
    s_branch L_end
CLS_122:
    ds_read_b128 v[76:79], v5 offset:0
    ds_read_b128 v[80:83], v5 offset:1024
    ds_read_b128 v[84:87], v5 offset:2048
    ds_read_b128 v[88:91], v5 offset:3072
    ds_read_b128 v[92:95], v5 offset:4096
    ds_read_b128 v[96:99], v5 offset:5120
    v_mov_b64 v[60:61], 0
    v_mov_b64 v[62:63], 0
    v_mov_b64 v[64:65], 0
    v_mov_b64 v[66:67], 0
    v_mov_b64 v[68:69], 0
    v_mov_b64 v[70:71], 0
    s_waitcnt lgkmcnt(0)
    s_branch CH_ent_131
CH_top_129:
GA_133:
    s_sub_u32 s28, s28, 1
    s_cbranch_scc1 GA_133_dead
    s_mov_b64 exec, s[12:13]
    buffer_load_dwordx4 v[20:23], v7, s[4:7], s34 offen sc1
    s_mov_b64 exec, s[14:15]
    buffer_load_dwordx4 v[24:27], v7, s[4:7], s10 offen sc1
    s_mov_b64 exec, s[16:17]
    buffer_load_dwordx4 v[28:31], v7, s[4:7], s11 offen sc1
    s_mov_b64 exec, s[18:19]
    buffer_load_dwordx4 v[32:35], v7, s[4:7], s36 offen sc1
    s_mov_b64 exec, s[8:9]
    buffer_load_dwordx4 v[36:39], v7, s[4:7], s3 offen sc1
    s_mov_b64 exec, s[96:97]
    buffer_load_dwordx4 v[40:43], v7, s[4:7], s101 offen sc1
    s_mov_b64 exec, -1
    s_add_u32 s26, s45, s63
    buffer_store_dwordx4 v[48:51], v3, s[4:7], s26 offen sc0 sc1
    s_waitcnt vmcnt(4)
    v_max_u32 v72, v20, v22
    v_max_u32 v73, v24, v26
    v_max_u32 v74, v28, v30
    v_cmp_eq_u32 s[12:13], -1, v72
    v_cmp_eq_u32 s[14:15], -1, v73
    v_cmp_eq_u32 s[16:17], -1, v74
    v_lshlrev_b32 v100, 16, v20
    v_and_b32 v101, 0xffff0000, v20
    v_lshlrev_b32 v102, 16, v21
    v_and_b32 v103, 0xffff0000, v21
    v_lshlrev_b32 v104, 16, v22
    v_and_b32 v105, 0xffff0000, v22
    v_lshlrev_b32 v106, 16, v23
    v_and_b32 v107, 0xffff0000, v23
    v_lshlrev_b32 v108, 16, v24
    v_and_b32 v109, 0xffff0000, v24
    v_lshlrev_b32 v112, 16, v25
    v_and_b32 v113, 0xffff0000, v25
    v_lshlrev_b32 v114, 16, v26
    v_and_b32 v115, 0xffff0000, v26
    v_lshlrev_b32 v116, 16, v27
    v_and_b32 v117, 0xffff0000, v27
    v_lshlrev_b32 v118, 16, v28
    v_and_b32 v119, 0xffff0000, v28
    v_lshlrev_b32 v56, 16, v29
    v_and_b32 v57, 0xffff0000, v29
    v_lshlrev_b32 v58, 16, v30
    v_and_b32 v59, 0xffff0000, v30
    v_lshlrev_b32 v73, 16, v31
    v_and_b32 v74, 0xffff0000, v31
    s_waitcnt vmcnt(3)
    v_max_u32 v72, v32, v34
    v_dot2_f32_bf16 v60, v32, s40, v100
    v_dot2_f32_bf16 v61, v32, s41, v101
    v_dot2_f32_bf16 v62, v33, s40, v102
    v_dot2_f32_bf16 v63, v33, s41, v103
    v_dot2_f32_bf16 v64, v34, s40, v104
    v_dot2_f32_bf16 v65, v34, s41, v105
    v_dot2_f32_bf16 v66, v35, s40, v106
    v_dot2_f32_bf16 v67, v35, s41, v107
    v_cmp_eq_u32 s[18:19], -1, v72
    v_cvt_pk_bf16_f32 v68, v60, v61
    v_cvt_pk_bf16_f32 v69, v62, v63
    v_cvt_pk_bf16_f32 v70, v64, v65
    v_cvt_pk_bf16_f32 v71, v66, v67
    ds_write_b128 v19, v[68:71] offset:0
    s_waitcnt vmcnt(2)
    v_max_u32 v72, v36, v38
    v_dot2_f32_bf16 v60, v36, s40, v108
    v_dot2_f32_bf16 v61, v36, s41, v109
    v_dot2_f32_bf16 v62, v37, s40, v112
    v_dot2_f32_bf16 v63, v37, s41, v113
    v_dot2_f32_bf16 v64, v38, s40, v114
    v_dot2_f32_bf16 v65, v38, s41, v115
    v_dot2_f32_bf16 v66, v39, s40, v116
    v_dot2_f32_bf16 v67, v39, s41, v117
    v_cmp_eq_u32 s[8:9], -1, v72
    v_cvt_pk_bf16_f32 v44, v60, v61
    v_cvt_pk_bf16_f32 v45, v62, v63
    v_cvt_pk_bf16_f32 v46, v64, v65
    v_cvt_pk_bf16_f32 v47, v66, v67
    ds_write_b128 v19, v[44:47] offset:4096
    s_waitcnt vmcnt(1)
    v_max_u32 v72, v40, v42
    v_dot2_f32_bf16 v60, v40, s40, v118
    v_dot2_f32_bf16 v61, v40, s41, v119
    v_dot2_f32_bf16 v62, v41, s40, v56
    v_dot2_f32_bf16 v63, v41, s41, v57
    v_dot2_f32_bf16 v64, v42, s40, v58
    v_dot2_f32_bf16 v65, v42, s41, v59
    v_dot2_f32_bf16 v66, v43, s40, v73
    v_dot2_f32_bf16 v67, v43, s41, v74
    v_cmp_eq_u32 s[96:97], -1, v72
    v_cvt_pk_bf16_f32 v68, v60, v61
    v_cvt_pk_bf16_f32 v69, v62, v63
    v_cvt_pk_bf16_f32 v70, v64, v65
    v_cvt_pk_bf16_f32 v71, v66, v67
    s_mov_b64 exec, s[68:69]
    ds_write_b128 v9, v[68:71] offset:0
    s_mov_b64 exec, -1
    s_or_b64 vcc, s[12:13], s[14:15]
    s_or_b64 vcc, vcc, s[16:17]
    s_or_b64 vcc, vcc, s[18:19]
    s_or_b64 vcc, vcc, s[8:9]
    s_or_b64 vcc, vcc, s[96:97]
    s_cbranch_scc1 GA_133
GA_133_ok:
    v_mov_b64 v[60:61], 0
    v_mov_b64 v[62:63], 0
    v_mov_b64 v[64:65], 0
    v_mov_b64 v[66:67], 0
    v_mov_b64 v[68:69], 0
    v_mov_b64 v[70:71], 0
    s_add_u32 s45, s45, 327680
    s_cmp_eq_u32 s22, 42
    s_cselect_b32 s26, s64, 49152
    s_add_u32 s36, s36, s26
    s_add_u32 s37, s37, s26
    s_waitcnt lgkmcnt(0)
CH_ent_131:
    s_barrier
    ds_read_b128 v[20:23], v4 offset:0
    ds_read_b128 v[24:27], v4 offset:1024
    ds_read_b128 v[28:31], v4 offset:2048
    s_waitcnt lgkmcnt(2)
    v_smfmac_f32_16x16x64_bf16 v[60:63], v[20:23], a[0:7], v2
    ds_read_b128 v[32:35], v4 offset:3072
    v_mov_b64 v[72:73], 0
    v_smfmac_f32_16x16x64_bf16 v[64:67], v[20:23], a[8:15], v2
    s_waitcnt lgkmcnt(2)
    ds_read_b128 v[36:39], v4 offset:4096
    v_mov_b64 v[74:75], 0
    v_smfmac_f32_16x16x64_bf16 v[60:63], v[24:27], a[16:23], v2
    ds_read_b128 v[40:43], v4 offset:5120
    v_smfmac_f32_16x16x64_bf16 v[64:67], v[24:27], a[24:31], v2
    s_waitcnt lgkmcnt(3)
    ds_read_b128 v[44:47], v4 offset:6144
    v_smfmac_f32_16x16x64_bf16 v[60:63], v[28:31], v[76:83], v2
    ds_read_b128 v[48:51], v4 offset:7168
    s_mov_b32 m0, s54
    v_smfmac_f32_16x16x64_bf16 v[64:67], v[28:31], a[32:39], v2
    s_waitcnt lgkmcnt(4)
    ds_read_b128 v[52:55], v4 offset:8192
    s_add_u32 s43, s38, 0
    v_smfmac_f32_16x16x64_bf16 v[60:63], v[32:35], a[40:47], v2
    buffer_load_dwordx4 v3, s[4:7], s43 offen offset:0 sc1 lds
    v_smfmac_f32_16x16x64_bf16 v[64:67], v[32:35], a[48:55], v2
    s_waitcnt lgkmcnt(4)
    ds_read_b128 v[56:59], v4 offset:9216
    v_smfmac_f32_16x16x64_bf16 v[60:63], v[36:39], a[56:63], v2
    ds_read_b128 v[76:79], v5 offset:6144
    s_add_u32 s43, s38, 39936
    v_smfmac_f32_16x16x64_bf16 v[64:67], v[36:39], v[84:91], v2
    s_waitcnt lgkmcnt(5)
    buffer_load_dwordx4 v3, s[4:7], s43 offen offset:1024 sc1 lds
    v_smfmac_f32_16x16x64_bf16 v[60:63], v[40:43], a[64:71], v2
    ds_read_b128 v[80:83], v5 offset:7168
    v_smfmac_f32_16x16x64_bf16 v[64:67], v[40:43], a[72:79], v2
    s_waitcnt lgkmcnt(5)
    ds_read_b128 v[84:87], v5 offset:8192
    v_smfmac_f32_16x16x64_bf16 v[60:63], v[44:47], a[80:87], v2
    ds_read_b128 v[88:91], v5 offset:9216
    s_add_u32 s43, s38, 79872
    v_smfmac_f32_16x16x64_bf16 v[64:67], v[44:47], a[88:95], v2
    s_waitcnt lgkmcnt(6)
    buffer_load_dwordx4 v3, s[4:7], s43 offen offset:2048 sc1 lds
    v_smfmac_f32_16x16x64_bf16 v[60:63], v[48:51], v[92:99], v2
    ds_read_b128 v[92:95], v5 offset:10240
    v_smfmac_f32_16x16x64_bf16 v[64:67], v[48:51], a[96:103], v2
    s_waitcnt lgkmcnt(6)
    ds_read_b128 v[96:99], v5 offset:11264
    v_smfmac_f32_16x16x64_bf16 v[60:63], v[52:55], a[104:111], v2
    s_add_u32 s43, s38, 119808
    buffer_load_dwordx4 v3, s[4:7], s43 offen offset:3072 sc1 lds
    v_smfmac_f32_16x16x64_bf16 v[64:67], v[52:55], a[112:119], v2
    s_waitcnt lgkmcnt(6)
    v_smfmac_f32_16x16x64_bf16 v[60:63], v[56:59], a[120:127], v2
    s_waitcnt lgkmcnt(4)
    v_smfmac_f32_16x16x64_bf16 v[64:67], v[56:59], v[76:83], v2
    ds_read_b128 v[76:79], v5 offset:12288
    v_smfmac_f32_16x16x64_bf16 v[68:71], v[20:23], a[128:135], v2
    ds_read_b128 v[80:83], v5 offset:13312
    v_smfmac_f32_16x16x64_bf16 v[68:71], v[24:27], a[136:143], v2
    v_add_f32 v60, v60, v61
    v_smfmac_f32_16x16x64_bf16 v[68:71], v[28:31], a[144:151], v2
    v_add_f32 v62, v62, v63
    v_smfmac_f32_16x16x64_bf16 v[68:71], v[32:35], a[152:159], v2
    s_waitcnt lgkmcnt(4)
    v_cvt_pk_bf16_f32 v60, v60, v62
    v_smfmac_f32_16x16x64_bf16 v[68:71], v[36:39], v[84:91], v2
    ds_write_b32 v6, v60 offset:0
    v_add_f32 v64, v64, v65
    v_smfmac_f32_16x16x64_bf16 v[68:71], v[40:43], a[160:167], v2
    ds_read_b128 v[84:87], v5 offset:14336
    v_add_f32 v66, v66, v67
    v_smfmac_f32_16x16x64_bf16 v[68:71], v[44:47], a[168:175], v2
    ds_read_b128 v[88:91], v5 offset:15360
    v_cvt_pk_bf16_f32 v64, v64, v66
    v_smfmac_f32_16x16x64_bf16 v[68:71], v[48:51], a[176:183], v2
    ds_write_b32 v6, v64 offset:256
    v_mov_b64 v[60:61], 0
    v_smfmac_f32_16x16x64_bf16 v[68:71], v[52:55], a[184:191], v2
    s_waitcnt lgkmcnt(6)
    v_mov_b64 v[62:63], 0
    v_smfmac_f32_16x16x64_bf16 v[68:71], v[56:59], v[92:99], v2
    ds_read_b128 v[92:95], v5 offset:16384
    v_mov_b64 v[64:65], 0
    v_smfmac_f32_16x16x64_bf16 v[72:75], v[20:23], a[192:199], v2
    ds_read_b128 v[96:99], v5 offset:17408
    v_mov_b64 v[66:67], 0
    v_smfmac_f32_16x16x64_bf16 v[72:75], v[24:27], a[200:207], v2
    v_smfmac_f32_16x16x64_bf16 v[72:75], v[28:31], a[208:215], v2
    v_add_f32 v68, v68, v69
    v_smfmac_f32_16x16x64_bf16 v[72:75], v[32:35], a[216:223], v2
    s_waitcnt lgkmcnt(6)
    v_add_f32 v70, v70, v71
    v_smfmac_f32_16x16x64_bf16 v[72:75], v[36:39], v[76:83], v2
    ds_read_b128 v[76:79], v5 offset:18432
    v_cvt_pk_bf16_f32 v68, v68, v70
    v_smfmac_f32_16x16x64_bf16 v[72:75], v[40:43], a[224:231], v2
    ds_write_b32 v6, v68 offset:512
    v_smfmac_f32_16x16x64_bf16 v[72:75], v[44:47], a[232:239], v2
    ds_read_b128 v[80:83], v5 offset:19456
    v_smfmac_f32_16x16x64_bf16 v[72:75], v[48:51], a[240:247], v2
    s_waitcnt lgkmcnt(1)
    s_barrier
    v_smfmac_f32_16x16x64_bf16 v[72:75], v[52:55], a[248:255], v2
    ds_read_b64_tr_b16 v[100:101], v8 offset:0
    v_smfmac_f32_16x16x64_bf16 v[72:75], v[56:59], v[84:91], v2
    ds_read_b64_tr_b16 v[102:103], v8 offset:256
    v_smfmac_f32_16x16x64_bf16 v[60:63], v[20:23], v[128:135], v2
    ds_read_b128 v[104:107], v17 offset:0
    v_smfmac_f32_16x16x64_bf16 v[64:67], v[20:23], v[136:143], v2
    ds_read_b64_tr_b16 v[108:109], v8 offset:768
    v_smfmac_f32_16x16x64_bf16 v[60:63], v[24:27], v[144:151], v2
    ds_read_b64_tr_b16 v[110:111], v8 offset:1024
    v_add_f32 v72, v72, v73
    v_smfmac_f32_16x16x64_bf16 v[64:67], v[24:27], v[152:159], v2
    ds_read_b128 v[112:115], v17 offset:1024
    v_add_f32 v74, v74, v75
    v_smfmac_f32_16x16x64_bf16 v[60:63], v[28:31], v[92:99], v2
    ds_read_b64_tr_b16 v[116:117], v8 offset:1536
    v_cvt_pk_bf16_f32 v72, v72, v74
    v_smfmac_f32_16x16x64_bf16 v[64:67], v[28:31], v[160:167], v2
    ds_read_b64_tr_b16 v[118:119], v8 offset:1792
    v_smfmac_f32_16x16x64_bf16 v[60:63], v[32:35], v[168:175], v2
    ds_read_b128 v[20:23], v17 offset:2048
    v_smfmac_f32_16x16x64_bf16 v[64:67], v[32:35], v[176:183], v2
    ds_read_b128 v[84:87], v5 offset:20480
    v_smfmac_f32_16x16x64_bf16 v[60:63], v[36:39], v[184:191], v2
    s_waitcnt lgkmcnt(10)
    s_waitcnt lgkmcnt(7)
    v_mfma_f32_16x16x32_bf16 v[68:71], v[104:107], v[100:103], 0
    ds_read_b128 v[88:91], v5 offset:21504
    v_smfmac_f32_16x16x64_bf16 v[64:67], v[36:39], v[76:83], v2
    ds_read_b128 v[92:95], v5 offset:22528
    v_smfmac_f32_16x16x64_bf16 v[60:63], v[40:43], v[192:199], v2
    ds_read_b128 v[96:99], v5 offset:23552
    v_smfmac_f32_16x16x64_bf16 v[64:67], v[40:43], v[200:207], v2
    s_waitcnt lgkmcnt(7)
    v_mfma_f32_16x16x32_bf16 v[68:71], v[112:115], v[108:111], v[68:71]
    ds_write_b32 v6, v72 offset:3072
    v_smfmac_f32_16x16x64_bf16 v[60:63], v[44:47], v[208:215], v2
    v_smfmac_f32_16x16x64_bf16 v[64:67], v[44:47], v[216:223], v2
    s_waitcnt lgkmcnt(3)
    v_smfmac_f32_16x16x64_bf16 v[60:63], v[48:51], v[84:91], v2
    v_mfma_f32_16x16x32_bf16 v[68:71], v[20:23], v[116:119], v[68:71]
    v_smfmac_f32_16x16x64_bf16 v[64:67], v[48:51], v[224:231], v2
    v_smfmac_f32_16x16x64_bf16 v[60:63], v[52:55], v[232:239], v2
    v_smfmac_f32_16x16x64_bf16 v[64:67], v[52:55], v[240:247], v2
    v_smfmac_f32_16x16x64_bf16 v[60:63], v[56:59], v[248:255], v2
    s_waitcnt lgkmcnt(1)
    v_smfmac_f32_16x16x64_bf16 v[64:67], v[56:59], v[92:99], v2
    ds_write_b128 v126, v[68:71] offset:61440
    v_xor_b32 v17, 245760, v17
    s_nop 2
    v_add_f32 v60, v60, v61
    v_add_f32 v62, v62, v63
    v_cvt_pk_bf16_f32 v60, v60, v62
    ds_write_b32 v6, v60 offset:3328
    v_add_f32 v64, v64, v65
    v_add_f32 v66, v66, v67
    v_cvt_pk_bf16_f32 v64, v64, v66
    ds_write_b32 v6, v64 offset:3584
    s_memrealtime s[76:77]
    s_add_u32 s91, s22, 1
    s_lshl_b32 s91, s91, 24
    s_lshl_b32 s26, s24, 2
    s_add_u32 s26, s26, s90
    s_waitcnt lgkmcnt(0)
    s_barrier
    s_cmp_eq_u32 s22, 63
    s_cbranch_scc1 CH_fin_130
    s_and_b32 s76, s76, 0xffffff
    s_or_b32 s76, s76, s91
    v_mov_b32 v72, s76
    s_cmp_eq_u32 s25, 0
    s_cbranch_scc1 ds_s_134
    s_mov_b64 exec, 1
    buffer_store_dword v72, v0, s[4:7], s26 offen
    s_mov_b64 exec, -1
ds_e_135:
    s_add_u32 s26, s32, s61
    s_add_u32 s27, s32, s62
    s_add_u32 s58, s30, s63
    v_mov_b64 v[28:29], 0
    v_mov_b64 v[30:31], 0
    s_xor_b32 s55, s55, 245760
    s_mov_b64 s[12:13], -1
    s_mov_b64 s[14:15], -1
    s_mov_b64 s[16:17], s[50:51]
    s_mov_b64 s[18:19], -1
    s_mov_b32 s3, s58
kc_lp_138:
    v_cmp_gt_u32 vcc, s42, v124
    s_cbranch_vccnz kc_s_136
kc_ok_137:
    s_mov_b32 s58, s3
    s_add_u32 s91, s22, 1
    s_lshl_b32 s91, s91, 24
    v_and_b32 v57, 15, v1
    v_lshlrev_b32 v57, 2, v57
    s_mov_b64 exec, 0xffff
HP_139:
    buffer_load_dword v58, v57, s[4:7], s90 offen sc1
    s_sub_u32 s28, s28, 1
    s_cbranch_scc1 HPe_141
    s_waitcnt vmcnt(0)
    v_cmp_gt_i32 vcc, s91, v58
    s_cbranch_vccnz HP_139
HPd_140:
    s_memrealtime s[76:77]
    s_nop 1
    v_max_i32_dpp v58, v58, v58 row_ror:1 row_mask:0xf bank_mask:0xf
    s_nop 1
    v_max_i32_dpp v58, v58, v58 row_ror:2 row_mask:0xf bank_mask:0xf
    s_nop 1
    v_max_i32_dpp v58, v58, v58 row_ror:4 row_mask:0xf bank_mask:0xf
    s_nop 1
    v_max_i32_dpp v58, v58, v58 row_ror:8 row_mask:0xf bank_mask:0xf
    s_nop 0
    v_readfirstlane_b32 s98, v58
    s_mov_b64 exec, -1
    s_waitcnt lgkmcnt(0)
    s_add_u32 s77, s98, 32
    s_sub_u32 s77, s77, s76
    s_and_b32 s77, s77, 0xffffff
    s_cmp_gt_u32 s77, 120
    s_cselect_b32 s77, 0, s77
    s_mul_i32 s77, s77, 363
TW_142:
    s_sub_u32 s77, s77, 704
    s_cmp_gt_i32 s77, 0
    s_cbranch_scc1 TW_142
    s_barrier
GB_143:
    s_sub_u32 s28, s28, 1
    s_cbranch_scc1 GB_143_dead
    s_mov_b64 exec, s[12:13]
    buffer_load_dwordx4 v[20:23], v3, s[4:7], s26 offen offset:0 sc1
    s_mov_b64 exec, s[14:15]
    buffer_load_dwordx4 v[24:27], v3, s[4:7], s26 offen offset:1024 sc1
    s_mov_b64 exec, s[16:17]
    buffer_load_dwordx4 v[28:31], v10, s[4:7], s27 offen sc1
    s_mov_b64 exec, s[18:19]
    buffer_load_dwordx4 v[48:51], v3, s[4:7], s58 offen sc1
    s_mov_b64 exec, -1
    s_waitcnt vmcnt(4)
    ds_read_b128 v[100:103], v15 offset:0
    ds_read_b128 v[104:107], v15 offset:1024
    ds_read_b128 v[108:111], v15 offset:2048
    ds_read_b128 v[112:115], v15 offset:3072
    s_mov_b32 m0, s55
    s_nop 0
    buffer_load_dwordx4 v3, s[4:7], s44 offen offset:0 sc1 lds
    buffer_load_dwordx4 v3, s[4:7], s44 offen offset:1024 sc1 lds
    buffer_load_dwordx4 v3, s[4:7], s44 offen offset:2048 sc1 lds
    buffer_load_dwordx4 v3, s[4:7], s44 offen offset:3072 sc1 lds
    s_waitcnt vmcnt(6) lgkmcnt(0)
    v_mfma_f32_16x16x32_bf16 v[40:43], v[104:107], v[20:23], 0
    v_max_u32 v32, v20, v22
    v_mfma_f32_16x16x32_bf16 v[68:71], v[100:103], v[20:23], 0
    v_max_u32 v33, v24, v26
    v_mfma_f32_16x16x32_bf16 v[40:43], v[112:115], v[24:27], v[40:43]
    v_cmp_eq_u32 s[12:13], -1, v32
    v_mfma_f32_16x16x32_bf16 v[68:71], v[108:111], v[24:27], v[68:71]
    v_cmp_eq_u32 s[14:15], -1, v33
    s_waitcnt vmcnt(4)
    v_mfma_f32_16x16x32_bf16 v[68:71], v[48:51], v[28:31], v[68:71]
    v_max_u32 v34, v28, v30
    v_max_u32 v35, v48, v50
    v_cmp_eq_u32 s[16:17], -1, v34
    v_cmp_eq_u32 s[18:19], -1, v35
    s_or_b64 vcc, s[12:13], s[14:15]
    s_or_b64 vcc, vcc, s[16:17]
    s_or_b64 vcc, vcc, s[18:19]
    s_cbranch_scc1 GB_143
GB_143_ok:
    s_add_u32 s44, s44, 393216
    s_add_u32 s42, s42, 1
    s_min_u32 s42, s42, 64
    s_add_u32 s11, s36, s99
    s_mov_b64 exec, 1
    buffer_load_dword v58, v0, s[4:7], s11 offen sc1
    s_mov_b64 exec, -1
    s_nop 0
    v_add_f32_dpp v68, v40, v68 row_ror:8 row_mask:0xf bank_mask:0xf
    v_add_f32_dpp v69, v41, v69 row_ror:8 row_mask:0xf bank_mask:0xf
    v_add_f32_dpp v70, v42, v70 row_ror:8 row_mask:0xf bank_mask:0xf
    v_add_f32_dpp v71, v43, v71 row_ror:8 row_mask:0xf bank_mask:0xf
    ds_write_b128 v126, v[68:71] offset:28672
    s_waitcnt lgkmcnt(0)
    s_barrier
    s_sleep 4
    ds_read_b128 v[44:47], v126 offset:12288
    s_waitcnt lgkmcnt(0)
    buffer_store_dwordx4 v[44:47], v7, s[4:7], s67 offen sc0 sc1
    s_add_u32 s67, s67, 98304
    v_cmp_le_u32 vcc, 32, v127
    s_add_u32 s26, s66, 1
    s_max_u32 s26, s26, s49
    s_cmp_lg_u64 vcc, 0
    s_cselect_b32 s49, s26, s49
    s_cselect_b32 s66, 2, 0
    s_add_u32 s58, s22, 1
    s_cmp_ge_u32 s58, s49
    s_cbranch_scc1 uc_s_144
uc_ok_145:
    s_add_u32 s66, s49, s66
    s_min_u32 s66, s66, 63
    s_lshl_b32 s26, s66, 7
    s_add_u32 s26, s26, 167841792
    buffer_load_dword v127, v0, s[4:7], s26 offen sc1
    s_add_u32 s26, s56, 167829504
    buffer_load_dword v124, v0, s[4:7], s26 offen sc1
    s_add_u32 s22, s22, 1
    s_mov_b32 s26, s30
    s_mov_b32 s30, s31
    s_mov_b32 s31, s46
    s_mov_b32 s46, s26
    s_mov_b32 s26, s32
    s_mov_b32 s32, s33
    s_mov_b32 s33, s47
    s_mov_b32 s47, s26
    s_mov_b32 s26, s34
    s_mov_b32 s34, s35
    s_mov_b32 s35, s26
    s_add_u32 s38, s38, 1310720
    s_add_u32 s57, s57, 128
    ds_read_b128 v[76:79], v5 offset:0
    ds_read_b128 v[80:83], v5 offset:1024
    ds_read_b128 v[84:87], v5 offset:2048
    ds_read_b128 v[88:91], v5 offset:3072
    ds_read_b128 v[92:95], v5 offset:4096
    ds_read_b128 v[96:99], v5 offset:5120
    v_mov_b64 v[28:29], 0
    v_mov_b64 v[30:31], 0
    v_mov_b64 v[40:41], 0
    v_mov_b64 v[42:43], 0
    s_add_u32 s10, s34, 4096
    s_add_u32 s11, s34, s65
    s_mov_b64 s[12:13], -1
    s_mov_b64 s[14:15], -1
    s_mov_b64 s[16:17], s[68:69]
    s_mov_b64 s[18:19], -1
    s_mov_b64 s[8:9], -1
    s_mov_b64 s[96:97], s[68:69]
    s_add_u32 s3, s36, 4096
    s_add_u32 s101, s36, s29
    s_waitcnt vmcnt(3)
    v_readfirstlane_b32 s27, v58
    s_cmp_lt_i32 s27, s91
    s_cbranch_scc1 XL_148
XLo_149:
    s_max_i32 s98, s98, s27
    s_memrealtime s[76:77]
    s_waitcnt lgkmcnt(0)
    s_add_u32 s77, s98, 98
    s_sub_u32 s77, s77, s76
    s_and_b32 s77, s77, 0xffffff
    s_cmp_gt_u32 s77, 120
    s_cselect_b32 s77, 0, s77
    s_mul_i32 s77, s77, 363
TW_150:
    s_sub_u32 s77, s77, 704
    s_cmp_gt_i32 s77, 0
    s_cbranch_scc1 TW_150
    s_barrier
    s_branch CH_top_129
GA_133_dead:
    s_mov_b32 s28, 0
    s_branch GA_133_ok
ds_s_134:
    s_mov_b64 exec, 1
    buffer_store_dword v72, v0, s[4:7], s26 offen sc0 sc1
    s_mov_b64 exec, -1
    s_branch ds_e_135
kc_s_136:
    s_sub_u32 s28, s28, 1
    s_cbranch_scc1 kc_s_136_d
    s_add_u32 s58, s56, 167829504
    buffer_load_dword v124, v0, s[4:7], s58 offen sc1
    s_waitcnt vmcnt(0)
    s_branch kc_lp_138
kc_s_136_d:
    s_mov_b32 s28, 0
    s_branch kc_ok_137
HPe_141:
    s_mov_b32 s28, 0
    s_waitcnt vmcnt(0)
    s_branch HPd_140
GB_143_dead:
    s_mov_b32 s28, 0
    s_branch GB_143_ok
uc_s_144:
    s_add_u32 s49, s58, 0
    s_min_u32 s49, s49, 63
    s_lshl_b32 s43, s49, 7
    s_add_u32 s43, s43, 167841792
    s_add_u32 s49, s49, 1
    buffer_load_dword v127, v0, s[4:7], s43 offen sc1
    s_waitcnt vmcnt(0)
    v_cmp_gt_u32 vcc, 32, v127
    s_cbranch_vccz uc_ok_145
    s_add_u32 s49, s58, 1
    s_min_u32 s58, s58, 63
    s_lshl_b32 s43, s58, 7
    s_add_u32 s43, s43, 167841792
uc_lp_146:
    buffer_load_dword v127, v0, s[4:7], s43 offen sc1
    s_waitcnt vmcnt(0)
    v_cmp_gt_u32 vcc, 32, v127
    s_cbranch_vccz uc_ok_145
    s_sub_u32 s28, s28, 1
    s_cbranch_scc0 uc_lp_146
    s_mov_b32 s28, 0
    s_branch uc_ok_145
XL_148:
    s_add_u32 s26, s36, s99
XL_148_l:
    buffer_load_dword v58, v0, s[4:7], s26 offen sc1
    s_sub_u32 s28, s28, 1
    s_cbranch_scc1 XL_148_d
    s_waitcnt vmcnt(0)
    v_readfirstlane_b32 s27, v58
    s_nop 0
    s_cmp_lt_i32 s27, s91
    s_cbranch_scc1 XL_148_l
    s_branch XLo_149
XL_148_d:
    s_mov_b32 s28, 0
    s_waitcnt vmcnt(0)
    s_branch XLo_149
CH_fin_130:
    ds_read_b128 v[100:103], v126 offset:12288
    s_waitcnt lgkmcnt(0)
    buffer_store_dwordx4 v[100:103], v7, s[4:7], s67 offen sc0 sc1
    s_waitcnt vmcnt(0)
    s_barrier
    s_branch L_end
CLS_120:
    ds_read_b128 v[76:79], v5 offset:0
    ds_read_b128 v[80:83], v5 offset:1024
    ds_read_b128 v[84:87], v5 offset:2048
    ds_read_b128 v[88:91], v5 offset:3072
    ds_read_b128 v[92:95], v5 offset:4096
    ds_read_b128 v[96:99], v5 offset:5120
    v_mov_b64 v[60:61], 0
    v_mov_b64 v[62:63], 0
    v_mov_b64 v[64:65], 0
    v_mov_b64 v[66:67], 0
    v_mov_b64 v[68:69], 0
    v_mov_b64 v[70:71], 0
    s_waitcnt lgkmcnt(0)
    s_branch CH_ent_153
CH_top_151:
GA_155:
    s_sub_u32 s28, s28, 1
    s_cbranch_scc1 GA_155_dead
    s_mov_b64 exec, s[12:13]
    buffer_load_dwordx4 v[20:23], v7, s[4:7], s34 offen sc1
    s_mov_b64 exec, s[14:15]
    buffer_load_dwordx4 v[24:27], v7, s[4:7], s10 offen sc1
    s_mov_b64 exec, s[16:17]
    buffer_load_dwordx4 v[28:31], v7, s[4:7], s11 offen sc1
    s_mov_b64 exec, s[18:19]
    buffer_load_dwordx4 v[32:35], v7, s[4:7], s36 offen sc1
    s_mov_b64 exec, s[8:9]
    buffer_load_dwordx4 v[36:39], v7, s[4:7], s3 offen sc1
    s_mov_b64 exec, s[96:97]
    buffer_load_dwordx4 v[40:43], v7, s[4:7], s101 offen sc1
    s_mov_b64 exec, -1
    s_add_u32 s26, s45, s63
    buffer_store_dwordx4 v[48:51], v3, s[4:7], s26 offen sc0 sc1
    s_mov_b64 exec, s[50:51]
    s_cmp_eq_u32 s25, 0
    s_cbranch_scc1 ds_s_156
    buffer_store_dwordx2 v[120:121], v14, s[4:7], s35 offen
ds_e_157:
    s_mov_b64 exec, -1
    s_add_u32 s26, s33, s59
    s_add_u32 s27, s33, s60
    s_cmp_eq_u32 s25, 0
    s_cbranch_scc1 ds_s_158
    s_mov_b64 exec, s[50:51]
    buffer_store_dwordx4 v[120:123], v3, s[4:7], s26 offen
    s_mov_b64 exec, s[52:53]
    buffer_store_dwordx2 v[120:121], v11, s[4:7], s27 offen
    s_mov_b64 exec, -1
ds_e_159:
    s_waitcnt vmcnt(7)
    v_max_u32 v72, v20, v22
    v_max_u32 v73, v24, v26
    v_max_u32 v74, v28, v30
    v_cmp_eq_u32 s[12:13], -1, v72
    v_cmp_eq_u32 s[14:15], -1, v73
    v_cmp_eq_u32 s[16:17], -1, v74
    v_lshlrev_b32 v100, 16, v20
    v_and_b32 v101, 0xffff0000, v20
    v_lshlrev_b32 v102, 16, v21
    v_and_b32 v103, 0xffff0000, v21
    v_lshlrev_b32 v104, 16, v22
    v_and_b32 v105, 0xffff0000, v22
    v_lshlrev_b32 v106, 16, v23
    v_and_b32 v107, 0xffff0000, v23
    v_lshlrev_b32 v108, 16, v24
    v_and_b32 v109, 0xffff0000, v24
    v_lshlrev_b32 v112, 16, v25
    v_and_b32 v113, 0xffff0000, v25
    v_lshlrev_b32 v114, 16, v26
    v_and_b32 v115, 0xffff0000, v26
    v_lshlrev_b32 v116, 16, v27
    v_and_b32 v117, 0xffff0000, v27
    v_lshlrev_b32 v118, 16, v28
    v_and_b32 v119, 0xffff0000, v28
    v_lshlrev_b32 v56, 16, v29
    v_and_b32 v57, 0xffff0000, v29
    v_lshlrev_b32 v58, 16, v30
    v_and_b32 v59, 0xffff0000, v30
    v_lshlrev_b32 v73, 16, v31
    v_and_b32 v74, 0xffff0000, v31
    s_waitcnt vmcnt(6)
    v_max_u32 v72, v32, v34
    v_dot2_f32_bf16 v60, v32, s40, v100
    v_dot2_f32_bf16 v61, v32, s41, v101
    v_dot2_f32_bf16 v62, v33, s40, v102
    v_dot2_f32_bf16 v63, v33, s41, v103
    v_dot2_f32_bf16 v64, v34, s40, v104
    v_dot2_f32_bf16 v65, v34, s41, v105
    v_dot2_f32_bf16 v66, v35, s40, v106
    v_dot2_f32_bf16 v67, v35, s41, v107
    v_cmp_eq_u32 s[18:19], -1, v72
    v_cvt_pk_bf16_f32 v68, v60, v61
    v_cvt_pk_bf16_f32 v69, v62, v63
    v_cvt_pk_bf16_f32 v70, v64, v65
    v_cvt_pk_bf16_f32 v71, v66, v67
    ds_write_b128 v19, v[68:71] offset:0
    s_waitcnt vmcnt(5)
    v_max_u32 v72, v36, v38
    v_dot2_f32_bf16 v60, v36, s40, v108
    v_dot2_f32_bf16 v61, v36, s41, v109
    v_dot2_f32_bf16 v62, v37, s40, v112
    v_dot2_f32_bf16 v63, v37, s41, v113
    v_dot2_f32_bf16 v64, v38, s40, v114
    v_dot2_f32_bf16 v65, v38, s41, v115
    v_dot2_f32_bf16 v66, v39, s40, v116
    v_dot2_f32_bf16 v67, v39, s41, v117
    v_cmp_eq_u32 s[8:9], -1, v72
    v_cvt_pk_bf16_f32 v44, v60, v61
    v_cvt_pk_bf16_f32 v45, v62, v63
    v_cvt_pk_bf16_f32 v46, v64, v65
    v_cvt_pk_bf16_f32 v47, v66, v67
    ds_write_b128 v19, v[44:47] offset:4096
    s_waitcnt vmcnt(4)
    v_max_u32 v72, v40, v42
    v_dot2_f32_bf16 v60, v40, s40, v118
    v_dot2_f32_bf16 v61, v40, s41, v119
    v_dot2_f32_bf16 v62, v41, s40, v56
    v_dot2_f32_bf16 v63, v41, s41, v57
    v_dot2_f32_bf16 v64, v42, s40, v58
    v_dot2_f32_bf16 v65, v42, s41, v59
    v_dot2_f32_bf16 v66, v43, s40, v73
    v_dot2_f32_bf16 v67, v43, s41, v74
    v_cmp_eq_u32 s[96:97], -1, v72
    v_cvt_pk_bf16_f32 v68, v60, v61
    v_cvt_pk_bf16_f32 v69, v62, v63
    v_cvt_pk_bf16_f32 v70, v64, v65
    v_cvt_pk_bf16_f32 v71, v66, v67
    s_mov_b64 exec, s[68:69]
    ds_write_b128 v9, v[68:71] offset:0
    s_mov_b64 exec, -1
    s_or_b64 vcc, s[12:13], s[14:15]
    s_or_b64 vcc, vcc, s[16:17]
    s_or_b64 vcc, vcc, s[18:19]
    s_or_b64 vcc, vcc, s[8:9]
    s_or_b64 vcc, vcc, s[96:97]
    s_cbranch_scc1 GA_155
GA_155_ok:
    v_mov_b64 v[60:61], 0
    v_mov_b64 v[62:63], 0
    v_mov_b64 v[64:65], 0
    v_mov_b64 v[66:67], 0
    v_mov_b64 v[68:69], 0
    v_mov_b64 v[70:71], 0
    s_add_u32 s45, s45, 327680
    s_cmp_eq_u32 s22, 42
    s_cselect_b32 s26, s64, 49152
    s_add_u32 s36, s36, s26
    s_add_u32 s37, s37, s26
    s_waitcnt lgkmcnt(0)
CH_ent_153:
    s_barrier
    ds_read_b128 v[20:23], v4 offset:0
    ds_read_b128 v[24:27], v4 offset:1024
    ds_read_b128 v[28:31], v4 offset:2048
    s_waitcnt lgkmcnt(2)
    v_smfmac_f32_16x16x64_bf16 v[60:63], v[20:23], a[0:7], v2
    ds_read_b128 v[32:35], v4 offset:3072
    v_mov_b64 v[72:73], 0
    v_smfmac_f32_16x16x64_bf16 v[64:67], v[20:23], a[8:15], v2
    s_waitcnt lgkmcnt(2)
    ds_read_b128 v[36:39], v4 offset:4096
    v_mov_b64 v[74:75], 0
    v_smfmac_f32_16x16x64_bf16 v[60:63], v[24:27], a[16:23], v2
    ds_read_b128 v[40:43], v4 offset:5120
    s_mov_b32 m0, s54
    v_smfmac_f32_16x16x64_bf16 v[64:67], v[24:27], a[24:31], v2
    s_waitcnt lgkmcnt(3)
    ds_read_b128 v[44:47], v4 offset:6144
    s_add_u32 s43, s38, 0
    v_smfmac_f32_16x16x64_bf16 v[60:63], v[28:31], v[76:83], v2
    buffer_load_dwordx4 v3, s[4:7], s43 offen offset:0 sc1 lds
    v_smfmac_f32_16x16x64_bf16 v[64:67], v[28:31], a[32:39], v2
    s_waitcnt lgkmcnt(3)
    ds_read_b128 v[48:51], v4 offset:7168
    v_smfmac_f32_16x16x64_bf16 v[60:63], v[32:35], a[40:47], v2
    ds_read_b128 v[52:55], v4 offset:8192
    s_add_u32 s43, s38, 39936
    v_smfmac_f32_16x16x64_bf16 v[64:67], v[32:35], a[48:55], v2
    s_waitcnt lgkmcnt(4)
    buffer_load_dwordx4 v3, s[4:7], s43 offen offset:1024 sc1 lds
    v_smfmac_f32_16x16x64_bf16 v[60:63], v[36:39], a[56:63], v2
    ds_read_b128 v[56:59], v4 offset:9216
    v_smfmac_f32_16x16x64_bf16 v[64:67], v[36:39], v[84:91], v2
    s_waitcnt lgkmcnt(4)
    ds_read_b128 v[76:79], v5 offset:6144
    v_smfmac_f32_16x16x64_bf16 v[60:63], v[40:43], a[64:71], v2
    ds_read_b128 v[80:83], v5 offset:7168
    s_add_u32 s43, s38, 79872
    v_smfmac_f32_16x16x64_bf16 v[64:67], v[40:43], a[72:79], v2
    s_waitcnt lgkmcnt(5)
    buffer_load_dwordx4 v3, s[4:7], s43 offen offset:2048 sc1 lds
    v_smfmac_f32_16x16x64_bf16 v[60:63], v[44:47], a[80:87], v2
    ds_read_b128 v[84:87], v5 offset:8192
    v_smfmac_f32_16x16x64_bf16 v[64:67], v[44:47], a[88:95], v2
    s_waitcnt lgkmcnt(5)
    ds_read_b128 v[88:91], v5 offset:9216
    v_smfmac_f32_16x16x64_bf16 v[60:63], v[48:51], v[92:99], v2
    ds_read_b128 v[92:95], v5 offset:10240
    s_add_u32 s43, s38, 119808
    v_smfmac_f32_16x16x64_bf16 v[64:67], v[48:51], a[96:103], v2
    s_waitcnt lgkmcnt(6)
    buffer_load_dwordx4 v3, s[4:7], s43 offen offset:3072 sc1 lds
    v_smfmac_f32_16x16x64_bf16 v[60:63], v[52:55], a[104:111], v2
    ds_read_b128 v[96:99], v5 offset:11264
    v_smfmac_f32_16x16x64_bf16 v[64:67], v[52:55], a[112:119], v2
    s_waitcnt lgkmcnt(6)
    v_smfmac_f32_16x16x64_bf16 v[60:63], v[56:59], a[120:127], v2
    s_waitcnt lgkmcnt(4)
    s_add_u32 s26, s56, 167837696
    s_sub_u32 s27, s22, 0
    s_max_i32 s27, s27, 0
    v_smfmac_f32_16x16x64_bf16 v[64:67], v[56:59], v[76:83], v2
    ds_read_b128 v[76:79], v5 offset:12288
    v_mov_b32 v127, s27
    v_smfmac_f32_16x16x64_bf16 v[68:71], v[20:23], a[128:135], v2
    s_mov_b64 exec, 1
    buffer_store_dword v127, v0, s[4:7], s26 offen sc0 sc1
    s_mov_b64 exec, -1
    v_smfmac_f32_16x16x64_bf16 v[68:71], v[24:27], a[136:143], v2
    ds_read_b128 v[80:83], v5 offset:13312
    v_add_f32 v60, v60, v61
    v_smfmac_f32_16x16x64_bf16 v[68:71], v[28:31], a[144:151], v2
    v_add_f32 v62, v62, v63
    v_smfmac_f32_16x16x64_bf16 v[68:71], v[32:35], a[152:159], v2
    s_waitcnt lgkmcnt(4)
    v_cvt_pk_bf16_f32 v60, v60, v62
    v_smfmac_f32_16x16x64_bf16 v[68:71], v[36:39], v[84:91], v2
    ds_write_b32 v6, v60 offset:0
    v_add_f32 v64, v64, v65
    v_smfmac_f32_16x16x64_bf16 v[68:71], v[40:43], a[160:167], v2
    ds_read_b128 v[84:87], v5 offset:14336
    v_add_f32 v66, v66, v67
    v_smfmac_f32_16x16x64_bf16 v[68:71], v[44:47], a[168:175], v2
    ds_read_b128 v[88:91], v5 offset:15360
    v_cvt_pk_bf16_f32 v64, v64, v66
    v_smfmac_f32_16x16x64_bf16 v[68:71], v[48:51], a[176:183], v2
    ds_write_b32 v6, v64 offset:256
    v_mov_b64 v[60:61], 0
    v_smfmac_f32_16x16x64_bf16 v[68:71], v[52:55], a[184:191], v2
    s_waitcnt lgkmcnt(6)
    v_mov_b64 v[62:63], 0
    v_smfmac_f32_16x16x64_bf16 v[68:71], v[56:59], v[92:99], v2
    ds_read_b128 v[92:95], v5 offset:16384
    v_mov_b64 v[64:65], 0
    v_smfmac_f32_16x16x64_bf16 v[72:75], v[20:23], a[192:199], v2
    ds_read_b128 v[96:99], v5 offset:17408
    v_mov_b64 v[66:67], 0
    v_smfmac_f32_16x16x64_bf16 v[72:75], v[24:27], a[200:207], v2
    v_smfmac_f32_16x16x64_bf16 v[72:75], v[28:31], a[208:215], v2
    v_add_f32 v68, v68, v69
    v_smfmac_f32_16x16x64_bf16 v[72:75], v[32:35], a[216:223], v2
    s_waitcnt lgkmcnt(6)
    v_add_f32 v70, v70, v71
    v_smfmac_f32_16x16x64_bf16 v[72:75], v[36:39], v[76:83], v2
    ds_read_b128 v[76:79], v5 offset:18432
    v_cvt_pk_bf16_f32 v68, v68, v70
    v_smfmac_f32_16x16x64_bf16 v[72:75], v[40:43], a[224:231], v2
    ds_write_b32 v6, v68 offset:512
    v_smfmac_f32_16x16x64_bf16 v[72:75], v[44:47], a[232:239], v2
    ds_read_b128 v[80:83], v5 offset:19456
    v_smfmac_f32_16x16x64_bf16 v[72:75], v[48:51], a[240:247], v2
    s_waitcnt lgkmcnt(1)
    s_barrier
    v_smfmac_f32_16x16x64_bf16 v[72:75], v[52:55], a[248:255], v2
    ds_read_b64_tr_b16 v[100:101], v8 offset:0
    v_smfmac_f32_16x16x64_bf16 v[72:75], v[56:59], v[84:91], v2
    ds_read_b64_tr_b16 v[102:103], v8 offset:256
    v_smfmac_f32_16x16x64_bf16 v[60:63], v[20:23], v[128:135], v2
    ds_read_b64_tr_b16 v[104:105], v8 offset:768
    v_smfmac_f32_16x16x64_bf16 v[64:67], v[20:23], v[136:143], v2
    ds_read_b64_tr_b16 v[106:107], v8 offset:1024
    v_smfmac_f32_16x16x64_bf16 v[60:63], v[24:27], v[144:151], v2
    ds_read_b64_tr_b16 v[108:109], v8 offset:1536
    v_add_f32 v72, v72, v73
    v_smfmac_f32_16x16x64_bf16 v[64:67], v[24:27], v[152:159], v2
    ds_read_b64_tr_b16 v[110:111], v8 offset:1792
    v_add_f32 v74, v74, v75
    v_smfmac_f32_16x16x64_bf16 v[60:63], v[28:31], v[92:99], v2
    ds_read_b128 v[24:27], v17 offset:0
    v_cvt_pk_bf16_f32 v72, v72, v74
    v_smfmac_f32_16x16x64_bf16 v[64:67], v[28:31], v[160:167], v2
    ds_read_b128 v[84:87], v5 offset:20480
    v_smfmac_f32_16x16x64_bf16 v[60:63], v[32:35], v[168:175], v2
    ds_read_b128 v[28:31], v17 offset:1024
    v_smfmac_f32_16x16x64_bf16 v[64:67], v[32:35], v[176:183], v2
    ds_read_b128 v[88:91], v5 offset:21504
    v_smfmac_f32_16x16x64_bf16 v[60:63], v[36:39], v[184:191], v2
    s_waitcnt lgkmcnt(10)
    ds_read_b128 v[32:35], v17 offset:2048
    v_smfmac_f32_16x16x64_bf16 v[64:67], v[36:39], v[76:83], v2
    ds_read_b128 v[92:95], v5 offset:22528
    v_smfmac_f32_16x16x64_bf16 v[60:63], v[40:43], v[192:199], v2
    ds_read_b128 v[96:99], v5 offset:23552
    v_smfmac_f32_16x16x64_bf16 v[64:67], v[40:43], v[200:207], v2
    s_waitcnt lgkmcnt(6)
    v_mfma_f32_16x16x32_bf16 v[68:71], v[24:27], v[100:103], 0
    ds_read_b64_tr_b16 v[112:113], v8 offset:2304
    v_smfmac_f32_16x16x64_bf16 v[60:63], v[44:47], v[208:215], v2
    ds_read_b64_tr_b16 v[114:115], v8 offset:2560
    v_smfmac_f32_16x16x64_bf16 v[64:67], v[44:47], v[216:223], v2
    s_waitcnt lgkmcnt(5)
    v_mfma_f32_16x16x32_bf16 v[68:71], v[28:31], v[104:107], v[68:71]
    ds_write_b32 v6, v72 offset:3072
    v_smfmac_f32_16x16x64_bf16 v[60:63], v[48:51], v[84:91], v2
    ds_read_b64_tr_b16 v[116:117], v18 offset:512
    v_smfmac_f32_16x16x64_bf16 v[64:67], v[48:51], v[224:231], v2
    s_waitcnt lgkmcnt(6)
    v_mfma_f32_16x16x32_bf16 v[68:71], v[32:35], v[108:111], v[68:71]
    ds_read_b64_tr_b16 v[118:119], v18 offset:576
    v_smfmac_f32_16x16x64_bf16 v[60:63], v[52:55], v[232:239], v2
    ds_read_b64_tr_b16 v[20:21], v18 offset:2048
    v_smfmac_f32_16x16x64_bf16 v[64:67], v[52:55], v[240:247], v2
    ds_read_b64_tr_b16 v[22:23], v18 offset:2112
    v_smfmac_f32_16x16x64_bf16 v[60:63], v[56:59], v[248:255], v2
    s_waitcnt lgkmcnt(7)
    v_smfmac_f32_16x16x64_bf16 v[64:67], v[56:59], v[92:99], v2
    ds_write_b128 v126, v[68:71] offset:61440
    v_xor_b32 v17, 245760, v17
    s_nop 2
    v_add_f32 v60, v60, v61
    v_add_f32 v62, v62, v63
    v_cvt_pk_bf16_f32 v60, v60, v62
    ds_write_b32 v6, v60 offset:3328
    v_add_f32 v64, v64, v65
    v_add_f32 v66, v66, v67
    v_cvt_pk_bf16_f32 v64, v64, v66
    ds_write_b32 v6, v64 offset:3584
    s_waitcnt lgkmcnt(0)
    s_barrier
    s_cmp_eq_u32 s22, 63
    s_cbranch_scc1 CH_fin_152
    ds_read_b128 v[44:47], v13
    ds_read_b128 v[48:51], v13 offset:1024
    ds_read_b64_tr_b16 v[76:77], v8 offset:3072
    ds_read_b64_tr_b16 v[78:79], v8 offset:3328
    ds_read_b64_tr_b16 v[80:81], v8 offset:3840
    ds_read_b64_tr_b16 v[82:83], v8 offset:4096
    ds_read_b64_tr_b16 v[84:85], v8 offset:4608
    ds_read_b64_tr_b16 v[86:87], v8 offset:4864
    ds_read_b64_tr_b16 v[88:89], v8 offset:5376
    ds_read_b64_tr_b16 v[90:91], v8 offset:5632
    ds_read_b64_tr_b16 v[92:93], v18 offset:3584
    ds_read_b64_tr_b16 v[94:95], v18 offset:3648
    ds_read_b64_tr_b16 v[96:97], v18 offset:5120
    ds_read_b64_tr_b16 v[98:99], v18 offset:5184
    s_waitcnt lgkmcnt(12)
    v_add_f32 v44, v44, v48
    v_add_f32 v45, v45, v49
    v_add_f32 v46, v46, v50
    v_add_f32 v47, v47, v51
    v_max3_f32 v58, v44, v45, v46
    v_max_f32 v58, v58, v47
    s_nop 1
    v_max_f32_dpp v58, v58, v58 row_ror:8 row_mask:0xf bank_mask:0xf
    s_waitcnt lgkmcnt(10)
    v_mov_b32 v56, v58
    s_nop 1
    v_mfma_f32_16x16x32_bf16 v[52:55], v[76:79], v[100:103], 0
    s_waitcnt lgkmcnt(8)
    v_permlane16_swap_b32 v58, v56
    v_mfma_f32_16x16x32_bf16 v[52:55], v[80:83], v[104:107], v[52:55]
    s_waitcnt lgkmcnt(6)
    v_max_f32 v58, v58, v56
    v_mfma_f32_16x16x32_bf16 v[52:55], v[84:87], v[108:111], v[52:55]
    s_waitcnt lgkmcnt(4)
    v_mov_b32 v56, v58
    s_nop 1
    v_mfma_f32_16x16x32_bf16 v[52:55], v[88:91], v[112:115], v[52:55]
    s_waitcnt lgkmcnt(2)
    v_permlane32_swap_b32 v58, v56
    v_mfma_f32_16x16x32_bf16 v[52:55], v[92:95], v[116:119], v[52:55]
    s_waitcnt lgkmcnt(0)
    v_max_f32 v58, v58, v56
    v_mfma_f32_16x16x32_bf16 v[52:55], v[96:99], v[20:23], v[52:55]
    s_add_u32 s26, s32, s59
    s_add_u32 s27, s32, s60
    s_waitcnt vmcnt(5)
    s_nop 4
    v_max3_f32 v62, v52, v53, v54
    v_max3_f32 v62, v62, v55, v58
    v_mov_b32 v56, v62
    s_nop 1
    v_permlane16_swap_b32 v62, v56
    v_max_f32 v62, v62, v56
    v_mul_f32 v62, s48, v62
    v_fma_f32 v44, v44, s48, -v62
    v_fma_f32 v45, v45, s48, -v62
    v_fma_f32 v46, v46, s48, -v62
    v_fma_f32 v47, v47, s48, -v62
    v_fma_f32 v52, v52, s48, -v62
    v_fma_f32 v53, v53, s48, -v62
    v_fma_f32 v54, v54, s48, -v62
    v_fma_f32 v55, v55, s48, -v62
    v_exp_f32 v44, v44
    v_exp_f32 v45, v45
    v_exp_f32 v46, v46
    v_exp_f32 v47, v47
    v_exp_f32 v52, v52
    v_exp_f32 v53, v53
    v_exp_f32 v54, v54
    v_exp_f32 v55, v55
    v_add_f32 v59, v44, v45
    v_add_f32 v56, v46, v47
    v_add_f32 v57, v52, v53
    v_add_f32 v62, v54, v55
    v_add_f32 v59, v59, v56
    v_add_f32 v57, v57, v62
    v_fmac_f32 v59, 0x3e800000, v57
    s_nop 1
    v_add_f32_dpp v59, v59, v59 row_ror:8 row_mask:0xf bank_mask:0xf
    v_mov_b32 v56, v59
    s_nop 1
    v_permlane16_swap_b32 v59, v56
    v_add_f32 v59, v59, v56
    v_mov_b32 v56, v59
    s_nop 1
    v_permlane32_swap_b32 v59, v56
    v_add_f32 v59, v59, v56
    v_rcp_f32 v59, v59
    s_cmp_eq_u32 s25, 0
    v_mul_f32 v44, v44, v59
    v_mul_f32 v45, v45, v59
    v_mul_f32 v46, v46, v59
    v_mul_f32 v47, v47, v59
    v_cvt_pk_bf16_f32 v64, v44, v45
    v_cvt_pk_bf16_f32 v65, v46, v47
    s_cmp_eq_u32 s25, 0
    s_cbranch_scc1 ds_s_160
    buffer_store_dwordx2 v[64:65], v16, s[4:7], s26 offen
ds_e_161:
    v_mul_f32 v52, v52, v59
    v_mul_f32 v53, v53, v59
    v_mul_f32 v54, v54, v59
    v_mul_f32 v55, v55, v59
    v_cvt_pk_bf16_f32 v52, v52, v53
    v_cvt_pk_bf16_f32 v53, v54, v55
    s_cmp_eq_u32 s25, 0
    s_cbranch_scc1 ds_s_162
    s_mov_b64 exec, s[52:53]
    buffer_store_dwordx2 v[52:53], v11, s[4:7], s27 offen
    s_mov_b64 exec, -1
ds_e_163:
    s_add_u32 s26, s32, s61
    s_add_u32 s27, s32, s62
    s_add_u32 s58, s30, s63
    v_mov_b64 v[28:29], 0
    v_mov_b64 v[30:31], 0
    s_mov_b64 s[12:13], -1
    s_mov_b64 s[14:15], -1
    s_mov_b64 s[16:17], s[50:51]
    s_mov_b64 s[18:19], -1
    s_sleep 2
    s_barrier
GB_164:
    s_sub_u32 s28, s28, 1
    s_cbranch_scc1 GB_164_dead
    s_mov_b64 exec, s[12:13]
    buffer_load_dwordx4 v[20:23], v3, s[4:7], s26 offen offset:0 sc1
    s_mov_b64 exec, s[14:15]
    buffer_load_dwordx4 v[24:27], v3, s[4:7], s26 offen offset:1024 sc1
    s_mov_b64 exec, s[16:17]
    buffer_load_dwordx4 v[28:31], v10, s[4:7], s27 offen sc1
    s_mov_b64 exec, s[18:19]
    buffer_load_dwordx4 v[48:51], v3, s[4:7], s58 offen sc1
    s_mov_b64 exec, -1
    s_waitcnt vmcnt(4)
    ds_read_b128 v[100:103], v15 offset:0
    ds_read_b128 v[104:107], v15 offset:1024
    ds_read_b128 v[108:111], v15 offset:2048
    ds_read_b128 v[112:115], v15 offset:3072
    s_waitcnt vmcnt(2) lgkmcnt(0)
    v_mfma_f32_16x16x32_bf16 v[40:43], v[104:107], v[20:23], 0
    v_max_u32 v32, v20, v22
    v_mfma_f32_16x16x32_bf16 v[68:71], v[100:103], v[20:23], 0
    v_max_u32 v33, v24, v26
    v_mfma_f32_16x16x32_bf16 v[40:43], v[112:115], v[24:27], v[40:43]
    v_cmp_eq_u32 s[12:13], -1, v32
    v_mfma_f32_16x16x32_bf16 v[68:71], v[108:111], v[24:27], v[68:71]
    v_cmp_eq_u32 s[14:15], -1, v33
    s_waitcnt vmcnt(0)
    v_mfma_f32_16x16x32_bf16 v[68:71], v[48:51], v[28:31], v[68:71]
    v_max_u32 v34, v28, v30
    v_max_u32 v35, v48, v50
    v_cmp_eq_u32 s[16:17], -1, v34
    v_cmp_eq_u32 s[18:19], -1, v35
    s_or_b64 vcc, s[12:13], s[14:15]
    s_or_b64 vcc, vcc, s[16:17]
    s_or_b64 vcc, vcc, s[18:19]
    s_cbranch_scc1 GB_164
GB_164_ok:
    s_nop 0
    v_add_f32_dpp v68, v40, v68 row_ror:8 row_mask:0xf bank_mask:0xf
    v_add_f32_dpp v69, v41, v69 row_ror:8 row_mask:0xf bank_mask:0xf
    v_add_f32_dpp v70, v42, v70 row_ror:8 row_mask:0xf bank_mask:0xf
    v_add_f32_dpp v71, v43, v71 row_ror:8 row_mask:0xf bank_mask:0xf
    ds_write_b128 v126, v[68:71] offset:28672
    s_waitcnt lgkmcnt(0)
    s_barrier
    ds_read_b128 v[20:23], v12 offset:0
    ds_read_b128 v[24:27], v12 offset:1024
    ds_read_b128 v[28:31], v12 offset:2048
    ds_read_b128 v[32:35], v12 offset:3072
    s_waitcnt lgkmcnt(2)
    v_add_f32 v20, v20, v24
    v_add_f32 v21, v21, v25
    v_add_f32 v22, v22, v26
    v_add_f32 v23, v23, v27
    s_waitcnt lgkmcnt(1)
    v_add_f32 v20, v20, v28
    v_add_f32 v21, v21, v29
    v_add_f32 v22, v22, v30
    v_add_f32 v23, v23, v31
    s_waitcnt lgkmcnt(0)
    v_add_f32 v20, v20, v32
    v_add_f32 v21, v21, v33
    v_add_f32 v22, v22, v34
    v_add_f32 v23, v23, v35
    v_cvt_pk_bf16_f32 v44, v20, v21
    v_cvt_pk_bf16_f32 v45, v22, v23
    v_mov_b64 v[46:47], v[44:45]
    s_nop 1
    v_permlane16_swap_b32 v44, v46
    v_permlane16_swap_b32 v45, v47
    s_mov_b32 exec_lo, 0x000000ff
    s_mov_b32 exec_hi, 0x000000ff
    buffer_store_dwordx4 v[44:47], v14, s[4:7], s37 offen sc0 sc1
    s_cmp_eq_u32 s25, 0
    s_cbranch_scc1 ds_s_165
    buffer_store_dwordx4 v[44:47], v14, s[4:7], s35 offen
ds_e_166:
    s_mov_b64 exec, -1
    s_add_u32 s22, s22, 1
    s_mov_b32 s26, s30
    s_mov_b32 s30, s31
    s_mov_b32 s31, s46
    s_mov_b32 s46, s26
    s_mov_b32 s26, s32
    s_mov_b32 s32, s33
    s_mov_b32 s33, s47
    s_mov_b32 s47, s26
    s_mov_b32 s26, s34
    s_mov_b32 s34, s35
    s_mov_b32 s35, s26
    s_add_u32 s38, s38, 1310720
    s_add_u32 s57, s57, 128
    ds_read_b128 v[76:79], v5 offset:0
    ds_read_b128 v[80:83], v5 offset:1024
    ds_read_b128 v[84:87], v5 offset:2048
    ds_read_b128 v[88:91], v5 offset:3072
    ds_read_b128 v[92:95], v5 offset:4096
    ds_read_b128 v[96:99], v5 offset:5120
    v_mov_b64 v[28:29], 0
    v_mov_b64 v[30:31], 0
    v_mov_b64 v[40:41], 0
    v_mov_b64 v[42:43], 0
    s_add_u32 s10, s34, 4096
    s_add_u32 s11, s34, s65
    s_mov_b64 s[12:13], -1
    s_mov_b64 s[14:15], -1
    s_mov_b64 s[16:17], s[68:69]
    s_mov_b64 s[18:19], -1
    s_mov_b64 s[8:9], -1
    s_mov_b64 s[96:97], s[68:69]
    s_add_u32 s3, s36, 4096
    s_add_u32 s101, s36, s29
    s_sleep 2
    s_barrier
    s_branch CH_top_151
ds_s_156:
    buffer_store_dwordx2 v[120:121], v14, s[4:7], s35 offen sc0 sc1
    s_branch ds_e_157
ds_s_158:
    s_mov_b64 exec, s[50:51]
    buffer_store_dwordx4 v[120:123], v3, s[4:7], s26 offen sc0 sc1
    s_mov_b64 exec, s[52:53]
    buffer_store_dwordx2 v[120:121], v11, s[4:7], s27 offen sc0 sc1
    s_mov_b64 exec, -1
    s_branch ds_e_159
GA_155_dead:
    s_mov_b32 s28, 0
    s_branch GA_155_ok
ds_s_160:
    buffer_store_dwordx2 v[64:65], v16, s[4:7], s26 offen sc0 sc1
    s_branch ds_e_161
ds_s_162:
    s_mov_b64 exec, s[52:53]
    buffer_store_dwordx2 v[52:53], v11, s[4:7], s27 offen sc0 sc1
    s_mov_b64 exec, -1
    s_branch ds_e_163
GB_164_dead:
    s_mov_b32 s28, 0
    s_branch GB_164_ok
ds_s_165:
    buffer_store_dwordx4 v[44:47], v14, s[4:7], s35 offen sc0 sc1
    s_branch ds_e_166
CH_fin_152:
    s_waitcnt vmcnt(0)
    s_barrier
    v_mov_b32 v56, 1
    v_mov_b32 v57, 64
    s_add_u32 s26, s56, 167837696
    s_mov_b64 exec, 1
    buffer_store_dword v57, v0, s[4:7], s26 offen sc0 sc1
    buffer_atomic_add v56, v0, s[4:7], s57 offen offset:128 sc1
    buffer_atomic_add v56, v0, s[4:7], s57 offen offset:256 sc1
    s_mov_b64 exec, -1
    s_branch L_end
L_exit:
    s_endpgm
L_chV:
    s_load_dwordx2 s[8:9], s[0:1], 32
    s_load_dwordx2 s[16:17], s[0:1], 40
    s_load_dwordx2 s[12:13], s[0:1], 8
    s_and_b32 s21, s24, 15
    s_lshl_b32 s26, s23, 4
    s_add_u32 s21, s21, s26
    s_getreg_b32 s25, hwreg(HW_REG_XCC_ID, 0, 4)
    s_lshl_b32 s26, s23, 5
    s_add_u32 s26, s26, s24
    s_lshl_b32 s26, s26, 2
    s_add_u32 s27, s26, 167809024
    s_waitcnt lgkmcnt(0)
    s_and_b32 s9, s9, 0xffff
    s_mov_b32 s10, 7864320
    s_mov_b32 s11, 0x20000
    s_and_b32 s17, s17, 0xffff
    s_mov_b32 s18, 7864320
    s_mov_b32 s19, 0x20000
    s_and_b32 s13, s13, 0xffff
    s_mov_b32 s14, 10240
    s_mov_b32 s15, 0x20000
    s_mul_i32 s66, s21, 384
    s_waitcnt vmcnt(0)
    v_add_u32 v121, 0, v1
    v_mul_u32_u24 v122, 2731, v121
    v_lshrrev_b32 v122, 16, v122
    v_mul_u32_u24 v123, 24, v122
    v_sub_u32 v123, v121, v123
    v_mul_u32_u24 v122, 12288, v122
    v_lshl_add_u32 v116, v123, 4, v122
    v_add_u32 v121, 64, v1
    v_mul_u32_u24 v122, 2731, v121
    v_lshrrev_b32 v122, 16, v122
    v_mul_u32_u24 v123, 24, v122
    v_sub_u32 v123, v121, v123
    v_mul_u32_u24 v122, 12288, v122
    v_lshl_add_u32 v117, v123, 4, v122
    v_add_u32 v121, 128, v1
    v_mul_u32_u24 v122, 2731, v121
    v_lshrrev_b32 v122, 16, v122
    v_mul_u32_u24 v123, 24, v122
    v_sub_u32 v123, v121, v123
    v_mul_u32_u24 v122, 12288, v122
    v_lshl_add_u32 v118, v123, 4, v122
    s_mul_i32 s41, s20, 196608
    s_add_u32 s40, s66, s41
    s_mul_i32 s42, s20, 6144
    v_lshrrev_b32 v121, 4, v1
    v_bfe_u32 v122, v1, 2, 2
    v_lshrrev_b32 v123, 1, v121
    v_and_b32 v121, 1, v121
    v_lshlrev_b32 v121, 2, v121
    v_lshl_add_u32 v121, v123, 4, v121
    v_lshrrev_b32 v123, 1, v122
    v_lshl_add_u32 v121, v123, 3, v121
    v_and_b32 v122, 1, v122
    v_add_u32 v121, v121, v122
    v_mul_u32_u24 v121, 384, v121
    v_and_b32 v122, 3, v1
    v_lshl_add_u32 v121, v122, 3, v121
    s_mul_i32 s41, s20, 96
    v_add_u32 v119, s41, v121
    v_add_u32 v120, 73728, v119
    s_add_u32 m0, s42, 0
    s_add_u32 s41, s40, 0
    buffer_load_dwordx4 v116, s[8:11], s41 offen lds
    s_add_u32 m0, s42, 1024
    s_add_u32 s41, s40, 0
    buffer_load_dwordx4 v117, s[8:11], s41 offen lds
    s_add_u32 m0, s42, 2048
    s_add_u32 s41, s40, 0
    buffer_load_dwordx4 v118, s[8:11], s41 offen lds
    s_add_u32 m0, s42, 3072
    s_add_u32 s41, s40, 98304
    buffer_load_dwordx4 v116, s[8:11], s41 offen lds
    s_add_u32 m0, s42, 4096
    s_add_u32 s41, s40, 98304
    buffer_load_dwordx4 v117, s[8:11], s41 offen lds
    s_add_u32 m0, s42, 5120
    s_add_u32 s41, s40, 98304
    buffer_load_dwordx4 v118, s[8:11], s41 offen lds
    s_add_u32 m0, s42, 24576
    s_add_u32 s41, s40, 786432
    buffer_load_dwordx4 v116, s[8:11], s41 offen lds
    s_add_u32 m0, s42, 25600
    s_add_u32 s41, s40, 786432
    buffer_load_dwordx4 v117, s[8:11], s41 offen lds
    s_add_u32 m0, s42, 26624
    s_add_u32 s41, s40, 786432
    buffer_load_dwordx4 v118, s[8:11], s41 offen lds
    s_add_u32 m0, s42, 27648
    s_add_u32 s41, s40, 884736
    buffer_load_dwordx4 v116, s[8:11], s41 offen lds
    s_add_u32 m0, s42, 28672
    s_add_u32 s41, s40, 884736
    buffer_load_dwordx4 v117, s[8:11], s41 offen lds
    s_add_u32 m0, s42, 29696
    s_add_u32 s41, s40, 884736
    buffer_load_dwordx4 v118, s[8:11], s41 offen lds
    s_add_u32 m0, s42, 49152
    s_add_u32 s41, s40, 1572864
    buffer_load_dwordx4 v116, s[8:11], s41 offen lds
    s_add_u32 m0, s42, 50176
    s_add_u32 s41, s40, 1572864
    buffer_load_dwordx4 v117, s[8:11], s41 offen lds
    s_add_u32 m0, s42, 51200
    s_add_u32 s41, s40, 1572864
    buffer_load_dwordx4 v118, s[8:11], s41 offen lds
    s_add_u32 m0, s42, 52224
    s_add_u32 s41, s40, 1671168
    buffer_load_dwordx4 v116, s[8:11], s41 offen lds
    s_add_u32 m0, s42, 53248
    s_add_u32 s41, s40, 1671168
    buffer_load_dwordx4 v117, s[8:11], s41 offen lds
    s_add_u32 m0, s42, 54272
    s_add_u32 s41, s40, 1671168
    buffer_load_dwordx4 v118, s[8:11], s41 offen lds
    s_add_u32 m0, s42, 73728
    s_add_u32 s41, s40, 2359296
    buffer_load_dwordx4 v116, s[8:11], s41 offen lds
    s_add_u32 m0, s42, 74752
    s_add_u32 s41, s40, 2359296
    buffer_load_dwordx4 v117, s[8:11], s41 offen lds
    s_add_u32 m0, s42, 75776
    s_add_u32 s41, s40, 2359296
    buffer_load_dwordx4 v118, s[8:11], s41 offen lds
    s_add_u32 m0, s42, 76800
    s_add_u32 s41, s40, 2457600
    buffer_load_dwordx4 v116, s[8:11], s41 offen lds
    s_add_u32 m0, s42, 77824
    s_add_u32 s41, s40, 2457600
    buffer_load_dwordx4 v117, s[8:11], s41 offen lds
    s_add_u32 m0, s42, 78848
    s_add_u32 s41, s40, 2457600
    buffer_load_dwordx4 v118, s[8:11], s41 offen lds
    s_add_u32 m0, s42, 98304
    s_add_u32 s41, s40, 3145728
    buffer_load_dwordx4 v116, s[8:11], s41 offen lds
    s_add_u32 m0, s42, 99328
    s_add_u32 s41, s40, 3145728
    buffer_load_dwordx4 v117, s[8:11], s41 offen lds
    s_add_u32 m0, s42, 100352
    s_add_u32 s41, s40, 3145728
    buffer_load_dwordx4 v118, s[8:11], s41 offen lds
    s_add_u32 m0, s42, 101376
    s_add_u32 s41, s40, 3244032
    buffer_load_dwordx4 v116, s[8:11], s41 offen lds
    s_add_u32 m0, s42, 102400
    s_add_u32 s41, s40, 3244032
    buffer_load_dwordx4 v117, s[8:11], s41 offen lds
    s_add_u32 m0, s42, 103424
    s_add_u32 s41, s40, 3244032
    buffer_load_dwordx4 v118, s[8:11], s41 offen lds
    s_waitcnt vmcnt(24)
    s_barrier
    s_add_u32 m0, s42, 122880
    s_add_u32 s41, s40, 3932160
    buffer_load_dwordx4 v116, s[8:11], s41 offen lds
    s_add_u32 m0, s42, 123904
    s_add_u32 s41, s40, 3932160
    buffer_load_dwordx4 v117, s[8:11], s41 offen lds
    s_add_u32 m0, s42, 124928
    s_add_u32 s41, s40, 3932160
    buffer_load_dwordx4 v118, s[8:11], s41 offen lds
    s_add_u32 m0, s42, 125952
    s_add_u32 s41, s40, 4030464
    buffer_load_dwordx4 v116, s[8:11], s41 offen lds
    s_add_u32 m0, s42, 126976
    s_add_u32 s41, s40, 4030464
    buffer_load_dwordx4 v117, s[8:11], s41 offen lds
    s_add_u32 m0, s42, 128000
    s_add_u32 s41, s40, 4030464
    buffer_load_dwordx4 v118, s[8:11], s41 offen lds
    ds_read_b64_tr_b16 a[0:1], v119 offset:0
    ds_read_b64_tr_b16 a[2:3], v119 offset:768
    ds_read_b64_tr_b16 a[8:9], v119 offset:32
    ds_read_b64_tr_b16 a[10:11], v119 offset:800
    ds_read_b64_tr_b16 a[128:129], v119 offset:64
    ds_read_b64_tr_b16 a[130:131], v119 offset:832
    ds_read_b64_tr_b16 a[4:5], v119 offset:12288
    ds_read_b64_tr_b16 a[6:7], v119 offset:13056
    ds_read_b64_tr_b16 a[12:13], v119 offset:12320
    ds_read_b64_tr_b16 a[14:15], v119 offset:13088
    ds_read_b64_tr_b16 a[132:133], v119 offset:12352
    ds_read_b64_tr_b16 a[134:135], v119 offset:13120
    s_waitcnt lgkmcnt(0)
    s_waitcnt vmcnt(24)
    s_barrier
    s_add_u32 m0, s42, 0
    s_add_u32 s41, s40, 4718592
    buffer_load_dwordx4 v116, s[8:11], s41 offen lds
    s_add_u32 m0, s42, 1024
    s_add_u32 s41, s40, 4718592
    buffer_load_dwordx4 v117, s[8:11], s41 offen lds
    s_add_u32 m0, s42, 2048
    s_add_u32 s41, s40, 4718592
    buffer_load_dwordx4 v118, s[8:11], s41 offen lds
    s_add_u32 m0, s42, 3072
    s_add_u32 s41, s40, 4816896
    buffer_load_dwordx4 v116, s[8:11], s41 offen lds
    s_add_u32 m0, s42, 4096
    s_add_u32 s41, s40, 4816896
    buffer_load_dwordx4 v117, s[8:11], s41 offen lds
    s_add_u32 m0, s42, 5120
    s_add_u32 s41, s40, 4816896
    buffer_load_dwordx4 v118, s[8:11], s41 offen lds
    ds_read_b64_tr_b16 a[16:17], v119 offset:24576
    ds_read_b64_tr_b16 a[18:19], v119 offset:25344
    ds_read_b64_tr_b16 a[24:25], v119 offset:24608
    ds_read_b64_tr_b16 a[26:27], v119 offset:25376
    ds_read_b64_tr_b16 a[136:137], v119 offset:24640
    ds_read_b64_tr_b16 a[138:139], v119 offset:25408
    ds_read_b64_tr_b16 a[20:21], v119 offset:36864
    ds_read_b64_tr_b16 a[22:23], v119 offset:37632
    ds_read_b64_tr_b16 a[28:29], v119 offset:36896
    ds_read_b64_tr_b16 a[30:31], v119 offset:37664
    ds_read_b64_tr_b16 a[140:141], v119 offset:36928
    ds_read_b64_tr_b16 a[142:143], v119 offset:37696
    s_waitcnt lgkmcnt(0)
    s_waitcnt vmcnt(24)
    s_barrier
    s_add_u32 m0, s42, 24576
    s_add_u32 s41, s40, 5505024
    buffer_load_dwordx4 v116, s[8:11], s41 offen lds
    s_add_u32 m0, s42, 25600
    s_add_u32 s41, s40, 5505024
    buffer_load_dwordx4 v117, s[8:11], s41 offen lds
    s_add_u32 m0, s42, 26624
    s_add_u32 s41, s40, 5505024
    buffer_load_dwordx4 v118, s[8:11], s41 offen lds
    s_add_u32 m0, s42, 27648
    s_add_u32 s41, s40, 5603328
    buffer_load_dwordx4 v116, s[8:11], s41 offen lds
    s_add_u32 m0, s42, 28672
    s_add_u32 s41, s40, 5603328
    buffer_load_dwordx4 v117, s[8:11], s41 offen lds
    s_add_u32 m0, s42, 29696
    s_add_u32 s41, s40, 5603328
    buffer_load_dwordx4 v118, s[8:11], s41 offen lds
    ds_read_b64_tr_b16 v[20:21], v119 offset:49152
    ds_read_b64_tr_b16 v[22:23], v119 offset:49920
    ds_read_b64_tr_b16 a[32:33], v119 offset:49184
    ds_read_b64_tr_b16 a[34:35], v119 offset:49952
    ds_read_b64_tr_b16 a[144:145], v119 offset:49216
    ds_read_b64_tr_b16 a[146:147], v119 offset:49984
    ds_read_b64_tr_b16 v[24:25], v119 offset:61440
    ds_read_b64_tr_b16 v[26:27], v119 offset:62208
    ds_read_b64_tr_b16 a[36:37], v119 offset:61472
    ds_read_b64_tr_b16 a[38:39], v119 offset:62240
    ds_read_b64_tr_b16 a[148:149], v119 offset:61504
    ds_read_b64_tr_b16 a[150:151], v119 offset:62272
    s_waitcnt lgkmcnt(0)
    s_waitcnt vmcnt(24)
    s_barrier
    s_add_u32 m0, s42, 49152
    s_add_u32 s41, s40, 6291456
    buffer_load_dwordx4 v116, s[8:11], s41 offen lds
    s_add_u32 m0, s42, 50176
    s_add_u32 s41, s40, 6291456
    buffer_load_dwordx4 v117, s[8:11], s41 offen lds
    s_add_u32 m0, s42, 51200
    s_add_u32 s41, s40, 6291456
    buffer_load_dwordx4 v118, s[8:11], s41 offen lds
    s_add_u32 m0, s42, 52224
    s_add_u32 s41, s40, 6389760
    buffer_load_dwordx4 v116, s[8:11], s41 offen lds
    s_add_u32 m0, s42, 53248
    s_add_u32 s41, s40, 6389760
    buffer_load_dwordx4 v117, s[8:11], s41 offen lds
    s_add_u32 m0, s42, 54272
    s_add_u32 s41, s40, 6389760
    buffer_load_dwordx4 v118, s[8:11], s41 offen lds
    ds_read_b64_tr_b16 a[40:41], v120 offset:0
    ds_read_b64_tr_b16 a[42:43], v120 offset:768
    ds_read_b64_tr_b16 a[48:49], v120 offset:32
    ds_read_b64_tr_b16 a[50:51], v120 offset:800
    ds_read_b64_tr_b16 a[152:153], v120 offset:64
    ds_read_b64_tr_b16 a[154:155], v120 offset:832
    ds_read_b64_tr_b16 a[44:45], v120 offset:12288
    ds_read_b64_tr_b16 a[46:47], v120 offset:13056
    ds_read_b64_tr_b16 a[52:53], v120 offset:12320
    ds_read_b64_tr_b16 a[54:55], v120 offset:13088
    ds_read_b64_tr_b16 a[156:157], v120 offset:12352
    ds_read_b64_tr_b16 a[158:159], v120 offset:13120
    s_waitcnt lgkmcnt(0)
    s_waitcnt vmcnt(24)
    s_barrier
    s_add_u32 m0, s42, 73728
    s_add_u32 s41, s40, 7077888
    buffer_load_dwordx4 v116, s[8:11], s41 offen lds
    s_add_u32 m0, s42, 74752
    s_add_u32 s41, s40, 7077888
    buffer_load_dwordx4 v117, s[8:11], s41 offen lds
    s_add_u32 m0, s42, 75776
    s_add_u32 s41, s40, 7077888
    buffer_load_dwordx4 v118, s[8:11], s41 offen lds
    s_add_u32 m0, s42, 76800
    s_add_u32 s41, s40, 7176192
    buffer_load_dwordx4 v116, s[8:11], s41 offen lds
    s_add_u32 m0, s42, 77824
    s_add_u32 s41, s40, 7176192
    buffer_load_dwordx4 v117, s[8:11], s41 offen lds
    s_add_u32 m0, s42, 78848
    s_add_u32 s41, s40, 7176192
    buffer_load_dwordx4 v118, s[8:11], s41 offen lds
    ds_read_b64_tr_b16 a[56:57], v120 offset:24576
    ds_read_b64_tr_b16 a[58:59], v120 offset:25344
    ds_read_b64_tr_b16 v[28:29], v120 offset:24608
    ds_read_b64_tr_b16 v[30:31], v120 offset:25376
    ds_read_b64_tr_b16 v[52:53], v120 offset:24640
    ds_read_b64_tr_b16 v[54:55], v120 offset:25408
    ds_read_b64_tr_b16 a[60:61], v120 offset:36864
    ds_read_b64_tr_b16 a[62:63], v120 offset:37632
    ds_read_b64_tr_b16 v[32:33], v120 offset:36896
    ds_read_b64_tr_b16 v[34:35], v120 offset:37664
    ds_read_b64_tr_b16 v[56:57], v120 offset:36928
    ds_read_b64_tr_b16 v[58:59], v120 offset:37696
    s_waitcnt lgkmcnt(0)
    s_waitcnt vmcnt(24)
    s_barrier
    ds_read_b64_tr_b16 a[64:65], v120 offset:49152
    ds_read_b64_tr_b16 a[66:67], v120 offset:49920
    ds_read_b64_tr_b16 a[72:73], v120 offset:49184
    ds_read_b64_tr_b16 a[74:75], v120 offset:49952
    ds_read_b64_tr_b16 a[160:161], v120 offset:49216
    ds_read_b64_tr_b16 a[162:163], v120 offset:49984
    ds_read_b64_tr_b16 a[68:69], v120 offset:61440
    ds_read_b64_tr_b16 a[70:71], v120 offset:62208
    ds_read_b64_tr_b16 a[76:77], v120 offset:61472
    ds_read_b64_tr_b16 a[78:79], v120 offset:62240
    ds_read_b64_tr_b16 a[164:165], v120 offset:61504
    ds_read_b64_tr_b16 a[166:167], v120 offset:62272
    s_waitcnt lgkmcnt(0)
    s_waitcnt vmcnt(18)
    s_barrier
    ds_read_b64_tr_b16 a[80:81], v119 offset:0
    ds_read_b64_tr_b16 a[82:83], v119 offset:768
    ds_read_b64_tr_b16 a[88:89], v119 offset:32
    ds_read_b64_tr_b16 a[90:91], v119 offset:800
    ds_read_b64_tr_b16 a[168:169], v119 offset:64
    ds_read_b64_tr_b16 a[170:171], v119 offset:832
    ds_read_b64_tr_b16 a[84:85], v119 offset:12288
    ds_read_b64_tr_b16 a[86:87], v119 offset:13056
    ds_read_b64_tr_b16 a[92:93], v119 offset:12320
    ds_read_b64_tr_b16 a[94:95], v119 offset:13088
    ds_read_b64_tr_b16 a[172:173], v119 offset:12352
    ds_read_b64_tr_b16 a[174:175], v119 offset:13120
    s_waitcnt lgkmcnt(0)
    s_waitcnt vmcnt(12)
    s_barrier
    ds_read_b64_tr_b16 v[36:37], v119 offset:24576
    ds_read_b64_tr_b16 v[38:39], v119 offset:25344
    ds_read_b64_tr_b16 a[96:97], v119 offset:24608
    ds_read_b64_tr_b16 a[98:99], v119 offset:25376
    ds_read_b64_tr_b16 a[176:177], v119 offset:24640
    ds_read_b64_tr_b16 a[178:179], v119 offset:25408
    ds_read_b64_tr_b16 v[40:41], v119 offset:36864
    ds_read_b64_tr_b16 v[42:43], v119 offset:37632
    ds_read_b64_tr_b16 a[100:101], v119 offset:36896
    ds_read_b64_tr_b16 a[102:103], v119 offset:37664
    ds_read_b64_tr_b16 a[180:181], v119 offset:36928
    ds_read_b64_tr_b16 a[182:183], v119 offset:37696
    s_waitcnt lgkmcnt(0)
    s_waitcnt vmcnt(6)
    s_barrier
    ds_read_b64_tr_b16 a[104:105], v119 offset:49152
    ds_read_b64_tr_b16 a[106:107], v119 offset:49920
    ds_read_b64_tr_b16 a[112:113], v119 offset:49184
    ds_read_b64_tr_b16 a[114:115], v119 offset:49952
    ds_read_b64_tr_b16 a[184:185], v119 offset:49216
    ds_read_b64_tr_b16 a[186:187], v119 offset:49984
    ds_read_b64_tr_b16 a[108:109], v119 offset:61440
    ds_read_b64_tr_b16 a[110:111], v119 offset:62208
    ds_read_b64_tr_b16 a[116:117], v119 offset:61472
    ds_read_b64_tr_b16 a[118:119], v119 offset:62240
    ds_read_b64_tr_b16 a[188:189], v119 offset:61504
    ds_read_b64_tr_b16 a[190:191], v119 offset:62272
    s_waitcnt lgkmcnt(0)
    v_mov_b32 v125, 0
    global_load_dword v124, v125, s[98:99] sc1
    s_waitcnt vmcnt(0)
    s_barrier
    ds_read_b64_tr_b16 a[120:121], v120 offset:0
    ds_read_b64_tr_b16 a[122:123], v120 offset:768
    ds_read_b64_tr_b16 v[44:45], v120 offset:32
    ds_read_b64_tr_b16 v[46:47], v120 offset:800
    ds_read_b64_tr_b16 v[60:61], v120 offset:64
    ds_read_b64_tr_b16 v[62:63], v120 offset:832
    ds_read_b64_tr_b16 a[124:125], v120 offset:12288
    ds_read_b64_tr_b16 a[126:127], v120 offset:13056
    ds_read_b64_tr_b16 v[48:49], v120 offset:12320
    ds_read_b64_tr_b16 v[50:51], v120 offset:13088
    ds_read_b64_tr_b16 v[64:65], v120 offset:12352
    ds_read_b64_tr_b16 v[66:67], v120 offset:13120
    s_waitcnt lgkmcnt(0)
    s_barrier
    s_mul_i32 s66, s21, 245760
    v_lshlrev_b32 v116, 4, v1
    s_mul_i32 s42, s20, 10240
    s_add_u32 s40, s66, s42
    s_lshr_b32 s41, s20, 1
    s_mul_i32 s41, s41, 40960
    s_add_u32 s43, s40, s41
    v_lshrrev_b32 v121, 4, v1
    v_bfe_u32 v122, v1, 2, 2
    v_and_b32 v123, 3, v1
    v_lshlrev_b32 v123, 3, v123
    s_mul_i32 s41, s20, 320
    v_add_u32 v123, s41, v123
    v_lshrrev_b32 v117, 1, v121
    v_and_b32 v121, 1, v121
    v_lshlrev_b32 v121, 2, v121
    v_lshl_add_u32 v121, v117, 4, v121
    v_lshrrev_b32 v117, 1, v122
    v_lshl_add_u32 v121, v117, 3, v121
    v_and_b32 v122, 1, v122
    v_add_u32 v121, v121, v122
    v_mul_u32_u24 v117, 1280, v121
    v_add_u32 v117, v117, v123
    v_mov_b32 v118, v117
    s_add_u32 s41, s40, 0
    s_add_u32 m0, s42, 0
    s_nop 0
    buffer_load_dwordx4 v116, s[16:19], s41 offen offset:0 lds
    buffer_load_dwordx4 v116, s[16:19], s41 offen offset:1024 lds
    buffer_load_dwordx4 v116, s[16:19], s41 offen offset:2048 lds
    buffer_load_dwordx4 v116, s[16:19], s41 offen offset:3072 lds
    s_add_u32 m0, s42, 4096
    s_add_u32 s41, s41, 4096
    buffer_load_dwordx4 v116, s[16:19], s41 offen offset:0 lds
    buffer_load_dwordx4 v116, s[16:19], s41 offen offset:1024 lds
    buffer_load_dwordx4 v116, s[16:19], s41 offen offset:2048 lds
    buffer_load_dwordx4 v116, s[16:19], s41 offen offset:3072 lds
    s_add_u32 m0, s42, 8192
    s_add_u32 s41, s41, 4096
    buffer_load_dwordx4 v116, s[16:19], s41 offen offset:0 lds
    buffer_load_dwordx4 v116, s[16:19], s41 offen offset:1024 lds
    s_add_u32 s41, s40, 61440
    s_add_u32 m0, s42, 40960
    s_nop 0
    buffer_load_dwordx4 v116, s[16:19], s41 offen offset:0 lds
    buffer_load_dwordx4 v116, s[16:19], s41 offen offset:1024 lds
    buffer_load_dwordx4 v116, s[16:19], s41 offen offset:2048 lds
    buffer_load_dwordx4 v116, s[16:19], s41 offen offset:3072 lds
    s_add_u32 m0, s42, 45056
    s_add_u32 s41, s41, 4096
    buffer_load_dwordx4 v116, s[16:19], s41 offen offset:0 lds
    buffer_load_dwordx4 v116, s[16:19], s41 offen offset:1024 lds
    buffer_load_dwordx4 v116, s[16:19], s41 offen offset:2048 lds
    buffer_load_dwordx4 v116, s[16:19], s41 offen offset:3072 lds
    s_add_u32 m0, s42, 49152
    s_add_u32 s41, s41, 4096
    buffer_load_dwordx4 v116, s[16:19], s41 offen offset:0 lds
    buffer_load_dwordx4 v116, s[16:19], s41 offen offset:1024 lds
    s_add_u32 s41, s40, 122880
    s_add_u32 m0, s42, 81920
    s_nop 0
    buffer_load_dwordx4 v116, s[16:19], s41 offen offset:0 lds
    buffer_load_dwordx4 v116, s[16:19], s41 offen offset:1024 lds
    buffer_load_dwordx4 v116, s[16:19], s41 offen offset:2048 lds
    buffer_load_dwordx4 v116, s[16:19], s41 offen offset:3072 lds
    s_add_u32 m0, s42, 86016
    s_add_u32 s41, s41, 4096
    buffer_load_dwordx4 v116, s[16:19], s41 offen offset:0 lds
    buffer_load_dwordx4 v116, s[16:19], s41 offen offset:1024 lds
    buffer_load_dwordx4 v116, s[16:19], s41 offen offset:2048 lds
    buffer_load_dwordx4 v116, s[16:19], s41 offen offset:3072 lds
    s_add_u32 m0, s42, 90112
    s_add_u32 s41, s41, 4096
    buffer_load_dwordx4 v116, s[16:19], s41 offen offset:0 lds
    buffer_load_dwordx4 v116, s[16:19], s41 offen offset:1024 lds
    s_waitcnt vmcnt(20)
    s_barrier
    s_add_u32 s41, s40, 184320
    s_add_u32 m0, s42, 122880
    s_nop 0
    buffer_load_dwordx4 v116, s[16:19], s41 offen offset:0 lds
    buffer_load_dwordx4 v116, s[16:19], s41 offen offset:1024 lds
    buffer_load_dwordx4 v116, s[16:19], s41 offen offset:2048 lds
    buffer_load_dwordx4 v116, s[16:19], s41 offen offset:3072 lds
    s_add_u32 m0, s42, 126976
    s_add_u32 s41, s41, 4096
    buffer_load_dwordx4 v116, s[16:19], s41 offen offset:0 lds
    buffer_load_dwordx4 v116, s[16:19], s41 offen offset:1024 lds
    buffer_load_dwordx4 v116, s[16:19], s41 offen offset:2048 lds
    buffer_load_dwordx4 v116, s[16:19], s41 offen offset:3072 lds
    s_add_u32 m0, s42, 131072
    s_add_u32 s41, s41, 4096
    buffer_load_dwordx4 v116, s[16:19], s41 offen offset:0 lds
    buffer_load_dwordx4 v116, s[16:19], s41 offen offset:1024 lds
    v_add_u32 v119, 0, v117
    ds_read_b64_tr_b16 a[192:193], v119 offset:0
    ds_read_b64_tr_b16 a[194:195], v119 offset:2560
    ds_read_b64_tr_b16 a[208:209], v119 offset:32
    ds_read_b64_tr_b16 a[210:211], v119 offset:2592
    ds_read_b64_tr_b16 v[68:69], v119 offset:64
    ds_read_b64_tr_b16 v[70:71], v119 offset:2624
    ds_read_b64_tr_b16 a[232:233], v119 offset:96
    ds_read_b64_tr_b16 a[234:235], v119 offset:2656
    ds_read_b64_tr_b16 a[248:249], v119 offset:128
    ds_read_b64_tr_b16 a[250:251], v119 offset:2688
    ds_read_b64_tr_b16 v[128:129], v119 offset:160
    ds_read_b64_tr_b16 v[130:131], v119 offset:2720
    ds_read_b64_tr_b16 v[168:169], v119 offset:192
    ds_read_b64_tr_b16 v[170:171], v119 offset:2752
    s_waitcnt lgkmcnt(0)
    ds_read_b64_tr_b16 v[92:93], v119 offset:224
    ds_read_b64_tr_b16 v[94:95], v119 offset:2784
    ds_read_b64_tr_b16 v[208:209], v119 offset:256
    ds_read_b64_tr_b16 v[210:211], v119 offset:2816
    ds_read_b64_tr_b16 v[224:225], v119 offset:288
    ds_read_b64_tr_b16 v[226:227], v119 offset:2848
    s_waitcnt lgkmcnt(0)
    s_waitcnt vmcnt(20)
    s_barrier
    s_add_u32 s41, s43, 40960
    s_add_u32 m0, s42, 0
    s_nop 0
    buffer_load_dwordx4 v116, s[16:19], s41 offen offset:0 lds
    buffer_load_dwordx4 v116, s[16:19], s41 offen offset:1024 lds
    buffer_load_dwordx4 v116, s[16:19], s41 offen offset:2048 lds
    buffer_load_dwordx4 v116, s[16:19], s41 offen offset:3072 lds
    s_add_u32 m0, s42, 4096
    s_add_u32 s41, s41, 4096
    buffer_load_dwordx4 v116, s[16:19], s41 offen offset:0 lds
    buffer_load_dwordx4 v116, s[16:19], s41 offen offset:1024 lds
    buffer_load_dwordx4 v116, s[16:19], s41 offen offset:2048 lds
    buffer_load_dwordx4 v116, s[16:19], s41 offen offset:3072 lds
    s_add_u32 m0, s42, 8192
    s_add_u32 s41, s41, 4096
    buffer_load_dwordx4 v116, s[16:19], s41 offen offset:0 lds
    buffer_load_dwordx4 v116, s[16:19], s41 offen offset:1024 lds
    v_add_u32 v119, 40960, v117
    ds_read_b64_tr_b16 a[196:197], v119 offset:0
    ds_read_b64_tr_b16 a[198:199], v119 offset:2560
    ds_read_b64_tr_b16 a[212:213], v119 offset:32
    ds_read_b64_tr_b16 a[214:215], v119 offset:2592
    ds_read_b64_tr_b16 v[72:73], v119 offset:64
    ds_read_b64_tr_b16 v[74:75], v119 offset:2624
    ds_read_b64_tr_b16 a[236:237], v119 offset:96
    ds_read_b64_tr_b16 a[238:239], v119 offset:2656
    ds_read_b64_tr_b16 a[252:253], v119 offset:128
    ds_read_b64_tr_b16 a[254:255], v119 offset:2688
    ds_read_b64_tr_b16 v[132:133], v119 offset:160
    ds_read_b64_tr_b16 v[134:135], v119 offset:2720
    ds_read_b64_tr_b16 v[172:173], v119 offset:192
    ds_read_b64_tr_b16 v[174:175], v119 offset:2752
    s_waitcnt lgkmcnt(0)
    ds_read_b64_tr_b16 v[96:97], v119 offset:224
    ds_read_b64_tr_b16 v[98:99], v119 offset:2784
    ds_read_b64_tr_b16 v[212:213], v119 offset:256
    ds_read_b64_tr_b16 v[214:215], v119 offset:2816
    ds_read_b64_tr_b16 v[228:229], v119 offset:288
    ds_read_b64_tr_b16 v[230:231], v119 offset:2848
    s_waitcnt lgkmcnt(0)
iw_lp_168:
    v_cmp_gt_u32 vcc, 27, v124
    s_cbranch_vccz iw_ok_167
    s_cmp_eq_u32 s100, 0
    s_cbranch_scc1 iw_ok_167
    s_sub_u32 s100, s100, 1
    s_sleep 2
    global_load_dword v124, v125, s[98:99] sc1
    s_waitcnt vmcnt(0)
    s_branch iw_lp_168
iw_ok_167:
    s_cmp_lg_u32 s20, 0
    s_cbranch_scc1 pf_169
    v_mov_b32 v126, s25
    v_mov_b32 v127, 0
    s_mov_b64 exec, 1
    buffer_store_dword v126, v127, s[4:7], s27 offen sc0 sc1
    s_mov_b64 exec, -1
pf_169:
    s_waitcnt vmcnt(20)
    s_barrier
    s_add_u32 s41, s43, 163840
    s_add_u32 m0, s42, 40960
    s_nop 0
    buffer_load_dwordx4 v116, s[16:19], s41 offen offset:0 lds
    buffer_load_dwordx4 v116, s[16:19], s41 offen offset:1024 lds
    buffer_load_dwordx4 v116, s[16:19], s41 offen offset:2048 lds
    buffer_load_dwordx4 v116, s[16:19], s41 offen offset:3072 lds
    s_add_u32 m0, s42, 45056
    s_add_u32 s41, s41, 4096
    buffer_load_dwordx4 v116, s[16:19], s41 offen offset:0 lds
    buffer_load_dwordx4 v116, s[16:19], s41 offen offset:1024 lds
    buffer_load_dwordx4 v116, s[16:19], s41 offen offset:2048 lds
    buffer_load_dwordx4 v116, s[16:19], s41 offen offset:3072 lds
    s_add_u32 m0, s42, 49152
    s_add_u32 s41, s41, 4096
    buffer_load_dwordx4 v116, s[16:19], s41 offen offset:0 lds
    buffer_load_dwordx4 v116, s[16:19], s41 offen offset:1024 lds
    v_add_u32 v119, 81920, v117
    ds_read_b64_tr_b16 a[200:201], v119 offset:0
    ds_read_b64_tr_b16 a[202:203], v119 offset:2560
    ds_read_b64_tr_b16 a[216:217], v119 offset:32
    ds_read_b64_tr_b16 a[218:219], v119 offset:2592
    ds_read_b64_tr_b16 a[224:225], v119 offset:64
    ds_read_b64_tr_b16 a[226:227], v119 offset:2624
    ds_read_b64_tr_b16 a[240:241], v119 offset:96
    ds_read_b64_tr_b16 a[242:243], v119 offset:2656
    ds_read_b64_tr_b16 v[76:77], v119 offset:128
    ds_read_b64_tr_b16 v[78:79], v119 offset:2688
    ds_read_b64_tr_b16 v[136:137], v119 offset:160
    ds_read_b64_tr_b16 v[138:139], v119 offset:2720
    ds_read_b64_tr_b16 v[176:177], v119 offset:192
    ds_read_b64_tr_b16 v[178:179], v119 offset:2752
    s_waitcnt lgkmcnt(0)
    ds_read_b64_tr_b16 v[192:193], v119 offset:224
    ds_read_b64_tr_b16 v[194:195], v119 offset:2784
    ds_read_b64_tr_b16 v[216:217], v119 offset:256
    ds_read_b64_tr_b16 v[218:219], v119 offset:2816
    ds_read_b64_tr_b16 v[232:233], v119 offset:288
    ds_read_b64_tr_b16 v[234:235], v119 offset:2848
    s_waitcnt lgkmcnt(0)
    s_waitcnt vmcnt(20)
    s_barrier
    v_add_u32 v119, 122880, v117
    ds_read_b64_tr_b16 a[204:205], v119 offset:0
    ds_read_b64_tr_b16 a[206:207], v119 offset:2560
    ds_read_b64_tr_b16 a[220:221], v119 offset:32
    ds_read_b64_tr_b16 a[222:223], v119 offset:2592
    ds_read_b64_tr_b16 a[228:229], v119 offset:64
    ds_read_b64_tr_b16 a[230:231], v119 offset:2624
    ds_read_b64_tr_b16 a[244:245], v119 offset:96
    ds_read_b64_tr_b16 a[246:247], v119 offset:2656
    ds_read_b64_tr_b16 v[80:81], v119 offset:128
    ds_read_b64_tr_b16 v[82:83], v119 offset:2688
    ds_read_b64_tr_b16 v[140:141], v119 offset:160
    ds_read_b64_tr_b16 v[142:143], v119 offset:2720
    ds_read_b64_tr_b16 v[180:181], v119 offset:192
    ds_read_b64_tr_b16 v[182:183], v119 offset:2752
    s_waitcnt lgkmcnt(0)
    ds_read_b64_tr_b16 v[196:197], v119 offset:224
    ds_read_b64_tr_b16 v[198:199], v119 offset:2784
    ds_read_b64_tr_b16 v[220:221], v119 offset:256
    ds_read_b64_tr_b16 v[222:223], v119 offset:2816
    ds_read_b64_tr_b16 v[236:237], v119 offset:288
    ds_read_b64_tr_b16 v[238:239], v119 offset:2848
    s_waitcnt lgkmcnt(0)
    s_waitcnt vmcnt(10)
    s_barrier
    v_add_u32 v119, 0, v118
    ds_read_b64_tr_b16 v[144:145], v119 offset:0
    ds_read_b64_tr_b16 v[146:147], v119 offset:2560
    ds_read_b64_tr_b16 v[152:153], v119 offset:32
    ds_read_b64_tr_b16 v[154:155], v119 offset:2592
    ds_read_b64_tr_b16 v[84:85], v119 offset:64
    ds_read_b64_tr_b16 v[86:87], v119 offset:2624
    ds_read_b64_tr_b16 v[160:161], v119 offset:96
    ds_read_b64_tr_b16 v[162:163], v119 offset:2656
    ds_read_b64_tr_b16 v[184:185], v119 offset:128
    ds_read_b64_tr_b16 v[186:187], v119 offset:2688
    ds_read_b64_tr_b16 v[200:201], v119 offset:160
    ds_read_b64_tr_b16 v[202:203], v119 offset:2720
    ds_read_b64_tr_b16 v[100:101], v119 offset:192
    ds_read_b64_tr_b16 v[102:103], v119 offset:2752
    s_waitcnt lgkmcnt(0)
    ds_read_b64_tr_b16 v[240:241], v119 offset:224
    ds_read_b64_tr_b16 v[242:243], v119 offset:2784
    ds_read_b64_tr_b16 v[248:249], v119 offset:256
    ds_read_b64_tr_b16 v[250:251], v119 offset:2816
    ds_read_b64_tr_b16 v[108:109], v119 offset:288
    ds_read_b64_tr_b16 v[110:111], v119 offset:2848
    s_waitcnt lgkmcnt(0)
    s_waitcnt vmcnt(0)
    s_barrier
    v_add_u32 v119, 40960, v118
    ds_read_b64_tr_b16 v[148:149], v119 offset:0
    ds_read_b64_tr_b16 v[150:151], v119 offset:2560
    ds_read_b64_tr_b16 v[156:157], v119 offset:32
    ds_read_b64_tr_b16 v[158:159], v119 offset:2592
    ds_read_b64_tr_b16 v[88:89], v119 offset:64
    ds_read_b64_tr_b16 v[90:91], v119 offset:2624
    ds_read_b64_tr_b16 v[164:165], v119 offset:96
    ds_read_b64_tr_b16 v[166:167], v119 offset:2656
    ds_read_b64_tr_b16 v[188:189], v119 offset:128
    ds_read_b64_tr_b16 v[190:191], v119 offset:2688
    ds_read_b64_tr_b16 v[204:205], v119 offset:160
    ds_read_b64_tr_b16 v[206:207], v119 offset:2720
    ds_read_b64_tr_b16 v[104:105], v119 offset:192
    ds_read_b64_tr_b16 v[106:107], v119 offset:2752
    s_waitcnt lgkmcnt(0)
    ds_read_b64_tr_b16 v[244:245], v119 offset:224
    ds_read_b64_tr_b16 v[246:247], v119 offset:2784
    ds_read_b64_tr_b16 v[252:253], v119 offset:256
    ds_read_b64_tr_b16 v[254:255], v119 offset:2816
    ds_read_b64_tr_b16 v[112:113], v119 offset:288
    ds_read_b64_tr_b16 v[114:115], v119 offset:2848
    s_waitcnt lgkmcnt(0)
    s_barrier
    s_mul_i32 s26, s20, 24576
    v_lshl_add_u32 v5, v1, 4, s26
    ds_write_b128 v5, v[20:23] offset:0
    ds_write_b128 v5, v[24:27] offset:1024
    ds_write_b128 v5, v[28:31] offset:2048
    ds_write_b128 v5, v[32:35] offset:3072
    ds_write_b128 v5, v[36:39] offset:4096
    ds_write_b128 v5, v[40:43] offset:5120
    ds_write_b128 v5, v[44:47] offset:6144
    ds_write_b128 v5, v[48:51] offset:7168
    ds_write_b128 v5, v[52:55] offset:8192
    ds_write_b128 v5, v[56:59] offset:9216
    ds_write_b128 v5, v[60:63] offset:10240
    ds_write_b128 v5, v[64:67] offset:11264
    ds_write_b128 v5, v[68:71] offset:12288
    ds_write_b128 v5, v[72:75] offset:13312
    ds_write_b128 v5, v[76:79] offset:14336
    ds_write_b128 v5, v[80:83] offset:15360
    ds_write_b128 v5, v[84:87] offset:16384
    ds_write_b128 v5, v[88:91] offset:17408
    ds_write_b128 v5, v[92:95] offset:18432
    ds_write_b128 v5, v[96:99] offset:19456
    ds_write_b128 v5, v[100:103] offset:20480
    ds_write_b128 v5, v[104:107] offset:21504
    ds_write_b128 v5, v[108:111] offset:22528
    ds_write_b128 v5, v[112:115] offset:23552
    s_waitcnt lgkmcnt(0)
    v_mov_b32 v118, 0
    global_load_dword v119, v118, s[98:99] offset:4 sc1
    v_mov_b32 v0, 0
    v_and_b32 v112, 15, v1
    v_lshrrev_b32 v113, 4, v1
    v_mov_b32 v2, 0x4444
    v_mov_b32 v114, 0xeeee
    v_and_b32 v3, 1, v1
    v_cmp_eq_u32 vcc, 1, v3
    s_nop 1
    v_cndmask_b32 v2, v2, v114, vcc
    v_lshlrev_b32 v3, 4, v1
    v_add_u32 v4, 98304, v3
    s_mul_i32 s26, s20, 24576
    v_add_u32 v5, s26, v3
    v_and_b32 v114, 7, v112
    v_lshlrev_b32 v114, 5, v114
    v_lshl_add_u32 v114, v113, 3, v114
    v_lshrrev_b32 v6, 3, v112
    v_lshl_add_u32 v114, v6, 1, v114
    s_mul_i32 s26, s20, 512
    s_add_u32 s26, s26, 133120
    v_add_u32 v6, s26, v114
    s_lshl_b32 s26, s20, 8
    s_add_u32 s26, s26, 135168
    v_add_u32 v111, s26, v114
    v_and_b32 v114, 7, v112
    v_lshl_add_u32 v10, v113, 3, v114
    v_lshlrev_b32 v10, 4, v10
    v_lshl_add_u32 v12, v113, 4, v114
    v_lshlrev_b32 v12, 4, v12
    s_and_b32 s26, s24, 1
    s_lshl_b32 s26, s26, 7
    v_add_u32 v124, s26, v12
    v_lshrrev_b32 v17, 3, v112
    v_mul_u32_u24 v17, 40960, v17
    v_add_u32 v17, v17, v124
    s_mul_i32 s26, s20, 6144
    s_add_u32 s26, s26, 112640
    v_add_u32 v18, s26, v12
    v_mov_b32 v12, v3
    v_add_u32 v12, 136192, v12
    s_mul_i32 s54, s20, 6144
    s_add_u32 s54, s54, 108544
    v_add_u32 v15, s54, v3
    s_mul_i32 s26, s20, 1024
    s_add_u32 s26, s26, 136192
    v_add_u32 v16, s26, v3
    v_lshrrev_b32 v14, 1, v113
    s_lshl_b32 s26, s24, 1
    v_add_u32 v14, s26, v14
    s_add_u32 s26, s24, 48
    v_mov_b32 v13, s26
    v_cmp_lt_u32 vcc, 7, v112
    s_nop 1
    v_cndmask_b32 v14, v14, v13, vcc
    v_lshrrev_b32 v13, 3, v112
    v_lshl_add_u32 v13, v13, 9, v10
    v_lshlrev_b32 v14, 7, v14
    v_lshl_add_u32 v14, v114, 4, v14
    v_and_b32 v114, 1, v113
    v_lshl_add_u32 v14, v114, 3, v14
    s_mov_b32 s50, 0x00ff00ff
    s_mov_b32 s51, 0x00ff00ff
    s_mov_b32 s52, 0xffffffff
    s_mov_b32 s53, 0x00ff00ff
    s_lshl_b32 s26, s20, 10
    v_add_u32 v7, s26, v3
    s_lshr_b32 s65, s20, 1
    s_add_u32 s65, s65, 8
    s_sub_u32 s65, s65, s20
    s_lshl_b32 s65, s65, 10
    s_and_b32 s27, s20, 1
    s_sub_u32 s68, s27, 1
    s_sub_u32 s69, 0, s27
    v_and_b32 v19, 7, v1
    v_lshlrev_b32 v19, 5, v19
    v_lshl_add_u32 v19, v113, 8, v19
    v_bfe_u32 v115, v1, 3, 1
    v_lshl_add_u32 v19, v115, 4, v19
    s_add_u32 s26, s26, 98304
    v_add_u32 v19, s26, v19
    v_add_u32 v9, s65, v19
    v_mov_b32 v120, -1
    v_mov_b32 v121, -1
    v_mov_b32 v122, -1
    v_mov_b32 v123, -1
    v_bfe_u32 v115, v1, 2, 2
    v_and_b32 v116, 1, v1
    v_lshlrev_b32 v116, 3, v116
    v_lshl_add_u32 v114, v113, 3, v115
    v_and_b32 v116, 3, v1
    v_lshlrev_b32 v116, 3, v116
    v_lshl_add_u32 v8, v114, 5, v116
    v_add_u32 v8, 133120, v8
    v_lshlrev_b32 v125, 13, v113
    v_and_b32 v114, 1, v113
    v_lshlrev_b32 v126, 13, v114
    v_lshrrev_b32 v114, 1, v113
    v_lshl_add_u32 v126, v114, 3, v126
    s_mul_i32 s26, s20, 81920
    s_lshl_b32 s27, s21, 8
    s_add_u32 s26, s26, s27
    v_lshl_add_u32 v114, v112, 4, s26
    v_add_u32 v125, v125, v114
    v_add_u32 v126, v126, v114
    v_add_u32 v126, 65536, v126
    s_mov_b32 s30, 166723584
    s_mov_b32 s31, 167051264
    s_mov_b32 s32, 167706624
    s_mov_b32 s33, 167727104
    s_mov_b32 s46, 167378944
    s_mov_b32 s47, 167747584
    s_mul_i32 s26, s23, 10240
    s_add_u32 s34, s26, 167768064
    s_add_u32 s35, s26, 167788544
    s_lshl_b32 s26, s23, 14
    s_add_u32 s37, s26, 171966464
    s_sub_u32 s36, 171982848, s26
    s_mul_i32 s26, s23, 14336
    s_add_u32 s29, s26, 10240
    s_add_u32 s29, s29, s65
    s_sub_u32 s26, 24576, s26
    v_add_u32 v110, s26, v14
    v_cmp_lt_u32 vcc, 7, v112
    s_nop 1
    v_cndmask_b32 v110, v14, v110, vcc
    s_mov_b32 s40, 0x00003f80
    s_mov_b32 s41, 0x3f800000
    s_mov_b32 s66, 0
    s_lshl_b32 s26, s23, 2
    s_add_u32 s26, s26, s20
    s_lshl_b32 s61, s26, 11
    s_lshl_b32 s62, s26, 9
    s_add_u32 s62, s62, 16384
    s_lshl_b32 s63, s26, 10
    s_mul_i32 s38, s26, 163840
    s_add_u32 s38, s38, 50331648
    s_sub_u32 s27, s24, 16
    s_lshr_b32 s27, s27, 1
    s_add_u32 s27, s27, 32
    s_lshl_b32 s58, s27, 13
    s_add_u32 s64, s63, s58
    s_lshl_b32 s58, s27, 10
    s_add_u32 s39, s38, s58
    s_lshl_b32 s58, s24, 13
    s_add_u32 s63, s63, s58
    s_lshl_b32 s58, s24, 10
    s_add_u32 s38, s38, s58
    s_mov_b32 s57, 167849728
    s_lshl_b32 s90, s23, 8
    s_add_u32 s90, s90, 167809280
    s_mul_i32 s27, s23, 16256
    s_sub_u32 s100, 36864, s27
    s_add_u32 s99, s27, 20608
    s_lshl_b32 s56, s21, 7
    s_mov_b32 s49, 0
    s_mov_b32 s42, 1
    v_mov_b32 v127, 0
    s_mov_b32 s48, 1037384597
    s_mov_b32 s22, 0
    s_mov_b32 s28, 61000
    s_mov_b32 s45, 134217728
    s_mul_i32 s67, s21, 3072
    s_add_u32 s67, s67, 160431104
    v_and_b32 v20, 31, v1
    v_lshlrev_b32 v20, 2, v20
    s_lshl_b32 s26, s23, 7
    s_add_u32 s26, s26, 167809024
XH_170:
    s_sub_u32 s28, s28, 1
    s_cbranch_scc1 XH_170_dead
    buffer_load_dword v21, v20, s[4:7], s26 offen sc1
    s_waitcnt vmcnt(0)
    v_cmp_eq_u32 vcc, -1, v21
    s_cbranch_vccnz XH_170
XH_170_ok:
    s_branch XJ_171
XH_170_dead:
    s_mov_b32 s28, 0
    s_mov_b64 exec, -1
    s_branch XH_170_ok
XJ_171:
    v_cmp_ne_u32 vcc, s25, v21
    s_cmp_eq_u64 vcc, 0
    s_cselect_b32 s25, 1, 0
    s_mov_b32 s26, 167809024
XN_172:
    s_sub_u32 s28, s28, 1
    s_cbranch_scc1 XN_172_dead
    buffer_load_dword v21, v0, s[4:7], s26 offen sc1
    s_waitcnt vmcnt(0)
    v_cmp_eq_u32 vcc, -1, v21
    s_cbranch_vccnz XN_172
XN_172_ok:
    s_branch XJ_173
XN_172_dead:
    s_mov_b32 s28, 0
    s_mov_b64 exec, -1
    s_branch XN_172_ok
XJ_173:
    v_readfirstlane_b32 s26, v21
    v_readfirstlane_b32 s27, v119
    s_bfe_u32 s26, s26, 0x10002
    s_mul_i32 s26, s26, 3
    s_xor_b32 s27, s27, s26
    s_and_b32 s26, s27, 1
    s_lshl_b32 s26, s26, 13
    s_bfe_u32 s27, s27, 0x10001
    s_lshl_b32 s27, s27, 13
    s_add_u32 s36, s36, s26
    s_add_u32 s37, s37, s26
    s_sub_u32 s27, s27, s26
    s_add_u32 s55, s27, 81920
    v_bfe_u32 v20, v1, 1, 3
    v_mul_u32_u24 v20, 1280, v20
    v_lshrrev_b32 v21, 4, v1
    v_lshl_add_u32 v20, v21, 5, v20
    v_and_b32 v21, 1, v1
    v_lshl_add_u32 v20, v21, 4, v20
    s_lshl_b32 s26, s20, 7
    s_lshl_b32 s27, s20, 10
    s_add_u32 m0, s27, 98304
    s_nop 0
    buffer_load_dwordx4 v20, s[12:15], s26 offen offset:0 lds
    s_add_u32 m0, s27, 101888
    s_nop 0
    buffer_load_dwordx4 v20, s[12:15], s26 offen offset:512 lds
    s_cmp_ge_u32 s20, 2
    s_cbranch_scc1 m0s_176
    s_add_u32 m0, s27, 105472
    s_nop 0
    buffer_load_dwordx4 v20, s[12:15], s26 offen offset:1024 lds
m0s_176:
    s_add_u32 s26, s30, s63
    buffer_load_dwordx4 v[24:27], v3, s[4:7], s26 offen sc1
    s_add_u32 s26, s30, s64
    buffer_load_dwordx4 v[24:27], v124, s[4:7], s26 offen sc1
    s_add_u32 s26, s32, s61
    buffer_load_dwordx4 v[24:27], v3, s[4:7], s26 offen sc1
    buffer_load_dwordx4 v[24:27], v3, s[4:7], s26 offen offset:1024 sc1
    s_add_u32 s26, s32, s62
    buffer_load_dwordx4 v[24:27], v10, s[4:7], s26 offen sc1
    s_add_u32 s26, s31, s63
    buffer_load_dwordx4 v[24:27], v3, s[4:7], s26 offen sc1
    s_add_u32 s26, s31, s64
    buffer_load_dwordx4 v[24:27], v124, s[4:7], s26 offen sc1
    s_add_u32 s26, s33, s61
    buffer_load_dwordx4 v[24:27], v3, s[4:7], s26 offen sc1
    buffer_load_dwordx4 v[24:27], v3, s[4:7], s26 offen offset:1024 sc1
    s_add_u32 s26, s33, s62
    buffer_load_dwordx4 v[24:27], v10, s[4:7], s26 offen sc1
    s_add_u32 s26, s46, s63
    buffer_load_dwordx4 v[24:27], v3, s[4:7], s26 offen sc1
    s_add_u32 s26, s46, s64
    buffer_load_dwordx4 v[24:27], v124, s[4:7], s26 offen sc1
    s_add_u32 s26, s47, s61
    buffer_load_dwordx4 v[24:27], v3, s[4:7], s26 offen sc1
    buffer_load_dwordx4 v[24:27], v3, s[4:7], s26 offen offset:1024 sc1
    s_add_u32 s26, s47, s62
    buffer_load_dwordx4 v[24:27], v10, s[4:7], s26 offen sc1
    s_add_u32 s26, s34, 0
    buffer_load_dwordx4 v[24:27], v7, s[4:7], s26 offen sc1
    s_add_u32 s26, s34, 4096
    buffer_load_dwordx4 v[24:27], v7, s[4:7], s26 offen sc1
    s_add_u32 s26, s34, 6144
    buffer_load_dwordx4 v[24:27], v7, s[4:7], s26 offen sc1
    s_add_u32 s26, s35, 0
    buffer_load_dwordx4 v[24:27], v7, s[4:7], s26 offen sc1
    s_add_u32 s26, s35, 4096
    buffer_load_dwordx4 v[24:27], v7, s[4:7], s26 offen sc1
    s_add_u32 s26, s35, 6144
    buffer_load_dwordx4 v[24:27], v7, s[4:7], s26 offen sc1
    s_add_u32 s58, s22, 0
    s_cmp_ge_u32 s58, s49
    s_cbranch_scc1 uc_s_177
uc_ok_178:
    s_mov_b32 s66, 1
    s_mov_b32 s26, 167841920
    buffer_load_dword v127, v0, s[4:7], s26 offen sc1
    s_waitcnt vmcnt(0)
    s_branch XJ_181
uc_s_177:
    s_add_u32 s49, s58, 0
    s_min_u32 s49, s49, 63
    s_lshl_b32 s43, s49, 7
    s_add_u32 s43, s43, 167841792
    s_add_u32 s49, s49, 1
    buffer_load_dword v127, v0, s[4:7], s43 offen sc1
    s_waitcnt vmcnt(0)
    v_cmp_gt_u32 vcc, 32, v127
    s_cbranch_vccz uc_ok_178
    s_add_u32 s49, s58, 1
    s_min_u32 s58, s58, 63
    s_lshl_b32 s43, s58, 7
    s_add_u32 s43, s43, 167841792
uc_lp_179:
    buffer_load_dword v127, v0, s[4:7], s43 offen sc1
    s_waitcnt vmcnt(0)
    v_cmp_gt_u32 vcc, 32, v127
    s_cbranch_vccz uc_ok_178
    s_sub_u32 s28, s28, 1
    s_cbranch_scc0 uc_lp_179
    s_mov_b32 s28, 0
    s_branch uc_ok_178
XJ_181:
    s_barrier
    s_cmp_eq_u32 s20, 0
    s_cbranch_scc1 CLS_182
    s_cmp_eq_u32 s20, 3
    s_cbranch_scc1 CLS_184
CLS_183:
    ds_read_b128 v[76:79], v5 offset:0
    ds_read_b128 v[80:83], v5 offset:1024
    ds_read_b128 v[84:87], v5 offset:2048
    ds_read_b128 v[88:91], v5 offset:3072
    ds_read_b128 v[92:95], v5 offset:4096
    ds_read_b128 v[96:99], v5 offset:5120
    v_mov_b64 v[60:61], 0
    v_mov_b64 v[62:63], 0
    v_mov_b64 v[64:65], 0
    v_mov_b64 v[66:67], 0
    v_mov_b64 v[68:69], 0
    v_mov_b64 v[70:71], 0
    s_waitcnt lgkmcnt(0)
    s_branch CH_ent_187
CH_top_185:
GA_189:
    s_sub_u32 s28, s28, 1
    s_cbranch_scc1 GA_189_dead
    s_mov_b64 exec, s[12:13]
    buffer_load_dwordx4 v[20:23], v7, s[4:7], s34 offen sc1
    s_mov_b64 exec, s[14:15]
    buffer_load_dwordx4 v[24:27], v7, s[4:7], s10 offen sc1
    s_mov_b64 exec, s[16:17]
    buffer_load_dwordx4 v[28:31], v7, s[4:7], s11 offen sc1
    s_mov_b64 exec, s[18:19]
    buffer_load_dwordx4 v[32:35], v7, s[4:7], s36 offen sc1
    s_mov_b64 exec, s[8:9]
    buffer_load_dwordx4 v[36:39], v7, s[4:7], s3 offen sc1
    s_mov_b64 exec, s[96:97]
    buffer_load_dwordx4 v[40:43], v7, s[4:7], s101 offen sc1
    s_mov_b64 exec, -1
    s_add_u32 s26, s45, s63
    buffer_store_dwordx4 v[48:51], v3, s[4:7], s26 offen sc0 sc1
    s_add_u32 s26, s45, s64
    s_mov_b64 exec, s[50:51]
    buffer_store_dwordx4 v[52:55], v124, s[4:7], s26 offen sc0 sc1
    s_mov_b64 exec, -1
    s_waitcnt vmcnt(5)
    v_max_u32 v72, v20, v22
    v_max_u32 v73, v24, v26
    v_max_u32 v74, v28, v30
    v_cmp_eq_u32 s[12:13], -1, v72
    v_cmp_eq_u32 s[14:15], -1, v73
    v_cmp_eq_u32 s[16:17], -1, v74
    v_lshlrev_b32 v100, 16, v20
    v_and_b32 v101, 0xffff0000, v20
    v_lshlrev_b32 v102, 16, v21
    v_and_b32 v103, 0xffff0000, v21
    v_lshlrev_b32 v104, 16, v22
    v_and_b32 v105, 0xffff0000, v22
    v_lshlrev_b32 v106, 16, v23
    v_and_b32 v107, 0xffff0000, v23
    v_lshlrev_b32 v108, 16, v24
    v_and_b32 v109, 0xffff0000, v24
    v_lshlrev_b32 v112, 16, v25
    v_and_b32 v113, 0xffff0000, v25
    v_lshlrev_b32 v114, 16, v26
    v_and_b32 v115, 0xffff0000, v26
    v_lshlrev_b32 v116, 16, v27
    v_and_b32 v117, 0xffff0000, v27
    v_lshlrev_b32 v118, 16, v28
    v_and_b32 v119, 0xffff0000, v28
    v_lshlrev_b32 v56, 16, v29
    v_and_b32 v57, 0xffff0000, v29
    v_lshlrev_b32 v58, 16, v30
    v_and_b32 v59, 0xffff0000, v30
    v_lshlrev_b32 v73, 16, v31
    v_and_b32 v74, 0xffff0000, v31
    s_waitcnt vmcnt(4)
    v_max_u32 v72, v32, v34
    v_dot2_f32_bf16 v60, v32, s40, v100
    v_dot2_f32_bf16 v61, v32, s41, v101
    v_dot2_f32_bf16 v62, v33, s40, v102
    v_dot2_f32_bf16 v63, v33, s41, v103
    v_dot2_f32_bf16 v64, v34, s40, v104
    v_dot2_f32_bf16 v65, v34, s41, v105
    v_dot2_f32_bf16 v66, v35, s40, v106
    v_dot2_f32_bf16 v67, v35, s41, v107
    v_cmp_eq_u32 s[18:19], -1, v72
    v_cvt_pk_bf16_f32 v68, v60, v61
    v_cvt_pk_bf16_f32 v69, v62, v63
    v_cvt_pk_bf16_f32 v70, v64, v65
    v_cvt_pk_bf16_f32 v71, v66, v67
    ds_write_b128 v19, v[68:71] offset:0
    s_waitcnt vmcnt(3)
    v_max_u32 v72, v36, v38
    v_dot2_f32_bf16 v60, v36, s40, v108
    v_dot2_f32_bf16 v61, v36, s41, v109
    v_dot2_f32_bf16 v62, v37, s40, v112
    v_dot2_f32_bf16 v63, v37, s41, v113
    v_dot2_f32_bf16 v64, v38, s40, v114
    v_dot2_f32_bf16 v65, v38, s41, v115
    v_dot2_f32_bf16 v66, v39, s40, v116
    v_dot2_f32_bf16 v67, v39, s41, v117
    v_cmp_eq_u32 s[8:9], -1, v72
    v_cvt_pk_bf16_f32 v44, v60, v61
    v_cvt_pk_bf16_f32 v45, v62, v63
    v_cvt_pk_bf16_f32 v46, v64, v65
    v_cvt_pk_bf16_f32 v47, v66, v67
    ds_write_b128 v19, v[44:47] offset:4096
    s_waitcnt vmcnt(2)
    v_max_u32 v72, v40, v42
    v_dot2_f32_bf16 v60, v40, s40, v118
    v_dot2_f32_bf16 v61, v40, s41, v119
    v_dot2_f32_bf16 v62, v41, s40, v56
    v_dot2_f32_bf16 v63, v41, s41, v57
    v_dot2_f32_bf16 v64, v42, s40, v58
    v_dot2_f32_bf16 v65, v42, s41, v59
    v_dot2_f32_bf16 v66, v43, s40, v73
    v_dot2_f32_bf16 v67, v43, s41, v74
    v_cmp_eq_u32 s[96:97], -1, v72
    v_cvt_pk_bf16_f32 v68, v60, v61
    v_cvt_pk_bf16_f32 v69, v62, v63
    v_cvt_pk_bf16_f32 v70, v64, v65
    v_cvt_pk_bf16_f32 v71, v66, v67
    s_mov_b64 exec, s[68:69]
    ds_write_b128 v9, v[68:71] offset:0
    s_mov_b64 exec, -1
    s_or_b64 vcc, s[12:13], s[14:15]
    s_or_b64 vcc, vcc, s[16:17]
    s_or_b64 vcc, vcc, s[18:19]
    s_or_b64 vcc, vcc, s[8:9]
    s_or_b64 vcc, vcc, s[96:97]
    s_cbranch_scc1 GA_189
GA_189_ok:
    v_mov_b64 v[60:61], 0
    v_mov_b64 v[62:63], 0
    v_mov_b64 v[64:65], 0
    v_mov_b64 v[66:67], 0
    v_mov_b64 v[68:69], 0
    v_mov_b64 v[70:71], 0
    s_add_u32 s45, s45, 327680
    s_cmp_eq_u32 s22, 42
    s_cselect_b32 s26, s55, 49152
    s_add_u32 s36, s36, s26
    s_add_u32 s37, s37, s26
    s_waitcnt lgkmcnt(0)
CH_ent_187:
    s_barrier
    ds_read_b128 v[20:23], v4 offset:0
    ds_read_b128 v[24:27], v4 offset:1024
    ds_read_b128 v[28:31], v4 offset:2048
    s_waitcnt lgkmcnt(2)
    v_smfmac_f32_16x16x64_bf16 v[60:63], v[20:23], a[0:7], v2
    ds_read_b128 v[32:35], v4 offset:3072
    v_mov_b64 v[72:73], 0
    v_smfmac_f32_16x16x64_bf16 v[64:67], v[20:23], a[8:15], v2
    s_waitcnt lgkmcnt(2)
    ds_read_b128 v[36:39], v4 offset:4096
    v_mov_b64 v[74:75], 0
    v_smfmac_f32_16x16x64_bf16 v[60:63], v[24:27], a[16:23], v2
    ds_read_b128 v[40:43], v4 offset:5120
    v_mov_b64 v[112:113], 0
    v_smfmac_f32_16x16x64_bf16 v[64:67], v[24:27], a[24:31], v2
    s_waitcnt lgkmcnt(3)
    ds_read_b128 v[44:47], v4 offset:6144
    v_mov_b64 v[114:115], 0
    v_smfmac_f32_16x16x64_bf16 v[60:63], v[28:31], v[76:83], v2
    ds_read_b128 v[48:51], v4 offset:7168
    v_mov_b64 v[116:117], 0
    v_smfmac_f32_16x16x64_bf16 v[64:67], v[28:31], a[32:39], v2
    s_waitcnt lgkmcnt(4)
    ds_read_b128 v[52:55], v4 offset:8192
    v_mov_b64 v[118:119], 0
    s_mov_b32 m0, s54
    s_add_u32 s43, s38, 0
    buffer_load_dwordx4 v3, s[4:7], s43 offen offset:0 sc1 lds
    v_smfmac_f32_16x16x64_bf16 v[60:63], v[32:35], a[40:47], v2
    ds_read_b128 v[56:59], v4 offset:9216
    s_add_u32 s43, s38, 39936
    v_smfmac_f32_16x16x64_bf16 v[64:67], v[32:35], a[48:55], v2
    s_waitcnt lgkmcnt(5)
    buffer_load_dwordx4 v3, s[4:7], s43 offen offset:1024 sc1 lds
    v_smfmac_f32_16x16x64_bf16 v[60:63], v[36:39], a[56:63], v2
    ds_read_b128 v[76:79], v5 offset:6144
    v_smfmac_f32_16x16x64_bf16 v[64:67], v[36:39], v[84:91], v2
    s_waitcnt lgkmcnt(5)
    ds_read_b128 v[80:83], v5 offset:7168
    s_add_u32 s43, s38, 79872
    v_smfmac_f32_16x16x64_bf16 v[60:63], v[40:43], a[64:71], v2
    buffer_load_dwordx4 v3, s[4:7], s43 offen offset:2048 sc1 lds
    v_smfmac_f32_16x16x64_bf16 v[64:67], v[40:43], a[72:79], v2
    s_waitcnt lgkmcnt(5)
    ds_read_b128 v[84:87], v5 offset:8192
    v_smfmac_f32_16x16x64_bf16 v[60:63], v[44:47], a[80:87], v2
    ds_read_b128 v[88:91], v5 offset:9216
    s_add_u32 s43, s38, 119808
    v_smfmac_f32_16x16x64_bf16 v[64:67], v[44:47], a[88:95], v2
    s_waitcnt lgkmcnt(6)
    buffer_load_dwordx4 v3, s[4:7], s43 offen offset:3072 sc1 lds
    v_smfmac_f32_16x16x64_bf16 v[60:63], v[48:51], v[92:99], v2
    ds_read_b128 v[92:95], v5 offset:10240
    v_smfmac_f32_16x16x64_bf16 v[64:67], v[48:51], a[96:103], v2
    s_waitcnt lgkmcnt(6)
    ds_read_b128 v[96:99], v5 offset:11264
    s_add_u32 m0, s54, 4096
    v_smfmac_f32_16x16x64_bf16 v[60:63], v[52:55], a[104:111], v2
    s_add_u32 s43, s39, 0
    buffer_load_dwordx4 v17, s[4:7], s43 offen offset:0 sc1 lds
    v_smfmac_f32_16x16x64_bf16 v[64:67], v[52:55], a[112:119], v2
    s_waitcnt lgkmcnt(6)
    v_smfmac_f32_16x16x64_bf16 v[60:63], v[56:59], a[120:127], v2
    s_waitcnt lgkmcnt(4)
    s_add_u32 s43, s39, 80896
    buffer_load_dwordx4 v17, s[4:7], s43 offen offset:1024 sc1 lds
    v_smfmac_f32_16x16x64_bf16 v[64:67], v[56:59], v[76:83], v2
    ds_read_b128 v[76:79], v5 offset:12288
    v_smfmac_f32_16x16x64_bf16 v[68:71], v[20:23], a[128:135], v2
    ds_read_b128 v[80:83], v5 offset:13312
    v_add_f32 v60, v60, v61
    v_smfmac_f32_16x16x64_bf16 v[68:71], v[24:27], a[136:143], v2
    v_add_f32 v62, v62, v63
    v_cvt_pk_bf16_f32 v60, v60, v62
    v_smfmac_f32_16x16x64_bf16 v[68:71], v[28:31], a[144:151], v2
    ds_write_b16 v6, v60 offset:0
    v_smfmac_f32_16x16x64_bf16 v[68:71], v[32:35], a[152:159], v2
    s_waitcnt lgkmcnt(5)
    ds_write_b16_d16_hi v6, v60 offset:4
    v_add_f32 v64, v64, v65
    v_smfmac_f32_16x16x64_bf16 v[68:71], v[36:39], v[84:91], v2
    ds_read_b128 v[84:87], v5 offset:14336
    v_add_f32 v66, v66, v67
    v_smfmac_f32_16x16x64_bf16 v[68:71], v[40:43], a[160:167], v2
    ds_read_b128 v[88:91], v5 offset:15360
    v_cvt_pk_bf16_f32 v64, v64, v66
    ds_write_b16 v6, v64 offset:256
    ds_write_b16_d16_hi v6, v64 offset:260
    v_smfmac_f32_16x16x64_bf16 v[68:71], v[44:47], a[168:175], v2
    s_waitcnt lgkmcnt(0)
    s_barrier
    ds_read_b64_tr_b16 v[20:21], v8 offset:0
    v_smfmac_f32_16x16x64_bf16 v[68:71], v[48:51], a[176:183], v2
    ds_read_b64_tr_b16 v[22:23], v8 offset:128
    v_mov_b64 v[60:61], 0
    v_smfmac_f32_16x16x64_bf16 v[68:71], v[52:55], a[184:191], v2
    ds_read_b64_tr_b16 v[24:25], v8 offset:1024
    v_mov_b64 v[62:63], 0
    ds_read_b64_tr_b16 v[26:27], v8 offset:1152
    v_smfmac_f32_16x16x64_bf16 v[68:71], v[56:59], v[92:99], v2
    s_waitcnt lgkmcnt(2)
    ds_read_b128 v[92:95], v5 offset:16384
    v_mov_b64 v[64:65], 0
    v_smfmac_f32_16x16x64_bf16 v[72:75], v[20:23], a[192:199], v2
    s_waitcnt lgkmcnt(1)
    ds_read_b128 v[96:99], v5 offset:17408
    v_mov_b64 v[66:67], 0
    v_smfmac_f32_16x16x64_bf16 v[72:75], v[24:27], a[200:207], v2
    v_mov_b64 v[32:33], 0
    v_mov_b64 v[34:35], 0
    v_smfmac_f32_16x16x64_bf16 v[112:115], v[20:23], a[208:215], v2
    v_add_f32 v68, v68, v69
    v_add_f32 v70, v70, v71
    v_smfmac_f32_16x16x64_bf16 v[112:115], v[24:27], a[216:223], v2
    v_cvt_pk_bf16_f32 v68, v68, v70
    v_mov_b64 v[36:37], 0
    v_smfmac_f32_16x16x64_bf16 v[116:119], v[20:23], v[76:83], v2
    ds_write_b16 v111, v68
    v_mov_b64 v[38:39], 0
    v_smfmac_f32_16x16x64_bf16 v[116:119], v[24:27], a[224:231], v2
    ds_write_b16_d16_hi v111, v68 offset:4
    v_mov_b64 v[40:41], 0
    v_smfmac_f32_16x16x64_bf16 v[60:63], v[20:23], a[232:239], v2
    ds_read_b128 v[76:79], v5 offset:18432
    v_mov_b64 v[42:43], 0
    v_smfmac_f32_16x16x64_bf16 v[60:63], v[24:27], a[240:247], v2
    s_waitcnt lgkmcnt(1)
    ds_read_b128 v[80:83], v5 offset:19456
    v_mov_b64 v[44:45], 0
    v_smfmac_f32_16x16x64_bf16 v[64:67], v[20:23], a[248:255], v2
    s_barrier
    ds_read_b64_tr_b16 v[28:29], v8 offset:2048
    v_smfmac_f32_16x16x64_bf16 v[64:67], v[24:27], v[84:91], v2
    ds_read_b64_tr_b16 v[30:31], v8 offset:2176
    v_mov_b64 v[46:47], 0
    v_smfmac_f32_16x16x64_bf16 v[32:35], v[20:23], v[128:135], v2
    ds_read_b128 v[84:87], v5 offset:20480
    v_mov_b64 v[68:69], 0
    v_smfmac_f32_16x16x64_bf16 v[32:35], v[24:27], v[136:143], v2
    s_waitcnt lgkmcnt(1)
    ds_read_b128 v[88:91], v5 offset:21504
    v_mov_b64 v[70:71], 0
    v_smfmac_f32_16x16x64_bf16 v[72:75], v[28:31], v[144:151], v2
    v_smfmac_f32_16x16x64_bf16 v[112:115], v[28:31], v[152:159], v2
    v_smfmac_f32_16x16x64_bf16 v[116:119], v[28:31], v[92:99], v2
    ds_read_b128 v[92:95], v5 offset:22528
    v_smfmac_f32_16x16x64_bf16 v[60:63], v[28:31], v[160:167], v2
    ds_read_b128 v[96:99], v5 offset:23552
    v_add_f32 v72, v72, v73
    v_smfmac_f32_16x16x64_bf16 v[36:39], v[20:23], v[168:175], v2
    v_add_f32 v74, v74, v75
    v_cvt_pk_bf16_f32 v100, v72, v74
    v_smfmac_f32_16x16x64_bf16 v[36:39], v[24:27], v[176:183], v2
    v_add_f32 v112, v112, v113
    v_add_f32 v114, v114, v115
    v_smfmac_f32_16x16x64_bf16 v[64:67], v[28:31], v[184:191], v2
    v_cvt_pk_bf16_f32 v101, v112, v114
    v_add_f32 v116, v116, v117
    v_smfmac_f32_16x16x64_bf16 v[40:43], v[20:23], v[76:83], v2
    v_add_f32 v118, v118, v119
    v_cvt_pk_bf16_f32 v102, v116, v118
    v_smfmac_f32_16x16x64_bf16 v[40:43], v[24:27], v[192:199], v2
    v_add_f32 v60, v60, v61
    v_add_f32 v62, v62, v63
    v_smfmac_f32_16x16x64_bf16 v[32:35], v[28:31], v[200:207], v2
    v_cvt_pk_bf16_f32 v103, v60, v62
    s_nop 0
    v_smfmac_f32_16x16x64_bf16 v[44:47], v[20:23], v[208:215], v2
    v_permlane32_swap_b32 v100, v102
    v_smfmac_f32_16x16x64_bf16 v[44:47], v[24:27], v[216:223], v2
    s_waitcnt lgkmcnt(2)
    v_permlane32_swap_b32 v101, v103
    v_smfmac_f32_16x16x64_bf16 v[36:39], v[28:31], v[84:91], v2
    s_nop 1
    v_smfmac_f32_16x16x64_bf16 v[68:71], v[20:23], v[224:231], v2
    v_permlane16_swap_b32 v100, v101
    v_smfmac_f32_16x16x64_bf16 v[68:71], v[24:27], v[232:239], v2
    v_permlane16_swap_b32 v102, v103
    v_smfmac_f32_16x16x64_bf16 v[40:43], v[28:31], v[240:247], v2
    s_add_u32 s26, s30, 0
    s_cmp_eq_u32 s25, 0
    s_cbranch_scc1 ds_s_190
    buffer_store_dwordx4 v[100:103], v125, s[4:7], s26 offen
ds_e_191:
    v_smfmac_f32_16x16x64_bf16 v[44:47], v[28:31], v[248:255], v2
    s_waitcnt lgkmcnt(0)
    v_add_f32 v64, v64, v65
    v_add_f32 v66, v66, v67
    v_smfmac_f32_16x16x64_bf16 v[68:71], v[28:31], v[92:99], v2
    v_cvt_pk_bf16_f32 v104, v64, v66
    v_add_f32 v32, v32, v33
    v_add_f32 v34, v34, v35
    v_cvt_pk_bf16_f32 v105, v32, v34
    v_add_f32 v36, v36, v37
    v_add_f32 v38, v38, v39
    v_cvt_pk_bf16_f32 v106, v36, v38
    v_add_f32 v40, v40, v41
    v_add_f32 v42, v42, v43
    v_cvt_pk_bf16_f32 v107, v40, v42
    v_add_f32 v44, v44, v45
    v_add_f32 v46, v46, v47
    v_cvt_pk_bf16_f32 v108, v44, v46
    v_permlane32_swap_b32 v104, v106
    v_permlane32_swap_b32 v105, v107
    s_nop 1
    v_permlane16_swap_b32 v104, v105
    v_permlane16_swap_b32 v106, v107
    s_add_u32 s26, s30, 32768
    s_cmp_eq_u32 s25, 0
    s_cbranch_scc1 ds_s_192
    buffer_store_dwordx4 v[104:107], v125, s[4:7], s26 offen
ds_e_193:
    s_nop 0
    v_add_f32 v68, v68, v69
    v_add_f32 v70, v70, v71
    v_cvt_pk_bf16_f32 v109, v68, v70
    s_nop 1
    v_permlane16_swap_b32 v108, v109
    s_cmp_eq_u32 s25, 0
    s_cbranch_scc1 ds_s_194
    buffer_store_dwordx2 v[108:109], v126, s[4:7], s30 offen
ds_e_195:
    s_cmp_eq_u32 s22, 63
    s_cbranch_scc1 CH_fin_186
    s_add_u32 s26, s32, s61
    s_add_u32 s27, s32, s62
    s_add_u32 s58, s30, s63
    s_add_u32 s43, s30, s64
    v_mov_b64 v[28:29], 0
    v_mov_b64 v[30:31], 0
    v_mov_b64 v[52:53], 0
    v_mov_b64 v[54:55], 0
    s_mov_b64 s[12:13], -1
    s_mov_b64 s[14:15], -1
    s_mov_b64 s[16:17], s[50:51]
    s_mov_b64 s[18:19], -1
    s_mov_b64 s[8:9], s[50:51]
    s_barrier
GB_196:
    s_sub_u32 s28, s28, 1
    s_cbranch_scc1 GB_196_dead
    s_mov_b64 exec, s[12:13]
    buffer_load_dwordx4 v[20:23], v3, s[4:7], s26 offen offset:0 sc1
    s_mov_b64 exec, s[14:15]
    buffer_load_dwordx4 v[24:27], v3, s[4:7], s26 offen offset:1024 sc1
    s_mov_b64 exec, s[16:17]
    buffer_load_dwordx4 v[28:31], v10, s[4:7], s27 offen sc1
    s_mov_b64 exec, s[18:19]
    buffer_load_dwordx4 v[48:51], v3, s[4:7], s58 offen sc1
    s_mov_b64 exec, s[8:9]
    buffer_load_dwordx4 v[52:55], v124, s[4:7], s43 offen sc1
    s_mov_b64 exec, -1
    s_waitcnt vmcnt(5)
    ds_read_b128 v[76:79], v15 offset:0
    ds_read_b128 v[80:83], v15 offset:1024
    ds_read_b128 v[84:87], v15 offset:2048
    ds_read_b128 v[88:91], v15 offset:3072
    ds_read_b128 v[92:95], v18 offset:0
    ds_read_b128 v[96:99], v18 offset:128
    ds_read_b128 v[60:63], v18 offset:1024
    ds_read_b128 v[64:67], v18 offset:1152
    s_waitcnt vmcnt(3) lgkmcnt(0)
    v_mfma_f32_16x16x32_bf16 v[40:43], v[80:83], v[20:23], 0
    v_max_u32 v32, v20, v22
    v_mfma_f32_16x16x32_bf16 v[68:71], v[76:79], v[20:23], 0
    v_max_u32 v33, v24, v26
    v_mfma_f32_16x16x32_bf16 v[40:43], v[88:91], v[24:27], v[40:43]
    v_cmp_eq_u32 s[12:13], -1, v32
    v_mfma_f32_16x16x32_bf16 v[68:71], v[84:87], v[24:27], v[68:71]
    v_cmp_eq_u32 s[14:15], -1, v33
    v_mfma_f32_16x16x32_bf16 v[44:47], v[96:99], v[20:23], 0
    v_mfma_f32_16x16x32_bf16 v[72:75], v[92:95], v[20:23], 0
    v_mfma_f32_16x16x32_bf16 v[44:47], v[64:67], v[24:27], v[44:47]
    v_mfma_f32_16x16x32_bf16 v[72:75], v[60:63], v[24:27], v[72:75]
    s_waitcnt vmcnt(0)
    v_mfma_f32_16x16x32_bf16 v[68:71], v[48:51], v[28:31], v[68:71]
    v_max_u32 v34, v28, v30
    v_max_u32 v35, v48, v50
    v_mfma_f32_16x16x32_bf16 v[72:75], v[52:55], v[28:31], v[72:75]
    v_max_u32 v36, v52, v54
    v_cmp_eq_u32 s[16:17], -1, v34
    v_cmp_eq_u32 s[18:19], -1, v35
    v_cmp_eq_u32 s[8:9], -1, v36
    s_or_b64 vcc, s[12:13], s[14:15]
    s_or_b64 vcc, vcc, s[16:17]
    s_or_b64 vcc, vcc, s[18:19]
    s_or_b64 vcc, vcc, s[8:9]
    s_cbranch_scc1 GB_196
GB_196_ok:
    s_nop 0
    v_add_f32_dpp v68, v40, v68 row_ror:8 row_mask:0xf bank_mask:0xf
    v_add_f32_dpp v69, v41, v69 row_ror:8 row_mask:0xf bank_mask:0xf
    v_add_f32_dpp v70, v42, v70 row_ror:8 row_mask:0xf bank_mask:0xf
    v_add_f32_dpp v71, v43, v71 row_ror:8 row_mask:0xf bank_mask:0xf
    v_add_f32_dpp v68, v72, v44 row_ror:8 row_mask:0xf bank_mask:0xc
    v_add_f32_dpp v69, v73, v45 row_ror:8 row_mask:0xf bank_mask:0xc
    v_add_f32_dpp v70, v74, v46 row_ror:8 row_mask:0xf bank_mask:0xc
    v_add_f32_dpp v71, v75, v47 row_ror:8 row_mask:0xf bank_mask:0xc
    ds_write_b128 v16, v[68:71] offset:0
    s_waitcnt lgkmcnt(0)
    s_barrier
    s_sleep 4
    s_add_u32 s27, s46, 32768
    s_cmp_eq_u32 s25, 0
    s_cbranch_scc1 ds_s_197
    buffer_store_dwordx4 v[120:123], v125, s[4:7], s46 offen
    buffer_store_dwordx4 v[120:123], v125, s[4:7], s27 offen
    buffer_store_dwordx2 v[120:121], v126, s[4:7], s46 offen
ds_e_198:
    s_add_u32 s22, s22, 1
    s_mov_b32 s26, s30
    s_mov_b32 s30, s31
    s_mov_b32 s31, s46
    s_mov_b32 s46, s26
    s_mov_b32 s26, s32
    s_mov_b32 s32, s33
    s_mov_b32 s33, s47
    s_mov_b32 s47, s26
    s_mov_b32 s26, s34
    s_mov_b32 s34, s35
    s_mov_b32 s35, s26
    s_add_u32 s38, s38, 1310720
    s_add_u32 s39, s39, 1310720
    s_add_u32 s57, s57, 128
    ds_read_b128 v[76:79], v5 offset:0
    ds_read_b128 v[80:83], v5 offset:1024
    ds_read_b128 v[84:87], v5 offset:2048
    ds_read_b128 v[88:91], v5 offset:3072
    ds_read_b128 v[92:95], v5 offset:4096
    ds_read_b128 v[96:99], v5 offset:5120
    v_mov_b64 v[28:29], 0
    v_mov_b64 v[30:31], 0
    v_mov_b64 v[40:41], 0
    v_mov_b64 v[42:43], 0
    s_add_u32 s10, s34, 4096
    s_add_u32 s11, s34, s65
    s_mov_b64 s[12:13], -1
    s_mov_b64 s[14:15], -1
    s_mov_b64 s[16:17], s[68:69]
    s_mov_b64 s[18:19], -1
    s_mov_b64 s[8:9], -1
    s_mov_b64 s[96:97], s[68:69]
    s_add_u32 s3, s36, 4096
    s_add_u32 s101, s36, s29
    s_barrier
    s_branch CH_top_185
GA_189_dead:
    s_mov_b32 s28, 0
    s_branch GA_189_ok
ds_s_190:
    buffer_store_dwordx4 v[100:103], v125, s[4:7], s26 offen sc0 sc1
    s_branch ds_e_191
ds_s_192:
    buffer_store_dwordx4 v[104:107], v125, s[4:7], s26 offen sc0 sc1
    s_branch ds_e_193
ds_s_194:
    buffer_store_dwordx2 v[108:109], v126, s[4:7], s30 offen sc0 sc1
    s_branch ds_e_195
GB_196_dead:
    s_mov_b32 s28, 0
    s_branch GB_196_ok
ds_s_197:
    buffer_store_dwordx4 v[120:123], v125, s[4:7], s46 offen sc0 sc1
    buffer_store_dwordx4 v[120:123], v125, s[4:7], s27 offen sc0 sc1
    buffer_store_dwordx2 v[120:121], v126, s[4:7], s46 offen sc0 sc1
    s_branch ds_e_198
CH_fin_186:
    s_add_u32 s27, s45, 32768
    buffer_store_dwordx4 v[100:103], v125, s[4:7], s45 offen sc0 sc1
    buffer_store_dwordx4 v[104:107], v125, s[4:7], s27 offen sc0 sc1
    buffer_store_dwordx2 v[108:109], v126, s[4:7], s45 offen sc0 sc1
    s_waitcnt vmcnt(0)
    s_barrier
    s_branch L_end
CLS_184:
    ds_read_b128 v[76:79], v5 offset:0
    ds_read_b128 v[80:83], v5 offset:1024
    ds_read_b128 v[84:87], v5 offset:2048
    ds_read_b128 v[88:91], v5 offset:3072
    ds_read_b128 v[92:95], v5 offset:4096
    ds_read_b128 v[96:99], v5 offset:5120
    v_mov_b64 v[60:61], 0
    v_mov_b64 v[62:63], 0
    v_mov_b64 v[64:65], 0
    v_mov_b64 v[66:67], 0
    v_mov_b64 v[68:69], 0
    v_mov_b64 v[70:71], 0
    s_waitcnt lgkmcnt(0)
    s_branch CH_ent_201
CH_top_199:
GA_203:
    s_sub_u32 s28, s28, 1
    s_cbranch_scc1 GA_203_dead
    s_mov_b64 exec, s[12:13]
    buffer_load_dwordx4 v[20:23], v7, s[4:7], s34 offen sc1
    s_mov_b64 exec, s[14:15]
    buffer_load_dwordx4 v[24:27], v7, s[4:7], s10 offen sc1
    s_mov_b64 exec, s[16:17]
    buffer_load_dwordx4 v[28:31], v7, s[4:7], s11 offen sc1
    s_mov_b64 exec, s[18:19]
    buffer_load_dwordx4 v[32:35], v7, s[4:7], s36 offen sc1
    s_mov_b64 exec, s[8:9]
    buffer_load_dwordx4 v[36:39], v7, s[4:7], s3 offen sc1
    s_mov_b64 exec, s[96:97]
    buffer_load_dwordx4 v[40:43], v7, s[4:7], s101 offen sc1
    s_mov_b64 exec, -1
    s_add_u32 s26, s45, s63
    buffer_store_dwordx4 v[48:51], v3, s[4:7], s26 offen sc0 sc1
    s_add_u32 s26, s45, s64
    s_mov_b64 exec, s[50:51]
    buffer_store_dwordx4 v[52:55], v124, s[4:7], s26 offen sc0 sc1
    s_mov_b64 exec, -1
    s_waitcnt vmcnt(5)
    v_max_u32 v72, v20, v22
    v_max_u32 v73, v24, v26
    v_max_u32 v74, v28, v30
    v_cmp_eq_u32 s[12:13], -1, v72
    v_cmp_eq_u32 s[14:15], -1, v73
    v_cmp_eq_u32 s[16:17], -1, v74
    v_lshlrev_b32 v100, 16, v20
    v_and_b32 v101, 0xffff0000, v20
    v_lshlrev_b32 v102, 16, v21
    v_and_b32 v103, 0xffff0000, v21
    v_lshlrev_b32 v104, 16, v22
    v_and_b32 v105, 0xffff0000, v22
    v_lshlrev_b32 v106, 16, v23
    v_and_b32 v107, 0xffff0000, v23
    v_lshlrev_b32 v108, 16, v24
    v_and_b32 v109, 0xffff0000, v24
    v_lshlrev_b32 v112, 16, v25
    v_and_b32 v113, 0xffff0000, v25
    v_lshlrev_b32 v114, 16, v26
    v_and_b32 v115, 0xffff0000, v26
    v_lshlrev_b32 v116, 16, v27
    v_and_b32 v117, 0xffff0000, v27
    v_lshlrev_b32 v118, 16, v28
    v_and_b32 v119, 0xffff0000, v28
    v_lshlrev_b32 v56, 16, v29
    v_and_b32 v57, 0xffff0000, v29
    v_lshlrev_b32 v58, 16, v30
    v_and_b32 v59, 0xffff0000, v30
    v_lshlrev_b32 v73, 16, v31
    v_and_b32 v74, 0xffff0000, v31
    s_waitcnt vmcnt(4)
    v_max_u32 v72, v32, v34
    v_dot2_f32_bf16 v60, v32, s40, v100
    v_dot2_f32_bf16 v61, v32, s41, v101
    v_dot2_f32_bf16 v62, v33, s40, v102
    v_dot2_f32_bf16 v63, v33, s41, v103
    v_dot2_f32_bf16 v64, v34, s40, v104
    v_dot2_f32_bf16 v65, v34, s41, v105
    v_dot2_f32_bf16 v66, v35, s40, v106
    v_dot2_f32_bf16 v67, v35, s41, v107
    v_cmp_eq_u32 s[18:19], -1, v72
    v_cvt_pk_bf16_f32 v68, v60, v61
    v_cvt_pk_bf16_f32 v69, v62, v63
    v_cvt_pk_bf16_f32 v70, v64, v65
    v_cvt_pk_bf16_f32 v71, v66, v67
    ds_write_b128 v19, v[68:71] offset:0
    s_waitcnt vmcnt(3)
    v_max_u32 v72, v36, v38
    v_dot2_f32_bf16 v60, v36, s40, v108
    v_dot2_f32_bf16 v61, v36, s41, v109
    v_dot2_f32_bf16 v62, v37, s40, v112
    v_dot2_f32_bf16 v63, v37, s41, v113
    v_dot2_f32_bf16 v64, v38, s40, v114
    v_dot2_f32_bf16 v65, v38, s41, v115
    v_dot2_f32_bf16 v66, v39, s40, v116
    v_dot2_f32_bf16 v67, v39, s41, v117
    v_cmp_eq_u32 s[8:9], -1, v72
    v_cvt_pk_bf16_f32 v44, v60, v61
    v_cvt_pk_bf16_f32 v45, v62, v63
    v_cvt_pk_bf16_f32 v46, v64, v65
    v_cvt_pk_bf16_f32 v47, v66, v67
    ds_write_b128 v19, v[44:47] offset:4096
    s_waitcnt vmcnt(2)
    v_max_u32 v72, v40, v42
    v_dot2_f32_bf16 v60, v40, s40, v118
    v_dot2_f32_bf16 v61, v40, s41, v119
    v_dot2_f32_bf16 v62, v41, s40, v56
    v_dot2_f32_bf16 v63, v41, s41, v57
    v_dot2_f32_bf16 v64, v42, s40, v58
    v_dot2_f32_bf16 v65, v42, s41, v59
    v_dot2_f32_bf16 v66, v43, s40, v73
    v_dot2_f32_bf16 v67, v43, s41, v74
    v_cmp_eq_u32 s[96:97], -1, v72
    v_cvt_pk_bf16_f32 v68, v60, v61
    v_cvt_pk_bf16_f32 v69, v62, v63
    v_cvt_pk_bf16_f32 v70, v64, v65
    v_cvt_pk_bf16_f32 v71, v66, v67
    s_mov_b64 exec, s[68:69]
    ds_write_b128 v9, v[68:71] offset:0
    s_mov_b64 exec, -1
    s_or_b64 vcc, s[12:13], s[14:15]
    s_or_b64 vcc, vcc, s[16:17]
    s_or_b64 vcc, vcc, s[18:19]
    s_or_b64 vcc, vcc, s[8:9]
    s_or_b64 vcc, vcc, s[96:97]
    s_cbranch_scc1 GA_203
GA_203_ok:
    v_mov_b64 v[60:61], 0
    v_mov_b64 v[62:63], 0
    v_mov_b64 v[64:65], 0
    v_mov_b64 v[66:67], 0
    v_mov_b64 v[68:69], 0
    v_mov_b64 v[70:71], 0
    s_add_u32 s45, s45, 327680
    s_cmp_eq_u32 s22, 42
    s_cselect_b32 s26, s55, 49152
    s_add_u32 s36, s36, s26
    s_add_u32 s37, s37, s26
    s_waitcnt lgkmcnt(0)
CH_ent_201:
    s_barrier
    ds_read_b128 v[20:23], v4 offset:0
    ds_read_b128 v[24:27], v4 offset:1024
    ds_read_b128 v[28:31], v4 offset:2048
    s_waitcnt lgkmcnt(2)
    v_smfmac_f32_16x16x64_bf16 v[60:63], v[20:23], a[0:7], v2
    ds_read_b128 v[32:35], v4 offset:3072
    v_mov_b64 v[72:73], 0
    v_smfmac_f32_16x16x64_bf16 v[64:67], v[20:23], a[8:15], v2
    s_waitcnt lgkmcnt(2)
    ds_read_b128 v[36:39], v4 offset:4096
    v_mov_b64 v[74:75], 0
    v_smfmac_f32_16x16x64_bf16 v[60:63], v[24:27], a[16:23], v2
    ds_read_b128 v[40:43], v4 offset:5120
    v_mov_b64 v[112:113], 0
    v_smfmac_f32_16x16x64_bf16 v[64:67], v[24:27], a[24:31], v2
    s_waitcnt lgkmcnt(3)
    ds_read_b128 v[44:47], v4 offset:6144
    v_mov_b64 v[114:115], 0
    v_smfmac_f32_16x16x64_bf16 v[60:63], v[28:31], v[76:83], v2
    ds_read_b128 v[48:51], v4 offset:7168
    v_mov_b64 v[116:117], 0
    v_smfmac_f32_16x16x64_bf16 v[64:67], v[28:31], a[32:39], v2
    s_waitcnt lgkmcnt(4)
    ds_read_b128 v[52:55], v4 offset:8192
    v_mov_b64 v[118:119], 0
    v_smfmac_f32_16x16x64_bf16 v[60:63], v[32:35], a[40:47], v2
    ds_read_b128 v[56:59], v4 offset:9216
    s_mov_b32 m0, s54
    s_add_u32 s43, s38, 0
    buffer_load_dwordx4 v3, s[4:7], s43 offen offset:0 sc1 lds
    v_smfmac_f32_16x16x64_bf16 v[64:67], v[32:35], a[48:55], v2
    s_waitcnt lgkmcnt(5)
    ds_read_b128 v[76:79], v5 offset:6144
    s_add_u32 s43, s38, 39936
    v_smfmac_f32_16x16x64_bf16 v[60:63], v[36:39], a[56:63], v2
    buffer_load_dwordx4 v3, s[4:7], s43 offen offset:1024 sc1 lds
    v_smfmac_f32_16x16x64_bf16 v[64:67], v[36:39], v[84:91], v2
    s_waitcnt lgkmcnt(5)
    ds_read_b128 v[80:83], v5 offset:7168
    v_smfmac_f32_16x16x64_bf16 v[60:63], v[40:43], a[64:71], v2
    ds_read_b128 v[84:87], v5 offset:8192
    s_add_u32 s43, s38, 79872
    v_smfmac_f32_16x16x64_bf16 v[64:67], v[40:43], a[72:79], v2
    s_waitcnt lgkmcnt(6)
    buffer_load_dwordx4 v3, s[4:7], s43 offen offset:2048 sc1 lds
    v_smfmac_f32_16x16x64_bf16 v[60:63], v[44:47], a[80:87], v2
    ds_read_b128 v[88:91], v5 offset:9216
    v_smfmac_f32_16x16x64_bf16 v[64:67], v[44:47], a[88:95], v2
    s_waitcnt lgkmcnt(6)
    s_add_u32 s43, s38, 119808
    buffer_load_dwordx4 v3, s[4:7], s43 offen offset:3072 sc1 lds
    v_smfmac_f32_16x16x64_bf16 v[60:63], v[48:51], v[92:99], v2
    ds_read_b128 v[92:95], v5 offset:10240
    v_smfmac_f32_16x16x64_bf16 v[64:67], v[48:51], a[96:103], v2
    s_waitcnt lgkmcnt(6)
    ds_read_b128 v[96:99], v5 offset:11264
    v_smfmac_f32_16x16x64_bf16 v[60:63], v[52:55], a[104:111], v2
    s_add_u32 m0, s54, 4096
    s_add_u32 s43, s39, 0
    v_smfmac_f32_16x16x64_bf16 v[64:67], v[52:55], a[112:119], v2
    s_waitcnt lgkmcnt(6)
    buffer_load_dwordx4 v17, s[4:7], s43 offen offset:0 sc1 lds
    v_smfmac_f32_16x16x64_bf16 v[60:63], v[56:59], a[120:127], v2
    s_waitcnt lgkmcnt(4)
    v_smfmac_f32_16x16x64_bf16 v[64:67], v[56:59], v[76:83], v2
    ds_read_b128 v[76:79], v5 offset:12288
    s_add_u32 s43, s39, 80896
    v_smfmac_f32_16x16x64_bf16 v[68:71], v[20:23], a[128:135], v2
    buffer_load_dwordx4 v17, s[4:7], s43 offen offset:1024 sc1 lds
    v_add_f32 v60, v60, v61
    v_smfmac_f32_16x16x64_bf16 v[68:71], v[24:27], a[136:143], v2
    ds_read_b128 v[80:83], v5 offset:13312
    v_add_f32 v62, v62, v63
    v_smfmac_f32_16x16x64_bf16 v[68:71], v[28:31], a[144:151], v2
    v_cvt_pk_bf16_f32 v60, v60, v62
    v_smfmac_f32_16x16x64_bf16 v[68:71], v[32:35], a[152:159], v2
    s_waitcnt lgkmcnt(4)
    ds_write_b16 v6, v60 offset:0
    v_smfmac_f32_16x16x64_bf16 v[68:71], v[36:39], v[84:91], v2
    ds_write_b16_d16_hi v6, v60 offset:4
    v_add_f32 v64, v64, v65
    v_smfmac_f32_16x16x64_bf16 v[68:71], v[40:43], a[160:167], v2
    ds_read_b128 v[84:87], v5 offset:14336
    v_add_f32 v66, v66, v67
    v_cvt_pk_bf16_f32 v64, v64, v66
    ds_write_b16 v6, v64 offset:256
    ds_write_b16_d16_hi v6, v64 offset:260
    v_smfmac_f32_16x16x64_bf16 v[68:71], v[44:47], a[168:175], v2
    s_waitcnt lgkmcnt(0)
    ds_read_b128 v[88:91], v5 offset:15360
    v_mov_b64 v[60:61], 0
    v_smfmac_f32_16x16x64_bf16 v[68:71], v[48:51], a[176:183], v2
    s_barrier
    ds_read_b64_tr_b16 v[20:21], v8 offset:0
    v_smfmac_f32_16x16x64_bf16 v[68:71], v[52:55], a[184:191], v2
    ds_read_b64_tr_b16 v[22:23], v8 offset:128
    v_mov_b64 v[62:63], 0
    ds_read_b64_tr_b16 v[24:25], v8 offset:1024
    ds_read_b64_tr_b16 v[26:27], v8 offset:1152
    v_smfmac_f32_16x16x64_bf16 v[68:71], v[56:59], v[92:99], v2
    s_waitcnt lgkmcnt(2)
    ds_read_b128 v[92:95], v5 offset:16384
    v_mov_b64 v[64:65], 0
    v_smfmac_f32_16x16x64_bf16 v[72:75], v[20:23], a[192:199], v2
    s_waitcnt lgkmcnt(1)
    ds_read_b128 v[96:99], v5 offset:17408
    v_mov_b64 v[66:67], 0
    v_smfmac_f32_16x16x64_bf16 v[72:75], v[24:27], a[200:207], v2
    v_mov_b64 v[32:33], 0
    v_mov_b64 v[34:35], 0
    v_smfmac_f32_16x16x64_bf16 v[112:115], v[20:23], a[208:215], v2
    v_add_f32 v68, v68, v69
    v_add_f32 v70, v70, v71
    v_smfmac_f32_16x16x64_bf16 v[112:115], v[24:27], a[216:223], v2
    v_cvt_pk_bf16_f32 v68, v68, v70
    v_mov_b64 v[36:37], 0
    v_smfmac_f32_16x16x64_bf16 v[116:119], v[20:23], v[76:83], v2
    ds_write_b16 v111, v68
    v_mov_b64 v[38:39], 0
    v_smfmac_f32_16x16x64_bf16 v[116:119], v[24:27], a[224:231], v2
    ds_write_b16_d16_hi v111, v68 offset:4
    v_mov_b64 v[40:41], 0
    v_smfmac_f32_16x16x64_bf16 v[60:63], v[20:23], a[232:239], v2
    ds_read_b128 v[76:79], v5 offset:18432
    v_mov_b64 v[42:43], 0
    v_smfmac_f32_16x16x64_bf16 v[60:63], v[24:27], a[240:247], v2
    s_waitcnt lgkmcnt(1)
    ds_read_b128 v[80:83], v5 offset:19456
    v_mov_b64 v[44:45], 0
    v_smfmac_f32_16x16x64_bf16 v[64:67], v[20:23], a[248:255], v2
    s_barrier
    ds_read_b64_tr_b16 v[28:29], v8 offset:2048
    v_smfmac_f32_16x16x64_bf16 v[64:67], v[24:27], v[84:91], v2
    ds_read_b64_tr_b16 v[30:31], v8 offset:2176
    v_mov_b64 v[46:47], 0
    v_smfmac_f32_16x16x64_bf16 v[32:35], v[20:23], v[128:135], v2
    ds_read_b128 v[84:87], v5 offset:20480
    v_mov_b64 v[68:69], 0
    v_smfmac_f32_16x16x64_bf16 v[32:35], v[24:27], v[136:143], v2
    s_waitcnt lgkmcnt(1)
    ds_read_b128 v[88:91], v5 offset:21504
    v_mov_b64 v[70:71], 0
    v_smfmac_f32_16x16x64_bf16 v[72:75], v[28:31], v[144:151], v2
    v_smfmac_f32_16x16x64_bf16 v[112:115], v[28:31], v[152:159], v2
    v_smfmac_f32_16x16x64_bf16 v[116:119], v[28:31], v[92:99], v2
    ds_read_b128 v[92:95], v5 offset:22528
    v_smfmac_f32_16x16x64_bf16 v[60:63], v[28:31], v[160:167], v2
    ds_read_b128 v[96:99], v5 offset:23552
    v_add_f32 v72, v72, v73
    v_smfmac_f32_16x16x64_bf16 v[36:39], v[20:23], v[168:175], v2
    v_add_f32 v74, v74, v75
    v_cvt_pk_bf16_f32 v100, v72, v74
    v_smfmac_f32_16x16x64_bf16 v[36:39], v[24:27], v[176:183], v2
    v_add_f32 v112, v112, v113
    v_add_f32 v114, v114, v115
    v_smfmac_f32_16x16x64_bf16 v[64:67], v[28:31], v[184:191], v2
    v_cvt_pk_bf16_f32 v101, v112, v114
    v_add_f32 v116, v116, v117
    v_smfmac_f32_16x16x64_bf16 v[40:43], v[20:23], v[76:83], v2
    v_add_f32 v118, v118, v119
    v_cvt_pk_bf16_f32 v102, v116, v118
    v_smfmac_f32_16x16x64_bf16 v[40:43], v[24:27], v[192:199], v2
    v_add_f32 v60, v60, v61
    v_add_f32 v62, v62, v63
    v_smfmac_f32_16x16x64_bf16 v[32:35], v[28:31], v[200:207], v2
    v_cvt_pk_bf16_f32 v103, v60, v62
    s_nop 0
    v_smfmac_f32_16x16x64_bf16 v[44:47], v[20:23], v[208:215], v2
    v_permlane32_swap_b32 v100, v102
    v_smfmac_f32_16x16x64_bf16 v[44:47], v[24:27], v[216:223], v2
    s_waitcnt lgkmcnt(2)
    v_permlane32_swap_b32 v101, v103
    v_smfmac_f32_16x16x64_bf16 v[36:39], v[28:31], v[84:91], v2
    s_nop 1
    v_smfmac_f32_16x16x64_bf16 v[68:71], v[20:23], v[224:231], v2
    v_permlane16_swap_b32 v100, v101
    v_smfmac_f32_16x16x64_bf16 v[68:71], v[24:27], v[232:239], v2
    v_permlane16_swap_b32 v102, v103
    v_smfmac_f32_16x16x64_bf16 v[40:43], v[28:31], v[240:247], v2
    s_add_u32 s26, s30, 0
    s_cmp_eq_u32 s25, 0
    s_cbranch_scc1 ds_s_204
    buffer_store_dwordx4 v[100:103], v125, s[4:7], s26 offen
ds_e_205:
    v_smfmac_f32_16x16x64_bf16 v[44:47], v[28:31], v[248:255], v2
    s_waitcnt lgkmcnt(0)
    v_add_f32 v64, v64, v65
    v_add_f32 v66, v66, v67
    v_smfmac_f32_16x16x64_bf16 v[68:71], v[28:31], v[92:99], v2
    v_cvt_pk_bf16_f32 v104, v64, v66
    v_add_f32 v32, v32, v33
    v_add_f32 v34, v34, v35
    v_cvt_pk_bf16_f32 v105, v32, v34
    v_add_f32 v36, v36, v37
    v_add_f32 v38, v38, v39
    v_cvt_pk_bf16_f32 v106, v36, v38
    v_add_f32 v40, v40, v41
    v_add_f32 v42, v42, v43
    v_cvt_pk_bf16_f32 v107, v40, v42
    v_add_f32 v44, v44, v45
    v_add_f32 v46, v46, v47
    v_cvt_pk_bf16_f32 v108, v44, v46
    v_permlane32_swap_b32 v104, v106
    v_permlane32_swap_b32 v105, v107
    s_nop 1
    v_permlane16_swap_b32 v104, v105
    v_permlane16_swap_b32 v106, v107
    s_add_u32 s26, s30, 32768
    s_cmp_eq_u32 s25, 0
    s_cbranch_scc1 ds_s_206
    buffer_store_dwordx4 v[104:107], v125, s[4:7], s26 offen
ds_e_207:
    s_nop 0
    v_add_f32 v68, v68, v69
    v_add_f32 v70, v70, v71
    v_cvt_pk_bf16_f32 v109, v68, v70
    s_nop 1
    v_permlane16_swap_b32 v108, v109
    s_cmp_eq_u32 s25, 0
    s_cbranch_scc1 ds_s_208
    buffer_store_dwordx2 v[108:109], v126, s[4:7], s30 offen
ds_e_209:
    s_cmp_eq_u32 s22, 63
    s_cbranch_scc1 CH_fin_200
    s_add_u32 s26, s32, s61
    s_add_u32 s27, s32, s62
    s_add_u32 s58, s30, s63
    s_add_u32 s43, s30, s64
    v_mov_b64 v[28:29], 0
    v_mov_b64 v[30:31], 0
    v_mov_b64 v[52:53], 0
    v_mov_b64 v[54:55], 0
    s_mov_b64 s[12:13], -1
    s_mov_b64 s[14:15], -1
    s_mov_b64 s[16:17], s[50:51]
    s_mov_b64 s[18:19], -1
    s_mov_b64 s[8:9], s[50:51]
    s_add_u32 s91, s22, 1
    s_lshl_b32 s91, s91, 24
    v_and_b32 v57, 15, v1
    v_lshlrev_b32 v57, 2, v57
    s_mov_b64 exec, 0xffff
HP_210:
    buffer_load_dword v58, v57, s[4:7], s90 offen sc1
    s_sub_u32 s28, s28, 1
    s_cbranch_scc1 HPe_212
    s_waitcnt vmcnt(0)
    v_cmp_gt_i32 vcc, s91, v58
    s_cbranch_vccnz HP_210
HPd_211:
    s_memrealtime s[76:77]
    s_nop 1
    v_max_i32_dpp v58, v58, v58 row_ror:1 row_mask:0xf bank_mask:0xf
    s_nop 1
    v_max_i32_dpp v58, v58, v58 row_ror:2 row_mask:0xf bank_mask:0xf
    s_nop 1
    v_max_i32_dpp v58, v58, v58 row_ror:4 row_mask:0xf bank_mask:0xf
    s_nop 1
    v_max_i32_dpp v58, v58, v58 row_ror:8 row_mask:0xf bank_mask:0xf
    s_nop 0
    v_readfirstlane_b32 s98, v58
    s_mov_b64 exec, -1
    v_lshrrev_b32 v59, 2, v3
    s_cmp_eq_u32 s24, 16
    v_mov_b32 v57, s98
    s_cselect_b32 exec_lo, -1, 0
    s_mov_b32 exec_hi, 0
    s_add_u32 s11, s37, s100
    buffer_store_dword v57, v59, s[4:7], s11 offen sc0 sc1
    s_mov_b64 exec, -1
    s_waitcnt lgkmcnt(0)
    s_add_u32 s77, s98, 32
    s_sub_u32 s77, s77, s76
    s_and_b32 s77, s77, 0xffffff
    s_cmp_gt_u32 s77, 120
    s_cselect_b32 s77, 0, s77
    s_mul_i32 s77, s77, 363
TW_213:
    s_sub_u32 s77, s77, 704
    s_cmp_gt_i32 s77, 0
    s_cbranch_scc1 TW_213
    s_barrier
GB_214:
    s_sub_u32 s28, s28, 1
    s_cbranch_scc1 GB_214_dead
    s_mov_b64 exec, s[12:13]
    buffer_load_dwordx4 v[20:23], v3, s[4:7], s26 offen offset:0 sc1
    s_mov_b64 exec, s[14:15]
    buffer_load_dwordx4 v[24:27], v3, s[4:7], s26 offen offset:1024 sc1
    s_mov_b64 exec, s[16:17]
    buffer_load_dwordx4 v[28:31], v10, s[4:7], s27 offen sc1
    s_mov_b64 exec, s[18:19]
    buffer_load_dwordx4 v[48:51], v3, s[4:7], s58 offen sc1
    s_mov_b64 exec, s[8:9]
    buffer_load_dwordx4 v[52:55], v124, s[4:7], s43 offen sc1
    s_mov_b64 exec, -1
    s_waitcnt vmcnt(5)
    ds_read_b128 v[76:79], v15 offset:0
    ds_read_b128 v[80:83], v15 offset:1024
    ds_read_b128 v[84:87], v15 offset:2048
    ds_read_b128 v[88:91], v15 offset:3072
    ds_read_b128 v[92:95], v18 offset:0
    ds_read_b128 v[96:99], v18 offset:128
    ds_read_b128 v[60:63], v18 offset:1024
    ds_read_b128 v[64:67], v18 offset:1152
    s_waitcnt vmcnt(3) lgkmcnt(0)
    v_mfma_f32_16x16x32_bf16 v[40:43], v[80:83], v[20:23], 0
    v_max_u32 v32, v20, v22
    v_mfma_f32_16x16x32_bf16 v[68:71], v[76:79], v[20:23], 0
    v_max_u32 v33, v24, v26
    v_mfma_f32_16x16x32_bf16 v[40:43], v[88:91], v[24:27], v[40:43]
    v_cmp_eq_u32 s[12:13], -1, v32
    v_mfma_f32_16x16x32_bf16 v[68:71], v[84:87], v[24:27], v[68:71]
    v_cmp_eq_u32 s[14:15], -1, v33
    v_mfma_f32_16x16x32_bf16 v[44:47], v[96:99], v[20:23], 0
    v_mfma_f32_16x16x32_bf16 v[72:75], v[92:95], v[20:23], 0
    v_mfma_f32_16x16x32_bf16 v[44:47], v[64:67], v[24:27], v[44:47]
    v_mfma_f32_16x16x32_bf16 v[72:75], v[60:63], v[24:27], v[72:75]
    s_waitcnt vmcnt(0)
    v_mfma_f32_16x16x32_bf16 v[68:71], v[48:51], v[28:31], v[68:71]
    v_max_u32 v34, v28, v30
    v_max_u32 v35, v48, v50
    v_mfma_f32_16x16x32_bf16 v[72:75], v[52:55], v[28:31], v[72:75]
    v_max_u32 v36, v52, v54
    v_cmp_eq_u32 s[16:17], -1, v34
    v_cmp_eq_u32 s[18:19], -1, v35
    v_cmp_eq_u32 s[8:9], -1, v36
    s_or_b64 vcc, s[12:13], s[14:15]
    s_or_b64 vcc, vcc, s[16:17]
    s_or_b64 vcc, vcc, s[18:19]
    s_or_b64 vcc, vcc, s[8:9]
    s_cbranch_scc1 GB_214
GB_214_ok:
    s_add_u32 s11, s36, s99
    s_mov_b64 exec, 1
    buffer_load_dword v58, v0, s[4:7], s11 offen sc1
    s_mov_b64 exec, -1
    s_nop 0
    v_add_f32_dpp v68, v40, v68 row_ror:8 row_mask:0xf bank_mask:0xf
    v_add_f32_dpp v69, v41, v69 row_ror:8 row_mask:0xf bank_mask:0xf
    v_add_f32_dpp v70, v42, v70 row_ror:8 row_mask:0xf bank_mask:0xf
    v_add_f32_dpp v71, v43, v71 row_ror:8 row_mask:0xf bank_mask:0xf
    v_add_f32_dpp v68, v72, v44 row_ror:8 row_mask:0xf bank_mask:0xc
    v_add_f32_dpp v69, v73, v45 row_ror:8 row_mask:0xf bank_mask:0xc
    v_add_f32_dpp v70, v74, v46 row_ror:8 row_mask:0xf bank_mask:0xc
    v_add_f32_dpp v71, v75, v47 row_ror:8 row_mask:0xf bank_mask:0xc
    ds_write_b128 v16, v[68:71] offset:0
    s_waitcnt lgkmcnt(0)
    s_barrier
    s_sleep 4
    s_add_u32 s27, s46, 32768
    s_cmp_eq_u32 s25, 0
    s_cbranch_scc1 ds_s_215
    buffer_store_dwordx4 v[120:123], v125, s[4:7], s46 offen
    buffer_store_dwordx4 v[120:123], v125, s[4:7], s27 offen
    buffer_store_dwordx2 v[120:121], v126, s[4:7], s46 offen
ds_e_216:
    v_cmp_le_u32 vcc, 32, v127
    s_add_u32 s26, s66, 1
    s_max_u32 s26, s26, s49
    s_cmp_lg_u64 vcc, 0
    s_cselect_b32 s49, s26, s49
    s_cselect_b32 s66, 2, 0
    s_add_u32 s58, s22, 1
    s_cmp_ge_u32 s58, s49
    s_cbranch_scc1 uc_s_217
uc_ok_218:
    s_add_u32 s66, s49, s66
    s_min_u32 s66, s66, 63
    s_lshl_b32 s26, s66, 7
    s_add_u32 s26, s26, 167841792
    buffer_load_dword v127, v0, s[4:7], s26 offen sc1
    s_add_u32 s22, s22, 1
    s_mov_b32 s26, s30
    s_mov_b32 s30, s31
    s_mov_b32 s31, s46
    s_mov_b32 s46, s26
    s_mov_b32 s26, s32
    s_mov_b32 s32, s33
    s_mov_b32 s33, s47
    s_mov_b32 s47, s26
    s_mov_b32 s26, s34
    s_mov_b32 s34, s35
    s_mov_b32 s35, s26
    s_add_u32 s38, s38, 1310720
    s_add_u32 s39, s39, 1310720
    s_add_u32 s57, s57, 128
    ds_read_b128 v[76:79], v5 offset:0
    ds_read_b128 v[80:83], v5 offset:1024
    ds_read_b128 v[84:87], v5 offset:2048
    ds_read_b128 v[88:91], v5 offset:3072
    ds_read_b128 v[92:95], v5 offset:4096
    ds_read_b128 v[96:99], v5 offset:5120
    v_mov_b64 v[28:29], 0
    v_mov_b64 v[30:31], 0
    v_mov_b64 v[40:41], 0
    v_mov_b64 v[42:43], 0
    s_add_u32 s10, s34, 4096
    s_add_u32 s11, s34, s65
    s_mov_b64 s[12:13], -1
    s_mov_b64 s[14:15], -1
    s_mov_b64 s[16:17], s[68:69]
    s_mov_b64 s[18:19], -1
    s_mov_b64 s[8:9], -1
    s_mov_b64 s[96:97], s[68:69]
    s_add_u32 s3, s36, 4096
    s_add_u32 s101, s36, s29
    s_waitcnt vmcnt(4)
    v_readfirstlane_b32 s27, v58
    s_cmp_lt_i32 s27, s91
    s_cbranch_scc1 XL_221
XLo_222:
    s_max_i32 s98, s98, s27
    s_memrealtime s[76:77]
    s_waitcnt lgkmcnt(0)
    s_add_u32 s77, s98, 98
    s_sub_u32 s77, s77, s76
    s_and_b32 s77, s77, 0xffffff
    s_cmp_gt_u32 s77, 120
    s_cselect_b32 s77, 0, s77
    s_mul_i32 s77, s77, 363
TW_223:
    s_sub_u32 s77, s77, 704
    s_cmp_gt_i32 s77, 0
    s_cbranch_scc1 TW_223
    s_barrier
    s_branch CH_top_199
GA_203_dead:
    s_mov_b32 s28, 0
    s_branch GA_203_ok
ds_s_204:
    buffer_store_dwordx4 v[100:103], v125, s[4:7], s26 offen sc0 sc1
    s_branch ds_e_205
ds_s_206:
    buffer_store_dwordx4 v[104:107], v125, s[4:7], s26 offen sc0 sc1
    s_branch ds_e_207
ds_s_208:
    buffer_store_dwordx2 v[108:109], v126, s[4:7], s30 offen sc0 sc1
    s_branch ds_e_209
HPe_212:
    s_mov_b32 s28, 0
    s_waitcnt vmcnt(0)
    s_branch HPd_211
GB_214_dead:
    s_mov_b32 s28, 0
    s_branch GB_214_ok
ds_s_215:
    buffer_store_dwordx4 v[120:123], v125, s[4:7], s46 offen sc0 sc1
    buffer_store_dwordx4 v[120:123], v125, s[4:7], s27 offen sc0 sc1
    buffer_store_dwordx2 v[120:121], v126, s[4:7], s46 offen sc0 sc1
    s_branch ds_e_216
uc_s_217:
    s_add_u32 s49, s58, 0
    s_min_u32 s49, s49, 63
    s_lshl_b32 s43, s49, 7
    s_add_u32 s43, s43, 167841792
    s_add_u32 s49, s49, 1
    buffer_load_dword v127, v0, s[4:7], s43 offen sc1
    s_waitcnt vmcnt(0)
    v_cmp_gt_u32 vcc, 32, v127
    s_cbranch_vccz uc_ok_218
    s_add_u32 s49, s58, 1
    s_min_u32 s58, s58, 63
    s_lshl_b32 s43, s58, 7
    s_add_u32 s43, s43, 167841792
uc_lp_219:
    buffer_load_dword v127, v0, s[4:7], s43 offen sc1
    s_waitcnt vmcnt(0)
    v_cmp_gt_u32 vcc, 32, v127
    s_cbranch_vccz uc_ok_218
    s_sub_u32 s28, s28, 1
    s_cbranch_scc0 uc_lp_219
    s_mov_b32 s28, 0
    s_branch uc_ok_218
XL_221:
    s_add_u32 s26, s36, s99
XL_221_l:
    buffer_load_dword v58, v0, s[4:7], s26 offen sc1
    s_sub_u32 s28, s28, 1
    s_cbranch_scc1 XL_221_d
    s_waitcnt vmcnt(0)
    v_readfirstlane_b32 s27, v58
    s_nop 0
    s_cmp_lt_i32 s27, s91
    s_cbranch_scc1 XL_221_l
    s_branch XLo_222
XL_221_d:
    s_mov_b32 s28, 0
    s_waitcnt vmcnt(0)
    s_branch XLo_222
CH_fin_200:
    s_add_u32 s27, s45, 32768
    buffer_store_dwordx4 v[100:103], v125, s[4:7], s45 offen sc0 sc1
    buffer_store_dwordx4 v[104:107], v125, s[4:7], s27 offen sc0 sc1
    buffer_store_dwordx2 v[108:109], v126, s[4:7], s45 offen sc0 sc1
    s_waitcnt vmcnt(0)
    s_barrier
    s_branch L_end
CLS_182:
    ds_read_b128 v[76:79], v5 offset:0
    ds_read_b128 v[80:83], v5 offset:1024
    ds_read_b128 v[84:87], v5 offset:2048
    ds_read_b128 v[88:91], v5 offset:3072
    ds_read_b128 v[92:95], v5 offset:4096
    ds_read_b128 v[96:99], v5 offset:5120
    v_mov_b64 v[60:61], 0
    v_mov_b64 v[62:63], 0
    v_mov_b64 v[64:65], 0
    v_mov_b64 v[66:67], 0
    v_mov_b64 v[68:69], 0
    v_mov_b64 v[70:71], 0
    s_waitcnt lgkmcnt(0)
    s_branch CH_ent_226
CH_top_224:
GA_228:
    s_sub_u32 s28, s28, 1
    s_cbranch_scc1 GA_228_dead
    s_mov_b64 exec, s[12:13]
    buffer_load_dwordx4 v[20:23], v7, s[4:7], s34 offen sc1
    s_mov_b64 exec, s[14:15]
    buffer_load_dwordx4 v[24:27], v7, s[4:7], s10 offen sc1
    s_mov_b64 exec, s[16:17]
    buffer_load_dwordx4 v[28:31], v7, s[4:7], s11 offen sc1
    s_mov_b64 exec, s[18:19]
    buffer_load_dwordx4 v[32:35], v7, s[4:7], s36 offen sc1
    s_mov_b64 exec, s[8:9]
    buffer_load_dwordx4 v[36:39], v7, s[4:7], s3 offen sc1
    s_mov_b64 exec, s[96:97]
    buffer_load_dwordx4 v[40:43], v7, s[4:7], s101 offen sc1
    s_mov_b64 exec, -1
    s_add_u32 s26, s45, s63
    buffer_store_dwordx4 v[48:51], v3, s[4:7], s26 offen sc0 sc1
    s_add_u32 s26, s45, s64
    s_mov_b64 exec, s[50:51]
    buffer_store_dwordx4 v[52:55], v124, s[4:7], s26 offen sc0 sc1
    s_mov_b64 exec, -1
    s_mov_b64 exec, s[52:53]
    s_cmp_eq_u32 s25, 0
    s_cbranch_scc1 ds_s_229
    buffer_store_dwordx2 v[120:121], v14, s[4:7], s35 offen
ds_e_230:
    s_mov_b64 exec, -1
    s_waitcnt vmcnt(6)
    v_max_u32 v72, v20, v22
    v_max_u32 v73, v24, v26
    v_max_u32 v74, v28, v30
    v_cmp_eq_u32 s[12:13], -1, v72
    v_cmp_eq_u32 s[14:15], -1, v73
    v_cmp_eq_u32 s[16:17], -1, v74
    v_lshlrev_b32 v100, 16, v20
    v_and_b32 v101, 0xffff0000, v20
    v_lshlrev_b32 v102, 16, v21
    v_and_b32 v103, 0xffff0000, v21
    v_lshlrev_b32 v104, 16, v22
    v_and_b32 v105, 0xffff0000, v22
    v_lshlrev_b32 v106, 16, v23
    v_and_b32 v107, 0xffff0000, v23
    v_lshlrev_b32 v108, 16, v24
    v_and_b32 v109, 0xffff0000, v24
    v_lshlrev_b32 v112, 16, v25
    v_and_b32 v113, 0xffff0000, v25
    v_lshlrev_b32 v114, 16, v26
    v_and_b32 v115, 0xffff0000, v26
    v_lshlrev_b32 v116, 16, v27
    v_and_b32 v117, 0xffff0000, v27
    v_lshlrev_b32 v118, 16, v28
    v_and_b32 v119, 0xffff0000, v28
    v_lshlrev_b32 v56, 16, v29
    v_and_b32 v57, 0xffff0000, v29
    v_lshlrev_b32 v58, 16, v30
    v_and_b32 v59, 0xffff0000, v30
    v_lshlrev_b32 v73, 16, v31
    v_and_b32 v74, 0xffff0000, v31
    s_waitcnt vmcnt(5)
    v_max_u32 v72, v32, v34
    v_dot2_f32_bf16 v60, v32, s40, v100
    v_dot2_f32_bf16 v61, v32, s41, v101
    v_dot2_f32_bf16 v62, v33, s40, v102
    v_dot2_f32_bf16 v63, v33, s41, v103
    v_dot2_f32_bf16 v64, v34, s40, v104
    v_dot2_f32_bf16 v65, v34, s41, v105
    v_dot2_f32_bf16 v66, v35, s40, v106
    v_dot2_f32_bf16 v67, v35, s41, v107
    v_cmp_eq_u32 s[18:19], -1, v72
    v_cvt_pk_bf16_f32 v68, v60, v61
    v_cvt_pk_bf16_f32 v69, v62, v63
    v_cvt_pk_bf16_f32 v70, v64, v65
    v_cvt_pk_bf16_f32 v71, v66, v67
    ds_write_b128 v19, v[68:71] offset:0
    s_waitcnt vmcnt(4)
    v_max_u32 v72, v36, v38
    v_dot2_f32_bf16 v60, v36, s40, v108
    v_dot2_f32_bf16 v61, v36, s41, v109
    v_dot2_f32_bf16 v62, v37, s40, v112
    v_dot2_f32_bf16 v63, v37, s41, v113
    v_dot2_f32_bf16 v64, v38, s40, v114
    v_dot2_f32_bf16 v65, v38, s41, v115
    v_dot2_f32_bf16 v66, v39, s40, v116
    v_dot2_f32_bf16 v67, v39, s41, v117
    v_cmp_eq_u32 s[8:9], -1, v72
    v_cvt_pk_bf16_f32 v44, v60, v61
    v_cvt_pk_bf16_f32 v45, v62, v63
    v_cvt_pk_bf16_f32 v46, v64, v65
    v_cvt_pk_bf16_f32 v47, v66, v67
    ds_write_b128 v19, v[44:47] offset:4096
    s_waitcnt vmcnt(3)
    v_max_u32 v72, v40, v42
    v_dot2_f32_bf16 v60, v40, s40, v118
    v_dot2_f32_bf16 v61, v40, s41, v119
    v_dot2_f32_bf16 v62, v41, s40, v56
    v_dot2_f32_bf16 v63, v41, s41, v57
    v_dot2_f32_bf16 v64, v42, s40, v58
    v_dot2_f32_bf16 v65, v42, s41, v59
    v_dot2_f32_bf16 v66, v43, s40, v73
    v_dot2_f32_bf16 v67, v43, s41, v74
    v_cmp_eq_u32 s[96:97], -1, v72
    v_cvt_pk_bf16_f32 v68, v60, v61
    v_cvt_pk_bf16_f32 v69, v62, v63
    v_cvt_pk_bf16_f32 v70, v64, v65
    v_cvt_pk_bf16_f32 v71, v66, v67
    s_mov_b64 exec, s[68:69]
    ds_write_b128 v9, v[68:71] offset:0
    s_mov_b64 exec, -1
    s_or_b64 vcc, s[12:13], s[14:15]
    s_or_b64 vcc, vcc, s[16:17]
    s_or_b64 vcc, vcc, s[18:19]
    s_or_b64 vcc, vcc, s[8:9]
    s_or_b64 vcc, vcc, s[96:97]
    s_cbranch_scc1 GA_228
GA_228_ok:
    v_mov_b64 v[60:61], 0
    v_mov_b64 v[62:63], 0
    v_mov_b64 v[64:65], 0
    v_mov_b64 v[66:67], 0
    v_mov_b64 v[68:69], 0
    v_mov_b64 v[70:71], 0
    s_add_u32 s45, s45, 327680
    s_cmp_eq_u32 s22, 42
    s_cselect_b32 s26, s55, 49152
    s_add_u32 s36, s36, s26
    s_add_u32 s37, s37, s26
    s_waitcnt lgkmcnt(0)
CH_ent_226:
    s_barrier
    ds_read_b128 v[20:23], v4 offset:0
    ds_read_b128 v[24:27], v4 offset:1024
    ds_read_b128 v[28:31], v4 offset:2048
    s_waitcnt lgkmcnt(2)
    v_smfmac_f32_16x16x64_bf16 v[60:63], v[20:23], a[0:7], v2
    ds_read_b128 v[32:35], v4 offset:3072
    v_mov_b64 v[72:73], 0
    v_smfmac_f32_16x16x64_bf16 v[64:67], v[20:23], a[8:15], v2
    s_waitcnt lgkmcnt(2)
    ds_read_b128 v[36:39], v4 offset:4096
    v_mov_b64 v[74:75], 0
    v_smfmac_f32_16x16x64_bf16 v[60:63], v[24:27], a[16:23], v2
    ds_read_b128 v[40:43], v4 offset:5120
    v_mov_b64 v[112:113], 0
    v_smfmac_f32_16x16x64_bf16 v[64:67], v[24:27], a[24:31], v2
    s_waitcnt lgkmcnt(3)
    ds_read_b128 v[44:47], v4 offset:6144
    v_mov_b64 v[114:115], 0
    v_smfmac_f32_16x16x64_bf16 v[60:63], v[28:31], v[76:83], v2
    ds_read_b128 v[48:51], v4 offset:7168
    v_mov_b64 v[116:117], 0
    s_mov_b32 m0, s54
    s_add_u32 s43, s38, 0
    buffer_load_dwordx4 v3, s[4:7], s43 offen offset:0 sc1 lds
    v_smfmac_f32_16x16x64_bf16 v[64:67], v[28:31], a[32:39], v2
    s_waitcnt lgkmcnt(4)
    ds_read_b128 v[52:55], v4 offset:8192
    v_mov_b64 v[118:119], 0
    v_smfmac_f32_16x16x64_bf16 v[60:63], v[32:35], a[40:47], v2
    ds_read_b128 v[56:59], v4 offset:9216
    s_add_u32 s43, s38, 39936
    v_smfmac_f32_16x16x64_bf16 v[64:67], v[32:35], a[48:55], v2
    s_waitcnt lgkmcnt(5)
    buffer_load_dwordx4 v3, s[4:7], s43 offen offset:1024 sc1 lds
    v_smfmac_f32_16x16x64_bf16 v[60:63], v[36:39], a[56:63], v2
    ds_read_b128 v[76:79], v5 offset:6144
    s_add_u32 s43, s38, 79872
    v_smfmac_f32_16x16x64_bf16 v[64:67], v[36:39], v[84:91], v2
    s_waitcnt lgkmcnt(5)
    buffer_load_dwordx4 v3, s[4:7], s43 offen offset:2048 sc1 lds
    v_smfmac_f32_16x16x64_bf16 v[60:63], v[40:43], a[64:71], v2
    ds_read_b128 v[80:83], v5 offset:7168
    v_smfmac_f32_16x16x64_bf16 v[64:67], v[40:43], a[72:79], v2
    s_waitcnt lgkmcnt(5)
    ds_read_b128 v[84:87], v5 offset:8192
    s_add_u32 s43, s38, 119808
    v_smfmac_f32_16x16x64_bf16 v[60:63], v[44:47], a[80:87], v2
    buffer_load_dwordx4 v3, s[4:7], s43 offen offset:3072 sc1 lds
    v_smfmac_f32_16x16x64_bf16 v[64:67], v[44:47], a[88:95], v2
    s_waitcnt lgkmcnt(5)
    ds_read_b128 v[88:91], v5 offset:9216
    v_smfmac_f32_16x16x64_bf16 v[60:63], v[48:51], v[92:99], v2
    ds_read_b128 v[92:95], v5 offset:10240
    s_add_u32 m0, s54, 4096
    v_smfmac_f32_16x16x64_bf16 v[64:67], v[48:51], a[96:103], v2
    s_waitcnt lgkmcnt(6)
    ds_read_b128 v[96:99], v5 offset:11264
    s_add_u32 s43, s39, 0
    v_smfmac_f32_16x16x64_bf16 v[60:63], v[52:55], a[104:111], v2
    buffer_load_dwordx4 v17, s[4:7], s43 offen offset:0 sc1 lds
    v_smfmac_f32_16x16x64_bf16 v[64:67], v[52:55], a[112:119], v2
    s_waitcnt lgkmcnt(6)
    s_add_u32 s43, s39, 80896
    buffer_load_dwordx4 v17, s[4:7], s43 offen offset:1024 sc1 lds
    v_smfmac_f32_16x16x64_bf16 v[60:63], v[56:59], a[120:127], v2
    s_waitcnt lgkmcnt(4)
    v_smfmac_f32_16x16x64_bf16 v[64:67], v[56:59], v[76:83], v2
    ds_read_b128 v[76:79], v5 offset:12288
    v_smfmac_f32_16x16x64_bf16 v[68:71], v[20:23], a[128:135], v2
    s_cmp_eq_u32 s24, 16
    s_cbranch_scc1 an_231
ab_232:
    v_smfmac_f32_16x16x64_bf16 v[68:71], v[24:27], a[136:143], v2
    ds_read_b128 v[80:83], v5 offset:13312
    v_add_f32 v60, v60, v61
    v_smfmac_f32_16x16x64_bf16 v[68:71], v[28:31], a[144:151], v2
    v_add_f32 v62, v62, v63
    v_cvt_pk_bf16_f32 v60, v60, v62
    v_smfmac_f32_16x16x64_bf16 v[68:71], v[32:35], a[152:159], v2
    s_waitcnt lgkmcnt(4)
    ds_write_b16 v6, v60 offset:0
    v_smfmac_f32_16x16x64_bf16 v[68:71], v[36:39], v[84:91], v2
    ds_write_b16_d16_hi v6, v60 offset:4
    v_add_f32 v64, v64, v65
    v_smfmac_f32_16x16x64_bf16 v[68:71], v[40:43], a[160:167], v2
    ds_read_b128 v[84:87], v5 offset:14336
    v_add_f32 v66, v66, v67
    v_cvt_pk_bf16_f32 v64, v64, v66
    ds_write_b16 v6, v64 offset:256
    ds_write_b16_d16_hi v6, v64 offset:260
    v_smfmac_f32_16x16x64_bf16 v[68:71], v[44:47], a[168:175], v2
    s_waitcnt lgkmcnt(0)
    ds_read_b128 v[88:91], v5 offset:15360
    v_mov_b64 v[60:61], 0
    v_smfmac_f32_16x16x64_bf16 v[68:71], v[48:51], a[176:183], v2
    s_barrier
    ds_read_b64_tr_b16 v[20:21], v8 offset:0
    v_smfmac_f32_16x16x64_bf16 v[68:71], v[52:55], a[184:191], v2
    ds_read_b64_tr_b16 v[22:23], v8 offset:128
    v_mov_b64 v[62:63], 0
    ds_read_b64_tr_b16 v[24:25], v8 offset:1024
    ds_read_b64_tr_b16 v[26:27], v8 offset:1152
    v_smfmac_f32_16x16x64_bf16 v[68:71], v[56:59], v[92:99], v2
    s_waitcnt lgkmcnt(2)
    ds_read_b128 v[92:95], v5 offset:16384
    v_mov_b64 v[64:65], 0
    v_smfmac_f32_16x16x64_bf16 v[72:75], v[20:23], a[192:199], v2
    s_waitcnt lgkmcnt(1)
    ds_read_b128 v[96:99], v5 offset:17408
    v_mov_b64 v[66:67], 0
    v_smfmac_f32_16x16x64_bf16 v[72:75], v[24:27], a[200:207], v2
    v_mov_b64 v[32:33], 0
    v_mov_b64 v[34:35], 0
    v_smfmac_f32_16x16x64_bf16 v[112:115], v[20:23], a[208:215], v2
    v_add_f32 v68, v68, v69
    v_add_f32 v70, v70, v71
    v_smfmac_f32_16x16x64_bf16 v[112:115], v[24:27], a[216:223], v2
    v_cvt_pk_bf16_f32 v68, v68, v70
    v_mov_b64 v[36:37], 0
    v_smfmac_f32_16x16x64_bf16 v[116:119], v[20:23], v[76:83], v2
    ds_write_b16 v111, v68
    v_mov_b64 v[38:39], 0
    v_smfmac_f32_16x16x64_bf16 v[116:119], v[24:27], a[224:231], v2
    ds_write_b16_d16_hi v111, v68 offset:4
    v_mov_b64 v[40:41], 0
    v_smfmac_f32_16x16x64_bf16 v[60:63], v[20:23], a[232:239], v2
    ds_read_b128 v[76:79], v5 offset:18432
    v_mov_b64 v[42:43], 0
    v_smfmac_f32_16x16x64_bf16 v[60:63], v[24:27], a[240:247], v2
    s_waitcnt lgkmcnt(1)
    ds_read_b128 v[80:83], v5 offset:19456
    v_mov_b64 v[44:45], 0
    v_smfmac_f32_16x16x64_bf16 v[64:67], v[20:23], a[248:255], v2
    s_barrier
    ds_read_b64_tr_b16 v[28:29], v8 offset:2048
    v_smfmac_f32_16x16x64_bf16 v[64:67], v[24:27], v[84:91], v2
    ds_read_b64_tr_b16 v[30:31], v8 offset:2176
    v_mov_b64 v[46:47], 0
    v_smfmac_f32_16x16x64_bf16 v[32:35], v[20:23], v[128:135], v2
    ds_read_b128 v[84:87], v5 offset:20480
    v_mov_b64 v[68:69], 0
    v_smfmac_f32_16x16x64_bf16 v[32:35], v[24:27], v[136:143], v2
    s_waitcnt lgkmcnt(1)
    ds_read_b128 v[88:91], v5 offset:21504
    v_mov_b64 v[70:71], 0
    v_smfmac_f32_16x16x64_bf16 v[72:75], v[28:31], v[144:151], v2
    v_smfmac_f32_16x16x64_bf16 v[112:115], v[28:31], v[152:159], v2
    v_smfmac_f32_16x16x64_bf16 v[116:119], v[28:31], v[92:99], v2
    ds_read_b128 v[92:95], v5 offset:22528
    v_smfmac_f32_16x16x64_bf16 v[60:63], v[28:31], v[160:167], v2
    ds_read_b128 v[96:99], v5 offset:23552
    v_add_f32 v72, v72, v73
    v_smfmac_f32_16x16x64_bf16 v[36:39], v[20:23], v[168:175], v2
    v_add_f32 v74, v74, v75
    v_cvt_pk_bf16_f32 v100, v72, v74
    v_smfmac_f32_16x16x64_bf16 v[36:39], v[24:27], v[176:183], v2
    v_add_f32 v112, v112, v113
    v_add_f32 v114, v114, v115
    v_smfmac_f32_16x16x64_bf16 v[64:67], v[28:31], v[184:191], v2
    v_cvt_pk_bf16_f32 v101, v112, v114
    v_add_f32 v116, v116, v117
    v_smfmac_f32_16x16x64_bf16 v[40:43], v[20:23], v[76:83], v2
    v_add_f32 v118, v118, v119
    v_cvt_pk_bf16_f32 v102, v116, v118
    v_smfmac_f32_16x16x64_bf16 v[40:43], v[24:27], v[192:199], v2
    v_add_f32 v60, v60, v61
    v_add_f32 v62, v62, v63
    v_smfmac_f32_16x16x64_bf16 v[32:35], v[28:31], v[200:207], v2
    v_cvt_pk_bf16_f32 v103, v60, v62
    s_nop 0
    v_smfmac_f32_16x16x64_bf16 v[44:47], v[20:23], v[208:215], v2
    v_permlane32_swap_b32 v100, v102
    v_smfmac_f32_16x16x64_bf16 v[44:47], v[24:27], v[216:223], v2
    s_waitcnt lgkmcnt(2)
    v_permlane32_swap_b32 v101, v103
    v_smfmac_f32_16x16x64_bf16 v[36:39], v[28:31], v[84:91], v2
    s_nop 1
    v_smfmac_f32_16x16x64_bf16 v[68:71], v[20:23], v[224:231], v2
    v_permlane16_swap_b32 v100, v101
    v_smfmac_f32_16x16x64_bf16 v[68:71], v[24:27], v[232:239], v2
    v_permlane16_swap_b32 v102, v103
    v_smfmac_f32_16x16x64_bf16 v[40:43], v[28:31], v[240:247], v2
    s_add_u32 s26, s30, 0
    s_cmp_eq_u32 s25, 0
    s_cbranch_scc1 ds_s_233
    buffer_store_dwordx4 v[100:103], v125, s[4:7], s26 offen
ds_e_234:
    v_smfmac_f32_16x16x64_bf16 v[44:47], v[28:31], v[248:255], v2
    s_waitcnt lgkmcnt(0)
    v_add_f32 v64, v64, v65
    v_add_f32 v66, v66, v67
    v_smfmac_f32_16x16x64_bf16 v[68:71], v[28:31], v[92:99], v2
    v_cvt_pk_bf16_f32 v104, v64, v66
    v_add_f32 v32, v32, v33
    v_add_f32 v34, v34, v35
    v_cvt_pk_bf16_f32 v105, v32, v34
    v_add_f32 v36, v36, v37
    v_add_f32 v38, v38, v39
    v_cvt_pk_bf16_f32 v106, v36, v38
    v_add_f32 v40, v40, v41
    v_add_f32 v42, v42, v43
    v_cvt_pk_bf16_f32 v107, v40, v42
    v_add_f32 v44, v44, v45
    v_add_f32 v46, v46, v47
    v_cvt_pk_bf16_f32 v108, v44, v46
    v_permlane32_swap_b32 v104, v106
    v_permlane32_swap_b32 v105, v107
    s_nop 1
    v_permlane16_swap_b32 v104, v105
    v_permlane16_swap_b32 v106, v107
    s_add_u32 s26, s30, 32768
    s_cmp_eq_u32 s25, 0
    s_cbranch_scc1 ds_s_235
    buffer_store_dwordx4 v[104:107], v125, s[4:7], s26 offen
ds_e_236:
    s_waitcnt vmcnt(8)
    v_add_f32 v68, v68, v69
    v_add_f32 v70, v70, v71
    v_cvt_pk_bf16_f32 v109, v68, v70
    s_nop 1
    v_permlane16_swap_b32 v108, v109
    s_cmp_eq_u32 s25, 0
    s_cbranch_scc1 ds_s_237
    buffer_store_dwordx2 v[108:109], v126, s[4:7], s30 offen
ds_e_238:
    s_cmp_eq_u32 s22, 63
    s_cbranch_scc1 CH_fin_225
    s_add_u32 s26, s32, s61
    s_add_u32 s27, s32, s62
    s_add_u32 s58, s30, s63
    s_add_u32 s43, s30, s64
    v_mov_b64 v[28:29], 0
    v_mov_b64 v[30:31], 0
    v_mov_b64 v[52:53], 0
    v_mov_b64 v[54:55], 0
    s_mov_b64 s[12:13], -1
    s_mov_b64 s[14:15], -1
    s_mov_b64 s[16:17], s[50:51]
    s_mov_b64 s[18:19], -1
    s_mov_b64 s[8:9], s[50:51]
    s_barrier
GB_239:
    s_sub_u32 s28, s28, 1
    s_cbranch_scc1 GB_239_dead
    s_mov_b64 exec, s[12:13]
    buffer_load_dwordx4 v[20:23], v3, s[4:7], s26 offen offset:0 sc1
    s_mov_b64 exec, s[14:15]
    buffer_load_dwordx4 v[24:27], v3, s[4:7], s26 offen offset:1024 sc1
    s_mov_b64 exec, s[16:17]
    buffer_load_dwordx4 v[28:31], v10, s[4:7], s27 offen sc1
    s_mov_b64 exec, s[18:19]
    buffer_load_dwordx4 v[48:51], v3, s[4:7], s58 offen sc1
    s_mov_b64 exec, s[8:9]
    buffer_load_dwordx4 v[52:55], v124, s[4:7], s43 offen sc1
    s_mov_b64 exec, -1
    s_waitcnt vmcnt(5)
    ds_read_b128 v[76:79], v15 offset:0
    ds_read_b128 v[80:83], v15 offset:1024
    ds_read_b128 v[84:87], v15 offset:2048
    ds_read_b128 v[88:91], v15 offset:3072
    ds_read_b128 v[92:95], v18 offset:0
    ds_read_b128 v[96:99], v18 offset:128
    ds_read_b128 v[60:63], v18 offset:1024
    ds_read_b128 v[64:67], v18 offset:1152
    s_waitcnt vmcnt(3) lgkmcnt(0)
    v_mfma_f32_16x16x32_bf16 v[40:43], v[80:83], v[20:23], 0
    v_max_u32 v32, v20, v22
    v_mfma_f32_16x16x32_bf16 v[68:71], v[76:79], v[20:23], 0
    v_max_u32 v33, v24, v26
    v_mfma_f32_16x16x32_bf16 v[40:43], v[88:91], v[24:27], v[40:43]
    v_cmp_eq_u32 s[12:13], -1, v32
    v_mfma_f32_16x16x32_bf16 v[68:71], v[84:87], v[24:27], v[68:71]
    v_cmp_eq_u32 s[14:15], -1, v33
    v_mfma_f32_16x16x32_bf16 v[44:47], v[96:99], v[20:23], 0
    v_mfma_f32_16x16x32_bf16 v[72:75], v[92:95], v[20:23], 0
    v_mfma_f32_16x16x32_bf16 v[44:47], v[64:67], v[24:27], v[44:47]
    v_mfma_f32_16x16x32_bf16 v[72:75], v[60:63], v[24:27], v[72:75]
    s_waitcnt vmcnt(0)
    v_mfma_f32_16x16x32_bf16 v[68:71], v[48:51], v[28:31], v[68:71]
    v_max_u32 v34, v28, v30
    v_max_u32 v35, v48, v50
    v_mfma_f32_16x16x32_bf16 v[72:75], v[52:55], v[28:31], v[72:75]
    v_max_u32 v36, v52, v54
    v_cmp_eq_u32 s[16:17], -1, v34
    v_cmp_eq_u32 s[18:19], -1, v35
    v_cmp_eq_u32 s[8:9], -1, v36
    s_or_b64 vcc, s[12:13], s[14:15]
    s_or_b64 vcc, vcc, s[16:17]
    s_or_b64 vcc, vcc, s[18:19]
    s_or_b64 vcc, vcc, s[8:9]
    s_cbranch_scc1 GB_239
GB_239_ok:
    s_nop 0
    v_add_f32_dpp v68, v40, v68 row_ror:8 row_mask:0xf bank_mask:0xf
    v_add_f32_dpp v69, v41, v69 row_ror:8 row_mask:0xf bank_mask:0xf
    v_add_f32_dpp v70, v42, v70 row_ror:8 row_mask:0xf bank_mask:0xf
    v_add_f32_dpp v71, v43, v71 row_ror:8 row_mask:0xf bank_mask:0xf
    v_add_f32_dpp v68, v72, v44 row_ror:8 row_mask:0xf bank_mask:0xc
    v_add_f32_dpp v69, v73, v45 row_ror:8 row_mask:0xf bank_mask:0xc
    v_add_f32_dpp v70, v74, v46 row_ror:8 row_mask:0xf bank_mask:0xc
    v_add_f32_dpp v71, v75, v47 row_ror:8 row_mask:0xf bank_mask:0xc
    ds_write_b128 v16, v[68:71] offset:0
    s_waitcnt lgkmcnt(0)
    s_barrier
    ds_read_b128 v[20:23], v12 offset:0
    ds_read_b128 v[24:27], v12 offset:1024
    ds_read_b128 v[28:31], v12 offset:2048
    ds_read_b128 v[32:35], v12 offset:3072
    s_waitcnt lgkmcnt(2)
    v_add_f32 v20, v20, v24
    v_add_f32 v21, v21, v25
    v_add_f32 v22, v22, v26
    v_add_f32 v23, v23, v27
    s_waitcnt lgkmcnt(1)
    v_add_f32 v20, v20, v28
    v_add_f32 v21, v21, v29
    v_add_f32 v22, v22, v30
    v_add_f32 v23, v23, v31
    s_waitcnt lgkmcnt(0)
    v_add_f32 v20, v20, v32
    v_add_f32 v21, v21, v33
    v_add_f32 v22, v22, v34
    v_add_f32 v23, v23, v35
    v_cvt_pk_bf16_f32 v44, v20, v21
    v_cvt_pk_bf16_f32 v45, v22, v23
    v_mov_b64 v[46:47], v[44:45]
    s_nop 1
    v_permlane16_swap_b32 v44, v46
    v_permlane16_swap_b32 v45, v47
    s_mov_b32 exec_lo, 0x0000ffff
    s_mov_b32 exec_hi, 0x000000ff
    buffer_store_dwordx4 v[44:47], v110, s[4:7], s37 offen sc0 sc1
    s_cmp_eq_u32 s25, 0
    s_cbranch_scc1 ds_s_240
    buffer_store_dwordx4 v[44:47], v14, s[4:7], s35 offen
ds_e_241:
    s_mov_b64 exec, -1
    s_add_u32 s27, s46, 32768
    s_cmp_eq_u32 s25, 0
    s_cbranch_scc1 ds_s_242
    buffer_store_dwordx4 v[120:123], v125, s[4:7], s46 offen
    buffer_store_dwordx4 v[120:123], v125, s[4:7], s27 offen
    buffer_store_dwordx2 v[120:121], v126, s[4:7], s46 offen
ds_e_243:
    s_add_u32 s22, s22, 1
    s_mov_b32 s26, s30
    s_mov_b32 s30, s31
    s_mov_b32 s31, s46
    s_mov_b32 s46, s26
    s_mov_b32 s26, s32
    s_mov_b32 s32, s33
    s_mov_b32 s33, s47
    s_mov_b32 s47, s26
    s_mov_b32 s26, s34
    s_mov_b32 s34, s35
    s_mov_b32 s35, s26
    s_add_u32 s38, s38, 1310720
    s_add_u32 s39, s39, 1310720
    s_add_u32 s57, s57, 128
    ds_read_b128 v[76:79], v5 offset:0
    ds_read_b128 v[80:83], v5 offset:1024
    ds_read_b128 v[84:87], v5 offset:2048
    ds_read_b128 v[88:91], v5 offset:3072
    ds_read_b128 v[92:95], v5 offset:4096
    ds_read_b128 v[96:99], v5 offset:5120
    v_mov_b64 v[28:29], 0
    v_mov_b64 v[30:31], 0
    v_mov_b64 v[40:41], 0
    v_mov_b64 v[42:43], 0
    s_add_u32 s10, s34, 4096
    s_add_u32 s11, s34, s65
    s_mov_b64 s[12:13], -1
    s_mov_b64 s[14:15], -1
    s_mov_b64 s[16:17], s[68:69]
    s_mov_b64 s[18:19], -1
    s_mov_b64 s[8:9], -1
    s_mov_b64 s[96:97], s[68:69]
    s_add_u32 s3, s36, 4096
    s_add_u32 s101, s36, s29
    s_sleep 2
    s_barrier
    s_branch CH_top_224
ds_s_229:
    buffer_store_dwordx2 v[120:121], v14, s[4:7], s35 offen sc0 sc1
    s_branch ds_e_230
GA_228_dead:
    s_mov_b32 s28, 0
    s_branch GA_228_ok
an_231:
    s_cmp_lt_u32 s22, 2
    s_cbranch_scc1 ab_232
    v_mov_b32 v11, 32
    s_mov_b64 exec, 1
    buffer_atomic_add v11, v0, s[4:7], s57 offen sc1
    s_mov_b64 exec, -1
    s_branch ab_232
ds_s_233:
    buffer_store_dwordx4 v[100:103], v125, s[4:7], s26 offen sc0 sc1
    s_branch ds_e_234
ds_s_235:
    buffer_store_dwordx4 v[104:107], v125, s[4:7], s26 offen sc0 sc1
    s_branch ds_e_236
ds_s_237:
    buffer_store_dwordx2 v[108:109], v126, s[4:7], s30 offen sc0 sc1
    s_branch ds_e_238
GB_239_dead:
    s_mov_b32 s28, 0
    s_branch GB_239_ok
ds_s_240:
    buffer_store_dwordx4 v[44:47], v14, s[4:7], s35 offen sc0 sc1
    s_branch ds_e_241
ds_s_242:
    buffer_store_dwordx4 v[120:123], v125, s[4:7], s46 offen sc0 sc1
    buffer_store_dwordx4 v[120:123], v125, s[4:7], s27 offen sc0 sc1
    buffer_store_dwordx2 v[120:121], v126, s[4:7], s46 offen sc0 sc1
    s_branch ds_e_243
CH_fin_225:
    s_add_u32 s27, s45, 32768
    buffer_store_dwordx4 v[100:103], v125, s[4:7], s45 offen sc0 sc1
    buffer_store_dwordx4 v[104:107], v125, s[4:7], s27 offen sc0 sc1
    buffer_store_dwordx2 v[108:109], v126, s[4:7], s45 offen sc0 sc1
    s_waitcnt vmcnt(0)
    s_barrier
    v_mov_b32 v56, 1
    v_mov_b32 v57, 64
    s_add_u32 s26, s56, 167837696
    s_mov_b64 exec, 1
    buffer_atomic_add v56, v0, s[4:7], s57 offen offset:128 sc1
    buffer_atomic_add v56, v0, s[4:7], s57 offen offset:256 sc1
    s_mov_b64 exec, -1
    s_branch L_end
L_bulk:
    s_mul_i32 s25, s24, 6
    s_add_u32 s25, s25, s23
    s_sub_u32 s25, s25, 2
    s_and_b32 s21, s25, 31
    s_cmp_ge_u32 s25, 64
    s_cbranch_scc1 L_notkv
    s_load_dwordx2 s[8:9], s[0:1], 24
    s_load_dwordx2 s[10:11], s[0:1], 32
    s_lshl_b32 s3, s21, 7
    s_waitcnt lgkmcnt(0)
    s_cmp_ge_u32 s25, 32
    s_cselect_b32 s8, s10, s8
    s_cselect_b32 s9, s11, s9
    s_cselect_b32 s24, 25165824, 0
    s_cselect_b32 s27, 4096, 0
    s_add_u32 s3, s3, 167829504
    s_add_u32 s27, s27, s3
    s_and_b32 s9, s9, 0xffff
    s_mov_b32 s10, 7864320
    s_mov_b32 s11, 0x20000
    s_load_dwordx2 s[12:13], s[0:1], 0
    s_mul_i32 s30, s21, 384
    s_mul_i32 s26, s21, 12288
    s_add_u32 s24, s24, s26
    s_waitcnt lgkmcnt(0)
    s_and_b32 s13, s13, 0xffff
    s_mov_b32 s14, 2621440
    s_mov_b32 s15, 0x20000
    v_add_u32 v205, 0, v1
    v_mul_u32_u24 v206, 2731, v205
    v_lshrrev_b32 v206, 16, v206
    v_mul_u32_u24 v207, 24, v206
    v_sub_u32 v207, v205, v207
    v_mul_u32_u24 v206, 12288, v206
    v_lshl_add_u32 v200, v207, 4, v206
    v_add_u32 v205, 64, v1
    v_mul_u32_u24 v206, 2731, v205
    v_lshrrev_b32 v206, 16, v206
    v_mul_u32_u24 v207, 24, v206
    v_sub_u32 v207, v205, v207
    v_mul_u32_u24 v206, 12288, v206
    v_lshl_add_u32 v201, v207, 4, v206
    v_add_u32 v205, 128, v1
    v_mul_u32_u24 v206, 2731, v205
    v_lshrrev_b32 v206, 16, v206
    v_mul_u32_u24 v207, 24, v206
    v_sub_u32 v207, v205, v207
    v_mul_u32_u24 v206, 12288, v206
    v_lshl_add_u32 v202, v207, 4, v206
    s_mul_i32 s41, s20, 196608
    s_add_u32 s40, s30, s41
    s_mul_i32 s42, s20, 6144
    v_lshrrev_b32 v205, 4, v1
    v_bfe_u32 v206, v1, 2, 2
    v_lshl_add_u32 v205, v205, 3, v206
    v_mul_u32_u24 v205, 384, v205
    v_and_b32 v206, 3, v1
    v_lshl_add_u32 v205, v206, 3, v205
    s_mul_i32 s41, s20, 96
    v_add_u32 v203, s41, v205
    v_add_u32 v204, 73728, v203
    s_add_u32 m0, s42, 0
    s_add_u32 s41, s40, 0
    buffer_load_dwordx4 v200, s[8:11], s41 offen lds
    s_add_u32 m0, s42, 1024
    s_add_u32 s41, s40, 0
    buffer_load_dwordx4 v201, s[8:11], s41 offen lds
    s_add_u32 m0, s42, 2048
    s_add_u32 s41, s40, 0
    buffer_load_dwordx4 v202, s[8:11], s41 offen lds
    s_add_u32 m0, s42, 3072
    s_add_u32 s41, s40, 98304
    buffer_load_dwordx4 v200, s[8:11], s41 offen lds
    s_add_u32 m0, s42, 4096
    s_add_u32 s41, s40, 98304
    buffer_load_dwordx4 v201, s[8:11], s41 offen lds
    s_add_u32 m0, s42, 5120
    s_add_u32 s41, s40, 98304
    buffer_load_dwordx4 v202, s[8:11], s41 offen lds
    s_add_u32 m0, s42, 24576
    s_add_u32 s41, s40, 786432
    buffer_load_dwordx4 v200, s[8:11], s41 offen lds
    s_add_u32 m0, s42, 25600
    s_add_u32 s41, s40, 786432
    buffer_load_dwordx4 v201, s[8:11], s41 offen lds
    s_add_u32 m0, s42, 26624
    s_add_u32 s41, s40, 786432
    buffer_load_dwordx4 v202, s[8:11], s41 offen lds
    s_add_u32 m0, s42, 27648
    s_add_u32 s41, s40, 884736
    buffer_load_dwordx4 v200, s[8:11], s41 offen lds
    s_add_u32 m0, s42, 28672
    s_add_u32 s41, s40, 884736
    buffer_load_dwordx4 v201, s[8:11], s41 offen lds
    s_add_u32 m0, s42, 29696
    s_add_u32 s41, s40, 884736
    buffer_load_dwordx4 v202, s[8:11], s41 offen lds
    s_add_u32 m0, s42, 49152
    s_add_u32 s41, s40, 1572864
    buffer_load_dwordx4 v200, s[8:11], s41 offen lds
    s_add_u32 m0, s42, 50176
    s_add_u32 s41, s40, 1572864
    buffer_load_dwordx4 v201, s[8:11], s41 offen lds
    s_add_u32 m0, s42, 51200
    s_add_u32 s41, s40, 1572864
    buffer_load_dwordx4 v202, s[8:11], s41 offen lds
    s_add_u32 m0, s42, 52224
    s_add_u32 s41, s40, 1671168
    buffer_load_dwordx4 v200, s[8:11], s41 offen lds
    s_add_u32 m0, s42, 53248
    s_add_u32 s41, s40, 1671168
    buffer_load_dwordx4 v201, s[8:11], s41 offen lds
    s_add_u32 m0, s42, 54272
    s_add_u32 s41, s40, 1671168
    buffer_load_dwordx4 v202, s[8:11], s41 offen lds
    s_add_u32 m0, s42, 73728
    s_add_u32 s41, s40, 2359296
    buffer_load_dwordx4 v200, s[8:11], s41 offen lds
    s_add_u32 m0, s42, 74752
    s_add_u32 s41, s40, 2359296
    buffer_load_dwordx4 v201, s[8:11], s41 offen lds
    s_add_u32 m0, s42, 75776
    s_add_u32 s41, s40, 2359296
    buffer_load_dwordx4 v202, s[8:11], s41 offen lds
    s_add_u32 m0, s42, 76800
    s_add_u32 s41, s40, 2457600
    buffer_load_dwordx4 v200, s[8:11], s41 offen lds
    s_add_u32 m0, s42, 77824
    s_add_u32 s41, s40, 2457600
    buffer_load_dwordx4 v201, s[8:11], s41 offen lds
    s_add_u32 m0, s42, 78848
    s_add_u32 s41, s40, 2457600
    buffer_load_dwordx4 v202, s[8:11], s41 offen lds
    s_add_u32 m0, s42, 98304
    s_add_u32 s41, s40, 3145728
    buffer_load_dwordx4 v200, s[8:11], s41 offen lds
    s_add_u32 m0, s42, 99328
    s_add_u32 s41, s40, 3145728
    buffer_load_dwordx4 v201, s[8:11], s41 offen lds
    s_add_u32 m0, s42, 100352
    s_add_u32 s41, s40, 3145728
    buffer_load_dwordx4 v202, s[8:11], s41 offen lds
    s_add_u32 m0, s42, 101376
    s_add_u32 s41, s40, 3244032
    buffer_load_dwordx4 v200, s[8:11], s41 offen lds
    s_add_u32 m0, s42, 102400
    s_add_u32 s41, s40, 3244032
    buffer_load_dwordx4 v201, s[8:11], s41 offen lds
    s_add_u32 m0, s42, 103424
    s_add_u32 s41, s40, 3244032
    buffer_load_dwordx4 v202, s[8:11], s41 offen lds
    s_waitcnt vmcnt(24)
    s_barrier
    s_add_u32 m0, s42, 122880
    s_add_u32 s41, s40, 3932160
    buffer_load_dwordx4 v200, s[8:11], s41 offen lds
    s_add_u32 m0, s42, 123904
    s_add_u32 s41, s40, 3932160
    buffer_load_dwordx4 v201, s[8:11], s41 offen lds
    s_add_u32 m0, s42, 124928
    s_add_u32 s41, s40, 3932160
    buffer_load_dwordx4 v202, s[8:11], s41 offen lds
    s_add_u32 m0, s42, 125952
    s_add_u32 s41, s40, 4030464
    buffer_load_dwordx4 v200, s[8:11], s41 offen lds
    s_add_u32 m0, s42, 126976
    s_add_u32 s41, s40, 4030464
    buffer_load_dwordx4 v201, s[8:11], s41 offen lds
    s_add_u32 m0, s42, 128000
    s_add_u32 s41, s40, 4030464
    buffer_load_dwordx4 v202, s[8:11], s41 offen lds
    ds_read_b64_tr_b16 a[0:1], v203 offset:0
    ds_read_b64_tr_b16 a[2:3], v203 offset:1536
    ds_read_b64_tr_b16 a[80:81], v203 offset:32
    ds_read_b64_tr_b16 a[82:83], v203 offset:1568
    ds_read_b64_tr_b16 a[160:161], v203 offset:64
    ds_read_b64_tr_b16 a[162:163], v203 offset:1600
    ds_read_b64_tr_b16 a[4:5], v203 offset:12288
    ds_read_b64_tr_b16 a[6:7], v203 offset:13824
    ds_read_b64_tr_b16 a[84:85], v203 offset:12320
    ds_read_b64_tr_b16 a[86:87], v203 offset:13856
    ds_read_b64_tr_b16 a[164:165], v203 offset:12352
    ds_read_b64_tr_b16 a[166:167], v203 offset:13888
    s_waitcnt lgkmcnt(0)
    s_waitcnt vmcnt(24)
    s_barrier
    s_add_u32 m0, s42, 0
    s_add_u32 s41, s40, 4718592
    buffer_load_dwordx4 v200, s[8:11], s41 offen lds
    s_add_u32 m0, s42, 1024
    s_add_u32 s41, s40, 4718592
    buffer_load_dwordx4 v201, s[8:11], s41 offen lds
    s_add_u32 m0, s42, 2048
    s_add_u32 s41, s40, 4718592
    buffer_load_dwordx4 v202, s[8:11], s41 offen lds
    s_add_u32 m0, s42, 3072
    s_add_u32 s41, s40, 4816896
    buffer_load_dwordx4 v200, s[8:11], s41 offen lds
    s_add_u32 m0, s42, 4096
    s_add_u32 s41, s40, 4816896
    buffer_load_dwordx4 v201, s[8:11], s41 offen lds
    s_add_u32 m0, s42, 5120
    s_add_u32 s41, s40, 4816896
    buffer_load_dwordx4 v202, s[8:11], s41 offen lds
    ds_read_b64_tr_b16 a[8:9], v203 offset:24576
    ds_read_b64_tr_b16 a[10:11], v203 offset:26112
    ds_read_b64_tr_b16 a[88:89], v203 offset:24608
    ds_read_b64_tr_b16 a[90:91], v203 offset:26144
    ds_read_b64_tr_b16 a[168:169], v203 offset:24640
    ds_read_b64_tr_b16 a[170:171], v203 offset:26176
    ds_read_b64_tr_b16 a[12:13], v203 offset:36864
    ds_read_b64_tr_b16 a[14:15], v203 offset:38400
    ds_read_b64_tr_b16 a[92:93], v203 offset:36896
    ds_read_b64_tr_b16 a[94:95], v203 offset:38432
    ds_read_b64_tr_b16 a[172:173], v203 offset:36928
    ds_read_b64_tr_b16 a[174:175], v203 offset:38464
    s_waitcnt lgkmcnt(0)
    s_waitcnt vmcnt(24)
    s_barrier
    s_add_u32 m0, s42, 24576
    s_add_u32 s41, s40, 5505024
    buffer_load_dwordx4 v200, s[8:11], s41 offen lds
    s_add_u32 m0, s42, 25600
    s_add_u32 s41, s40, 5505024
    buffer_load_dwordx4 v201, s[8:11], s41 offen lds
    s_add_u32 m0, s42, 26624
    s_add_u32 s41, s40, 5505024
    buffer_load_dwordx4 v202, s[8:11], s41 offen lds
    s_add_u32 m0, s42, 27648
    s_add_u32 s41, s40, 5603328
    buffer_load_dwordx4 v200, s[8:11], s41 offen lds
    s_add_u32 m0, s42, 28672
    s_add_u32 s41, s40, 5603328
    buffer_load_dwordx4 v201, s[8:11], s41 offen lds
    s_add_u32 m0, s42, 29696
    s_add_u32 s41, s40, 5603328
    buffer_load_dwordx4 v202, s[8:11], s41 offen lds
    ds_read_b64_tr_b16 a[16:17], v203 offset:49152
    ds_read_b64_tr_b16 a[18:19], v203 offset:50688
    ds_read_b64_tr_b16 a[96:97], v203 offset:49184
    ds_read_b64_tr_b16 a[98:99], v203 offset:50720
    ds_read_b64_tr_b16 a[176:177], v203 offset:49216
    ds_read_b64_tr_b16 a[178:179], v203 offset:50752
    ds_read_b64_tr_b16 a[20:21], v203 offset:61440
    ds_read_b64_tr_b16 a[22:23], v203 offset:62976
    ds_read_b64_tr_b16 a[100:101], v203 offset:61472
    ds_read_b64_tr_b16 a[102:103], v203 offset:63008
    ds_read_b64_tr_b16 a[180:181], v203 offset:61504
    ds_read_b64_tr_b16 a[182:183], v203 offset:63040
    s_waitcnt lgkmcnt(0)
    s_waitcnt vmcnt(24)
    s_barrier
    s_add_u32 m0, s42, 49152
    s_add_u32 s41, s40, 6291456
    buffer_load_dwordx4 v200, s[8:11], s41 offen lds
    s_add_u32 m0, s42, 50176
    s_add_u32 s41, s40, 6291456
    buffer_load_dwordx4 v201, s[8:11], s41 offen lds
    s_add_u32 m0, s42, 51200
    s_add_u32 s41, s40, 6291456
    buffer_load_dwordx4 v202, s[8:11], s41 offen lds
    s_add_u32 m0, s42, 52224
    s_add_u32 s41, s40, 6389760
    buffer_load_dwordx4 v200, s[8:11], s41 offen lds
    s_add_u32 m0, s42, 53248
    s_add_u32 s41, s40, 6389760
    buffer_load_dwordx4 v201, s[8:11], s41 offen lds
    s_add_u32 m0, s42, 54272
    s_add_u32 s41, s40, 6389760
    buffer_load_dwordx4 v202, s[8:11], s41 offen lds
    ds_read_b64_tr_b16 a[24:25], v204 offset:0
    ds_read_b64_tr_b16 a[26:27], v204 offset:1536
    ds_read_b64_tr_b16 a[104:105], v204 offset:32
    ds_read_b64_tr_b16 a[106:107], v204 offset:1568
    ds_read_b64_tr_b16 a[184:185], v204 offset:64
    ds_read_b64_tr_b16 a[186:187], v204 offset:1600
    ds_read_b64_tr_b16 a[28:29], v204 offset:12288
    ds_read_b64_tr_b16 a[30:31], v204 offset:13824
    ds_read_b64_tr_b16 a[108:109], v204 offset:12320
    ds_read_b64_tr_b16 a[110:111], v204 offset:13856
    ds_read_b64_tr_b16 a[188:189], v204 offset:12352
    ds_read_b64_tr_b16 a[190:191], v204 offset:13888
    s_waitcnt lgkmcnt(0)
    s_waitcnt vmcnt(24)
    s_barrier
    s_add_u32 m0, s42, 73728
    s_add_u32 s41, s40, 7077888
    buffer_load_dwordx4 v200, s[8:11], s41 offen lds
    s_add_u32 m0, s42, 74752
    s_add_u32 s41, s40, 7077888
    buffer_load_dwordx4 v201, s[8:11], s41 offen lds
    s_add_u32 m0, s42, 75776
    s_add_u32 s41, s40, 7077888
    buffer_load_dwordx4 v202, s[8:11], s41 offen lds
    s_add_u32 m0, s42, 76800
    s_add_u32 s41, s40, 7176192
    buffer_load_dwordx4 v200, s[8:11], s41 offen lds
    s_add_u32 m0, s42, 77824
    s_add_u32 s41, s40, 7176192
    buffer_load_dwordx4 v201, s[8:11], s41 offen lds
    s_add_u32 m0, s42, 78848
    s_add_u32 s41, s40, 7176192
    buffer_load_dwordx4 v202, s[8:11], s41 offen lds
    ds_read_b64_tr_b16 a[32:33], v204 offset:24576
    ds_read_b64_tr_b16 a[34:35], v204 offset:26112
    ds_read_b64_tr_b16 a[112:113], v204 offset:24608
    ds_read_b64_tr_b16 a[114:115], v204 offset:26144
    ds_read_b64_tr_b16 a[192:193], v204 offset:24640
    ds_read_b64_tr_b16 a[194:195], v204 offset:26176
    ds_read_b64_tr_b16 a[36:37], v204 offset:36864
    ds_read_b64_tr_b16 a[38:39], v204 offset:38400
    ds_read_b64_tr_b16 a[116:117], v204 offset:36896
    ds_read_b64_tr_b16 a[118:119], v204 offset:38432
    ds_read_b64_tr_b16 a[196:197], v204 offset:36928
    ds_read_b64_tr_b16 a[198:199], v204 offset:38464
    s_waitcnt lgkmcnt(0)
    s_waitcnt vmcnt(24)
    s_barrier
    ds_read_b64_tr_b16 a[40:41], v204 offset:49152
    ds_read_b64_tr_b16 a[42:43], v204 offset:50688
    ds_read_b64_tr_b16 a[120:121], v204 offset:49184
    ds_read_b64_tr_b16 a[122:123], v204 offset:50720
    ds_read_b64_tr_b16 a[200:201], v204 offset:49216
    ds_read_b64_tr_b16 a[202:203], v204 offset:50752
    ds_read_b64_tr_b16 a[44:45], v204 offset:61440
    ds_read_b64_tr_b16 a[46:47], v204 offset:62976
    ds_read_b64_tr_b16 a[124:125], v204 offset:61472
    ds_read_b64_tr_b16 a[126:127], v204 offset:63008
    ds_read_b64_tr_b16 a[204:205], v204 offset:61504
    ds_read_b64_tr_b16 a[206:207], v204 offset:63040
    s_waitcnt lgkmcnt(0)
    s_waitcnt vmcnt(18)
    s_barrier
    ds_read_b64_tr_b16 a[48:49], v203 offset:0
    ds_read_b64_tr_b16 a[50:51], v203 offset:1536
    ds_read_b64_tr_b16 a[128:129], v203 offset:32
    ds_read_b64_tr_b16 a[130:131], v203 offset:1568
    ds_read_b64_tr_b16 a[208:209], v203 offset:64
    ds_read_b64_tr_b16 a[210:211], v203 offset:1600
    ds_read_b64_tr_b16 a[52:53], v203 offset:12288
    ds_read_b64_tr_b16 a[54:55], v203 offset:13824
    ds_read_b64_tr_b16 a[132:133], v203 offset:12320
    ds_read_b64_tr_b16 a[134:135], v203 offset:13856
    ds_read_b64_tr_b16 a[212:213], v203 offset:12352
    ds_read_b64_tr_b16 a[214:215], v203 offset:13888
    s_waitcnt lgkmcnt(0)
    s_waitcnt vmcnt(12)
    s_barrier
    ds_read_b64_tr_b16 a[56:57], v203 offset:24576
    ds_read_b64_tr_b16 a[58:59], v203 offset:26112
    ds_read_b64_tr_b16 a[136:137], v203 offset:24608
    ds_read_b64_tr_b16 a[138:139], v203 offset:26144
    ds_read_b64_tr_b16 a[216:217], v203 offset:24640
    ds_read_b64_tr_b16 a[218:219], v203 offset:26176
    ds_read_b64_tr_b16 a[60:61], v203 offset:36864
    ds_read_b64_tr_b16 a[62:63], v203 offset:38400
    ds_read_b64_tr_b16 a[140:141], v203 offset:36896
    ds_read_b64_tr_b16 a[142:143], v203 offset:38432
    ds_read_b64_tr_b16 a[220:221], v203 offset:36928
    ds_read_b64_tr_b16 a[222:223], v203 offset:38464
    s_waitcnt lgkmcnt(0)
    s_waitcnt vmcnt(6)
    s_barrier
    ds_read_b64_tr_b16 a[64:65], v203 offset:49152
    ds_read_b64_tr_b16 a[66:67], v203 offset:50688
    ds_read_b64_tr_b16 a[144:145], v203 offset:49184
    ds_read_b64_tr_b16 a[146:147], v203 offset:50720
    ds_read_b64_tr_b16 a[224:225], v203 offset:49216
    ds_read_b64_tr_b16 a[226:227], v203 offset:50752
    ds_read_b64_tr_b16 a[68:69], v203 offset:61440
    ds_read_b64_tr_b16 a[70:71], v203 offset:62976
    ds_read_b64_tr_b16 a[148:149], v203 offset:61472
    ds_read_b64_tr_b16 a[150:151], v203 offset:63008
    ds_read_b64_tr_b16 a[228:229], v203 offset:61504
    ds_read_b64_tr_b16 a[230:231], v203 offset:63040
    s_waitcnt lgkmcnt(0)
    s_waitcnt vmcnt(0)
    s_barrier
    ds_read_b64_tr_b16 a[72:73], v204 offset:0
    ds_read_b64_tr_b16 a[74:75], v204 offset:1536
    ds_read_b64_tr_b16 a[152:153], v204 offset:32
    ds_read_b64_tr_b16 a[154:155], v204 offset:1568
    ds_read_b64_tr_b16 a[232:233], v204 offset:64
    ds_read_b64_tr_b16 a[234:235], v204 offset:1600
    ds_read_b64_tr_b16 a[76:77], v204 offset:12288
    ds_read_b64_tr_b16 a[78:79], v204 offset:13824
    ds_read_b64_tr_b16 a[156:157], v204 offset:12320
    ds_read_b64_tr_b16 a[158:159], v204 offset:13856
    ds_read_b64_tr_b16 a[236:237], v204 offset:12352
    ds_read_b64_tr_b16 a[238:239], v204 offset:13888
    s_waitcnt lgkmcnt(0)
    s_barrier
    v_mov_b32 v251, 0
    global_load_dword v250, v251, s[98:99] sc1
    s_waitcnt vmcnt(0)
iw_lp_245:
    v_cmp_gt_u32 vcc, 27, v250
    s_cbranch_vccz iw_ok_244
    s_cmp_eq_u32 s100, 0
    s_cbranch_scc1 iw_ok_244
    s_sub_u32 s100, s100, 1
    s_sleep 2
    global_load_dword v250, v251, s[98:99] sc1
    s_waitcnt vmcnt(0)
    s_branch iw_lp_245
iw_ok_244:
    v_lshrrev_b32 v6, 3, v1
    s_and_b32 s26, s20, 1
    s_lshl_b32 s26, s26, 2
    v_lshrrev_b32 v7, 4, v1
    v_add_u32 v7, s26, v7
    v_and_b32 v2, 7, v1
    v_xor_b32 v7, v7, v2
    v_mul_u32_u24 v6, 1280, v6
    v_lshl_add_u32 v6, v7, 4, v6
    s_mul_i32 s26, s20, 10240
    v_add_u32 v2, s26, v6
    s_mul_i32 s25, s20, 10240
    v_and_b32 v6, 15, v1
    v_lshrrev_b32 v7, 1, v6
    v_lshrrev_b32 v3, 4, v1
    v_xor_b32 v7, v7, v3
    v_lshlrev_b32 v7, 4, v7
    v_lshrrev_b32 v3, 3, v6
    v_mul_u32_u24 v3, 10240, v3
    v_and_b32 v6, 7, v6
    v_lshl_add_u32 v6, v6, 7, v7
    v_add_u32 v3, v3, v6
    v_xor_b32 v93, 64, v3
    v_mov_b32 v92, v3
    v_add_u32 v94, 40960, v92
    v_add_u32 v95, 40960, v93
    s_lshl_b32 s26, s20, 10
    v_lshl_add_u32 v4, v1, 4, s26
    v_lshrrev_b32 v7, 4, v1
    v_and_b32 v6, 1, v7
    v_mul_u32_u24 v6, 6144, v6
    v_lshrrev_b32 v7, 1, v7
    v_lshl_add_u32 v6, v7, 8, v6
    v_and_b32 v7, 15, v1
    v_lshl_add_u32 v6, v7, 4, v6
    s_lshr_b32 s26, s20, 1
    s_lshl_b32 s26, s26, 10
    s_add_u32 s26, s26, 4096
    v_add_u32 v6, s26, v6
    s_and_b32 s26, s20, 1
    s_lshl_b32 s26, s26, 9
    v_add_u32 v5, s26, v6
    s_mul_i32 s26, s21, 13108
    s_lshr_b32 s26, s26, 16
    s_mul_i32 s26, s26, 5
    s_sub_u32 s26, s21, s26
    s_lshl_b32 s26, s26, 2
    s_add_u32 s26, s26, s20
    s_lshl_b32 s26, s26, 11
    s_add_u32 s26, s26, 122880
    v_lshl_add_u32 v96, v1, 7, s26
    v_add_u32 v6, 6144, v4
    v_add_u32 v7, 0, v1
    s_mov_b32 s23, 0
    s_mov_b32 s22, 0
    s_add_u32 m0, s25, 0
    s_nop 0
    buffer_load_dwordx4 v2, s[12:15], s23 offen offset:0  lds
    s_add_u32 m0, s25, 896
    s_nop 0
    buffer_load_dwordx4 v2, s[12:15], s23 offen offset:128  lds
    s_add_u32 m0, s25, 1792
    s_nop 0
    buffer_load_dwordx4 v2, s[12:15], s23 offen offset:256  lds
    s_add_u32 m0, s25, 2688
    s_nop 0
    buffer_load_dwordx4 v2, s[12:15], s23 offen offset:384  lds
    s_add_u32 m0, s25, 3584
    s_nop 0
    buffer_load_dwordx4 v2, s[12:15], s23 offen offset:512  lds
    s_add_u32 m0, s25, 4480
    s_nop 0
    buffer_load_dwordx4 v2, s[12:15], s23 offen offset:640  lds
    s_add_u32 m0, s25, 5376
    s_nop 0
    buffer_load_dwordx4 v2, s[12:15], s23 offen offset:768  lds
    s_add_u32 m0, s25, 6272
    s_nop 0
    buffer_load_dwordx4 v2, s[12:15], s23 offen offset:896  lds
    s_add_u32 m0, s25, 7168
    s_nop 0
    buffer_load_dwordx4 v2, s[12:15], s23 offen offset:1024  lds
    s_add_u32 m0, s25, 8064
    s_nop 0
    buffer_load_dwordx4 v2, s[12:15], s23 offen offset:1152  lds
    s_sub_u32 s24, s24, 393216
    v_subrev_u32 v96, 81920, v96
    s_mov_b64 exec, 0xffff
    buffer_load_dword v97, v96, s[12:15], s23 offen
    s_mov_b64 exec, -1
    v_add_u32 v96, 40960, v96
    s_mov_b64 exec, 0xffff
    buffer_load_dword v97, v96, s[12:15], s23 offen
    s_mov_b64 exec, -1
    v_add_u32 v96, 40960, v96
    s_mov_b64 exec, 0xffff
    buffer_load_dword v97, v96, s[12:15], s23 offen
    s_mov_b64 exec, -1
    v_mov_b32 v100, 0
    v_mov_b32 v101, 0
    s_lshl_b32 s32, s21, 7
    s_add_u32 s32, s32, 167837696
KV_loop_246:
    s_waitcnt vmcnt(1)
    s_barrier
    ds_read_b128 v[8:11], v92 offset:0
    ds_read_b128 v[12:15], v92 offset:20480
    ds_read_b128 v[16:19], v93 offset:0
    ds_read_b128 v[20:23], v93 offset:20480
    s_cmp_eq_u32 s22, 0
    s_cbranch_scc1 KV_skip_247
    s_cmp_le_u32 s22, 5
    s_cbranch_scc1 KV_np_248
    s_cmp_lg_u32 s20, 0
    s_cbranch_scc1 pf_249
    s_sub_u32 s26, s22, 1
    v_mov_b32 v98, s26
    v_mov_b32 v99, 0
    s_mov_b64 exec, 1
    buffer_store_dword v98, v99, s[4:7], s27 offen sc0 sc1
    s_mov_b64 exec, -1
pf_249:
KV_np_248:
    s_nop 4
    v_cvt_pk_bf16_f32 v80, v56, v57
    v_cvt_pk_bf16_f32 v81, v58, v59
    v_cvt_pk_bf16_f32 v82, v64, v65
    v_cvt_pk_bf16_f32 v83, v66, v67
    v_cvt_pk_bf16_f32 v84, v60, v61
    v_cvt_pk_bf16_f32 v85, v62, v63
    v_cvt_pk_bf16_f32 v86, v68, v69
    v_cvt_pk_bf16_f32 v87, v70, v71
    v_cvt_pk_bf16_f32 v88, v72, v73
    v_cvt_pk_bf16_f32 v89, v74, v75
    v_cvt_pk_bf16_f32 v90, v76, v77
    v_cvt_pk_bf16_f32 v91, v78, v79
    buffer_store_dwordx4 v[80:83], v4, s[4:7], s24 offen sc0 sc1
    buffer_store_dwordx4 v[84:87], v6, s[4:7], s24 offen sc0 sc1
    s_nop 1
    v_permlane16_swap_b32 v88, v90
    v_permlane16_swap_b32 v89, v91
    buffer_store_dwordx4 v[88:91], v5, s[4:7], s24 offen sc0 sc1
KV_skip_247:
    s_add_u32 s24, s24, 393216
    s_add_u32 s23, s23, 40960
    s_add_u32 m0, s25, 40960
    ds_read_b128 v[24:27], v92 offset:1024
    ds_read_b128 v[28:31], v92 offset:21504
    s_waitcnt lgkmcnt(4)
    v_mfma_f32_16x16x32_bf16 v[32:35], a[0:3], v[8:11], 0
    v_mfma_f32_16x16x32_bf16 v[36:39], a[0:3], v[12:15], 0
    v_mfma_f32_16x16x32_bf16 v[40:43], a[80:83], v[8:11], 0
    buffer_load_dwordx4 v2, s[12:15], s23 offen offset:0  lds
    v_mfma_f32_16x16x32_bf16 v[44:47], a[80:83], v[12:15], 0
    v_mfma_f32_16x16x32_bf16 v[48:51], a[160:163], v[8:11], 0
    v_mfma_f32_16x16x32_bf16 v[52:55], a[160:163], v[12:15], 0
    s_add_u32 m0, s25, 41856
    ds_read_b128 v[8:11], v93 offset:1024
    ds_read_b128 v[12:15], v93 offset:21504
    s_waitcnt lgkmcnt(4)
    v_mfma_f32_16x16x32_bf16 v[32:35], a[4:7], v[16:19], v[32:35]
    v_mfma_f32_16x16x32_bf16 v[36:39], a[4:7], v[20:23], v[36:39]
    v_mfma_f32_16x16x32_bf16 v[40:43], a[84:87], v[16:19], v[40:43]
    buffer_load_dwordx4 v2, s[12:15], s23 offen offset:128  lds
    v_mfma_f32_16x16x32_bf16 v[44:47], a[84:87], v[20:23], v[44:47]
    v_mfma_f32_16x16x32_bf16 v[48:51], a[164:167], v[16:19], v[48:51]
    v_mfma_f32_16x16x32_bf16 v[52:55], a[164:167], v[20:23], v[52:55]
    s_add_u32 m0, s25, 42752
    ds_read_b128 v[16:19], v92 offset:2048
    ds_read_b128 v[20:23], v92 offset:22528
    s_waitcnt lgkmcnt(4)
    v_mfma_f32_16x16x32_bf16 v[32:35], a[8:11], v[24:27], v[32:35]
    v_mfma_f32_16x16x32_bf16 v[36:39], a[8:11], v[28:31], v[36:39]
    v_mfma_f32_16x16x32_bf16 v[40:43], a[88:91], v[24:27], v[40:43]
    buffer_load_dwordx4 v2, s[12:15], s23 offen offset:256  lds
    v_mfma_f32_16x16x32_bf16 v[44:47], a[88:91], v[28:31], v[44:47]
    v_mfma_f32_16x16x32_bf16 v[48:51], a[168:171], v[24:27], v[48:51]
    v_mfma_f32_16x16x32_bf16 v[52:55], a[168:171], v[28:31], v[52:55]
    s_add_u32 m0, s25, 43648
    ds_read_b128 v[24:27], v93 offset:2048
    ds_read_b128 v[28:31], v93 offset:22528
    s_waitcnt lgkmcnt(4)
    v_mfma_f32_16x16x32_bf16 v[32:35], a[12:15], v[8:11], v[32:35]
    v_mfma_f32_16x16x32_bf16 v[36:39], a[12:15], v[12:15], v[36:39]
    v_mfma_f32_16x16x32_bf16 v[40:43], a[92:95], v[8:11], v[40:43]
    buffer_load_dwordx4 v2, s[12:15], s23 offen offset:384  lds
    v_mfma_f32_16x16x32_bf16 v[44:47], a[92:95], v[12:15], v[44:47]
    v_mfma_f32_16x16x32_bf16 v[48:51], a[172:175], v[8:11], v[48:51]
    v_mfma_f32_16x16x32_bf16 v[52:55], a[172:175], v[12:15], v[52:55]
    s_add_u32 m0, s25, 44544
    ds_read_b128 v[8:11], v92 offset:3072
    ds_read_b128 v[12:15], v92 offset:23552
    s_waitcnt lgkmcnt(4)
    v_mfma_f32_16x16x32_bf16 v[32:35], a[16:19], v[16:19], v[32:35]
    v_mfma_f32_16x16x32_bf16 v[36:39], a[16:19], v[20:23], v[36:39]
    v_mfma_f32_16x16x32_bf16 v[40:43], a[96:99], v[16:19], v[40:43]
    buffer_load_dwordx4 v2, s[12:15], s23 offen offset:512  lds
    v_mfma_f32_16x16x32_bf16 v[44:47], a[96:99], v[20:23], v[44:47]
    v_mfma_f32_16x16x32_bf16 v[48:51], a[176:179], v[16:19], v[48:51]
    v_mfma_f32_16x16x32_bf16 v[52:55], a[176:179], v[20:23], v[52:55]
    s_add_u32 m0, s25, 45440
    ds_read_b128 v[16:19], v93 offset:3072
    ds_read_b128 v[20:23], v93 offset:23552
    s_waitcnt lgkmcnt(4)
    v_mfma_f32_16x16x32_bf16 v[32:35], a[20:23], v[24:27], v[32:35]
    v_mfma_f32_16x16x32_bf16 v[36:39], a[20:23], v[28:31], v[36:39]
    v_mfma_f32_16x16x32_bf16 v[40:43], a[100:103], v[24:27], v[40:43]
    buffer_load_dwordx4 v2, s[12:15], s23 offen offset:640  lds
    v_mfma_f32_16x16x32_bf16 v[44:47], a[100:103], v[28:31], v[44:47]
    v_mfma_f32_16x16x32_bf16 v[48:51], a[180:183], v[24:27], v[48:51]
    v_mfma_f32_16x16x32_bf16 v[52:55], a[180:183], v[28:31], v[52:55]
    s_add_u32 m0, s25, 46336
    ds_read_b128 v[24:27], v92 offset:4096
    ds_read_b128 v[28:31], v92 offset:24576
    s_waitcnt lgkmcnt(4)
    v_mfma_f32_16x16x32_bf16 v[32:35], a[24:27], v[8:11], v[32:35]
    v_mfma_f32_16x16x32_bf16 v[36:39], a[24:27], v[12:15], v[36:39]
    v_mfma_f32_16x16x32_bf16 v[40:43], a[104:107], v[8:11], v[40:43]
    buffer_load_dwordx4 v2, s[12:15], s23 offen offset:768  lds
    v_mfma_f32_16x16x32_bf16 v[44:47], a[104:107], v[12:15], v[44:47]
    v_mfma_f32_16x16x32_bf16 v[48:51], a[184:187], v[8:11], v[48:51]
    v_mfma_f32_16x16x32_bf16 v[52:55], a[184:187], v[12:15], v[52:55]
    s_add_u32 m0, s25, 47232
    ds_read_b128 v[8:11], v93 offset:4096
    ds_read_b128 v[12:15], v93 offset:24576
    s_waitcnt lgkmcnt(4)
    v_mfma_f32_16x16x32_bf16 v[32:35], a[28:31], v[16:19], v[32:35]
    v_mfma_f32_16x16x32_bf16 v[36:39], a[28:31], v[20:23], v[36:39]
    v_mfma_f32_16x16x32_bf16 v[40:43], a[108:111], v[16:19], v[40:43]
    buffer_load_dwordx4 v2, s[12:15], s23 offen offset:896  lds
    v_mfma_f32_16x16x32_bf16 v[44:47], a[108:111], v[20:23], v[44:47]
    v_mfma_f32_16x16x32_bf16 v[48:51], a[188:191], v[16:19], v[48:51]
    v_mfma_f32_16x16x32_bf16 v[52:55], a[188:191], v[20:23], v[52:55]
    s_add_u32 m0, s25, 48128
    ds_read_b128 v[16:19], v92 offset:5120
    ds_read_b128 v[20:23], v92 offset:25600
    s_waitcnt lgkmcnt(4)
    v_mfma_f32_16x16x32_bf16 v[32:35], a[32:35], v[24:27], v[32:35]
    v_mfma_f32_16x16x32_bf16 v[36:39], a[32:35], v[28:31], v[36:39]
    v_mfma_f32_16x16x32_bf16 v[40:43], a[112:115], v[24:27], v[40:43]
    buffer_load_dwordx4 v2, s[12:15], s23 offen offset:1024  lds
    v_mfma_f32_16x16x32_bf16 v[44:47], a[112:115], v[28:31], v[44:47]
    v_mfma_f32_16x16x32_bf16 v[48:51], a[192:195], v[24:27], v[48:51]
    v_mfma_f32_16x16x32_bf16 v[52:55], a[192:195], v[28:31], v[52:55]
    s_add_u32 m0, s25, 49024
    ds_read_b128 v[24:27], v93 offset:5120
    ds_read_b128 v[28:31], v93 offset:25600
    s_waitcnt lgkmcnt(4)
    v_mfma_f32_16x16x32_bf16 v[32:35], a[36:39], v[8:11], v[32:35]
    v_mfma_f32_16x16x32_bf16 v[36:39], a[36:39], v[12:15], v[36:39]
    v_mfma_f32_16x16x32_bf16 v[40:43], a[116:119], v[8:11], v[40:43]
    buffer_load_dwordx4 v2, s[12:15], s23 offen offset:1152  lds
    v_mfma_f32_16x16x32_bf16 v[44:47], a[116:119], v[12:15], v[44:47]
    v_mfma_f32_16x16x32_bf16 v[48:51], a[196:199], v[8:11], v[48:51]
    v_mfma_f32_16x16x32_bf16 v[52:55], a[196:199], v[12:15], v[52:55]
    ds_read_b128 v[8:11], v92 offset:6144
    ds_read_b128 v[12:15], v92 offset:26624
    s_waitcnt lgkmcnt(4)
    v_mfma_f32_16x16x32_bf16 v[32:35], a[40:43], v[16:19], v[32:35]
    v_mfma_f32_16x16x32_bf16 v[36:39], a[40:43], v[20:23], v[36:39]
    v_mfma_f32_16x16x32_bf16 v[40:43], a[120:123], v[16:19], v[40:43]
    v_mfma_f32_16x16x32_bf16 v[44:47], a[120:123], v[20:23], v[44:47]
    v_mfma_f32_16x16x32_bf16 v[48:51], a[200:203], v[16:19], v[48:51]
    v_mfma_f32_16x16x32_bf16 v[52:55], a[200:203], v[20:23], v[52:55]
    ds_read_b128 v[16:19], v93 offset:6144
    ds_read_b128 v[20:23], v93 offset:26624
    s_waitcnt lgkmcnt(4)
    v_mfma_f32_16x16x32_bf16 v[32:35], a[44:47], v[24:27], v[32:35]
    v_mfma_f32_16x16x32_bf16 v[36:39], a[44:47], v[28:31], v[36:39]
    v_mfma_f32_16x16x32_bf16 v[40:43], a[124:127], v[24:27], v[40:43]
    s_mov_b64 exec, 0xffff
    buffer_load_dword v97, v96, s[12:15], s23 offen
    s_mov_b64 exec, -1
    v_mfma_f32_16x16x32_bf16 v[44:47], a[124:127], v[28:31], v[44:47]
    v_mfma_f32_16x16x32_bf16 v[48:51], a[204:207], v[24:27], v[48:51]
    v_mfma_f32_16x16x32_bf16 v[52:55], a[204:207], v[28:31], v[52:55]
    ds_read_b128 v[24:27], v92 offset:7168
    ds_read_b128 v[28:31], v92 offset:27648
    s_waitcnt lgkmcnt(4)
    v_mfma_f32_16x16x32_bf16 v[32:35], a[48:51], v[8:11], v[32:35]
    v_mfma_f32_16x16x32_bf16 v[36:39], a[48:51], v[12:15], v[36:39]
    v_mfma_f32_16x16x32_bf16 v[40:43], a[128:131], v[8:11], v[40:43]
    v_mfma_f32_16x16x32_bf16 v[44:47], a[128:131], v[12:15], v[44:47]
    v_mfma_f32_16x16x32_bf16 v[48:51], a[208:211], v[8:11], v[48:51]
    v_mfma_f32_16x16x32_bf16 v[52:55], a[208:211], v[12:15], v[52:55]
    ds_read_b128 v[8:11], v93 offset:7168
    ds_read_b128 v[12:15], v93 offset:27648
    s_waitcnt lgkmcnt(4)
    v_mfma_f32_16x16x32_bf16 v[32:35], a[52:55], v[16:19], v[32:35]
    v_mfma_f32_16x16x32_bf16 v[36:39], a[52:55], v[20:23], v[36:39]
    v_mfma_f32_16x16x32_bf16 v[40:43], a[132:135], v[16:19], v[40:43]
    v_mfma_f32_16x16x32_bf16 v[44:47], a[132:135], v[20:23], v[44:47]
    v_mfma_f32_16x16x32_bf16 v[48:51], a[212:215], v[16:19], v[48:51]
    v_mfma_f32_16x16x32_bf16 v[52:55], a[212:215], v[20:23], v[52:55]
    ds_read_b128 v[16:19], v92 offset:8192
    ds_read_b128 v[20:23], v92 offset:28672
    s_waitcnt lgkmcnt(4)
    v_mfma_f32_16x16x32_bf16 v[32:35], a[56:59], v[24:27], v[32:35]
    v_mfma_f32_16x16x32_bf16 v[36:39], a[56:59], v[28:31], v[36:39]
    v_mfma_f32_16x16x32_bf16 v[40:43], a[136:139], v[24:27], v[40:43]
    v_mfma_f32_16x16x32_bf16 v[44:47], a[136:139], v[28:31], v[44:47]
    v_mfma_f32_16x16x32_bf16 v[48:51], a[216:219], v[24:27], v[48:51]
    v_mfma_f32_16x16x32_bf16 v[52:55], a[216:219], v[28:31], v[52:55]
    ds_read_b128 v[24:27], v93 offset:8192
    ds_read_b128 v[28:31], v93 offset:28672
    s_waitcnt lgkmcnt(4)
    v_mfma_f32_16x16x32_bf16 v[32:35], a[60:63], v[8:11], v[32:35]
    v_mfma_f32_16x16x32_bf16 v[36:39], a[60:63], v[12:15], v[36:39]
    v_mfma_f32_16x16x32_bf16 v[40:43], a[140:143], v[8:11], v[40:43]
    v_mfma_f32_16x16x32_bf16 v[44:47], a[140:143], v[12:15], v[44:47]
    v_mfma_f32_16x16x32_bf16 v[48:51], a[220:223], v[8:11], v[48:51]
    v_mfma_f32_16x16x32_bf16 v[52:55], a[220:223], v[12:15], v[52:55]
    ds_read_b128 v[8:11], v92 offset:9216
    ds_read_b128 v[12:15], v92 offset:29696
    s_waitcnt lgkmcnt(4)
    v_mfma_f32_16x16x32_bf16 v[32:35], a[64:67], v[16:19], v[32:35]
    v_mfma_f32_16x16x32_bf16 v[36:39], a[64:67], v[20:23], v[36:39]
    v_mfma_f32_16x16x32_bf16 v[40:43], a[144:147], v[16:19], v[40:43]
    v_mfma_f32_16x16x32_bf16 v[44:47], a[144:147], v[20:23], v[44:47]
    v_mfma_f32_16x16x32_bf16 v[48:51], a[224:227], v[16:19], v[48:51]
    v_mfma_f32_16x16x32_bf16 v[52:55], a[224:227], v[20:23], v[52:55]
    ds_read_b128 v[16:19], v93 offset:9216
    ds_read_b128 v[20:23], v93 offset:29696
    s_waitcnt lgkmcnt(4)
    v_mfma_f32_16x16x32_bf16 v[32:35], a[68:71], v[24:27], v[32:35]
    v_mfma_f32_16x16x32_bf16 v[36:39], a[68:71], v[28:31], v[36:39]
    v_mfma_f32_16x16x32_bf16 v[40:43], a[148:151], v[24:27], v[40:43]
    v_mfma_f32_16x16x32_bf16 v[44:47], a[148:151], v[28:31], v[44:47]
    v_mfma_f32_16x16x32_bf16 v[48:51], a[228:231], v[24:27], v[48:51]
    v_mfma_f32_16x16x32_bf16 v[52:55], a[228:231], v[28:31], v[52:55]
    s_waitcnt lgkmcnt(2)
    v_mfma_f32_16x16x32_bf16 v[32:35], a[72:75], v[8:11], v[32:35]
    v_mfma_f32_16x16x32_bf16 v[36:39], a[72:75], v[12:15], v[36:39]
    v_mfma_f32_16x16x32_bf16 v[40:43], a[152:155], v[8:11], v[40:43]
    v_mfma_f32_16x16x32_bf16 v[44:47], a[152:155], v[12:15], v[44:47]
    v_mfma_f32_16x16x32_bf16 v[48:51], a[232:235], v[8:11], v[48:51]
    v_mfma_f32_16x16x32_bf16 v[52:55], a[232:235], v[12:15], v[52:55]
    s_waitcnt lgkmcnt(0)
    v_mfma_f32_16x16x32_bf16 v[32:35], a[76:79], v[16:19], v[32:35]
    v_mfma_f32_16x16x32_bf16 v[36:39], a[76:79], v[20:23], v[36:39]
    v_mfma_f32_16x16x32_bf16 v[40:43], a[156:159], v[16:19], v[40:43]
    v_mfma_f32_16x16x32_bf16 v[44:47], a[156:159], v[20:23], v[44:47]
    v_mfma_f32_16x16x32_bf16 v[48:51], a[236:239], v[16:19], v[48:51]
    v_mfma_f32_16x16x32_bf16 v[52:55], a[236:239], v[20:23], v[52:55]
    s_add_u32 s22, s22, 1
    s_cmp_gt_u32 s22, 4
    s_cbranch_scc1 KV_ne_250
    s_nop 5
    v_cvt_pk_bf16_f32 v80, v32, v33
    v_cvt_pk_bf16_f32 v81, v34, v35
    v_cvt_pk_bf16_f32 v82, v40, v41
    v_cvt_pk_bf16_f32 v83, v42, v43
    v_cvt_pk_bf16_f32 v84, v36, v37
    v_cvt_pk_bf16_f32 v85, v38, v39
    v_cvt_pk_bf16_f32 v86, v44, v45
    v_cvt_pk_bf16_f32 v87, v46, v47
    v_cvt_pk_bf16_f32 v88, v48, v49
    v_cvt_pk_bf16_f32 v89, v50, v51
    v_cvt_pk_bf16_f32 v90, v52, v53
    v_cvt_pk_bf16_f32 v91, v54, v55
    buffer_store_dwordx4 v[80:83], v4, s[4:7], s24 offen sc0 sc1
    buffer_store_dwordx4 v[84:87], v6, s[4:7], s24 offen sc0 sc1
    v_permlane16_swap_b32 v88, v90
    v_permlane16_swap_b32 v89, v91
    buffer_store_dwordx4 v[88:91], v5, s[4:7], s24 offen sc0 sc1
    s_waitcnt vmcnt(0)
    s_barrier
    s_cmp_lg_u32 s20, 0
    s_cbranch_scc1 pf_251
    v_mov_b32 v98, s22
    v_mov_b32 v99, 0
    s_mov_b64 exec, 1
    buffer_store_dword v98, v99, s[4:7], s27 offen sc0 sc1
    s_mov_b64 exec, -1
pf_251:
KV_ne_250:
    s_waitcnt vmcnt(1)
    s_barrier
    ds_read_b128 v[8:11], v94 offset:0
    ds_read_b128 v[12:15], v94 offset:20480
    ds_read_b128 v[16:19], v95 offset:0
    ds_read_b128 v[20:23], v95 offset:20480
    s_cmp_le_u32 s22, 5
    s_cbranch_scc1 KV_np_253
    s_cmp_lg_u32 s20, 0
    s_cbranch_scc1 pf_254
    s_sub_u32 s26, s22, 1
    v_mov_b32 v98, s26
    v_mov_b32 v99, 0
    s_mov_b64 exec, 1
    buffer_store_dword v98, v99, s[4:7], s27 offen sc0 sc1
    s_mov_b64 exec, -1
pf_254:
KV_np_253:
    s_nop 4
    v_cvt_pk_bf16_f32 v80, v32, v33
    v_cvt_pk_bf16_f32 v81, v34, v35
    v_cvt_pk_bf16_f32 v82, v40, v41
    v_cvt_pk_bf16_f32 v83, v42, v43
    v_cvt_pk_bf16_f32 v84, v36, v37
    v_cvt_pk_bf16_f32 v85, v38, v39
    v_cvt_pk_bf16_f32 v86, v44, v45
    v_cvt_pk_bf16_f32 v87, v46, v47
    v_cvt_pk_bf16_f32 v88, v48, v49
    v_cvt_pk_bf16_f32 v89, v50, v51
    v_cvt_pk_bf16_f32 v90, v52, v53
    v_cvt_pk_bf16_f32 v91, v54, v55
    buffer_store_dwordx4 v[80:83], v4, s[4:7], s24 offen sc0 sc1
    buffer_store_dwordx4 v[84:87], v6, s[4:7], s24 offen sc0 sc1
    s_nop 1
    v_permlane16_swap_b32 v88, v90
    v_permlane16_swap_b32 v89, v91
    buffer_store_dwordx4 v[88:91], v5, s[4:7], s24 offen sc0 sc1
KV_skip_252:
    s_add_u32 s24, s24, 393216
    s_add_u32 s23, s23, 40960
    s_add_u32 m0, s25, 0
    ds_read_b128 v[24:27], v94 offset:1024
    ds_read_b128 v[28:31], v94 offset:21504
    s_waitcnt lgkmcnt(4)
    v_mfma_f32_16x16x32_bf16 v[56:59], a[0:3], v[8:11], 0
    v_mfma_f32_16x16x32_bf16 v[60:63], a[0:3], v[12:15], 0
    v_mfma_f32_16x16x32_bf16 v[64:67], a[80:83], v[8:11], 0
    buffer_load_dwordx4 v2, s[12:15], s23 offen offset:0  lds
    v_mfma_f32_16x16x32_bf16 v[68:71], a[80:83], v[12:15], 0
    v_mfma_f32_16x16x32_bf16 v[72:75], a[160:163], v[8:11], 0
    v_mfma_f32_16x16x32_bf16 v[76:79], a[160:163], v[12:15], 0
    s_add_u32 m0, s25, 896
    ds_read_b128 v[8:11], v95 offset:1024
    ds_read_b128 v[12:15], v95 offset:21504
    s_waitcnt lgkmcnt(4)
    v_mfma_f32_16x16x32_bf16 v[56:59], a[4:7], v[16:19], v[56:59]
    v_mfma_f32_16x16x32_bf16 v[60:63], a[4:7], v[20:23], v[60:63]
    v_mfma_f32_16x16x32_bf16 v[64:67], a[84:87], v[16:19], v[64:67]
    buffer_load_dwordx4 v2, s[12:15], s23 offen offset:128  lds
    v_mfma_f32_16x16x32_bf16 v[68:71], a[84:87], v[20:23], v[68:71]
    v_mfma_f32_16x16x32_bf16 v[72:75], a[164:167], v[16:19], v[72:75]
    v_mfma_f32_16x16x32_bf16 v[76:79], a[164:167], v[20:23], v[76:79]
    s_add_u32 m0, s25, 1792
    ds_read_b128 v[16:19], v94 offset:2048
    ds_read_b128 v[20:23], v94 offset:22528
    s_waitcnt lgkmcnt(4)
    v_mfma_f32_16x16x32_bf16 v[56:59], a[8:11], v[24:27], v[56:59]
    v_mfma_f32_16x16x32_bf16 v[60:63], a[8:11], v[28:31], v[60:63]
    v_mfma_f32_16x16x32_bf16 v[64:67], a[88:91], v[24:27], v[64:67]
    buffer_load_dwordx4 v2, s[12:15], s23 offen offset:256  lds
    v_mfma_f32_16x16x32_bf16 v[68:71], a[88:91], v[28:31], v[68:71]
    v_mfma_f32_16x16x32_bf16 v[72:75], a[168:171], v[24:27], v[72:75]
    v_mfma_f32_16x16x32_bf16 v[76:79], a[168:171], v[28:31], v[76:79]
    s_add_u32 m0, s25, 2688
    ds_read_b128 v[24:27], v95 offset:2048
    ds_read_b128 v[28:31], v95 offset:22528
    s_waitcnt lgkmcnt(4)
    v_mfma_f32_16x16x32_bf16 v[56:59], a[12:15], v[8:11], v[56:59]
    v_mfma_f32_16x16x32_bf16 v[60:63], a[12:15], v[12:15], v[60:63]
    v_mfma_f32_16x16x32_bf16 v[64:67], a[92:95], v[8:11], v[64:67]
    buffer_load_dwordx4 v2, s[12:15], s23 offen offset:384  lds
    v_mfma_f32_16x16x32_bf16 v[68:71], a[92:95], v[12:15], v[68:71]
    v_mfma_f32_16x16x32_bf16 v[72:75], a[172:175], v[8:11], v[72:75]
    v_mfma_f32_16x16x32_bf16 v[76:79], a[172:175], v[12:15], v[76:79]
    s_add_u32 m0, s25, 3584
    ds_read_b128 v[8:11], v94 offset:3072
    ds_read_b128 v[12:15], v94 offset:23552
    s_waitcnt lgkmcnt(4)
    v_mfma_f32_16x16x32_bf16 v[56:59], a[16:19], v[16:19], v[56:59]
    v_mfma_f32_16x16x32_bf16 v[60:63], a[16:19], v[20:23], v[60:63]
    v_mfma_f32_16x16x32_bf16 v[64:67], a[96:99], v[16:19], v[64:67]
    buffer_load_dwordx4 v2, s[12:15], s23 offen offset:512  lds
    v_mfma_f32_16x16x32_bf16 v[68:71], a[96:99], v[20:23], v[68:71]
    v_mfma_f32_16x16x32_bf16 v[72:75], a[176:179], v[16:19], v[72:75]
    v_mfma_f32_16x16x32_bf16 v[76:79], a[176:179], v[20:23], v[76:79]
    s_add_u32 m0, s25, 4480
    ds_read_b128 v[16:19], v95 offset:3072
    ds_read_b128 v[20:23], v95 offset:23552
    s_waitcnt lgkmcnt(4)
    v_mfma_f32_16x16x32_bf16 v[56:59], a[20:23], v[24:27], v[56:59]
    v_mfma_f32_16x16x32_bf16 v[60:63], a[20:23], v[28:31], v[60:63]
    v_mfma_f32_16x16x32_bf16 v[64:67], a[100:103], v[24:27], v[64:67]
    buffer_load_dwordx4 v2, s[12:15], s23 offen offset:640  lds
    v_mfma_f32_16x16x32_bf16 v[68:71], a[100:103], v[28:31], v[68:71]
    v_mfma_f32_16x16x32_bf16 v[72:75], a[180:183], v[24:27], v[72:75]
    v_mfma_f32_16x16x32_bf16 v[76:79], a[180:183], v[28:31], v[76:79]
    s_add_u32 m0, s25, 5376
    ds_read_b128 v[24:27], v94 offset:4096
    ds_read_b128 v[28:31], v94 offset:24576
    s_waitcnt lgkmcnt(4)
    v_mfma_f32_16x16x32_bf16 v[56:59], a[24:27], v[8:11], v[56:59]
    v_mfma_f32_16x16x32_bf16 v[60:63], a[24:27], v[12:15], v[60:63]
    v_mfma_f32_16x16x32_bf16 v[64:67], a[104:107], v[8:11], v[64:67]
    buffer_load_dwordx4 v2, s[12:15], s23 offen offset:768  lds
    v_mfma_f32_16x16x32_bf16 v[68:71], a[104:107], v[12:15], v[68:71]
    v_mfma_f32_16x16x32_bf16 v[72:75], a[184:187], v[8:11], v[72:75]
    v_mfma_f32_16x16x32_bf16 v[76:79], a[184:187], v[12:15], v[76:79]
    s_add_u32 m0, s25, 6272
    ds_read_b128 v[8:11], v95 offset:4096
    ds_read_b128 v[12:15], v95 offset:24576
    s_waitcnt lgkmcnt(4)
    v_mfma_f32_16x16x32_bf16 v[56:59], a[28:31], v[16:19], v[56:59]
    v_mfma_f32_16x16x32_bf16 v[60:63], a[28:31], v[20:23], v[60:63]
    v_mfma_f32_16x16x32_bf16 v[64:67], a[108:111], v[16:19], v[64:67]
    buffer_load_dwordx4 v2, s[12:15], s23 offen offset:896  lds
    v_mfma_f32_16x16x32_bf16 v[68:71], a[108:111], v[20:23], v[68:71]
    v_mfma_f32_16x16x32_bf16 v[72:75], a[188:191], v[16:19], v[72:75]
    v_mfma_f32_16x16x32_bf16 v[76:79], a[188:191], v[20:23], v[76:79]
    s_add_u32 m0, s25, 7168
    ds_read_b128 v[16:19], v94 offset:5120
    ds_read_b128 v[20:23], v94 offset:25600
    s_waitcnt lgkmcnt(4)
    v_mfma_f32_16x16x32_bf16 v[56:59], a[32:35], v[24:27], v[56:59]
    v_mfma_f32_16x16x32_bf16 v[60:63], a[32:35], v[28:31], v[60:63]
    v_mfma_f32_16x16x32_bf16 v[64:67], a[112:115], v[24:27], v[64:67]
    buffer_load_dwordx4 v2, s[12:15], s23 offen offset:1024  lds
    v_mfma_f32_16x16x32_bf16 v[68:71], a[112:115], v[28:31], v[68:71]
    v_mfma_f32_16x16x32_bf16 v[72:75], a[192:195], v[24:27], v[72:75]
    v_mfma_f32_16x16x32_bf16 v[76:79], a[192:195], v[28:31], v[76:79]
    s_add_u32 m0, s25, 8064
    ds_read_b128 v[24:27], v95 offset:5120
    ds_read_b128 v[28:31], v95 offset:25600
    s_waitcnt lgkmcnt(4)
    v_mfma_f32_16x16x32_bf16 v[56:59], a[36:39], v[8:11], v[56:59]
    v_mfma_f32_16x16x32_bf16 v[60:63], a[36:39], v[12:15], v[60:63]
    v_mfma_f32_16x16x32_bf16 v[64:67], a[116:119], v[8:11], v[64:67]
    buffer_load_dwordx4 v2, s[12:15], s23 offen offset:1152  lds
    v_mfma_f32_16x16x32_bf16 v[68:71], a[116:119], v[12:15], v[68:71]
    v_mfma_f32_16x16x32_bf16 v[72:75], a[196:199], v[8:11], v[72:75]
    v_mfma_f32_16x16x32_bf16 v[76:79], a[196:199], v[12:15], v[76:79]
    ds_read_b128 v[8:11], v94 offset:6144
    ds_read_b128 v[12:15], v94 offset:26624
    s_waitcnt lgkmcnt(4)
    v_mfma_f32_16x16x32_bf16 v[56:59], a[40:43], v[16:19], v[56:59]
    v_mfma_f32_16x16x32_bf16 v[60:63], a[40:43], v[20:23], v[60:63]
    v_mfma_f32_16x16x32_bf16 v[64:67], a[120:123], v[16:19], v[64:67]
    v_mfma_f32_16x16x32_bf16 v[68:71], a[120:123], v[20:23], v[68:71]
    v_mfma_f32_16x16x32_bf16 v[72:75], a[200:203], v[16:19], v[72:75]
    v_mfma_f32_16x16x32_bf16 v[76:79], a[200:203], v[20:23], v[76:79]
    ds_read_b128 v[16:19], v95 offset:6144
    ds_read_b128 v[20:23], v95 offset:26624
    s_waitcnt lgkmcnt(4)
    v_mfma_f32_16x16x32_bf16 v[56:59], a[44:47], v[24:27], v[56:59]
    v_mfma_f32_16x16x32_bf16 v[60:63], a[44:47], v[28:31], v[60:63]
    v_mfma_f32_16x16x32_bf16 v[64:67], a[124:127], v[24:27], v[64:67]
    s_mov_b64 exec, 0xffff
    buffer_load_dword v97, v96, s[12:15], s23 offen
    s_mov_b64 exec, -1
    v_mfma_f32_16x16x32_bf16 v[68:71], a[124:127], v[28:31], v[68:71]
    v_mfma_f32_16x16x32_bf16 v[72:75], a[204:207], v[24:27], v[72:75]
    v_mfma_f32_16x16x32_bf16 v[76:79], a[204:207], v[28:31], v[76:79]
    ds_read_b128 v[24:27], v94 offset:7168
    ds_read_b128 v[28:31], v94 offset:27648
    s_waitcnt lgkmcnt(4)
    v_mfma_f32_16x16x32_bf16 v[56:59], a[48:51], v[8:11], v[56:59]
    v_mfma_f32_16x16x32_bf16 v[60:63], a[48:51], v[12:15], v[60:63]
    v_mfma_f32_16x16x32_bf16 v[64:67], a[128:131], v[8:11], v[64:67]
    v_mfma_f32_16x16x32_bf16 v[68:71], a[128:131], v[12:15], v[68:71]
    v_mfma_f32_16x16x32_bf16 v[72:75], a[208:211], v[8:11], v[72:75]
    v_mfma_f32_16x16x32_bf16 v[76:79], a[208:211], v[12:15], v[76:79]
    ds_read_b128 v[8:11], v95 offset:7168
    ds_read_b128 v[12:15], v95 offset:27648
    s_waitcnt lgkmcnt(4)
    v_mfma_f32_16x16x32_bf16 v[56:59], a[52:55], v[16:19], v[56:59]
    v_mfma_f32_16x16x32_bf16 v[60:63], a[52:55], v[20:23], v[60:63]
    v_mfma_f32_16x16x32_bf16 v[64:67], a[132:135], v[16:19], v[64:67]
    v_mfma_f32_16x16x32_bf16 v[68:71], a[132:135], v[20:23], v[68:71]
    v_mfma_f32_16x16x32_bf16 v[72:75], a[212:215], v[16:19], v[72:75]
    v_mfma_f32_16x16x32_bf16 v[76:79], a[212:215], v[20:23], v[76:79]
    ds_read_b128 v[16:19], v94 offset:8192
    ds_read_b128 v[20:23], v94 offset:28672
    s_waitcnt lgkmcnt(4)
    v_mfma_f32_16x16x32_bf16 v[56:59], a[56:59], v[24:27], v[56:59]
    v_mfma_f32_16x16x32_bf16 v[60:63], a[56:59], v[28:31], v[60:63]
    v_mfma_f32_16x16x32_bf16 v[64:67], a[136:139], v[24:27], v[64:67]
    v_mfma_f32_16x16x32_bf16 v[68:71], a[136:139], v[28:31], v[68:71]
    v_mfma_f32_16x16x32_bf16 v[72:75], a[216:219], v[24:27], v[72:75]
    v_mfma_f32_16x16x32_bf16 v[76:79], a[216:219], v[28:31], v[76:79]
    ds_read_b128 v[24:27], v95 offset:8192
    ds_read_b128 v[28:31], v95 offset:28672
    s_waitcnt lgkmcnt(4)
    v_mfma_f32_16x16x32_bf16 v[56:59], a[60:63], v[8:11], v[56:59]
    v_mfma_f32_16x16x32_bf16 v[60:63], a[60:63], v[12:15], v[60:63]
    v_mfma_f32_16x16x32_bf16 v[64:67], a[140:143], v[8:11], v[64:67]
    v_mfma_f32_16x16x32_bf16 v[68:71], a[140:143], v[12:15], v[68:71]
    v_mfma_f32_16x16x32_bf16 v[72:75], a[220:223], v[8:11], v[72:75]
    v_mfma_f32_16x16x32_bf16 v[76:79], a[220:223], v[12:15], v[76:79]
    ds_read_b128 v[8:11], v94 offset:9216
    ds_read_b128 v[12:15], v94 offset:29696
    s_waitcnt lgkmcnt(4)
    v_mfma_f32_16x16x32_bf16 v[56:59], a[64:67], v[16:19], v[56:59]
    v_mfma_f32_16x16x32_bf16 v[60:63], a[64:67], v[20:23], v[60:63]
    v_mfma_f32_16x16x32_bf16 v[64:67], a[144:147], v[16:19], v[64:67]
    v_mfma_f32_16x16x32_bf16 v[68:71], a[144:147], v[20:23], v[68:71]
    v_mfma_f32_16x16x32_bf16 v[72:75], a[224:227], v[16:19], v[72:75]
    v_mfma_f32_16x16x32_bf16 v[76:79], a[224:227], v[20:23], v[76:79]
    ds_read_b128 v[16:19], v95 offset:9216
    ds_read_b128 v[20:23], v95 offset:29696
    s_waitcnt lgkmcnt(4)
    v_mfma_f32_16x16x32_bf16 v[56:59], a[68:71], v[24:27], v[56:59]
    v_mfma_f32_16x16x32_bf16 v[60:63], a[68:71], v[28:31], v[60:63]
    v_mfma_f32_16x16x32_bf16 v[64:67], a[148:151], v[24:27], v[64:67]
    v_mfma_f32_16x16x32_bf16 v[68:71], a[148:151], v[28:31], v[68:71]
    v_mfma_f32_16x16x32_bf16 v[72:75], a[228:231], v[24:27], v[72:75]
    v_mfma_f32_16x16x32_bf16 v[76:79], a[228:231], v[28:31], v[76:79]
    s_waitcnt lgkmcnt(2)
    v_mfma_f32_16x16x32_bf16 v[56:59], a[72:75], v[8:11], v[56:59]
    v_mfma_f32_16x16x32_bf16 v[60:63], a[72:75], v[12:15], v[60:63]
    v_mfma_f32_16x16x32_bf16 v[64:67], a[152:155], v[8:11], v[64:67]
    v_mfma_f32_16x16x32_bf16 v[68:71], a[152:155], v[12:15], v[68:71]
    v_mfma_f32_16x16x32_bf16 v[72:75], a[232:235], v[8:11], v[72:75]
    v_mfma_f32_16x16x32_bf16 v[76:79], a[232:235], v[12:15], v[76:79]
    s_waitcnt lgkmcnt(0)
    v_mfma_f32_16x16x32_bf16 v[56:59], a[76:79], v[16:19], v[56:59]
    v_mfma_f32_16x16x32_bf16 v[60:63], a[76:79], v[20:23], v[60:63]
    v_mfma_f32_16x16x32_bf16 v[64:67], a[156:159], v[16:19], v[64:67]
    v_mfma_f32_16x16x32_bf16 v[68:71], a[156:159], v[20:23], v[68:71]
    v_mfma_f32_16x16x32_bf16 v[72:75], a[236:239], v[16:19], v[72:75]
    v_mfma_f32_16x16x32_bf16 v[76:79], a[236:239], v[20:23], v[76:79]
    s_add_u32 s22, s22, 1
    s_cmp_gt_u32 s22, 4
    s_cbranch_scc1 KV_ne_255
    s_nop 5
    v_cvt_pk_bf16_f32 v80, v56, v57
    v_cvt_pk_bf16_f32 v81, v58, v59
    v_cvt_pk_bf16_f32 v82, v64, v65
    v_cvt_pk_bf16_f32 v83, v66, v67
    v_cvt_pk_bf16_f32 v84, v60, v61
    v_cvt_pk_bf16_f32 v85, v62, v63
    v_cvt_pk_bf16_f32 v86, v68, v69
    v_cvt_pk_bf16_f32 v87, v70, v71
    v_cvt_pk_bf16_f32 v88, v72, v73
    v_cvt_pk_bf16_f32 v89, v74, v75
    v_cvt_pk_bf16_f32 v90, v76, v77
    v_cvt_pk_bf16_f32 v91, v78, v79
    buffer_store_dwordx4 v[80:83], v4, s[4:7], s24 offen sc0 sc1
    buffer_store_dwordx4 v[84:87], v6, s[4:7], s24 offen sc0 sc1
    v_permlane16_swap_b32 v88, v90
    v_permlane16_swap_b32 v89, v91
    buffer_store_dwordx4 v[88:91], v5, s[4:7], s24 offen sc0 sc1
    s_waitcnt vmcnt(0)
    s_barrier
    s_cmp_lg_u32 s20, 0
    s_cbranch_scc1 pf_256
    v_mov_b32 v98, s22
    v_mov_b32 v99, 0
    s_mov_b64 exec, 1
    buffer_store_dword v98, v99, s[4:7], s27 offen sc0 sc1
    s_mov_b64 exec, -1
pf_256:
KV_ne_255:
    s_cmp_lt_u32 s22, 64
    s_cbranch_scc1 KV_loop_246
    s_waitcnt vmcnt(0)
    s_barrier
    s_cmp_lg_u32 s20, 0
    s_cbranch_scc1 pf_257
    s_sub_u32 s26, s22, 1
    v_mov_b32 v98, s26
    v_mov_b32 v99, 0
    s_mov_b64 exec, 1
    buffer_store_dword v98, v99, s[4:7], s27 offen sc0 sc1
    s_mov_b64 exec, -1
pf_257:
    s_nop 7
    v_cvt_pk_bf16_f32 v80, v56, v57
    v_cvt_pk_bf16_f32 v81, v58, v59
    v_cvt_pk_bf16_f32 v82, v64, v65
    v_cvt_pk_bf16_f32 v83, v66, v67
    v_cvt_pk_bf16_f32 v84, v60, v61
    v_cvt_pk_bf16_f32 v85, v62, v63
    v_cvt_pk_bf16_f32 v86, v68, v69
    v_cvt_pk_bf16_f32 v87, v70, v71
    v_cvt_pk_bf16_f32 v88, v72, v73
    v_cvt_pk_bf16_f32 v89, v74, v75
    v_cvt_pk_bf16_f32 v90, v76, v77
    v_cvt_pk_bf16_f32 v91, v78, v79
    buffer_store_dwordx4 v[80:83], v4, s[4:7], s24 offen sc0 sc1
    buffer_store_dwordx4 v[84:87], v6, s[4:7], s24 offen sc0 sc1
    s_nop 1
    v_permlane16_swap_b32 v88, v90
    v_permlane16_swap_b32 v89, v91
    buffer_store_dwordx4 v[88:91], v5, s[4:7], s24 offen sc0 sc1
    s_waitcnt vmcnt(0)
    s_barrier
    s_add_u32 s22, s22, 1
    s_cmp_lg_u32 s20, 0
    s_cbranch_scc1 pf_258
    s_sub_u32 s26, s22, 1
    v_mov_b32 v98, s26
    v_mov_b32 v99, 0
    s_mov_b64 exec, 1
    buffer_store_dword v98, v99, s[4:7], s27 offen sc0 sc1
    s_mov_b64 exec, -1
pf_258:
    s_branch L_end
L_notkv:
    s_cmp_ge_u32 s25, 96
    s_cbranch_scc1 L_notu
    s_lshl_b32 s3, s21, 7
    s_mov_b32 s27, 167841792
    s_add_u32 s28, s3, 167833600
    s_load_dwordx2 s[8:9], s[0:1], 40
    s_mul_i32 s32, s21, 245760
    s_waitcnt lgkmcnt(0)
    s_and_b32 s9, s9, 0xffff
    s_mov_b32 s10, 7864320
    s_mov_b32 s11, 0x20000
    v_lshlrev_b32 v200, 4, v1
    s_mul_i32 s42, s20, 10240
    s_add_u32 s40, s32, s42
    s_lshr_b32 s41, s20, 1
    s_mul_i32 s41, s41, 40960
    s_add_u32 s43, s40, s41
    v_lshrrev_b32 v205, 4, v1
    v_bfe_u32 v206, v1, 2, 2
    v_and_b32 v207, 3, v1
    v_lshlrev_b32 v207, 3, v207
    s_mul_i32 s41, s20, 320
    v_add_u32 v207, s41, v207
    v_lshl_add_u32 v201, v205, 2, v206
    v_lshl_add_u32 v202, v205, 3, v206
    v_mul_u32_u24 v201, 1280, v201
    v_mul_u32_u24 v202, 1280, v202
    v_add_u32 v201, v201, v207
    v_add_u32 v202, v202, v207
    s_add_u32 s41, s40, 0
    s_add_u32 m0, s42, 0
    s_nop 0
    buffer_load_dwordx4 v200, s[8:11], s41 offen offset:0 lds
    buffer_load_dwordx4 v200, s[8:11], s41 offen offset:1024 lds
    buffer_load_dwordx4 v200, s[8:11], s41 offen offset:2048 lds
    buffer_load_dwordx4 v200, s[8:11], s41 offen offset:3072 lds
    s_add_u32 m0, s42, 4096
    s_add_u32 s41, s41, 4096
    buffer_load_dwordx4 v200, s[8:11], s41 offen offset:0 lds
    buffer_load_dwordx4 v200, s[8:11], s41 offen offset:1024 lds
    buffer_load_dwordx4 v200, s[8:11], s41 offen offset:2048 lds
    buffer_load_dwordx4 v200, s[8:11], s41 offen offset:3072 lds
    s_add_u32 m0, s42, 8192
    s_add_u32 s41, s41, 4096
    buffer_load_dwordx4 v200, s[8:11], s41 offen offset:0 lds
    buffer_load_dwordx4 v200, s[8:11], s41 offen offset:1024 lds
    s_add_u32 s41, s40, 61440
    s_add_u32 m0, s42, 40960
    s_nop 0
    buffer_load_dwordx4 v200, s[8:11], s41 offen offset:0 lds
    buffer_load_dwordx4 v200, s[8:11], s41 offen offset:1024 lds
    buffer_load_dwordx4 v200, s[8:11], s41 offen offset:2048 lds
    buffer_load_dwordx4 v200, s[8:11], s41 offen offset:3072 lds
    s_add_u32 m0, s42, 45056
    s_add_u32 s41, s41, 4096
    buffer_load_dwordx4 v200, s[8:11], s41 offen offset:0 lds
    buffer_load_dwordx4 v200, s[8:11], s41 offen offset:1024 lds
    buffer_load_dwordx4 v200, s[8:11], s41 offen offset:2048 lds
    buffer_load_dwordx4 v200, s[8:11], s41 offen offset:3072 lds
    s_add_u32 m0, s42, 49152
    s_add_u32 s41, s41, 4096
    buffer_load_dwordx4 v200, s[8:11], s41 offen offset:0 lds
    buffer_load_dwordx4 v200, s[8:11], s41 offen offset:1024 lds
    s_add_u32 s41, s40, 122880
    s_add_u32 m0, s42, 81920
    s_nop 0
    buffer_load_dwordx4 v200, s[8:11], s41 offen offset:0 lds
    buffer_load_dwordx4 v200, s[8:11], s41 offen offset:1024 lds
    buffer_load_dwordx4 v200, s[8:11], s41 offen offset:2048 lds
    buffer_load_dwordx4 v200, s[8:11], s41 offen offset:3072 lds
    s_add_u32 m0, s42, 86016
    s_add_u32 s41, s41, 4096
    buffer_load_dwordx4 v200, s[8:11], s41 offen offset:0 lds
    buffer_load_dwordx4 v200, s[8:11], s41 offen offset:1024 lds
    buffer_load_dwordx4 v200, s[8:11], s41 offen offset:2048 lds
    buffer_load_dwordx4 v200, s[8:11], s41 offen offset:3072 lds
    s_add_u32 m0, s42, 90112
    s_add_u32 s41, s41, 4096
    buffer_load_dwordx4 v200, s[8:11], s41 offen offset:0 lds
    buffer_load_dwordx4 v200, s[8:11], s41 offen offset:1024 lds
    s_waitcnt vmcnt(20)
    s_barrier
    s_add_u32 s41, s40, 184320
    s_add_u32 m0, s42, 122880
    s_nop 0
    buffer_load_dwordx4 v200, s[8:11], s41 offen offset:0 lds
    buffer_load_dwordx4 v200, s[8:11], s41 offen offset:1024 lds
    buffer_load_dwordx4 v200, s[8:11], s41 offen offset:2048 lds
    buffer_load_dwordx4 v200, s[8:11], s41 offen offset:3072 lds
    s_add_u32 m0, s42, 126976
    s_add_u32 s41, s41, 4096
    buffer_load_dwordx4 v200, s[8:11], s41 offen offset:0 lds
    buffer_load_dwordx4 v200, s[8:11], s41 offen offset:1024 lds
    buffer_load_dwordx4 v200, s[8:11], s41 offen offset:2048 lds
    buffer_load_dwordx4 v200, s[8:11], s41 offen offset:3072 lds
    s_add_u32 m0, s42, 131072
    s_add_u32 s41, s41, 4096
    buffer_load_dwordx4 v200, s[8:11], s41 offen offset:0 lds
    buffer_load_dwordx4 v200, s[8:11], s41 offen offset:1024 lds
    v_add_u32 v203, 0, v201
    ds_read_b64_tr_b16 a[0:1], v203 offset:0
    ds_read_b64_tr_b16 a[2:3], v203 offset:20480
    ds_read_b64_tr_b16 a[24:25], v203 offset:32
    ds_read_b64_tr_b16 a[26:27], v203 offset:20512
    ds_read_b64_tr_b16 a[48:49], v203 offset:64
    ds_read_b64_tr_b16 a[50:51], v203 offset:20544
    ds_read_b64_tr_b16 a[72:73], v203 offset:96
    ds_read_b64_tr_b16 a[74:75], v203 offset:20576
    ds_read_b64_tr_b16 a[96:97], v203 offset:128
    ds_read_b64_tr_b16 a[98:99], v203 offset:20608
    ds_read_b64_tr_b16 a[120:121], v203 offset:160
    ds_read_b64_tr_b16 a[122:123], v203 offset:20640
    ds_read_b64_tr_b16 a[144:145], v203 offset:192
    ds_read_b64_tr_b16 a[146:147], v203 offset:20672
    s_waitcnt lgkmcnt(0)
    ds_read_b64_tr_b16 a[168:169], v203 offset:224
    ds_read_b64_tr_b16 a[170:171], v203 offset:20704
    ds_read_b64_tr_b16 a[192:193], v203 offset:256
    ds_read_b64_tr_b16 a[194:195], v203 offset:20736
    ds_read_b64_tr_b16 a[216:217], v203 offset:288
    ds_read_b64_tr_b16 a[218:219], v203 offset:20768
    s_waitcnt lgkmcnt(0)
    s_waitcnt vmcnt(20)
    s_barrier
    s_add_u32 s41, s43, 40960
    s_add_u32 m0, s42, 0
    s_nop 0
    buffer_load_dwordx4 v200, s[8:11], s41 offen offset:0 lds
    buffer_load_dwordx4 v200, s[8:11], s41 offen offset:1024 lds
    buffer_load_dwordx4 v200, s[8:11], s41 offen offset:2048 lds
    buffer_load_dwordx4 v200, s[8:11], s41 offen offset:3072 lds
    s_add_u32 m0, s42, 4096
    s_add_u32 s41, s41, 4096
    buffer_load_dwordx4 v200, s[8:11], s41 offen offset:0 lds
    buffer_load_dwordx4 v200, s[8:11], s41 offen offset:1024 lds
    buffer_load_dwordx4 v200, s[8:11], s41 offen offset:2048 lds
    buffer_load_dwordx4 v200, s[8:11], s41 offen offset:3072 lds
    s_add_u32 m0, s42, 8192
    s_add_u32 s41, s41, 4096
    buffer_load_dwordx4 v200, s[8:11], s41 offen offset:0 lds
    buffer_load_dwordx4 v200, s[8:11], s41 offen offset:1024 lds
    v_add_u32 v203, 40960, v201
    ds_read_b64_tr_b16 a[4:5], v203 offset:0
    ds_read_b64_tr_b16 a[6:7], v203 offset:20480
    ds_read_b64_tr_b16 a[28:29], v203 offset:32
    ds_read_b64_tr_b16 a[30:31], v203 offset:20512
    ds_read_b64_tr_b16 a[52:53], v203 offset:64
    ds_read_b64_tr_b16 a[54:55], v203 offset:20544
    ds_read_b64_tr_b16 a[76:77], v203 offset:96
    ds_read_b64_tr_b16 a[78:79], v203 offset:20576
    ds_read_b64_tr_b16 a[100:101], v203 offset:128
    ds_read_b64_tr_b16 a[102:103], v203 offset:20608
    ds_read_b64_tr_b16 a[124:125], v203 offset:160
    ds_read_b64_tr_b16 a[126:127], v203 offset:20640
    ds_read_b64_tr_b16 a[148:149], v203 offset:192
    ds_read_b64_tr_b16 a[150:151], v203 offset:20672
    s_waitcnt lgkmcnt(0)
    ds_read_b64_tr_b16 a[172:173], v203 offset:224
    ds_read_b64_tr_b16 a[174:175], v203 offset:20704
    ds_read_b64_tr_b16 a[196:197], v203 offset:256
    ds_read_b64_tr_b16 a[198:199], v203 offset:20736
    ds_read_b64_tr_b16 a[220:221], v203 offset:288
    ds_read_b64_tr_b16 a[222:223], v203 offset:20768
    s_waitcnt lgkmcnt(0)
    s_waitcnt vmcnt(20)
    s_barrier
    s_add_u32 s41, s43, 163840
    s_add_u32 m0, s42, 40960
    s_nop 0
    buffer_load_dwordx4 v200, s[8:11], s41 offen offset:0 lds
    buffer_load_dwordx4 v200, s[8:11], s41 offen offset:1024 lds
    buffer_load_dwordx4 v200, s[8:11], s41 offen offset:2048 lds
    buffer_load_dwordx4 v200, s[8:11], s41 offen offset:3072 lds
    s_add_u32 m0, s42, 45056
    s_add_u32 s41, s41, 4096
    buffer_load_dwordx4 v200, s[8:11], s41 offen offset:0 lds
    buffer_load_dwordx4 v200, s[8:11], s41 offen offset:1024 lds
    buffer_load_dwordx4 v200, s[8:11], s41 offen offset:2048 lds
    buffer_load_dwordx4 v200, s[8:11], s41 offen offset:3072 lds
    s_add_u32 m0, s42, 49152
    s_add_u32 s41, s41, 4096
    buffer_load_dwordx4 v200, s[8:11], s41 offen offset:0 lds
    buffer_load_dwordx4 v200, s[8:11], s41 offen offset:1024 lds
    v_add_u32 v203, 81920, v201
    ds_read_b64_tr_b16 a[8:9], v203 offset:0
    ds_read_b64_tr_b16 a[10:11], v203 offset:20480
    ds_read_b64_tr_b16 a[32:33], v203 offset:32
    ds_read_b64_tr_b16 a[34:35], v203 offset:20512
    ds_read_b64_tr_b16 a[56:57], v203 offset:64
    ds_read_b64_tr_b16 a[58:59], v203 offset:20544
    ds_read_b64_tr_b16 a[80:81], v203 offset:96
    ds_read_b64_tr_b16 a[82:83], v203 offset:20576
    ds_read_b64_tr_b16 a[104:105], v203 offset:128
    ds_read_b64_tr_b16 a[106:107], v203 offset:20608
    ds_read_b64_tr_b16 a[128:129], v203 offset:160
    ds_read_b64_tr_b16 a[130:131], v203 offset:20640
    ds_read_b64_tr_b16 a[152:153], v203 offset:192
    ds_read_b64_tr_b16 a[154:155], v203 offset:20672
    s_waitcnt lgkmcnt(0)
    ds_read_b64_tr_b16 a[176:177], v203 offset:224
    ds_read_b64_tr_b16 a[178:179], v203 offset:20704
    ds_read_b64_tr_b16 a[200:201], v203 offset:256
    ds_read_b64_tr_b16 a[202:203], v203 offset:20736
    ds_read_b64_tr_b16 a[224:225], v203 offset:288
    ds_read_b64_tr_b16 a[226:227], v203 offset:20768
    s_waitcnt lgkmcnt(0)
    s_waitcnt vmcnt(20)
    s_barrier
    v_add_u32 v203, 122880, v201
    ds_read_b64_tr_b16 a[12:13], v203 offset:0
    ds_read_b64_tr_b16 a[14:15], v203 offset:20480
    ds_read_b64_tr_b16 a[36:37], v203 offset:32
    ds_read_b64_tr_b16 a[38:39], v203 offset:20512
    ds_read_b64_tr_b16 a[60:61], v203 offset:64
    ds_read_b64_tr_b16 a[62:63], v203 offset:20544
    ds_read_b64_tr_b16 a[84:85], v203 offset:96
    ds_read_b64_tr_b16 a[86:87], v203 offset:20576
    ds_read_b64_tr_b16 a[108:109], v203 offset:128
    ds_read_b64_tr_b16 a[110:111], v203 offset:20608
    ds_read_b64_tr_b16 a[132:133], v203 offset:160
    ds_read_b64_tr_b16 a[134:135], v203 offset:20640
    ds_read_b64_tr_b16 a[156:157], v203 offset:192
    ds_read_b64_tr_b16 a[158:159], v203 offset:20672
    s_waitcnt lgkmcnt(0)
    ds_read_b64_tr_b16 a[180:181], v203 offset:224
    ds_read_b64_tr_b16 a[182:183], v203 offset:20704
    ds_read_b64_tr_b16 a[204:205], v203 offset:256
    ds_read_b64_tr_b16 a[206:207], v203 offset:20736
    ds_read_b64_tr_b16 a[228:229], v203 offset:288
    ds_read_b64_tr_b16 a[230:231], v203 offset:20768
    s_waitcnt lgkmcnt(0)
    s_waitcnt vmcnt(10)
    s_barrier
    v_add_u32 v203, 0, v202
    ds_read_b64_tr_b16 a[16:17], v203 offset:0
    ds_read_b64_tr_b16 a[18:19], v203 offset:5120
    ds_read_b64_tr_b16 a[40:41], v203 offset:32
    ds_read_b64_tr_b16 a[42:43], v203 offset:5152
    ds_read_b64_tr_b16 a[64:65], v203 offset:64
    ds_read_b64_tr_b16 a[66:67], v203 offset:5184
    ds_read_b64_tr_b16 a[88:89], v203 offset:96
    ds_read_b64_tr_b16 a[90:91], v203 offset:5216
    ds_read_b64_tr_b16 a[112:113], v203 offset:128
    ds_read_b64_tr_b16 a[114:115], v203 offset:5248
    ds_read_b64_tr_b16 a[136:137], v203 offset:160
    ds_read_b64_tr_b16 a[138:139], v203 offset:5280
    ds_read_b64_tr_b16 a[160:161], v203 offset:192
    ds_read_b64_tr_b16 a[162:163], v203 offset:5312
    s_waitcnt lgkmcnt(0)
    ds_read_b64_tr_b16 a[184:185], v203 offset:224
    ds_read_b64_tr_b16 a[186:187], v203 offset:5344
    ds_read_b64_tr_b16 a[208:209], v203 offset:256
    ds_read_b64_tr_b16 a[210:211], v203 offset:5376
    ds_read_b64_tr_b16 a[232:233], v203 offset:288
    ds_read_b64_tr_b16 a[234:235], v203 offset:5408
    s_waitcnt lgkmcnt(0)
    s_waitcnt vmcnt(0)
    s_barrier
    v_add_u32 v203, 40960, v202
    ds_read_b64_tr_b16 a[20:21], v203 offset:0
    ds_read_b64_tr_b16 a[22:23], v203 offset:5120
    ds_read_b64_tr_b16 a[44:45], v203 offset:32
    ds_read_b64_tr_b16 a[46:47], v203 offset:5152
    ds_read_b64_tr_b16 a[68:69], v203 offset:64
    ds_read_b64_tr_b16 a[70:71], v203 offset:5184
    ds_read_b64_tr_b16 a[92:93], v203 offset:96
    ds_read_b64_tr_b16 a[94:95], v203 offset:5216
    ds_read_b64_tr_b16 a[116:117], v203 offset:128
    ds_read_b64_tr_b16 a[118:119], v203 offset:5248
    ds_read_b64_tr_b16 a[140:141], v203 offset:160
    ds_read_b64_tr_b16 a[142:143], v203 offset:5280
    ds_read_b64_tr_b16 a[164:165], v203 offset:192
    ds_read_b64_tr_b16 a[166:167], v203 offset:5312
    s_waitcnt lgkmcnt(0)
    ds_read_b64_tr_b16 a[188:189], v203 offset:224
    ds_read_b64_tr_b16 a[190:191], v203 offset:5344
    ds_read_b64_tr_b16 a[212:213], v203 offset:256
    ds_read_b64_tr_b16 a[214:215], v203 offset:5376
    ds_read_b64_tr_b16 a[236:237], v203 offset:288
    ds_read_b64_tr_b16 a[238:239], v203 offset:5408
    s_waitcnt lgkmcnt(0)
    s_barrier
    v_mov_b32 v251, 0
    global_load_dword v250, v251, s[98:99] sc1
    s_waitcnt vmcnt(0)
iw_lp_260:
    v_cmp_gt_u32 vcc, 27, v250
    s_cbranch_vccz iw_ok_259
    s_cmp_eq_u32 s100, 0
    s_cbranch_scc1 iw_ok_259
    s_sub_u32 s100, s100, 1
    s_sleep 2
    global_load_dword v250, v251, s[98:99] sc1
    s_waitcnt vmcnt(0)
    s_branch iw_lp_260
iw_ok_259:
    s_mul_i32 s25, s20, 3072
    v_lshlrev_b32 v3, 4, v1
    v_add_u32 v2, s25, v3
    s_mul_i32 s26, s20, 10240
    v_add_u32 v4, s26, v3
    v_mov_b32 v6, 0
    s_mul_i32 s23, s21, 12288
    s_add_u32 s23, s23, 25165824
    s_mul_i32 s24, s21, 40960
    s_add_u32 s24, s24, 49020928
    s_mov_b32 s22, 0
    v_mov_b32 v5, 0
    s_mov_b32 s29, 1
fw_lp_262:
    v_cmp_gt_u32 vcc, s29, v5
    s_cbranch_vccz fw_ok_261
    s_cmp_eq_u32 s100, 0
    s_cbranch_scc1 fw_ok_261
    s_sub_u32 s100, s100, 1
    s_sleep 2
    buffer_load_dword v5, v6, s[4:7], s28 offen sc1
    s_waitcnt vmcnt(0)
    s_branch fw_lp_262
fw_ok_261:
    s_add_u32 m0, s25, 0
    s_nop 0
    buffer_load_dwordx4 v2, s[4:7], s23 offen offset:0 sc1 lds
    buffer_load_dwordx4 v2, s[4:7], s23 offen offset:1024 sc1 lds
    buffer_load_dwordx4 v2, s[4:7], s23 offen offset:2048 sc1 lds
    s_waitcnt vmcnt(0)
U_loop_263:
    s_waitcnt vmcnt(9)
    s_barrier
    ds_read_b128 v[8:11], v3 offset:0
    ds_read_b128 v[12:15], v3 offset:6144
    ds_read_b128 v[16:19], v3 offset:1024
    ds_read_b128 v[20:23], v3 offset:7168
    ds_read_b128 v[24:27], v3 offset:2048
    ds_read_b128 v[28:31], v3 offset:8192
    ds_read_b128 v[32:35], v3 offset:3072
    ds_read_b128 v[36:39], v3 offset:9216
    ds_read_b128 v[40:43], v3 offset:4096
    ds_read_b128 v[44:47], v3 offset:10240
    ds_read_b128 v[48:51], v3 offset:5120
    ds_read_b128 v[52:55], v3 offset:11264
    s_cmp_eq_u32 s22, 0
    s_cbranch_scc1 U_skip_264
    s_cmp_lt_u32 s22, 5
    s_cbranch_scc1 U_s2_265
    s_cmp_lg_u32 s20, 0
    s_cbranch_scc1 ar_266
    v_mov_b32 v98, 1
    v_mov_b32 v99, 0
    s_mov_b64 exec, 1
    buffer_atomic_add v98, v99, s[4:7], s27 offen sc1
    s_mov_b64 exec, -1
ar_266:
    s_add_u32 s27, s27, 128
U_s2_265:
    v_cvt_pk_bf16_f32 v76, v64, v65
    v_cvt_pk_bf16_f32 v77, v66, v67
    v_cvt_pk_bf16_f32 v78, v68, v69
    v_cvt_pk_bf16_f32 v79, v70, v71
    s_add_u32 s31, s24, 9216
    buffer_store_dwordx4 v[76:79], v4, s[4:7], s31 offen sc0 sc1
U_skip_264:
    s_add_u32 s24, s24, 1310720
    s_add_u32 s23, s23, 393216
    s_add_u32 s29, s22, 2
    s_min_u32 s29, s29, 64
fw_lp_268:
    v_cmp_gt_u32 vcc, s29, v5
    s_cbranch_vccz fw_ok_267
    s_cmp_eq_u32 s100, 0
    s_cbranch_scc1 fw_ok_267
    s_sub_u32 s100, s100, 1
    s_sleep 2
    buffer_load_dword v5, v6, s[4:7], s28 offen sc1
    s_waitcnt vmcnt(0)
    s_branch fw_lp_268
fw_ok_267:
    buffer_load_dword v5, v6, s[4:7], s28 offen sc1
    s_add_u32 m0, s25, 12288
    s_nop 0
    buffer_load_dwordx4 v2, s[4:7], s23 offen offset:0 sc1 lds
    buffer_load_dwordx4 v2, s[4:7], s23 offen offset:1024 sc1 lds
    buffer_load_dwordx4 v2, s[4:7], s23 offen offset:2048 sc1 lds
    s_waitcnt lgkmcnt(10)
    v_mfma_f32_16x16x32_bf16 v[56:59], v[8:11], a[0:3], 0
    v_mfma_f32_16x16x32_bf16 v[60:63], v[12:15], a[0:3], 0
    s_waitcnt lgkmcnt(8)
    v_mfma_f32_16x16x32_bf16 v[56:59], v[16:19], a[4:7], v[56:59]
    v_mfma_f32_16x16x32_bf16 v[60:63], v[20:23], a[4:7], v[60:63]
    s_waitcnt lgkmcnt(6)
    v_mfma_f32_16x16x32_bf16 v[56:59], v[24:27], a[8:11], v[56:59]
    v_mfma_f32_16x16x32_bf16 v[60:63], v[28:31], a[8:11], v[60:63]
    s_waitcnt lgkmcnt(4)
    v_mfma_f32_16x16x32_bf16 v[56:59], v[32:35], a[12:15], v[56:59]
    v_mfma_f32_16x16x32_bf16 v[60:63], v[36:39], a[12:15], v[60:63]
    s_waitcnt lgkmcnt(2)
    v_mfma_f32_16x16x32_bf16 v[56:59], v[40:43], a[16:19], v[56:59]
    v_mfma_f32_16x16x32_bf16 v[60:63], v[44:47], a[16:19], v[60:63]
    s_waitcnt lgkmcnt(0)
    v_mfma_f32_16x16x32_bf16 v[56:59], v[48:51], a[20:23], v[56:59]
    v_mfma_f32_16x16x32_bf16 v[60:63], v[52:55], a[20:23], v[60:63]
    v_mfma_f32_16x16x32_bf16 v[64:67], v[8:11], a[24:27], 0
    v_mfma_f32_16x16x32_bf16 v[68:71], v[12:15], a[24:27], 0
    v_mfma_f32_16x16x32_bf16 v[64:67], v[16:19], a[28:31], v[64:67]
    v_mfma_f32_16x16x32_bf16 v[68:71], v[20:23], a[28:31], v[68:71]
    v_cvt_pk_bf16_f32 v72, v56, v57
    v_mfma_f32_16x16x32_bf16 v[64:67], v[24:27], a[32:35], v[64:67]
    v_cvt_pk_bf16_f32 v73, v58, v59
    v_mfma_f32_16x16x32_bf16 v[68:71], v[28:31], a[32:35], v[68:71]
    v_cvt_pk_bf16_f32 v74, v60, v61
    v_mfma_f32_16x16x32_bf16 v[64:67], v[32:35], a[36:39], v[64:67]
    v_cvt_pk_bf16_f32 v75, v62, v63
    v_mfma_f32_16x16x32_bf16 v[68:71], v[36:39], a[36:39], v[68:71]
    s_add_u32 s31, s24, 0
    v_mfma_f32_16x16x32_bf16 v[64:67], v[40:43], a[40:43], v[64:67]
    buffer_store_dwordx4 v[72:75], v4, s[4:7], s31 offen sc0 sc1
    v_mfma_f32_16x16x32_bf16 v[68:71], v[44:47], a[40:43], v[68:71]
    v_mfma_f32_16x16x32_bf16 v[64:67], v[48:51], a[44:47], v[64:67]
    v_mfma_f32_16x16x32_bf16 v[68:71], v[52:55], a[44:47], v[68:71]
    v_mfma_f32_16x16x32_bf16 v[56:59], v[8:11], a[48:51], 0
    v_mfma_f32_16x16x32_bf16 v[60:63], v[12:15], a[48:51], 0
    v_mfma_f32_16x16x32_bf16 v[56:59], v[16:19], a[52:55], v[56:59]
    v_mfma_f32_16x16x32_bf16 v[60:63], v[20:23], a[52:55], v[60:63]
    v_cvt_pk_bf16_f32 v76, v64, v65
    v_mfma_f32_16x16x32_bf16 v[56:59], v[24:27], a[56:59], v[56:59]
    v_cvt_pk_bf16_f32 v77, v66, v67
    v_mfma_f32_16x16x32_bf16 v[60:63], v[28:31], a[56:59], v[60:63]
    v_cvt_pk_bf16_f32 v78, v68, v69
    v_mfma_f32_16x16x32_bf16 v[56:59], v[32:35], a[60:63], v[56:59]
    v_cvt_pk_bf16_f32 v79, v70, v71
    v_mfma_f32_16x16x32_bf16 v[60:63], v[36:39], a[60:63], v[60:63]
    s_add_u32 s31, s24, 1024
    v_mfma_f32_16x16x32_bf16 v[56:59], v[40:43], a[64:67], v[56:59]
    buffer_store_dwordx4 v[76:79], v4, s[4:7], s31 offen sc0 sc1
    v_mfma_f32_16x16x32_bf16 v[60:63], v[44:47], a[64:67], v[60:63]
    v_mfma_f32_16x16x32_bf16 v[56:59], v[48:51], a[68:71], v[56:59]
    v_mfma_f32_16x16x32_bf16 v[60:63], v[52:55], a[68:71], v[60:63]
    v_mfma_f32_16x16x32_bf16 v[64:67], v[8:11], a[72:75], 0
    v_mfma_f32_16x16x32_bf16 v[68:71], v[12:15], a[72:75], 0
    v_mfma_f32_16x16x32_bf16 v[64:67], v[16:19], a[76:79], v[64:67]
    v_mfma_f32_16x16x32_bf16 v[68:71], v[20:23], a[76:79], v[68:71]
    v_cvt_pk_bf16_f32 v72, v56, v57
    v_mfma_f32_16x16x32_bf16 v[64:67], v[24:27], a[80:83], v[64:67]
    v_cvt_pk_bf16_f32 v73, v58, v59
    v_mfma_f32_16x16x32_bf16 v[68:71], v[28:31], a[80:83], v[68:71]
    v_cvt_pk_bf16_f32 v74, v60, v61
    v_mfma_f32_16x16x32_bf16 v[64:67], v[32:35], a[84:87], v[64:67]
    v_cvt_pk_bf16_f32 v75, v62, v63
    v_mfma_f32_16x16x32_bf16 v[68:71], v[36:39], a[84:87], v[68:71]
    s_add_u32 s31, s24, 2048
    v_mfma_f32_16x16x32_bf16 v[64:67], v[40:43], a[88:91], v[64:67]
    buffer_store_dwordx4 v[72:75], v4, s[4:7], s31 offen sc0 sc1
    v_mfma_f32_16x16x32_bf16 v[68:71], v[44:47], a[88:91], v[68:71]
    v_mfma_f32_16x16x32_bf16 v[64:67], v[48:51], a[92:95], v[64:67]
    v_mfma_f32_16x16x32_bf16 v[68:71], v[52:55], a[92:95], v[68:71]
    v_mfma_f32_16x16x32_bf16 v[56:59], v[8:11], a[96:99], 0
    v_mfma_f32_16x16x32_bf16 v[60:63], v[12:15], a[96:99], 0
    v_mfma_f32_16x16x32_bf16 v[56:59], v[16:19], a[100:103], v[56:59]
    v_mfma_f32_16x16x32_bf16 v[60:63], v[20:23], a[100:103], v[60:63]
    v_cvt_pk_bf16_f32 v76, v64, v65
    v_mfma_f32_16x16x32_bf16 v[56:59], v[24:27], a[104:107], v[56:59]
    v_cvt_pk_bf16_f32 v77, v66, v67
    v_mfma_f32_16x16x32_bf16 v[60:63], v[28:31], a[104:107], v[60:63]
    v_cvt_pk_bf16_f32 v78, v68, v69
    v_mfma_f32_16x16x32_bf16 v[56:59], v[32:35], a[108:111], v[56:59]
    v_cvt_pk_bf16_f32 v79, v70, v71
    v_mfma_f32_16x16x32_bf16 v[60:63], v[36:39], a[108:111], v[60:63]
    s_add_u32 s31, s24, 3072
    v_mfma_f32_16x16x32_bf16 v[56:59], v[40:43], a[112:115], v[56:59]
    buffer_store_dwordx4 v[76:79], v4, s[4:7], s31 offen sc0 sc1
    v_mfma_f32_16x16x32_bf16 v[60:63], v[44:47], a[112:115], v[60:63]
    v_mfma_f32_16x16x32_bf16 v[56:59], v[48:51], a[116:119], v[56:59]
    v_mfma_f32_16x16x32_bf16 v[60:63], v[52:55], a[116:119], v[60:63]
    v_mfma_f32_16x16x32_bf16 v[64:67], v[8:11], a[120:123], 0
    v_mfma_f32_16x16x32_bf16 v[68:71], v[12:15], a[120:123], 0
    v_mfma_f32_16x16x32_bf16 v[64:67], v[16:19], a[124:127], v[64:67]
    v_mfma_f32_16x16x32_bf16 v[68:71], v[20:23], a[124:127], v[68:71]
    v_cvt_pk_bf16_f32 v72, v56, v57
    v_mfma_f32_16x16x32_bf16 v[64:67], v[24:27], a[128:131], v[64:67]
    v_cvt_pk_bf16_f32 v73, v58, v59
    v_mfma_f32_16x16x32_bf16 v[68:71], v[28:31], a[128:131], v[68:71]
    v_cvt_pk_bf16_f32 v74, v60, v61
    v_mfma_f32_16x16x32_bf16 v[64:67], v[32:35], a[132:135], v[64:67]
    v_cvt_pk_bf16_f32 v75, v62, v63
    v_mfma_f32_16x16x32_bf16 v[68:71], v[36:39], a[132:135], v[68:71]
    s_add_u32 s31, s24, 4096
    v_mfma_f32_16x16x32_bf16 v[64:67], v[40:43], a[136:139], v[64:67]
    buffer_store_dwordx4 v[72:75], v4, s[4:7], s31 offen sc0 sc1
    v_mfma_f32_16x16x32_bf16 v[68:71], v[44:47], a[136:139], v[68:71]
    v_mfma_f32_16x16x32_bf16 v[64:67], v[48:51], a[140:143], v[64:67]
    v_mfma_f32_16x16x32_bf16 v[68:71], v[52:55], a[140:143], v[68:71]
    v_mfma_f32_16x16x32_bf16 v[56:59], v[8:11], a[144:147], 0
    v_mfma_f32_16x16x32_bf16 v[60:63], v[12:15], a[144:147], 0
    v_mfma_f32_16x16x32_bf16 v[56:59], v[16:19], a[148:151], v[56:59]
    v_mfma_f32_16x16x32_bf16 v[60:63], v[20:23], a[148:151], v[60:63]
    v_cvt_pk_bf16_f32 v76, v64, v65
    v_mfma_f32_16x16x32_bf16 v[56:59], v[24:27], a[152:155], v[56:59]
    v_cvt_pk_bf16_f32 v77, v66, v67
    v_mfma_f32_16x16x32_bf16 v[60:63], v[28:31], a[152:155], v[60:63]
    v_cvt_pk_bf16_f32 v78, v68, v69
    v_mfma_f32_16x16x32_bf16 v[56:59], v[32:35], a[156:159], v[56:59]
    v_cvt_pk_bf16_f32 v79, v70, v71
    v_mfma_f32_16x16x32_bf16 v[60:63], v[36:39], a[156:159], v[60:63]
    s_add_u32 s31, s24, 5120
    v_mfma_f32_16x16x32_bf16 v[56:59], v[40:43], a[160:163], v[56:59]
    buffer_store_dwordx4 v[76:79], v4, s[4:7], s31 offen sc0 sc1
    v_mfma_f32_16x16x32_bf16 v[60:63], v[44:47], a[160:163], v[60:63]
    v_mfma_f32_16x16x32_bf16 v[56:59], v[48:51], a[164:167], v[56:59]
    v_mfma_f32_16x16x32_bf16 v[60:63], v[52:55], a[164:167], v[60:63]
    v_mfma_f32_16x16x32_bf16 v[64:67], v[8:11], a[168:171], 0
    v_mfma_f32_16x16x32_bf16 v[68:71], v[12:15], a[168:171], 0
    v_mfma_f32_16x16x32_bf16 v[64:67], v[16:19], a[172:175], v[64:67]
    v_mfma_f32_16x16x32_bf16 v[68:71], v[20:23], a[172:175], v[68:71]
    v_cvt_pk_bf16_f32 v72, v56, v57
    v_mfma_f32_16x16x32_bf16 v[64:67], v[24:27], a[176:179], v[64:67]
    v_cvt_pk_bf16_f32 v73, v58, v59
    v_mfma_f32_16x16x32_bf16 v[68:71], v[28:31], a[176:179], v[68:71]
    v_cvt_pk_bf16_f32 v74, v60, v61
    v_mfma_f32_16x16x32_bf16 v[64:67], v[32:35], a[180:183], v[64:67]
    v_cvt_pk_bf16_f32 v75, v62, v63
    v_mfma_f32_16x16x32_bf16 v[68:71], v[36:39], a[180:183], v[68:71]
    s_add_u32 s31, s24, 6144
    v_mfma_f32_16x16x32_bf16 v[64:67], v[40:43], a[184:187], v[64:67]
    buffer_store_dwordx4 v[72:75], v4, s[4:7], s31 offen sc0 sc1
    v_mfma_f32_16x16x32_bf16 v[68:71], v[44:47], a[184:187], v[68:71]
    v_mfma_f32_16x16x32_bf16 v[64:67], v[48:51], a[188:191], v[64:67]
    v_mfma_f32_16x16x32_bf16 v[68:71], v[52:55], a[188:191], v[68:71]
    v_mfma_f32_16x16x32_bf16 v[56:59], v[8:11], a[192:195], 0
    v_mfma_f32_16x16x32_bf16 v[60:63], v[12:15], a[192:195], 0
    v_mfma_f32_16x16x32_bf16 v[56:59], v[16:19], a[196:199], v[56:59]
    v_mfma_f32_16x16x32_bf16 v[60:63], v[20:23], a[196:199], v[60:63]
    v_cvt_pk_bf16_f32 v76, v64, v65
    v_mfma_f32_16x16x32_bf16 v[56:59], v[24:27], a[200:203], v[56:59]
    v_cvt_pk_bf16_f32 v77, v66, v67
    v_mfma_f32_16x16x32_bf16 v[60:63], v[28:31], a[200:203], v[60:63]
    v_cvt_pk_bf16_f32 v78, v68, v69
    v_mfma_f32_16x16x32_bf16 v[56:59], v[32:35], a[204:207], v[56:59]
    v_cvt_pk_bf16_f32 v79, v70, v71
    v_mfma_f32_16x16x32_bf16 v[60:63], v[36:39], a[204:207], v[60:63]
    s_add_u32 s31, s24, 7168
    v_mfma_f32_16x16x32_bf16 v[56:59], v[40:43], a[208:211], v[56:59]
    buffer_store_dwordx4 v[76:79], v4, s[4:7], s31 offen sc0 sc1
    v_mfma_f32_16x16x32_bf16 v[60:63], v[44:47], a[208:211], v[60:63]
    v_mfma_f32_16x16x32_bf16 v[56:59], v[48:51], a[212:215], v[56:59]
    v_mfma_f32_16x16x32_bf16 v[60:63], v[52:55], a[212:215], v[60:63]
    v_mfma_f32_16x16x32_bf16 v[64:67], v[8:11], a[216:219], 0
    v_mfma_f32_16x16x32_bf16 v[68:71], v[12:15], a[216:219], 0
    v_mfma_f32_16x16x32_bf16 v[64:67], v[16:19], a[220:223], v[64:67]
    v_mfma_f32_16x16x32_bf16 v[68:71], v[20:23], a[220:223], v[68:71]
    v_cvt_pk_bf16_f32 v72, v56, v57
    v_mfma_f32_16x16x32_bf16 v[64:67], v[24:27], a[224:227], v[64:67]
    v_cvt_pk_bf16_f32 v73, v58, v59
    v_mfma_f32_16x16x32_bf16 v[68:71], v[28:31], a[224:227], v[68:71]
    v_cvt_pk_bf16_f32 v74, v60, v61
    v_mfma_f32_16x16x32_bf16 v[64:67], v[32:35], a[228:231], v[64:67]
    v_cvt_pk_bf16_f32 v75, v62, v63
    v_mfma_f32_16x16x32_bf16 v[68:71], v[36:39], a[228:231], v[68:71]
    s_add_u32 s31, s24, 8192
    v_mfma_f32_16x16x32_bf16 v[64:67], v[40:43], a[232:235], v[64:67]
    buffer_store_dwordx4 v[72:75], v4, s[4:7], s31 offen sc0 sc1
    v_mfma_f32_16x16x32_bf16 v[68:71], v[44:47], a[232:235], v[68:71]
    v_mfma_f32_16x16x32_bf16 v[64:67], v[48:51], a[236:239], v[64:67]
    v_mfma_f32_16x16x32_bf16 v[68:71], v[52:55], a[236:239], v[68:71]
    s_add_u32 s22, s22, 1
    s_cmp_gt_u32 s22, 3
    s_cbranch_scc1 U_ne_269
    s_nop 5
    v_cvt_pk_bf16_f32 v76, v64, v65
    v_cvt_pk_bf16_f32 v77, v66, v67
    v_cvt_pk_bf16_f32 v78, v68, v69
    v_cvt_pk_bf16_f32 v79, v70, v71
    s_add_u32 s31, s24, 9216
    buffer_store_dwordx4 v[76:79], v4, s[4:7], s31 offen sc0 sc1
    s_waitcnt vmcnt(0)
    s_barrier
    s_cmp_lg_u32 s20, 0
    s_cbranch_scc1 ar_270
    v_mov_b32 v98, 1
    v_mov_b32 v99, 0
    s_mov_b64 exec, 1
    buffer_atomic_add v98, v99, s[4:7], s27 offen sc1
    s_mov_b64 exec, -1
ar_270:
    s_add_u32 s27, s27, 128
U_ne_269:
    s_waitcnt vmcnt(9)
    s_barrier
    ds_read_b128 v[8:11], v3 offset:12288
    ds_read_b128 v[12:15], v3 offset:18432
    ds_read_b128 v[16:19], v3 offset:13312
    ds_read_b128 v[20:23], v3 offset:19456
    ds_read_b128 v[24:27], v3 offset:14336
    ds_read_b128 v[28:31], v3 offset:20480
    ds_read_b128 v[32:35], v3 offset:15360
    ds_read_b128 v[36:39], v3 offset:21504
    ds_read_b128 v[40:43], v3 offset:16384
    ds_read_b128 v[44:47], v3 offset:22528
    ds_read_b128 v[48:51], v3 offset:17408
    ds_read_b128 v[52:55], v3 offset:23552
    s_cmp_lt_u32 s22, 5
    s_cbranch_scc1 U_s2_272
    s_cmp_lg_u32 s20, 0
    s_cbranch_scc1 ar_273
    v_mov_b32 v98, 1
    v_mov_b32 v99, 0
    s_mov_b64 exec, 1
    buffer_atomic_add v98, v99, s[4:7], s27 offen sc1
    s_mov_b64 exec, -1
ar_273:
    s_add_u32 s27, s27, 128
U_s2_272:
    v_cvt_pk_bf16_f32 v76, v64, v65
    v_cvt_pk_bf16_f32 v77, v66, v67
    v_cvt_pk_bf16_f32 v78, v68, v69
    v_cvt_pk_bf16_f32 v79, v70, v71
    s_add_u32 s31, s24, 9216
    buffer_store_dwordx4 v[76:79], v4, s[4:7], s31 offen sc0 sc1
U_skip_271:
    s_add_u32 s24, s24, 1310720
    s_add_u32 s23, s23, 393216
    s_add_u32 s29, s22, 2
    s_min_u32 s29, s29, 64
fw_lp_275:
    v_cmp_gt_u32 vcc, s29, v5
    s_cbranch_vccz fw_ok_274
    s_cmp_eq_u32 s100, 0
    s_cbranch_scc1 fw_ok_274
    s_sub_u32 s100, s100, 1
    s_sleep 2
    buffer_load_dword v5, v6, s[4:7], s28 offen sc1
    s_waitcnt vmcnt(0)
    s_branch fw_lp_275
fw_ok_274:
    buffer_load_dword v5, v6, s[4:7], s28 offen sc1
    s_add_u32 m0, s25, 0
    s_nop 0
    buffer_load_dwordx4 v2, s[4:7], s23 offen offset:0 sc1 lds
    buffer_load_dwordx4 v2, s[4:7], s23 offen offset:1024 sc1 lds
    buffer_load_dwordx4 v2, s[4:7], s23 offen offset:2048 sc1 lds
    s_waitcnt lgkmcnt(10)
    v_mfma_f32_16x16x32_bf16 v[56:59], v[8:11], a[0:3], 0
    v_mfma_f32_16x16x32_bf16 v[60:63], v[12:15], a[0:3], 0
    s_waitcnt lgkmcnt(8)
    v_mfma_f32_16x16x32_bf16 v[56:59], v[16:19], a[4:7], v[56:59]
    v_mfma_f32_16x16x32_bf16 v[60:63], v[20:23], a[4:7], v[60:63]
    s_waitcnt lgkmcnt(6)
    v_mfma_f32_16x16x32_bf16 v[56:59], v[24:27], a[8:11], v[56:59]
    v_mfma_f32_16x16x32_bf16 v[60:63], v[28:31], a[8:11], v[60:63]
    s_waitcnt lgkmcnt(4)
    v_mfma_f32_16x16x32_bf16 v[56:59], v[32:35], a[12:15], v[56:59]
    v_mfma_f32_16x16x32_bf16 v[60:63], v[36:39], a[12:15], v[60:63]
    s_waitcnt lgkmcnt(2)
    v_mfma_f32_16x16x32_bf16 v[56:59], v[40:43], a[16:19], v[56:59]
    v_mfma_f32_16x16x32_bf16 v[60:63], v[44:47], a[16:19], v[60:63]
    s_waitcnt lgkmcnt(0)
    v_mfma_f32_16x16x32_bf16 v[56:59], v[48:51], a[20:23], v[56:59]
    v_mfma_f32_16x16x32_bf16 v[60:63], v[52:55], a[20:23], v[60:63]
    v_mfma_f32_16x16x32_bf16 v[64:67], v[8:11], a[24:27], 0
    v_mfma_f32_16x16x32_bf16 v[68:71], v[12:15], a[24:27], 0
    v_mfma_f32_16x16x32_bf16 v[64:67], v[16:19], a[28:31], v[64:67]
    v_mfma_f32_16x16x32_bf16 v[68:71], v[20:23], a[28:31], v[68:71]
    v_cvt_pk_bf16_f32 v72, v56, v57
    v_mfma_f32_16x16x32_bf16 v[64:67], v[24:27], a[32:35], v[64:67]
    v_cvt_pk_bf16_f32 v73, v58, v59
    v_mfma_f32_16x16x32_bf16 v[68:71], v[28:31], a[32:35], v[68:71]
    v_cvt_pk_bf16_f32 v74, v60, v61
    v_mfma_f32_16x16x32_bf16 v[64:67], v[32:35], a[36:39], v[64:67]
    v_cvt_pk_bf16_f32 v75, v62, v63
    v_mfma_f32_16x16x32_bf16 v[68:71], v[36:39], a[36:39], v[68:71]
    s_add_u32 s31, s24, 0
    v_mfma_f32_16x16x32_bf16 v[64:67], v[40:43], a[40:43], v[64:67]
    buffer_store_dwordx4 v[72:75], v4, s[4:7], s31 offen sc0 sc1
    v_mfma_f32_16x16x32_bf16 v[68:71], v[44:47], a[40:43], v[68:71]
    v_mfma_f32_16x16x32_bf16 v[64:67], v[48:51], a[44:47], v[64:67]
    v_mfma_f32_16x16x32_bf16 v[68:71], v[52:55], a[44:47], v[68:71]
    v_mfma_f32_16x16x32_bf16 v[56:59], v[8:11], a[48:51], 0
    v_mfma_f32_16x16x32_bf16 v[60:63], v[12:15], a[48:51], 0
    v_mfma_f32_16x16x32_bf16 v[56:59], v[16:19], a[52:55], v[56:59]
    v_mfma_f32_16x16x32_bf16 v[60:63], v[20:23], a[52:55], v[60:63]
    v_cvt_pk_bf16_f32 v76, v64, v65
    v_mfma_f32_16x16x32_bf16 v[56:59], v[24:27], a[56:59], v[56:59]
    v_cvt_pk_bf16_f32 v77, v66, v67
    v_mfma_f32_16x16x32_bf16 v[60:63], v[28:31], a[56:59], v[60:63]
    v_cvt_pk_bf16_f32 v78, v68, v69
    v_mfma_f32_16x16x32_bf16 v[56:59], v[32:35], a[60:63], v[56:59]
    v_cvt_pk_bf16_f32 v79, v70, v71
    v_mfma_f32_16x16x32_bf16 v[60:63], v[36:39], a[60:63], v[60:63]
    s_add_u32 s31, s24, 1024
    v_mfma_f32_16x16x32_bf16 v[56:59], v[40:43], a[64:67], v[56:59]
    buffer_store_dwordx4 v[76:79], v4, s[4:7], s31 offen sc0 sc1
    v_mfma_f32_16x16x32_bf16 v[60:63], v[44:47], a[64:67], v[60:63]
    v_mfma_f32_16x16x32_bf16 v[56:59], v[48:51], a[68:71], v[56:59]
    v_mfma_f32_16x16x32_bf16 v[60:63], v[52:55], a[68:71], v[60:63]
    v_mfma_f32_16x16x32_bf16 v[64:67], v[8:11], a[72:75], 0
    v_mfma_f32_16x16x32_bf16 v[68:71], v[12:15], a[72:75], 0
    v_mfma_f32_16x16x32_bf16 v[64:67], v[16:19], a[76:79], v[64:67]
    v_mfma_f32_16x16x32_bf16 v[68:71], v[20:23], a[76:79], v[68:71]
    v_cvt_pk_bf16_f32 v72, v56, v57
    v_mfma_f32_16x16x32_bf16 v[64:67], v[24:27], a[80:83], v[64:67]
    v_cvt_pk_bf16_f32 v73, v58, v59
    v_mfma_f32_16x16x32_bf16 v[68:71], v[28:31], a[80:83], v[68:71]
    v_cvt_pk_bf16_f32 v74, v60, v61
    v_mfma_f32_16x16x32_bf16 v[64:67], v[32:35], a[84:87], v[64:67]
    v_cvt_pk_bf16_f32 v75, v62, v63
    v_mfma_f32_16x16x32_bf16 v[68:71], v[36:39], a[84:87], v[68:71]
    s_add_u32 s31, s24, 2048
    v_mfma_f32_16x16x32_bf16 v[64:67], v[40:43], a[88:91], v[64:67]
    buffer_store_dwordx4 v[72:75], v4, s[4:7], s31 offen sc0 sc1
    v_mfma_f32_16x16x32_bf16 v[68:71], v[44:47], a[88:91], v[68:71]
    v_mfma_f32_16x16x32_bf16 v[64:67], v[48:51], a[92:95], v[64:67]
    v_mfma_f32_16x16x32_bf16 v[68:71], v[52:55], a[92:95], v[68:71]
    v_mfma_f32_16x16x32_bf16 v[56:59], v[8:11], a[96:99], 0
    v_mfma_f32_16x16x32_bf16 v[60:63], v[12:15], a[96:99], 0
    v_mfma_f32_16x16x32_bf16 v[56:59], v[16:19], a[100:103], v[56:59]
    v_mfma_f32_16x16x32_bf16 v[60:63], v[20:23], a[100:103], v[60:63]
    v_cvt_pk_bf16_f32 v76, v64, v65
    v_mfma_f32_16x16x32_bf16 v[56:59], v[24:27], a[104:107], v[56:59]
    v_cvt_pk_bf16_f32 v77, v66, v67
    v_mfma_f32_16x16x32_bf16 v[60:63], v[28:31], a[104:107], v[60:63]
    v_cvt_pk_bf16_f32 v78, v68, v69
    v_mfma_f32_16x16x32_bf16 v[56:59], v[32:35], a[108:111], v[56:59]
    v_cvt_pk_bf16_f32 v79, v70, v71
    v_mfma_f32_16x16x32_bf16 v[60:63], v[36:39], a[108:111], v[60:63]
    s_add_u32 s31, s24, 3072
    v_mfma_f32_16x16x32_bf16 v[56:59], v[40:43], a[112:115], v[56:59]
    buffer_store_dwordx4 v[76:79], v4, s[4:7], s31 offen sc0 sc1
    v_mfma_f32_16x16x32_bf16 v[60:63], v[44:47], a[112:115], v[60:63]
    v_mfma_f32_16x16x32_bf16 v[56:59], v[48:51], a[116:119], v[56:59]
    v_mfma_f32_16x16x32_bf16 v[60:63], v[52:55], a[116:119], v[60:63]
    v_mfma_f32_16x16x32_bf16 v[64:67], v[8:11], a[120:123], 0
    v_mfma_f32_16x16x32_bf16 v[68:71], v[12:15], a[120:123], 0
    v_mfma_f32_16x16x32_bf16 v[64:67], v[16:19], a[124:127], v[64:67]
    v_mfma_f32_16x16x32_bf16 v[68:71], v[20:23], a[124:127], v[68:71]
    v_cvt_pk_bf16_f32 v72, v56, v57
    v_mfma_f32_16x16x32_bf16 v[64:67], v[24:27], a[128:131], v[64:67]
    v_cvt_pk_bf16_f32 v73, v58, v59
    v_mfma_f32_16x16x32_bf16 v[68:71], v[28:31], a[128:131], v[68:71]
    v_cvt_pk_bf16_f32 v74, v60, v61
    v_mfma_f32_16x16x32_bf16 v[64:67], v[32:35], a[132:135], v[64:67]
    v_cvt_pk_bf16_f32 v75, v62, v63
    v_mfma_f32_16x16x32_bf16 v[68:71], v[36:39], a[132:135], v[68:71]
    s_add_u32 s31, s24, 4096
    v_mfma_f32_16x16x32_bf16 v[64:67], v[40:43], a[136:139], v[64:67]
    buffer_store_dwordx4 v[72:75], v4, s[4:7], s31 offen sc0 sc1
    v_mfma_f32_16x16x32_bf16 v[68:71], v[44:47], a[136:139], v[68:71]
    v_mfma_f32_16x16x32_bf16 v[64:67], v[48:51], a[140:143], v[64:67]
    v_mfma_f32_16x16x32_bf16 v[68:71], v[52:55], a[140:143], v[68:71]
    v_mfma_f32_16x16x32_bf16 v[56:59], v[8:11], a[144:147], 0
    v_mfma_f32_16x16x32_bf16 v[60:63], v[12:15], a[144:147], 0
    v_mfma_f32_16x16x32_bf16 v[56:59], v[16:19], a[148:151], v[56:59]
    v_mfma_f32_16x16x32_bf16 v[60:63], v[20:23], a[148:151], v[60:63]
    v_cvt_pk_bf16_f32 v76, v64, v65
    v_mfma_f32_16x16x32_bf16 v[56:59], v[24:27], a[152:155], v[56:59]
    v_cvt_pk_bf16_f32 v77, v66, v67
    v_mfma_f32_16x16x32_bf16 v[60:63], v[28:31], a[152:155], v[60:63]
    v_cvt_pk_bf16_f32 v78, v68, v69
    v_mfma_f32_16x16x32_bf16 v[56:59], v[32:35], a[156:159], v[56:59]
    v_cvt_pk_bf16_f32 v79, v70, v71
    v_mfma_f32_16x16x32_bf16 v[60:63], v[36:39], a[156:159], v[60:63]
    s_add_u32 s31, s24, 5120
    v_mfma_f32_16x16x32_bf16 v[56:59], v[40:43], a[160:163], v[56:59]
    buffer_store_dwordx4 v[76:79], v4, s[4:7], s31 offen sc0 sc1
    v_mfma_f32_16x16x32_bf16 v[60:63], v[44:47], a[160:163], v[60:63]
    v_mfma_f32_16x16x32_bf16 v[56:59], v[48:51], a[164:167], v[56:59]
    v_mfma_f32_16x16x32_bf16 v[60:63], v[52:55], a[164:167], v[60:63]
    v_mfma_f32_16x16x32_bf16 v[64:67], v[8:11], a[168:171], 0
    v_mfma_f32_16x16x32_bf16 v[68:71], v[12:15], a[168:171], 0
    v_mfma_f32_16x16x32_bf16 v[64:67], v[16:19], a[172:175], v[64:67]
    v_mfma_f32_16x16x32_bf16 v[68:71], v[20:23], a[172:175], v[68:71]
    v_cvt_pk_bf16_f32 v72, v56, v57
    v_mfma_f32_16x16x32_bf16 v[64:67], v[24:27], a[176:179], v[64:67]
    v_cvt_pk_bf16_f32 v73, v58, v59
    v_mfma_f32_16x16x32_bf16 v[68:71], v[28:31], a[176:179], v[68:71]
    v_cvt_pk_bf16_f32 v74, v60, v61
    v_mfma_f32_16x16x32_bf16 v[64:67], v[32:35], a[180:183], v[64:67]
    v_cvt_pk_bf16_f32 v75, v62, v63
    v_mfma_f32_16x16x32_bf16 v[68:71], v[36:39], a[180:183], v[68:71]
    s_add_u32 s31, s24, 6144
    v_mfma_f32_16x16x32_bf16 v[64:67], v[40:43], a[184:187], v[64:67]
    buffer_store_dwordx4 v[72:75], v4, s[4:7], s31 offen sc0 sc1
    v_mfma_f32_16x16x32_bf16 v[68:71], v[44:47], a[184:187], v[68:71]
    v_mfma_f32_16x16x32_bf16 v[64:67], v[48:51], a[188:191], v[64:67]
    v_mfma_f32_16x16x32_bf16 v[68:71], v[52:55], a[188:191], v[68:71]
    v_mfma_f32_16x16x32_bf16 v[56:59], v[8:11], a[192:195], 0
    v_mfma_f32_16x16x32_bf16 v[60:63], v[12:15], a[192:195], 0
    v_mfma_f32_16x16x32_bf16 v[56:59], v[16:19], a[196:199], v[56:59]
    v_mfma_f32_16x16x32_bf16 v[60:63], v[20:23], a[196:199], v[60:63]
    v_cvt_pk_bf16_f32 v76, v64, v65
    v_mfma_f32_16x16x32_bf16 v[56:59], v[24:27], a[200:203], v[56:59]
    v_cvt_pk_bf16_f32 v77, v66, v67
    v_mfma_f32_16x16x32_bf16 v[60:63], v[28:31], a[200:203], v[60:63]
    v_cvt_pk_bf16_f32 v78, v68, v69
    v_mfma_f32_16x16x32_bf16 v[56:59], v[32:35], a[204:207], v[56:59]
    v_cvt_pk_bf16_f32 v79, v70, v71
    v_mfma_f32_16x16x32_bf16 v[60:63], v[36:39], a[204:207], v[60:63]
    s_add_u32 s31, s24, 7168
    v_mfma_f32_16x16x32_bf16 v[56:59], v[40:43], a[208:211], v[56:59]
    buffer_store_dwordx4 v[76:79], v4, s[4:7], s31 offen sc0 sc1
    v_mfma_f32_16x16x32_bf16 v[60:63], v[44:47], a[208:211], v[60:63]
    v_mfma_f32_16x16x32_bf16 v[56:59], v[48:51], a[212:215], v[56:59]
    v_mfma_f32_16x16x32_bf16 v[60:63], v[52:55], a[212:215], v[60:63]
    v_mfma_f32_16x16x32_bf16 v[64:67], v[8:11], a[216:219], 0
    v_mfma_f32_16x16x32_bf16 v[68:71], v[12:15], a[216:219], 0
    v_mfma_f32_16x16x32_bf16 v[64:67], v[16:19], a[220:223], v[64:67]
    v_mfma_f32_16x16x32_bf16 v[68:71], v[20:23], a[220:223], v[68:71]
    v_cvt_pk_bf16_f32 v72, v56, v57
    v_mfma_f32_16x16x32_bf16 v[64:67], v[24:27], a[224:227], v[64:67]
    v_cvt_pk_bf16_f32 v73, v58, v59
    v_mfma_f32_16x16x32_bf16 v[68:71], v[28:31], a[224:227], v[68:71]
    v_cvt_pk_bf16_f32 v74, v60, v61
    v_mfma_f32_16x16x32_bf16 v[64:67], v[32:35], a[228:231], v[64:67]
    v_cvt_pk_bf16_f32 v75, v62, v63
    v_mfma_f32_16x16x32_bf16 v[68:71], v[36:39], a[228:231], v[68:71]
    s_add_u32 s31, s24, 8192
    v_mfma_f32_16x16x32_bf16 v[64:67], v[40:43], a[232:235], v[64:67]
    buffer_store_dwordx4 v[72:75], v4, s[4:7], s31 offen sc0 sc1
    v_mfma_f32_16x16x32_bf16 v[68:71], v[44:47], a[232:235], v[68:71]
    v_mfma_f32_16x16x32_bf16 v[64:67], v[48:51], a[236:239], v[64:67]
    v_mfma_f32_16x16x32_bf16 v[68:71], v[52:55], a[236:239], v[68:71]
    s_add_u32 s22, s22, 1
    s_cmp_gt_u32 s22, 3
    s_cbranch_scc1 U_ne_276
    s_nop 5
    v_cvt_pk_bf16_f32 v76, v64, v65
    v_cvt_pk_bf16_f32 v77, v66, v67
    v_cvt_pk_bf16_f32 v78, v68, v69
    v_cvt_pk_bf16_f32 v79, v70, v71
    s_add_u32 s31, s24, 9216
    buffer_store_dwordx4 v[76:79], v4, s[4:7], s31 offen sc0 sc1
    s_waitcnt vmcnt(0)
    s_barrier
    s_cmp_lg_u32 s20, 0
    s_cbranch_scc1 ar_277
    v_mov_b32 v98, 1
    v_mov_b32 v99, 0
    s_mov_b64 exec, 1
    buffer_atomic_add v98, v99, s[4:7], s27 offen sc1
    s_mov_b64 exec, -1
ar_277:
    s_add_u32 s27, s27, 128
U_ne_276:
    s_cmp_lt_u32 s22, 64
    s_cbranch_scc1 U_loop_263
    s_nop 7
    v_cvt_pk_bf16_f32 v76, v64, v65
    v_cvt_pk_bf16_f32 v77, v66, v67
    v_cvt_pk_bf16_f32 v78, v68, v69
    v_cvt_pk_bf16_f32 v79, v70, v71
    s_add_u32 s31, s24, 9216
    buffer_store_dwordx4 v[76:79], v4, s[4:7], s31 offen sc0 sc1
    s_waitcnt vmcnt(0)
    s_barrier
    s_cmp_lg_u32 s20, 0
    s_cbranch_scc1 ar_278
    v_mov_b32 v98, 1
    v_mov_b32 v99, 0
    s_mov_b64 exec, 1
    buffer_atomic_add v98, v99, s[4:7], s27 offen sc1
    s_mov_b64 exec, -1
ar_278:
    s_add_u32 s27, s27, 128
    s_cmp_lg_u32 s20, 0
    s_cbranch_scc1 ar_279
    v_mov_b32 v98, 1
    v_mov_b32 v99, 0
    s_mov_b64 exec, 1
    buffer_atomic_add v98, v99, s[4:7], s27 offen sc1
    s_mov_b64 exec, -1
ar_279:
    s_branch L_end
L_notu:
    s_cmp_ge_u32 s25, 128
    s_cbranch_scc1 L_notq
    s_load_dwordx2 s[8:9], s[0:1], 16
    s_load_dwordx2 s[12:13], s[0:1], 0
    s_mul_i32 s30, s21, 384
    s_waitcnt lgkmcnt(0)
    s_and_b32 s9, s9, 0xffff
    s_mov_b32 s10, 7864320
    s_mov_b32 s11, 0x20000
    s_and_b32 s13, s13, 0xffff
    s_mov_b32 s14, 2621440
    s_mov_b32 s15, 0x20000
    v_mov_b32 v251, 0
    global_load_dword v250, v251, s[98:99] sc1
    s_waitcnt vmcnt(0)
iw_lp_281:
    v_cmp_gt_u32 vcc, 27, v250
    s_cbranch_vccz iw_ok_280
    s_cmp_eq_u32 s100, 0
    s_cbranch_scc1 iw_ok_280
    s_sub_u32 s100, s100, 1
    s_sleep 2
    global_load_dword v250, v251, s[98:99] sc1
    s_waitcnt vmcnt(0)
    s_branch iw_lp_281
iw_ok_280:
    s_lshl_b32 s88, s21, 7
    s_add_u32 s88, s88, 167829504
    s_mov_b32 s89, 4
    v_mov_b32 v250, 0
fw_lp_283:
    v_cmp_gt_u32 vcc, s89, v250
    s_cbranch_vccz fw_ok_282
    s_cmp_eq_u32 s100, 0
    s_cbranch_scc1 fw_ok_282
    s_sub_u32 s100, s100, 1
    s_sleep 16
    buffer_load_dword v250, v251, s[4:7], s88 offen sc1
    s_waitcnt vmcnt(0)
    s_branch fw_lp_283
fw_ok_282:
    v_add_u32 v205, 0, v1
    v_mul_u32_u24 v206, 2731, v205
    v_lshrrev_b32 v206, 16, v206
    v_mul_u32_u24 v207, 24, v206
    v_sub_u32 v207, v205, v207
    v_mul_u32_u24 v206, 12288, v206
    v_lshl_add_u32 v200, v207, 4, v206
    v_add_u32 v205, 64, v1
    v_mul_u32_u24 v206, 2731, v205
    v_lshrrev_b32 v206, 16, v206
    v_mul_u32_u24 v207, 24, v206
    v_sub_u32 v207, v205, v207
    v_mul_u32_u24 v206, 12288, v206
    v_lshl_add_u32 v201, v207, 4, v206
    v_add_u32 v205, 128, v1
    v_mul_u32_u24 v206, 2731, v205
    v_lshrrev_b32 v206, 16, v206
    v_mul_u32_u24 v207, 24, v206
    v_sub_u32 v207, v205, v207
    v_mul_u32_u24 v206, 12288, v206
    v_lshl_add_u32 v202, v207, 4, v206
    s_mul_i32 s41, s20, 196608
    s_add_u32 s40, s30, s41
    s_mul_i32 s42, s20, 6144
    v_lshrrev_b32 v205, 4, v1
    v_bfe_u32 v206, v1, 2, 2
    v_lshl_add_u32 v205, v205, 3, v206
    v_mul_u32_u24 v205, 384, v205
    v_and_b32 v206, 3, v1
    v_lshl_add_u32 v205, v206, 3, v205
    s_mul_i32 s41, s20, 96
    v_add_u32 v203, s41, v205
    v_add_u32 v204, 73728, v203
    s_add_u32 m0, s42, 0
    s_add_u32 s41, s40, 0
    buffer_load_dwordx4 v200, s[8:11], s41 offen lds
    s_add_u32 m0, s42, 1024
    s_add_u32 s41, s40, 0
    buffer_load_dwordx4 v201, s[8:11], s41 offen lds
    s_add_u32 m0, s42, 2048
    s_add_u32 s41, s40, 0
    buffer_load_dwordx4 v202, s[8:11], s41 offen lds
    s_add_u32 m0, s42, 3072
    s_add_u32 s41, s40, 98304
    buffer_load_dwordx4 v200, s[8:11], s41 offen lds
    s_add_u32 m0, s42, 4096
    s_add_u32 s41, s40, 98304
    buffer_load_dwordx4 v201, s[8:11], s41 offen lds
    s_add_u32 m0, s42, 5120
    s_add_u32 s41, s40, 98304
    buffer_load_dwordx4 v202, s[8:11], s41 offen lds
    s_add_u32 m0, s42, 24576
    s_add_u32 s41, s40, 786432
    buffer_load_dwordx4 v200, s[8:11], s41 offen lds
    s_add_u32 m0, s42, 25600
    s_add_u32 s41, s40, 786432
    buffer_load_dwordx4 v201, s[8:11], s41 offen lds
    s_add_u32 m0, s42, 26624
    s_add_u32 s41, s40, 786432
    buffer_load_dwordx4 v202, s[8:11], s41 offen lds
    s_add_u32 m0, s42, 27648
    s_add_u32 s41, s40, 884736
    buffer_load_dwordx4 v200, s[8:11], s41 offen lds
    s_add_u32 m0, s42, 28672
    s_add_u32 s41, s40, 884736
    buffer_load_dwordx4 v201, s[8:11], s41 offen lds
    s_add_u32 m0, s42, 29696
    s_add_u32 s41, s40, 884736
    buffer_load_dwordx4 v202, s[8:11], s41 offen lds
    s_add_u32 m0, s42, 49152
    s_add_u32 s41, s40, 1572864
    buffer_load_dwordx4 v200, s[8:11], s41 offen lds
    s_add_u32 m0, s42, 50176
    s_add_u32 s41, s40, 1572864
    buffer_load_dwordx4 v201, s[8:11], s41 offen lds
    s_add_u32 m0, s42, 51200
    s_add_u32 s41, s40, 1572864
    buffer_load_dwordx4 v202, s[8:11], s41 offen lds
    s_add_u32 m0, s42, 52224
    s_add_u32 s41, s40, 1671168
    buffer_load_dwordx4 v200, s[8:11], s41 offen lds
    s_add_u32 m0, s42, 53248
    s_add_u32 s41, s40, 1671168
    buffer_load_dwordx4 v201, s[8:11], s41 offen lds
    s_add_u32 m0, s42, 54272
    s_add_u32 s41, s40, 1671168
    buffer_load_dwordx4 v202, s[8:11], s41 offen lds
    s_add_u32 m0, s42, 73728
    s_add_u32 s41, s40, 2359296
    buffer_load_dwordx4 v200, s[8:11], s41 offen lds
    s_add_u32 m0, s42, 74752
    s_add_u32 s41, s40, 2359296
    buffer_load_dwordx4 v201, s[8:11], s41 offen lds
    s_add_u32 m0, s42, 75776
    s_add_u32 s41, s40, 2359296
    buffer_load_dwordx4 v202, s[8:11], s41 offen lds
    s_add_u32 m0, s42, 76800
    s_add_u32 s41, s40, 2457600
    buffer_load_dwordx4 v200, s[8:11], s41 offen lds
    s_add_u32 m0, s42, 77824
    s_add_u32 s41, s40, 2457600
    buffer_load_dwordx4 v201, s[8:11], s41 offen lds
    s_add_u32 m0, s42, 78848
    s_add_u32 s41, s40, 2457600
    buffer_load_dwordx4 v202, s[8:11], s41 offen lds
    s_add_u32 m0, s42, 98304
    s_add_u32 s41, s40, 3145728
    buffer_load_dwordx4 v200, s[8:11], s41 offen lds
    s_add_u32 m0, s42, 99328
    s_add_u32 s41, s40, 3145728
    buffer_load_dwordx4 v201, s[8:11], s41 offen lds
    s_add_u32 m0, s42, 100352
    s_add_u32 s41, s40, 3145728
    buffer_load_dwordx4 v202, s[8:11], s41 offen lds
    s_add_u32 m0, s42, 101376
    s_add_u32 s41, s40, 3244032
    buffer_load_dwordx4 v200, s[8:11], s41 offen lds
    s_add_u32 m0, s42, 102400
    s_add_u32 s41, s40, 3244032
    buffer_load_dwordx4 v201, s[8:11], s41 offen lds
    s_add_u32 m0, s42, 103424
    s_add_u32 s41, s40, 3244032
    buffer_load_dwordx4 v202, s[8:11], s41 offen lds
    s_waitcnt vmcnt(24)
    s_barrier
    s_add_u32 m0, s42, 122880
    s_add_u32 s41, s40, 3932160
    buffer_load_dwordx4 v200, s[8:11], s41 offen lds
    s_add_u32 m0, s42, 123904
    s_add_u32 s41, s40, 3932160
    buffer_load_dwordx4 v201, s[8:11], s41 offen lds
    s_add_u32 m0, s42, 124928
    s_add_u32 s41, s40, 3932160
    buffer_load_dwordx4 v202, s[8:11], s41 offen lds
    s_add_u32 m0, s42, 125952
    s_add_u32 s41, s40, 4030464
    buffer_load_dwordx4 v200, s[8:11], s41 offen lds
    s_add_u32 m0, s42, 126976
    s_add_u32 s41, s40, 4030464
    buffer_load_dwordx4 v201, s[8:11], s41 offen lds
    s_add_u32 m0, s42, 128000
    s_add_u32 s41, s40, 4030464
    buffer_load_dwordx4 v202, s[8:11], s41 offen lds
    ds_read_b64_tr_b16 a[0:1], v203 offset:0
    ds_read_b64_tr_b16 a[2:3], v203 offset:1536
    ds_read_b64_tr_b16 a[80:81], v203 offset:32
    ds_read_b64_tr_b16 a[82:83], v203 offset:1568
    ds_read_b64_tr_b16 a[160:161], v203 offset:64
    ds_read_b64_tr_b16 a[162:163], v203 offset:1600
    ds_read_b64_tr_b16 a[4:5], v203 offset:12288
    ds_read_b64_tr_b16 a[6:7], v203 offset:13824
    ds_read_b64_tr_b16 a[84:85], v203 offset:12320
    ds_read_b64_tr_b16 a[86:87], v203 offset:13856
    ds_read_b64_tr_b16 a[164:165], v203 offset:12352
    ds_read_b64_tr_b16 a[166:167], v203 offset:13888
    s_waitcnt lgkmcnt(0)
    s_waitcnt vmcnt(24)
    s_barrier
    s_add_u32 m0, s42, 0
    s_add_u32 s41, s40, 4718592
    buffer_load_dwordx4 v200, s[8:11], s41 offen lds
    s_add_u32 m0, s42, 1024
    s_add_u32 s41, s40, 4718592
    buffer_load_dwordx4 v201, s[8:11], s41 offen lds
    s_add_u32 m0, s42, 2048
    s_add_u32 s41, s40, 4718592
    buffer_load_dwordx4 v202, s[8:11], s41 offen lds
    s_add_u32 m0, s42, 3072
    s_add_u32 s41, s40, 4816896
    buffer_load_dwordx4 v200, s[8:11], s41 offen lds
    s_add_u32 m0, s42, 4096
    s_add_u32 s41, s40, 4816896
    buffer_load_dwordx4 v201, s[8:11], s41 offen lds
    s_add_u32 m0, s42, 5120
    s_add_u32 s41, s40, 4816896
    buffer_load_dwordx4 v202, s[8:11], s41 offen lds
    ds_read_b64_tr_b16 a[8:9], v203 offset:24576
    ds_read_b64_tr_b16 a[10:11], v203 offset:26112
    ds_read_b64_tr_b16 a[88:89], v203 offset:24608
    ds_read_b64_tr_b16 a[90:91], v203 offset:26144
    ds_read_b64_tr_b16 a[168:169], v203 offset:24640
    ds_read_b64_tr_b16 a[170:171], v203 offset:26176
    ds_read_b64_tr_b16 a[12:13], v203 offset:36864
    ds_read_b64_tr_b16 a[14:15], v203 offset:38400
    ds_read_b64_tr_b16 a[92:93], v203 offset:36896
    ds_read_b64_tr_b16 a[94:95], v203 offset:38432
    ds_read_b64_tr_b16 a[172:173], v203 offset:36928
    ds_read_b64_tr_b16 a[174:175], v203 offset:38464
    s_waitcnt lgkmcnt(0)
    s_waitcnt vmcnt(24)
    s_barrier
    s_add_u32 m0, s42, 24576
    s_add_u32 s41, s40, 5505024
    buffer_load_dwordx4 v200, s[8:11], s41 offen lds
    s_add_u32 m0, s42, 25600
    s_add_u32 s41, s40, 5505024
    buffer_load_dwordx4 v201, s[8:11], s41 offen lds
    s_add_u32 m0, s42, 26624
    s_add_u32 s41, s40, 5505024
    buffer_load_dwordx4 v202, s[8:11], s41 offen lds
    s_add_u32 m0, s42, 27648
    s_add_u32 s41, s40, 5603328
    buffer_load_dwordx4 v200, s[8:11], s41 offen lds
    s_add_u32 m0, s42, 28672
    s_add_u32 s41, s40, 5603328
    buffer_load_dwordx4 v201, s[8:11], s41 offen lds
    s_add_u32 m0, s42, 29696
    s_add_u32 s41, s40, 5603328
    buffer_load_dwordx4 v202, s[8:11], s41 offen lds
    ds_read_b64_tr_b16 a[16:17], v203 offset:49152
    ds_read_b64_tr_b16 a[18:19], v203 offset:50688
    ds_read_b64_tr_b16 a[96:97], v203 offset:49184
    ds_read_b64_tr_b16 a[98:99], v203 offset:50720
    ds_read_b64_tr_b16 a[176:177], v203 offset:49216
    ds_read_b64_tr_b16 a[178:179], v203 offset:50752
    ds_read_b64_tr_b16 a[20:21], v203 offset:61440
    ds_read_b64_tr_b16 a[22:23], v203 offset:62976
    ds_read_b64_tr_b16 a[100:101], v203 offset:61472
    ds_read_b64_tr_b16 a[102:103], v203 offset:63008
    ds_read_b64_tr_b16 a[180:181], v203 offset:61504
    ds_read_b64_tr_b16 a[182:183], v203 offset:63040
    s_waitcnt lgkmcnt(0)
    s_waitcnt vmcnt(24)
    s_barrier
    s_add_u32 m0, s42, 49152
    s_add_u32 s41, s40, 6291456
    buffer_load_dwordx4 v200, s[8:11], s41 offen lds
    s_add_u32 m0, s42, 50176
    s_add_u32 s41, s40, 6291456
    buffer_load_dwordx4 v201, s[8:11], s41 offen lds
    s_add_u32 m0, s42, 51200
    s_add_u32 s41, s40, 6291456
    buffer_load_dwordx4 v202, s[8:11], s41 offen lds
    s_add_u32 m0, s42, 52224
    s_add_u32 s41, s40, 6389760
    buffer_load_dwordx4 v200, s[8:11], s41 offen lds
    s_add_u32 m0, s42, 53248
    s_add_u32 s41, s40, 6389760
    buffer_load_dwordx4 v201, s[8:11], s41 offen lds
    s_add_u32 m0, s42, 54272
    s_add_u32 s41, s40, 6389760
    buffer_load_dwordx4 v202, s[8:11], s41 offen lds
    ds_read_b64_tr_b16 a[24:25], v204 offset:0
    ds_read_b64_tr_b16 a[26:27], v204 offset:1536
    ds_read_b64_tr_b16 a[104:105], v204 offset:32
    ds_read_b64_tr_b16 a[106:107], v204 offset:1568
    ds_read_b64_tr_b16 a[184:185], v204 offset:64
    ds_read_b64_tr_b16 a[186:187], v204 offset:1600
    ds_read_b64_tr_b16 a[28:29], v204 offset:12288
    ds_read_b64_tr_b16 a[30:31], v204 offset:13824
    ds_read_b64_tr_b16 a[108:109], v204 offset:12320
    ds_read_b64_tr_b16 a[110:111], v204 offset:13856
    ds_read_b64_tr_b16 a[188:189], v204 offset:12352
    ds_read_b64_tr_b16 a[190:191], v204 offset:13888
    s_waitcnt lgkmcnt(0)
    s_waitcnt vmcnt(24)
    s_barrier
    s_add_u32 m0, s42, 73728
    s_add_u32 s41, s40, 7077888
    buffer_load_dwordx4 v200, s[8:11], s41 offen lds
    s_add_u32 m0, s42, 74752
    s_add_u32 s41, s40, 7077888
    buffer_load_dwordx4 v201, s[8:11], s41 offen lds
    s_add_u32 m0, s42, 75776
    s_add_u32 s41, s40, 7077888
    buffer_load_dwordx4 v202, s[8:11], s41 offen lds
    s_add_u32 m0, s42, 76800
    s_add_u32 s41, s40, 7176192
    buffer_load_dwordx4 v200, s[8:11], s41 offen lds
    s_add_u32 m0, s42, 77824
    s_add_u32 s41, s40, 7176192
    buffer_load_dwordx4 v201, s[8:11], s41 offen lds
    s_add_u32 m0, s42, 78848
    s_add_u32 s41, s40, 7176192
    buffer_load_dwordx4 v202, s[8:11], s41 offen lds
    ds_read_b64_tr_b16 a[32:33], v204 offset:24576
    ds_read_b64_tr_b16 a[34:35], v204 offset:26112
    ds_read_b64_tr_b16 a[112:113], v204 offset:24608
    ds_read_b64_tr_b16 a[114:115], v204 offset:26144
    ds_read_b64_tr_b16 a[192:193], v204 offset:24640
    ds_read_b64_tr_b16 a[194:195], v204 offset:26176
    ds_read_b64_tr_b16 a[36:37], v204 offset:36864
    ds_read_b64_tr_b16 a[38:39], v204 offset:38400
    ds_read_b64_tr_b16 a[116:117], v204 offset:36896
    ds_read_b64_tr_b16 a[118:119], v204 offset:38432
    ds_read_b64_tr_b16 a[196:197], v204 offset:36928
    ds_read_b64_tr_b16 a[198:199], v204 offset:38464
    s_waitcnt lgkmcnt(0)
    s_waitcnt vmcnt(24)
    s_barrier
    ds_read_b64_tr_b16 a[40:41], v204 offset:49152
    ds_read_b64_tr_b16 a[42:43], v204 offset:50688
    ds_read_b64_tr_b16 a[120:121], v204 offset:49184
    ds_read_b64_tr_b16 a[122:123], v204 offset:50720
    ds_read_b64_tr_b16 a[200:201], v204 offset:49216
    ds_read_b64_tr_b16 a[202:203], v204 offset:50752
    ds_read_b64_tr_b16 a[44:45], v204 offset:61440
    ds_read_b64_tr_b16 a[46:47], v204 offset:62976
    ds_read_b64_tr_b16 a[124:125], v204 offset:61472
    ds_read_b64_tr_b16 a[126:127], v204 offset:63008
    ds_read_b64_tr_b16 a[204:205], v204 offset:61504
    ds_read_b64_tr_b16 a[206:207], v204 offset:63040
    s_waitcnt lgkmcnt(0)
    s_waitcnt vmcnt(18)
    s_barrier
    ds_read_b64_tr_b16 a[48:49], v203 offset:0
    ds_read_b64_tr_b16 a[50:51], v203 offset:1536
    ds_read_b64_tr_b16 a[128:129], v203 offset:32
    ds_read_b64_tr_b16 a[130:131], v203 offset:1568
    ds_read_b64_tr_b16 a[208:209], v203 offset:64
    ds_read_b64_tr_b16 a[210:211], v203 offset:1600
    ds_read_b64_tr_b16 a[52:53], v203 offset:12288
    ds_read_b64_tr_b16 a[54:55], v203 offset:13824
    ds_read_b64_tr_b16 a[132:133], v203 offset:12320
    ds_read_b64_tr_b16 a[134:135], v203 offset:13856
    ds_read_b64_tr_b16 a[212:213], v203 offset:12352
    ds_read_b64_tr_b16 a[214:215], v203 offset:13888
    s_waitcnt lgkmcnt(0)
    s_waitcnt vmcnt(12)
    s_barrier
    ds_read_b64_tr_b16 a[56:57], v203 offset:24576
    ds_read_b64_tr_b16 a[58:59], v203 offset:26112
    ds_read_b64_tr_b16 a[136:137], v203 offset:24608
    ds_read_b64_tr_b16 a[138:139], v203 offset:26144
    ds_read_b64_tr_b16 a[216:217], v203 offset:24640
    ds_read_b64_tr_b16 a[218:219], v203 offset:26176
    ds_read_b64_tr_b16 a[60:61], v203 offset:36864
    ds_read_b64_tr_b16 a[62:63], v203 offset:38400
    ds_read_b64_tr_b16 a[140:141], v203 offset:36896
    ds_read_b64_tr_b16 a[142:143], v203 offset:38432
    ds_read_b64_tr_b16 a[220:221], v203 offset:36928
    ds_read_b64_tr_b16 a[222:223], v203 offset:38464
    s_waitcnt lgkmcnt(0)
    s_waitcnt vmcnt(6)
    s_barrier
    ds_read_b64_tr_b16 a[64:65], v203 offset:49152
    ds_read_b64_tr_b16 a[66:67], v203 offset:50688
    ds_read_b64_tr_b16 a[144:145], v203 offset:49184
    ds_read_b64_tr_b16 a[146:147], v203 offset:50720
    ds_read_b64_tr_b16 a[224:225], v203 offset:49216
    ds_read_b64_tr_b16 a[226:227], v203 offset:50752
    ds_read_b64_tr_b16 a[68:69], v203 offset:61440
    ds_read_b64_tr_b16 a[70:71], v203 offset:62976
    ds_read_b64_tr_b16 a[148:149], v203 offset:61472
    ds_read_b64_tr_b16 a[150:151], v203 offset:63008
    ds_read_b64_tr_b16 a[228:229], v203 offset:61504
    ds_read_b64_tr_b16 a[230:231], v203 offset:63040
    s_waitcnt lgkmcnt(0)
    s_waitcnt vmcnt(0)
    s_barrier
    ds_read_b64_tr_b16 a[72:73], v204 offset:0
    ds_read_b64_tr_b16 a[74:75], v204 offset:1536
    ds_read_b64_tr_b16 a[152:153], v204 offset:32
    ds_read_b64_tr_b16 a[154:155], v204 offset:1568
    ds_read_b64_tr_b16 a[232:233], v204 offset:64
    ds_read_b64_tr_b16 a[234:235], v204 offset:1600
    ds_read_b64_tr_b16 a[76:77], v204 offset:12288
    ds_read_b64_tr_b16 a[78:79], v204 offset:13824
    ds_read_b64_tr_b16 a[156:157], v204 offset:12320
    ds_read_b64_tr_b16 a[158:159], v204 offset:13856
    ds_read_b64_tr_b16 a[236:237], v204 offset:12352
    ds_read_b64_tr_b16 a[238:239], v204 offset:13888
    s_waitcnt lgkmcnt(0)
    s_barrier
    v_lshrrev_b32 v6, 3, v1
    s_and_b32 s26, s20, 1
    s_lshl_b32 s26, s26, 2
    v_lshrrev_b32 v7, 4, v1
    v_add_u32 v7, s26, v7
    v_and_b32 v2, 7, v1
    v_xor_b32 v7, v7, v2
    v_mul_u32_u24 v6, 1280, v6
    v_lshl_add_u32 v6, v7, 4, v6
    s_mul_i32 s26, s20, 10240
    v_add_u32 v2, s26, v6
    s_mul_i32 s25, s20, 10240
    v_and_b32 v6, 15, v1
    v_lshrrev_b32 v7, 1, v6
    v_lshrrev_b32 v3, 4, v1
    v_xor_b32 v7, v7, v3
    v_lshlrev_b32 v7, 4, v7
    v_lshrrev_b32 v3, 3, v6
    v_mul_u32_u24 v3, 10240, v3
    v_and_b32 v6, 7, v6
    v_lshl_add_u32 v6, v6, 7, v7
    v_add_u32 v3, v3, v6
    v_xor_b32 v93, 64, v3
    v_mov_b32 v92, v3
    v_add_u32 v94, 40960, v92
    v_add_u32 v95, 40960, v93
    s_lshl_b32 s26, s20, 10
    v_lshl_add_u32 v4, v1, 4, s26
    v_lshrrev_b32 v7, 4, v1
    v_and_b32 v6, 1, v7
    v_mul_u32_u24 v6, 6144, v6
    v_lshrrev_b32 v7, 1, v7
    v_lshl_add_u32 v6, v7, 8, v6
    v_and_b32 v7, 15, v1
    v_lshl_add_u32 v6, v7, 4, v6
    s_lshr_b32 s26, s20, 1
    s_lshl_b32 s26, s26, 10
    s_add_u32 s26, s26, 4096
    v_add_u32 v6, s26, v6
    s_and_b32 s26, s20, 1
    s_lshl_b32 s26, s26, 9
    v_add_u32 v5, s26, v6
    s_mul_i32 s26, s21, 13108
    s_lshr_b32 s26, s26, 16
    s_mul_i32 s26, s26, 5
    s_sub_u32 s26, s21, s26
    s_lshl_b32 s26, s26, 2
    s_add_u32 s26, s26, s20
    s_lshl_b32 s26, s26, 11
    s_add_u32 s26, s26, 122880
    v_lshl_add_u32 v96, v1, 7, s26
    v_add_u32 v215, 81920, v4
    v_add_u32 v217, 81920, v5
    v_lshlrev_b32 v214, 4, v1
    s_and_b32 s26, s20, 1
    s_mul_i32 s32, s26, 40960
    s_mul_i32 s26, s26, 6144
    s_add_u32 s26, s26, 81920
    v_add_u32 v218, s26, v214
    v_and_b32 v224, 15, v1
    v_lshrrev_b32 v225, 4, v1
    v_bfe_u32 v226, v1, 2, 2
    v_and_b32 v227, 1, v1
    v_lshlrev_b32 v227, 3, v227
    v_add_u32 v227, 94208, v227
    v_lshl_add_u32 v212, v225, 2, v226
    v_lshl_add_u32 v212, v212, 4, v227
    v_lshrrev_b32 v228, 1, v225
    v_mul_u32_u24 v228, 48, v228
    v_and_b32 v213, 1, v225
    v_lshl_add_u32 v213, v213, 3, v228
    v_add_u32 v213, v213, v226
    v_lshl_add_u32 v213, v213, 4, v227
    v_lshlrev_b32 v219, 4, v224
    v_lshl_add_u32 v219, v225, 3, v219
    v_lshlrev_b32 v228, 2, v225
    v_mov_b32 v227, 4048155338
    v_add_u32 v226, 0, v228
    v_cmp_gt_u32 vcc, v226, v224
    s_nop 1
    v_cndmask_b32 v208, 0, v227, vcc
    v_add_u32 v226, 1, v228
    v_cmp_gt_u32 vcc, v226, v224
    s_nop 1
    v_cndmask_b32 v209, 0, v227, vcc
    v_add_u32 v226, 2, v228
    v_cmp_gt_u32 vcc, v226, v224
    s_nop 1
    v_cndmask_b32 v210, 0, v227, vcc
    v_add_u32 v226, 3, v228
    v_cmp_gt_u32 vcc, v226, v224
    s_nop 1
    v_cndmask_b32 v211, 0, v227, vcc
    s_mov_b32 s50, -1
    s_mov_b32 s51, 0
    v_mov_b32 v221, 0
    v_mov_b32 v220, 0
    v_mov_b32 v222, 0
    s_mov_b32 s34, 1037384597
    s_mul_i32 s30, s21, 12288
    s_add_u32 s30, s30, 0
    s_mul_i32 s31, s21, 3072
    s_add_u32 s31, s31, 160432128
    s_add_u32 s32, s32, 155189248
    s_lshl_b32 s26, s21, 8
    s_add_u32 s33, s32, s26
    s_add_u32 s33, s33, 32768
    s_lshl_b32 s26, s21, 10
    s_add_u32 s32, s32, s26
    s_lshl_b32 s26, s21, 7
    s_mov_b32 s37, 167858176
    s_add_u32 s38, s26, 167837696
    s_add_u32 s39, s26, 167829504
    s_mov_b32 s23, 0
    s_mov_b32 s22, 0
    s_add_u32 m0, s25, 0
    s_nop 0
    buffer_load_dwordx4 v2, s[12:15], s23 offen offset:0  lds
    s_add_u32 m0, s25, 896
    s_nop 0
    buffer_load_dwordx4 v2, s[12:15], s23 offen offset:128  lds
    s_add_u32 m0, s25, 1792
    s_nop 0
    buffer_load_dwordx4 v2, s[12:15], s23 offen offset:256  lds
    s_add_u32 m0, s25, 2688
    s_nop 0
    buffer_load_dwordx4 v2, s[12:15], s23 offen offset:384  lds
    s_add_u32 m0, s25, 3584
    s_nop 0
    buffer_load_dwordx4 v2, s[12:15], s23 offen offset:512  lds
    s_add_u32 m0, s25, 4480
    s_nop 0
    buffer_load_dwordx4 v2, s[12:15], s23 offen offset:640  lds
    s_add_u32 m0, s25, 5376
    s_nop 0
    buffer_load_dwordx4 v2, s[12:15], s23 offen offset:768  lds
    s_add_u32 m0, s25, 6272
    s_nop 0
    buffer_load_dwordx4 v2, s[12:15], s23 offen offset:896  lds
    s_add_u32 m0, s25, 7168
    s_nop 0
    buffer_load_dwordx4 v2, s[12:15], s23 offen offset:1024  lds
    s_add_u32 m0, s25, 8064
    s_nop 0
    buffer_load_dwordx4 v2, s[12:15], s23 offen offset:1152  lds
    v_subrev_u32 v96, 81920, v96
    s_mov_b64 exec, 0xffff
    buffer_load_dword v97, v96, s[12:15], s23 offen
    s_mov_b64 exec, -1
    v_add_u32 v96, 40960, v96
    s_mov_b64 exec, 0xffff
    buffer_load_dword v97, v96, s[12:15], s23 offen
    s_mov_b64 exec, -1
    v_add_u32 v96, 40960, v96
    s_mov_b64 exec, 0xffff
    buffer_load_dword v97, v96, s[12:15], s23 offen
    s_mov_b64 exec, -1
Q_loop_284:
    s_waitcnt vmcnt(0)
    s_barrier
    ds_read_b128 v[8:11], v92 offset:0
    ds_read_b128 v[12:15], v92 offset:20480
    ds_read_b128 v[16:19], v93 offset:0
    ds_read_b128 v[20:23], v93 offset:20480
    s_cmp_eq_u32 s22, 0
    s_cbranch_scc1 Q_s0_285
    s_cmp_lg_u32 s20, 0
    s_cbranch_scc1 al_286
    v_mov_b32 v224, 1
    v_mov_b32 v225, 0
    v_mov_b32 v226, 8192
    s_mov_b64 exec, 1
    buffer_atomic_add v224, v225, s[4:7], s37 offen sc0 sc1
    s_waitcnt vmcnt(0)
    v_cmp_eq_u32 vcc, 31, v224
    s_cbranch_vccz al_286_x
    buffer_store_dword v224, v226, s[4:7], s37 offen sc0 sc1
al_286_x:
    s_mov_b64 exec, -1
al_286:
    s_add_u32 s37, s37, 128
Q_s0_285:
    s_add_u32 s35, s22, 1
    s_cmp_ge_u32 s20, 2
    s_cbranch_scc1 Q_nok_287
fw_lp_289:
    v_cmp_gt_u32 vcc, s35, v222
    s_cbranch_vccz fw_ok_288
    s_cmp_eq_u32 s100, 0
    s_cbranch_scc1 fw_ok_288
    s_sub_u32 s100, s100, 1
    s_sleep 2
    buffer_load_dword v222, v221, s[4:7], s39 offen sc1
    s_waitcnt vmcnt(0)
    s_branch fw_lp_289
fw_ok_288:
    s_add_u32 s26, s30, 0
    buffer_load_dwordx4 v[100:103], v214, s[4:7], s26 offen offset:0 sc1
    buffer_load_dwordx4 v[104:107], v214, s[4:7], s26 offen offset:1024 sc1
    buffer_load_dwordx4 v[108:111], v214, s[4:7], s26 offen offset:2048 sc1
    buffer_load_dwordx4 v[112:115], v214, s[4:7], s26 offen offset:3072 sc1
    s_add_u32 s26, s30, 4096
    buffer_load_dwordx4 v[116:119], v214, s[4:7], s26 offen offset:0 sc1
    buffer_load_dwordx4 v[120:123], v214, s[4:7], s26 offen offset:1024 sc1
    buffer_load_dwordx4 v[124:127], v214, s[4:7], s26 offen offset:2048 sc1
    buffer_load_dwordx4 v[128:131], v214, s[4:7], s26 offen offset:3072 sc1
    s_add_u32 s26, s30, 8192
    buffer_load_dwordx4 v[132:135], v214, s[4:7], s26 offen offset:0 sc1
    buffer_load_dwordx4 v[136:139], v214, s[4:7], s26 offen offset:1024 sc1
    buffer_load_dwordx4 v[140:143], v214, s[4:7], s26 offen offset:2048 sc1
    buffer_load_dwordx4 v[144:147], v214, s[4:7], s26 offen offset:3072 sc1
Q_nok_287:
    s_add_u32 s23, s23, 40960
    s_add_u32 m0, s25, 40960
    ds_read_b128 v[24:27], v92 offset:1024
    ds_read_b128 v[28:31], v92 offset:21504
    s_waitcnt lgkmcnt(4)
    v_mfma_f32_16x16x32_bf16 v[32:35], a[0:3], v[8:11], 0
    v_mfma_f32_16x16x32_bf16 v[36:39], a[0:3], v[12:15], 0
    v_mfma_f32_16x16x32_bf16 v[40:43], a[80:83], v[8:11], 0
    buffer_load_dwordx4 v2, s[12:15], s23 offen offset:0  lds
    v_mfma_f32_16x16x32_bf16 v[44:47], a[80:83], v[12:15], 0
    v_mfma_f32_16x16x32_bf16 v[48:51], a[160:163], v[8:11], 0
    v_mfma_f32_16x16x32_bf16 v[52:55], a[160:163], v[12:15], 0
    s_add_u32 m0, s25, 41856
    ds_read_b128 v[8:11], v93 offset:1024
    ds_read_b128 v[12:15], v93 offset:21504
    s_waitcnt lgkmcnt(4)
    v_mfma_f32_16x16x32_bf16 v[32:35], a[4:7], v[16:19], v[32:35]
    v_mfma_f32_16x16x32_bf16 v[36:39], a[4:7], v[20:23], v[36:39]
    v_mfma_f32_16x16x32_bf16 v[40:43], a[84:87], v[16:19], v[40:43]
    buffer_load_dwordx4 v2, s[12:15], s23 offen offset:128  lds
    v_mfma_f32_16x16x32_bf16 v[44:47], a[84:87], v[20:23], v[44:47]
    v_mfma_f32_16x16x32_bf16 v[48:51], a[164:167], v[16:19], v[48:51]
    v_mfma_f32_16x16x32_bf16 v[52:55], a[164:167], v[20:23], v[52:55]
    s_add_u32 m0, s25, 42752
    ds_read_b128 v[16:19], v92 offset:2048
    ds_read_b128 v[20:23], v92 offset:22528
    s_waitcnt lgkmcnt(4)
    v_mfma_f32_16x16x32_bf16 v[32:35], a[8:11], v[24:27], v[32:35]
    v_mfma_f32_16x16x32_bf16 v[36:39], a[8:11], v[28:31], v[36:39]
    v_mfma_f32_16x16x32_bf16 v[40:43], a[88:91], v[24:27], v[40:43]
    buffer_load_dwordx4 v2, s[12:15], s23 offen offset:256  lds
    v_mfma_f32_16x16x32_bf16 v[44:47], a[88:91], v[28:31], v[44:47]
    v_mfma_f32_16x16x32_bf16 v[48:51], a[168:171], v[24:27], v[48:51]
    v_mfma_f32_16x16x32_bf16 v[52:55], a[168:171], v[28:31], v[52:55]
    s_add_u32 m0, s25, 43648
    ds_read_b128 v[24:27], v93 offset:2048
    ds_read_b128 v[28:31], v93 offset:22528
    s_waitcnt lgkmcnt(4)
    v_mfma_f32_16x16x32_bf16 v[32:35], a[12:15], v[8:11], v[32:35]
    v_mfma_f32_16x16x32_bf16 v[36:39], a[12:15], v[12:15], v[36:39]
    v_mfma_f32_16x16x32_bf16 v[40:43], a[92:95], v[8:11], v[40:43]
    buffer_load_dwordx4 v2, s[12:15], s23 offen offset:384  lds
    v_mfma_f32_16x16x32_bf16 v[44:47], a[92:95], v[12:15], v[44:47]
    v_mfma_f32_16x16x32_bf16 v[48:51], a[172:175], v[8:11], v[48:51]
    v_mfma_f32_16x16x32_bf16 v[52:55], a[172:175], v[12:15], v[52:55]
    s_add_u32 m0, s25, 44544
    ds_read_b128 v[8:11], v92 offset:3072
    ds_read_b128 v[12:15], v92 offset:23552
    s_waitcnt lgkmcnt(4)
    v_mfma_f32_16x16x32_bf16 v[32:35], a[16:19], v[16:19], v[32:35]
    v_mfma_f32_16x16x32_bf16 v[36:39], a[16:19], v[20:23], v[36:39]
    v_mfma_f32_16x16x32_bf16 v[40:43], a[96:99], v[16:19], v[40:43]
    buffer_load_dwordx4 v2, s[12:15], s23 offen offset:512  lds
    v_mfma_f32_16x16x32_bf16 v[44:47], a[96:99], v[20:23], v[44:47]
    v_mfma_f32_16x16x32_bf16 v[48:51], a[176:179], v[16:19], v[48:51]
    v_mfma_f32_16x16x32_bf16 v[52:55], a[176:179], v[20:23], v[52:55]
    s_add_u32 m0, s25, 45440
    ds_read_b128 v[16:19], v93 offset:3072
    ds_read_b128 v[20:23], v93 offset:23552
    s_waitcnt lgkmcnt(4)
    v_mfma_f32_16x16x32_bf16 v[32:35], a[20:23], v[24:27], v[32:35]
    v_mfma_f32_16x16x32_bf16 v[36:39], a[20:23], v[28:31], v[36:39]
    v_mfma_f32_16x16x32_bf16 v[40:43], a[100:103], v[24:27], v[40:43]
    buffer_load_dwordx4 v2, s[12:15], s23 offen offset:640  lds
    v_mfma_f32_16x16x32_bf16 v[44:47], a[100:103], v[28:31], v[44:47]
    v_mfma_f32_16x16x32_bf16 v[48:51], a[180:183], v[24:27], v[48:51]
    v_mfma_f32_16x16x32_bf16 v[52:55], a[180:183], v[28:31], v[52:55]
    s_add_u32 m0, s25, 46336
    ds_read_b128 v[24:27], v92 offset:4096
    ds_read_b128 v[28:31], v92 offset:24576
    s_waitcnt lgkmcnt(4)
    v_mfma_f32_16x16x32_bf16 v[32:35], a[24:27], v[8:11], v[32:35]
    v_mfma_f32_16x16x32_bf16 v[36:39], a[24:27], v[12:15], v[36:39]
    v_mfma_f32_16x16x32_bf16 v[40:43], a[104:107], v[8:11], v[40:43]
    buffer_load_dwordx4 v2, s[12:15], s23 offen offset:768  lds
    v_mfma_f32_16x16x32_bf16 v[44:47], a[104:107], v[12:15], v[44:47]
    v_mfma_f32_16x16x32_bf16 v[48:51], a[184:187], v[8:11], v[48:51]
    v_mfma_f32_16x16x32_bf16 v[52:55], a[184:187], v[12:15], v[52:55]
    s_add_u32 m0, s25, 47232
    ds_read_b128 v[8:11], v93 offset:4096
    ds_read_b128 v[12:15], v93 offset:24576
    s_waitcnt lgkmcnt(4)
    v_mfma_f32_16x16x32_bf16 v[32:35], a[28:31], v[16:19], v[32:35]
    v_mfma_f32_16x16x32_bf16 v[36:39], a[28:31], v[20:23], v[36:39]
    v_mfma_f32_16x16x32_bf16 v[40:43], a[108:111], v[16:19], v[40:43]
    buffer_load_dwordx4 v2, s[12:15], s23 offen offset:896  lds
    v_mfma_f32_16x16x32_bf16 v[44:47], a[108:111], v[20:23], v[44:47]
    v_mfma_f32_16x16x32_bf16 v[48:51], a[188:191], v[16:19], v[48:51]
    v_mfma_f32_16x16x32_bf16 v[52:55], a[188:191], v[20:23], v[52:55]
    s_add_u32 m0, s25, 48128
    ds_read_b128 v[16:19], v92 offset:5120
    ds_read_b128 v[20:23], v92 offset:25600
    s_waitcnt lgkmcnt(4)
    v_mfma_f32_16x16x32_bf16 v[32:35], a[32:35], v[24:27], v[32:35]
    v_mfma_f32_16x16x32_bf16 v[36:39], a[32:35], v[28:31], v[36:39]
    v_mfma_f32_16x16x32_bf16 v[40:43], a[112:115], v[24:27], v[40:43]
    buffer_load_dwordx4 v2, s[12:15], s23 offen offset:1024  lds
    v_mfma_f32_16x16x32_bf16 v[44:47], a[112:115], v[28:31], v[44:47]
    v_mfma_f32_16x16x32_bf16 v[48:51], a[192:195], v[24:27], v[48:51]
    v_mfma_f32_16x16x32_bf16 v[52:55], a[192:195], v[28:31], v[52:55]
    s_add_u32 m0, s25, 49024
    ds_read_b128 v[24:27], v93 offset:5120
    ds_read_b128 v[28:31], v93 offset:25600
    s_waitcnt lgkmcnt(4)
    v_mfma_f32_16x16x32_bf16 v[32:35], a[36:39], v[8:11], v[32:35]
    v_mfma_f32_16x16x32_bf16 v[36:39], a[36:39], v[12:15], v[36:39]
    v_mfma_f32_16x16x32_bf16 v[40:43], a[116:119], v[8:11], v[40:43]
    buffer_load_dwordx4 v2, s[12:15], s23 offen offset:1152  lds
    v_mfma_f32_16x16x32_bf16 v[44:47], a[116:119], v[12:15], v[44:47]
    v_mfma_f32_16x16x32_bf16 v[48:51], a[196:199], v[8:11], v[48:51]
    v_mfma_f32_16x16x32_bf16 v[52:55], a[196:199], v[12:15], v[52:55]
    ds_read_b128 v[8:11], v92 offset:6144
    ds_read_b128 v[12:15], v92 offset:26624
    s_waitcnt lgkmcnt(4)
    v_mfma_f32_16x16x32_bf16 v[32:35], a[40:43], v[16:19], v[32:35]
    v_mfma_f32_16x16x32_bf16 v[36:39], a[40:43], v[20:23], v[36:39]
    v_mfma_f32_16x16x32_bf16 v[40:43], a[120:123], v[16:19], v[40:43]
    v_mfma_f32_16x16x32_bf16 v[44:47], a[120:123], v[20:23], v[44:47]
    v_mfma_f32_16x16x32_bf16 v[48:51], a[200:203], v[16:19], v[48:51]
    v_mfma_f32_16x16x32_bf16 v[52:55], a[200:203], v[20:23], v[52:55]
    ds_read_b128 v[16:19], v93 offset:6144
    ds_read_b128 v[20:23], v93 offset:26624
    s_waitcnt lgkmcnt(4)
    v_mfma_f32_16x16x32_bf16 v[32:35], a[44:47], v[24:27], v[32:35]
    v_mfma_f32_16x16x32_bf16 v[36:39], a[44:47], v[28:31], v[36:39]
    v_mfma_f32_16x16x32_bf16 v[40:43], a[124:127], v[24:27], v[40:43]
    s_mov_b64 exec, 0xffff
    buffer_load_dword v97, v96, s[12:15], s23 offen
    s_mov_b64 exec, -1
    v_mfma_f32_16x16x32_bf16 v[44:47], a[124:127], v[28:31], v[44:47]
    v_mfma_f32_16x16x32_bf16 v[48:51], a[204:207], v[24:27], v[48:51]
    v_mfma_f32_16x16x32_bf16 v[52:55], a[204:207], v[28:31], v[52:55]
    ds_read_b128 v[24:27], v92 offset:7168
    ds_read_b128 v[28:31], v92 offset:27648
    s_waitcnt lgkmcnt(4)
    v_mfma_f32_16x16x32_bf16 v[32:35], a[48:51], v[8:11], v[32:35]
    v_mfma_f32_16x16x32_bf16 v[36:39], a[48:51], v[12:15], v[36:39]
    v_mfma_f32_16x16x32_bf16 v[40:43], a[128:131], v[8:11], v[40:43]
    v_mfma_f32_16x16x32_bf16 v[44:47], a[128:131], v[12:15], v[44:47]
    v_mfma_f32_16x16x32_bf16 v[48:51], a[208:211], v[8:11], v[48:51]
    v_mfma_f32_16x16x32_bf16 v[52:55], a[208:211], v[12:15], v[52:55]
    ds_read_b128 v[8:11], v93 offset:7168
    ds_read_b128 v[12:15], v93 offset:27648
    s_waitcnt lgkmcnt(4)
    v_mfma_f32_16x16x32_bf16 v[32:35], a[52:55], v[16:19], v[32:35]
    v_mfma_f32_16x16x32_bf16 v[36:39], a[52:55], v[20:23], v[36:39]
    v_mfma_f32_16x16x32_bf16 v[40:43], a[132:135], v[16:19], v[40:43]
    v_mfma_f32_16x16x32_bf16 v[44:47], a[132:135], v[20:23], v[44:47]
    v_mfma_f32_16x16x32_bf16 v[48:51], a[212:215], v[16:19], v[48:51]
    v_mfma_f32_16x16x32_bf16 v[52:55], a[212:215], v[20:23], v[52:55]
    ds_read_b128 v[16:19], v92 offset:8192
    ds_read_b128 v[20:23], v92 offset:28672
    s_waitcnt lgkmcnt(4)
    v_mfma_f32_16x16x32_bf16 v[32:35], a[56:59], v[24:27], v[32:35]
    v_mfma_f32_16x16x32_bf16 v[36:39], a[56:59], v[28:31], v[36:39]
    v_mfma_f32_16x16x32_bf16 v[40:43], a[136:139], v[24:27], v[40:43]
    v_mfma_f32_16x16x32_bf16 v[44:47], a[136:139], v[28:31], v[44:47]
    v_mfma_f32_16x16x32_bf16 v[48:51], a[216:219], v[24:27], v[48:51]
    v_mfma_f32_16x16x32_bf16 v[52:55], a[216:219], v[28:31], v[52:55]
    ds_read_b128 v[24:27], v93 offset:8192
    ds_read_b128 v[28:31], v93 offset:28672
    s_waitcnt lgkmcnt(4)
    v_mfma_f32_16x16x32_bf16 v[32:35], a[60:63], v[8:11], v[32:35]
    v_mfma_f32_16x16x32_bf16 v[36:39], a[60:63], v[12:15], v[36:39]
    v_mfma_f32_16x16x32_bf16 v[40:43], a[140:143], v[8:11], v[40:43]
    v_mfma_f32_16x16x32_bf16 v[44:47], a[140:143], v[12:15], v[44:47]
    v_mfma_f32_16x16x32_bf16 v[48:51], a[220:223], v[8:11], v[48:51]
    v_mfma_f32_16x16x32_bf16 v[52:55], a[220:223], v[12:15], v[52:55]
    ds_read_b128 v[8:11], v92 offset:9216
    ds_read_b128 v[12:15], v92 offset:29696
    s_waitcnt lgkmcnt(4)
    v_mfma_f32_16x16x32_bf16 v[32:35], a[64:67], v[16:19], v[32:35]
    v_mfma_f32_16x16x32_bf16 v[36:39], a[64:67], v[20:23], v[36:39]
    v_mfma_f32_16x16x32_bf16 v[40:43], a[144:147], v[16:19], v[40:43]
    v_mfma_f32_16x16x32_bf16 v[44:47], a[144:147], v[20:23], v[44:47]
    v_mfma_f32_16x16x32_bf16 v[48:51], a[224:227], v[16:19], v[48:51]
    v_mfma_f32_16x16x32_bf16 v[52:55], a[224:227], v[20:23], v[52:55]
    ds_read_b128 v[16:19], v93 offset:9216
    ds_read_b128 v[20:23], v93 offset:29696
    s_waitcnt lgkmcnt(4)
    v_mfma_f32_16x16x32_bf16 v[32:35], a[68:71], v[24:27], v[32:35]
    v_mfma_f32_16x16x32_bf16 v[36:39], a[68:71], v[28:31], v[36:39]
    v_mfma_f32_16x16x32_bf16 v[40:43], a[148:151], v[24:27], v[40:43]
    v_mfma_f32_16x16x32_bf16 v[44:47], a[148:151], v[28:31], v[44:47]
    v_mfma_f32_16x16x32_bf16 v[48:51], a[228:231], v[24:27], v[48:51]
    v_mfma_f32_16x16x32_bf16 v[52:55], a[228:231], v[28:31], v[52:55]
    s_waitcnt lgkmcnt(2)
    v_mfma_f32_16x16x32_bf16 v[32:35], a[72:75], v[8:11], v[32:35]
    v_mfma_f32_16x16x32_bf16 v[36:39], a[72:75], v[12:15], v[36:39]
    v_mfma_f32_16x16x32_bf16 v[40:43], a[152:155], v[8:11], v[40:43]
    v_mfma_f32_16x16x32_bf16 v[44:47], a[152:155], v[12:15], v[44:47]
    v_mfma_f32_16x16x32_bf16 v[48:51], a[232:235], v[8:11], v[48:51]
    v_mfma_f32_16x16x32_bf16 v[52:55], a[232:235], v[12:15], v[52:55]
    s_waitcnt lgkmcnt(0)
    v_mfma_f32_16x16x32_bf16 v[32:35], a[76:79], v[16:19], v[32:35]
    v_mfma_f32_16x16x32_bf16 v[36:39], a[76:79], v[20:23], v[36:39]
    v_mfma_f32_16x16x32_bf16 v[40:43], a[156:159], v[16:19], v[40:43]
    v_mfma_f32_16x16x32_bf16 v[44:47], a[156:159], v[20:23], v[44:47]
    v_mfma_f32_16x16x32_bf16 v[48:51], a[236:239], v[16:19], v[48:51]
    v_mfma_f32_16x16x32_bf16 v[52:55], a[236:239], v[20:23], v[52:55]
    s_cmp_lg_u32 s20, 3
    s_cbranch_scc1 Q_nom_290
fw_lp_292:
    v_cmp_gt_u32 vcc, s35, v220
    s_cbranch_vccz fw_ok_291
    s_cmp_eq_u32 s100, 0
    s_cbranch_scc1 fw_ok_291
    s_sub_u32 s100, s100, 1
    s_sleep 2
    buffer_load_dword v220, v221, s[4:7], s38 offen sc1
    s_waitcnt vmcnt(0)
    s_branch fw_lp_292
fw_ok_291:
    s_mov_b32 m0, 94208
    s_nop 0
    buffer_load_dwordx4 v214, s[4:7], s31 offen offset:0 sc1 lds
    buffer_load_dwordx4 v214, s[4:7], s31 offen offset:1024 sc1 lds
    buffer_load_dwordx4 v214, s[4:7], s31 offen offset:2048 sc1 lds
Q_nom_290:
    s_nop 7
    v_cvt_pk_bf16_f32 v80, v32, v33
    v_cvt_pk_bf16_f32 v81, v34, v35
    v_cvt_pk_bf16_f32 v82, v40, v41
    v_cvt_pk_bf16_f32 v83, v42, v43
    v_cvt_pk_bf16_f32 v84, v36, v37
    v_cvt_pk_bf16_f32 v85, v38, v39
    v_cvt_pk_bf16_f32 v86, v44, v45
    v_cvt_pk_bf16_f32 v87, v46, v47
    v_cvt_pk_bf16_f32 v88, v48, v49
    v_cvt_pk_bf16_f32 v89, v50, v51
    v_cvt_pk_bf16_f32 v90, v52, v53
    v_cvt_pk_bf16_f32 v91, v54, v55
    ds_write_b128 v215, v[80:83]
    ds_write_b128 v215, v[84:87] offset:6144
    v_permlane16_swap_b32 v88, v90
    v_permlane16_swap_b32 v89, v91
    ds_write_b128 v217, v[88:91]
    s_cmp_lg_u32 s20, 3
    s_cbranch_scc1 Q_w3_293
    s_waitcnt vmcnt(0)
Q_w3_293:
    s_waitcnt vmcnt(11) lgkmcnt(0)
    s_barrier
    s_cmp_ge_u32 s20, 2
    s_cbranch_scc1 Q_done_295
    s_cmp_eq_u32 s20, 0
    s_cbranch_scc1 Q_a0_294
    ds_read_b128 v[148:151], v218 offset:0
    ds_read_b128 v[152:155], v218 offset:1024
    ds_read_b128 v[156:159], v218 offset:2048
    ds_read_b128 v[160:163], v218 offset:3072
    ds_read_b128 v[164:167], v218 offset:4096
    ds_read_b128 v[168:171], v218 offset:5120
    ds_read_b64_tr_b16 v[172:173], v212 offset:0
    ds_read_b64_tr_b16 v[174:175], v212 offset:256
    ds_read_b64_tr_b16 v[176:177], v212 offset:768
    ds_read_b64_tr_b16 v[178:179], v212 offset:1024
    ds_read_b64_tr_b16 v[180:181], v212 offset:1536
    ds_read_b64_tr_b16 v[182:183], v212 offset:1792
    ds_read_b64_tr_b16 v[184:185], v212 offset:2304
    ds_read_b64_tr_b16 v[186:187], v212 offset:2560
    s_waitcnt lgkmcnt(8)
    ds_read_b64_tr_b16 v[188:189], v213 offset:512
    ds_read_b64_tr_b16 v[190:191], v213 offset:576
    ds_read_b64_tr_b16 v[192:193], v213 offset:2048
    ds_read_b64_tr_b16 v[194:195], v213 offset:2112
    v_mfma_f32_16x16x32_bf16 v[200:203], v[100:103], v[148:151], 0
    v_mfma_f32_16x16x32_bf16 v[204:207], v[124:127], v[148:151], v[208:211]
    v_mfma_f32_16x16x32_bf16 v[200:203], v[104:107], v[152:155], v[200:203]
    v_mfma_f32_16x16x32_bf16 v[204:207], v[128:131], v[152:155], v[204:207]
    v_mfma_f32_16x16x32_bf16 v[200:203], v[108:111], v[156:159], v[200:203]
    v_mfma_f32_16x16x32_bf16 v[204:207], v[132:135], v[156:159], v[204:207]
    v_mfma_f32_16x16x32_bf16 v[200:203], v[112:115], v[160:163], v[200:203]
    v_mfma_f32_16x16x32_bf16 v[204:207], v[136:139], v[160:163], v[204:207]
    v_mfma_f32_16x16x32_bf16 v[200:203], v[116:119], v[164:167], v[200:203]
    v_mfma_f32_16x16x32_bf16 v[204:207], v[140:143], v[164:167], v[204:207]
    v_mfma_f32_16x16x32_bf16 v[200:203], v[120:123], v[168:171], v[200:203]
    v_mfma_f32_16x16x32_bf16 v[204:207], v[144:147], v[168:171], v[204:207]
    s_waitcnt lgkmcnt(0)
    v_mfma_f32_16x16x32_bf16 v[196:199], v[172:175], v[148:151], 0
    v_mfma_f32_16x16x32_bf16 v[196:199], v[176:179], v[152:155], v[196:199]
    v_mfma_f32_16x16x32_bf16 v[196:199], v[180:183], v[156:159], v[196:199]
    v_mfma_f32_16x16x32_bf16 v[196:199], v[184:187], v[160:163], v[196:199]
    v_mfma_f32_16x16x32_bf16 v[196:199], v[188:191], v[164:167], v[196:199]
    v_mfma_f32_16x16x32_bf16 v[196:199], v[192:195], v[168:171], v[196:199]
    v_max3_f32 v224, v200, v201, v202
    v_max3_f32 v224, v224, v204, v205
    v_max3_f32 v224, v224, v206, v207
    s_nop 6
    v_max3_f32 v224, v224, v203, v196
    v_max3_f32 v225, v197, v198, v199
    v_max_f32 v224, v224, v225
    v_mov_b32 v225, v224
    s_nop 1
    v_permlane16_swap_b32 v224, v225
    v_max_f32 v224, v224, v225
    v_mov_b32 v225, v224
    s_nop 1
    v_permlane32_swap_b32 v224, v225
    v_max_f32 v224, v224, v225
    v_mul_f32 v224, s34, v224
    v_fma_f32 v196, v196, s34, -v224
    v_fma_f32 v197, v197, s34, -v224
    v_fma_f32 v198, v198, s34, -v224
    v_fma_f32 v199, v199, s34, -v224
    v_fma_f32 v200, v200, s34, -v224
    v_fma_f32 v201, v201, s34, -v224
    v_fma_f32 v202, v202, s34, -v224
    v_fma_f32 v203, v203, s34, -v224
    v_fma_f32 v204, v204, s34, -v224
    v_fma_f32 v205, v205, s34, -v224
    v_fma_f32 v206, v206, s34, -v224
    v_fma_f32 v207, v207, s34, -v224
    v_exp_f32 v196, v196
    v_exp_f32 v197, v197
    v_exp_f32 v198, v198
    v_exp_f32 v199, v199
    v_exp_f32 v200, v200
    v_exp_f32 v201, v201
    v_exp_f32 v202, v202
    v_exp_f32 v203, v203
    v_exp_f32 v204, v204
    v_exp_f32 v205, v205
    v_exp_f32 v206, v206
    v_exp_f32 v207, v207
    v_add_f32 v226, v196, v197
    v_add_f32 v225, v198, v199
    v_add_f32 v226, v226, v225
    v_mul_f32 v226, 0.5, v226
    v_add_f32 v226, v226, v200
    v_add_f32 v226, v226, v201
    v_add_f32 v226, v226, v202
    v_add_f32 v226, v226, v203
    v_add_f32 v226, v226, v204
    v_add_f32 v226, v226, v205
    v_add_f32 v226, v226, v206
    v_add_f32 v226, v226, v207
    v_mov_b32 v225, v226
    s_nop 1
    v_permlane16_swap_b32 v226, v225
    v_add_f32 v226, v226, v225
    v_mov_b32 v225, v226
    s_nop 1
    v_permlane32_swap_b32 v226, v225
    v_add_f32 v226, v226, v225
    v_rcp_f32 v226, v226
    s_nop 0
    v_mul_f32 v196, v196, v226
    v_mul_f32 v197, v197, v226
    v_mul_f32 v198, v198, v226
    v_mul_f32 v199, v199, v226
    v_mul_f32 v200, v200, v226
    v_mul_f32 v201, v201, v226
    v_mul_f32 v202, v202, v226
    v_mul_f32 v203, v203, v226
    v_mul_f32 v204, v204, v226
    v_mul_f32 v205, v205, v226
    v_mul_f32 v206, v206, v226
    v_mul_f32 v207, v207, v226
    v_cvt_pk_bf16_f32 v232, v196, v197
    v_cvt_pk_bf16_f32 v233, v198, v199
    v_cvt_pk_bf16_f32 v228, v200, v201
    v_cvt_pk_bf16_f32 v229, v202, v203
    v_cvt_pk_bf16_f32 v230, v204, v205
    v_cvt_pk_bf16_f32 v231, v206, v207
    buffer_store_dwordx4 v[228:231], v214, s[4:7], s32 offen sc0 sc1
    s_mov_b64 exec, s[50:51]
    buffer_store_dwordx2 v[232:233], v219, s[4:7], s33 offen sc0 sc1
    s_mov_b64 exec, -1
    s_branch Q_done_295
Q_a0_294:
    ds_read_b128 v[148:151], v218 offset:0
    ds_read_b128 v[152:155], v218 offset:1024
    ds_read_b128 v[156:159], v218 offset:2048
    ds_read_b128 v[160:163], v218 offset:3072
    ds_read_b128 v[164:167], v218 offset:4096
    ds_read_b128 v[168:171], v218 offset:5120
    ds_read_b64_tr_b16 v[172:173], v212 offset:0
    ds_read_b64_tr_b16 v[174:175], v212 offset:256
    ds_read_b64_tr_b16 v[176:177], v212 offset:768
    ds_read_b64_tr_b16 v[178:179], v212 offset:1024
    ds_read_b64_tr_b16 v[180:181], v212 offset:1536
    ds_read_b64_tr_b16 v[182:183], v212 offset:1792
    ds_read_b64_tr_b16 v[184:185], v212 offset:2304
    ds_read_b64_tr_b16 v[186:187], v212 offset:2560
    s_waitcnt lgkmcnt(8)
    ds_read_b64_tr_b16 v[188:189], v213 offset:512
    ds_read_b64_tr_b16 v[190:191], v213 offset:576
    ds_read_b64_tr_b16 v[192:193], v213 offset:2048
    ds_read_b64_tr_b16 v[194:195], v213 offset:2112
    v_mfma_f32_16x16x32_bf16 v[200:203], v[100:103], v[148:151], v[208:211]
    v_mfma_f32_16x16x32_bf16 v[200:203], v[104:107], v[152:155], v[200:203]
    v_mfma_f32_16x16x32_bf16 v[200:203], v[108:111], v[156:159], v[200:203]
    v_mfma_f32_16x16x32_bf16 v[200:203], v[112:115], v[160:163], v[200:203]
    v_mfma_f32_16x16x32_bf16 v[200:203], v[116:119], v[164:167], v[200:203]
    v_mfma_f32_16x16x32_bf16 v[200:203], v[120:123], v[168:171], v[200:203]
    s_waitcnt lgkmcnt(0)
    v_mfma_f32_16x16x32_bf16 v[196:199], v[172:175], v[148:151], 0
    v_mfma_f32_16x16x32_bf16 v[196:199], v[176:179], v[152:155], v[196:199]
    v_mfma_f32_16x16x32_bf16 v[196:199], v[180:183], v[156:159], v[196:199]
    v_mfma_f32_16x16x32_bf16 v[196:199], v[184:187], v[160:163], v[196:199]
    v_mfma_f32_16x16x32_bf16 v[196:199], v[188:191], v[164:167], v[196:199]
    v_mfma_f32_16x16x32_bf16 v[196:199], v[192:195], v[168:171], v[196:199]
    v_max3_f32 v224, v200, v201, v202
    s_nop 6
    v_max3_f32 v224, v224, v203, v196
    v_max3_f32 v225, v197, v198, v199
    v_max_f32 v224, v224, v225
    v_mov_b32 v225, v224
    s_nop 1
    v_permlane16_swap_b32 v224, v225
    v_max_f32 v224, v224, v225
    v_mov_b32 v225, v224
    s_nop 1
    v_permlane32_swap_b32 v224, v225
    v_max_f32 v224, v224, v225
    v_mul_f32 v224, s34, v224
    v_fma_f32 v196, v196, s34, -v224
    v_fma_f32 v197, v197, s34, -v224
    v_fma_f32 v198, v198, s34, -v224
    v_fma_f32 v199, v199, s34, -v224
    v_fma_f32 v200, v200, s34, -v224
    v_fma_f32 v201, v201, s34, -v224
    v_fma_f32 v202, v202, s34, -v224
    v_fma_f32 v203, v203, s34, -v224
    v_exp_f32 v196, v196
    v_exp_f32 v197, v197
    v_exp_f32 v198, v198
    v_exp_f32 v199, v199
    v_exp_f32 v200, v200
    v_exp_f32 v201, v201
    v_exp_f32 v202, v202
    v_exp_f32 v203, v203
    v_add_f32 v226, v196, v197
    v_add_f32 v225, v198, v199
    v_add_f32 v226, v226, v225
    v_mul_f32 v226, 0.5, v226
    v_add_f32 v226, v226, v200
    v_add_f32 v226, v226, v201
    v_add_f32 v226, v226, v202
    v_add_f32 v226, v226, v203
    v_mov_b32 v225, v226
    s_nop 1
    v_permlane16_swap_b32 v226, v225
    v_add_f32 v226, v226, v225
    v_mov_b32 v225, v226
    s_nop 1
    v_permlane32_swap_b32 v226, v225
    v_add_f32 v226, v226, v225
    v_rcp_f32 v226, v226
    s_nop 0
    v_mul_f32 v196, v196, v226
    v_mul_f32 v197, v197, v226
    v_mul_f32 v198, v198, v226
    v_mul_f32 v199, v199, v226
    v_mul_f32 v200, v200, v226
    v_mul_f32 v201, v201, v226
    v_mul_f32 v202, v202, v226
    v_mul_f32 v203, v203, v226
    v_cvt_pk_bf16_f32 v232, v196, v197
    v_cvt_pk_bf16_f32 v233, v198, v199
    v_cvt_pk_bf16_f32 v228, v200, v201
    v_cvt_pk_bf16_f32 v229, v202, v203
    v_mov_b64 v[230:231], 0
    buffer_store_dwordx4 v[228:231], v214, s[4:7], s32 offen sc0 sc1
    s_mov_b64 exec, s[50:51]
    buffer_store_dwordx2 v[232:233], v219, s[4:7], s33 offen sc0 sc1
    s_mov_b64 exec, -1
Q_done_295:
    s_add_u32 s30, s30, 393216
    s_add_u32 s31, s31, 98304
    s_add_u32 s32, s32, 81920
    s_add_u32 s33, s33, 81920
    s_add_u32 s22, s22, 1
    s_waitcnt vmcnt(0)
    s_barrier
    ds_read_b128 v[8:11], v94 offset:0
    ds_read_b128 v[12:15], v94 offset:20480
    ds_read_b128 v[16:19], v95 offset:0
    ds_read_b128 v[20:23], v95 offset:20480
    s_cmp_lg_u32 s20, 0
    s_cbranch_scc1 al_297
    v_mov_b32 v224, 1
    v_mov_b32 v225, 0
    v_mov_b32 v226, 8192
    s_mov_b64 exec, 1
    buffer_atomic_add v224, v225, s[4:7], s37 offen sc0 sc1
    s_waitcnt vmcnt(0)
    v_cmp_eq_u32 vcc, 31, v224
    s_cbranch_vccz al_297_x
    buffer_store_dword v224, v226, s[4:7], s37 offen sc0 sc1
al_297_x:
    s_mov_b64 exec, -1
al_297:
    s_add_u32 s37, s37, 128
Q_s0_296:
    s_add_u32 s35, s22, 1
    s_cmp_ge_u32 s20, 2
    s_cbranch_scc1 Q_nok_298
fw_lp_300:
    v_cmp_gt_u32 vcc, s35, v222
    s_cbranch_vccz fw_ok_299
    s_cmp_eq_u32 s100, 0
    s_cbranch_scc1 fw_ok_299
    s_sub_u32 s100, s100, 1
    s_sleep 2
    buffer_load_dword v222, v221, s[4:7], s39 offen sc1
    s_waitcnt vmcnt(0)
    s_branch fw_lp_300
fw_ok_299:
    s_add_u32 s26, s30, 0
    buffer_load_dwordx4 v[100:103], v214, s[4:7], s26 offen offset:0 sc1
    buffer_load_dwordx4 v[104:107], v214, s[4:7], s26 offen offset:1024 sc1
    buffer_load_dwordx4 v[108:111], v214, s[4:7], s26 offen offset:2048 sc1
    buffer_load_dwordx4 v[112:115], v214, s[4:7], s26 offen offset:3072 sc1
    s_add_u32 s26, s30, 4096
    buffer_load_dwordx4 v[116:119], v214, s[4:7], s26 offen offset:0 sc1
    buffer_load_dwordx4 v[120:123], v214, s[4:7], s26 offen offset:1024 sc1
    buffer_load_dwordx4 v[124:127], v214, s[4:7], s26 offen offset:2048 sc1
    buffer_load_dwordx4 v[128:131], v214, s[4:7], s26 offen offset:3072 sc1
    s_add_u32 s26, s30, 8192
    buffer_load_dwordx4 v[132:135], v214, s[4:7], s26 offen offset:0 sc1
    buffer_load_dwordx4 v[136:139], v214, s[4:7], s26 offen offset:1024 sc1
    buffer_load_dwordx4 v[140:143], v214, s[4:7], s26 offen offset:2048 sc1
    buffer_load_dwordx4 v[144:147], v214, s[4:7], s26 offen offset:3072 sc1
Q_nok_298:
    s_add_u32 s23, s23, 40960
    s_add_u32 m0, s25, 0
    ds_read_b128 v[24:27], v94 offset:1024
    ds_read_b128 v[28:31], v94 offset:21504
    s_waitcnt lgkmcnt(4)
    v_mfma_f32_16x16x32_bf16 v[32:35], a[0:3], v[8:11], 0
    v_mfma_f32_16x16x32_bf16 v[36:39], a[0:3], v[12:15], 0
    v_mfma_f32_16x16x32_bf16 v[40:43], a[80:83], v[8:11], 0
    buffer_load_dwordx4 v2, s[12:15], s23 offen offset:0  lds
    v_mfma_f32_16x16x32_bf16 v[44:47], a[80:83], v[12:15], 0
    v_mfma_f32_16x16x32_bf16 v[48:51], a[160:163], v[8:11], 0
    v_mfma_f32_16x16x32_bf16 v[52:55], a[160:163], v[12:15], 0
    s_add_u32 m0, s25, 896
    ds_read_b128 v[8:11], v95 offset:1024
    ds_read_b128 v[12:15], v95 offset:21504
    s_waitcnt lgkmcnt(4)
    v_mfma_f32_16x16x32_bf16 v[32:35], a[4:7], v[16:19], v[32:35]
    v_mfma_f32_16x16x32_bf16 v[36:39], a[4:7], v[20:23], v[36:39]
    v_mfma_f32_16x16x32_bf16 v[40:43], a[84:87], v[16:19], v[40:43]
    buffer_load_dwordx4 v2, s[12:15], s23 offen offset:128  lds
    v_mfma_f32_16x16x32_bf16 v[44:47], a[84:87], v[20:23], v[44:47]
    v_mfma_f32_16x16x32_bf16 v[48:51], a[164:167], v[16:19], v[48:51]
    v_mfma_f32_16x16x32_bf16 v[52:55], a[164:167], v[20:23], v[52:55]
    s_add_u32 m0, s25, 1792
    ds_read_b128 v[16:19], v94 offset:2048
    ds_read_b128 v[20:23], v94 offset:22528
    s_waitcnt lgkmcnt(4)
    v_mfma_f32_16x16x32_bf16 v[32:35], a[8:11], v[24:27], v[32:35]
    v_mfma_f32_16x16x32_bf16 v[36:39], a[8:11], v[28:31], v[36:39]
    v_mfma_f32_16x16x32_bf16 v[40:43], a[88:91], v[24:27], v[40:43]
    buffer_load_dwordx4 v2, s[12:15], s23 offen offset:256  lds
    v_mfma_f32_16x16x32_bf16 v[44:47], a[88:91], v[28:31], v[44:47]
    v_mfma_f32_16x16x32_bf16 v[48:51], a[168:171], v[24:27], v[48:51]
    v_mfma_f32_16x16x32_bf16 v[52:55], a[168:171], v[28:31], v[52:55]
    s_add_u32 m0, s25, 2688
    ds_read_b128 v[24:27], v95 offset:2048
    ds_read_b128 v[28:31], v95 offset:22528
    s_waitcnt lgkmcnt(4)
    v_mfma_f32_16x16x32_bf16 v[32:35], a[12:15], v[8:11], v[32:35]
    v_mfma_f32_16x16x32_bf16 v[36:39], a[12:15], v[12:15], v[36:39]
    v_mfma_f32_16x16x32_bf16 v[40:43], a[92:95], v[8:11], v[40:43]
    buffer_load_dwordx4 v2, s[12:15], s23 offen offset:384  lds
    v_mfma_f32_16x16x32_bf16 v[44:47], a[92:95], v[12:15], v[44:47]
    v_mfma_f32_16x16x32_bf16 v[48:51], a[172:175], v[8:11], v[48:51]
    v_mfma_f32_16x16x32_bf16 v[52:55], a[172:175], v[12:15], v[52:55]
    s_add_u32 m0, s25, 3584
    ds_read_b128 v[8:11], v94 offset:3072
    ds_read_b128 v[12:15], v94 offset:23552
    s_waitcnt lgkmcnt(4)
    v_mfma_f32_16x16x32_bf16 v[32:35], a[16:19], v[16:19], v[32:35]
    v_mfma_f32_16x16x32_bf16 v[36:39], a[16:19], v[20:23], v[36:39]
    v_mfma_f32_16x16x32_bf16 v[40:43], a[96:99], v[16:19], v[40:43]
    buffer_load_dwordx4 v2, s[12:15], s23 offen offset:512  lds
    v_mfma_f32_16x16x32_bf16 v[44:47], a[96:99], v[20:23], v[44:47]
    v_mfma_f32_16x16x32_bf16 v[48:51], a[176:179], v[16:19], v[48:51]
    v_mfma_f32_16x16x32_bf16 v[52:55], a[176:179], v[20:23], v[52:55]
    s_add_u32 m0, s25, 4480
    ds_read_b128 v[16:19], v95 offset:3072
    ds_read_b128 v[20:23], v95 offset:23552
    s_waitcnt lgkmcnt(4)
    v_mfma_f32_16x16x32_bf16 v[32:35], a[20:23], v[24:27], v[32:35]
    v_mfma_f32_16x16x32_bf16 v[36:39], a[20:23], v[28:31], v[36:39]
    v_mfma_f32_16x16x32_bf16 v[40:43], a[100:103], v[24:27], v[40:43]
    buffer_load_dwordx4 v2, s[12:15], s23 offen offset:640  lds
    v_mfma_f32_16x16x32_bf16 v[44:47], a[100:103], v[28:31], v[44:47]
    v_mfma_f32_16x16x32_bf16 v[48:51], a[180:183], v[24:27], v[48:51]
    v_mfma_f32_16x16x32_bf16 v[52:55], a[180:183], v[28:31], v[52:55]
    s_add_u32 m0, s25, 5376
    ds_read_b128 v[24:27], v94 offset:4096
    ds_read_b128 v[28:31], v94 offset:24576
    s_waitcnt lgkmcnt(4)
    v_mfma_f32_16x16x32_bf16 v[32:35], a[24:27], v[8:11], v[32:35]
    v_mfma_f32_16x16x32_bf16 v[36:39], a[24:27], v[12:15], v[36:39]
    v_mfma_f32_16x16x32_bf16 v[40:43], a[104:107], v[8:11], v[40:43]
    buffer_load_dwordx4 v2, s[12:15], s23 offen offset:768  lds
    v_mfma_f32_16x16x32_bf16 v[44:47], a[104:107], v[12:15], v[44:47]
    v_mfma_f32_16x16x32_bf16 v[48:51], a[184:187], v[8:11], v[48:51]
    v_mfma_f32_16x16x32_bf16 v[52:55], a[184:187], v[12:15], v[52:55]
    s_add_u32 m0, s25, 6272
    ds_read_b128 v[8:11], v95 offset:4096
    ds_read_b128 v[12:15], v95 offset:24576
    s_waitcnt lgkmcnt(4)
    v_mfma_f32_16x16x32_bf16 v[32:35], a[28:31], v[16:19], v[32:35]
    v_mfma_f32_16x16x32_bf16 v[36:39], a[28:31], v[20:23], v[36:39]
    v_mfma_f32_16x16x32_bf16 v[40:43], a[108:111], v[16:19], v[40:43]
    buffer_load_dwordx4 v2, s[12:15], s23 offen offset:896  lds
    v_mfma_f32_16x16x32_bf16 v[44:47], a[108:111], v[20:23], v[44:47]
    v_mfma_f32_16x16x32_bf16 v[48:51], a[188:191], v[16:19], v[48:51]
    v_mfma_f32_16x16x32_bf16 v[52:55], a[188:191], v[20:23], v[52:55]
    s_add_u32 m0, s25, 7168
    ds_read_b128 v[16:19], v94 offset:5120
    ds_read_b128 v[20:23], v94 offset:25600
    s_waitcnt lgkmcnt(4)
    v_mfma_f32_16x16x32_bf16 v[32:35], a[32:35], v[24:27], v[32:35]
    v_mfma_f32_16x16x32_bf16 v[36:39], a[32:35], v[28:31], v[36:39]
    v_mfma_f32_16x16x32_bf16 v[40:43], a[112:115], v[24:27], v[40:43]
    buffer_load_dwordx4 v2, s[12:15], s23 offen offset:1024  lds
    v_mfma_f32_16x16x32_bf16 v[44:47], a[112:115], v[28:31], v[44:47]
    v_mfma_f32_16x16x32_bf16 v[48:51], a[192:195], v[24:27], v[48:51]
    v_mfma_f32_16x16x32_bf16 v[52:55], a[192:195], v[28:31], v[52:55]
    s_add_u32 m0, s25, 8064
    ds_read_b128 v[24:27], v95 offset:5120
    ds_read_b128 v[28:31], v95 offset:25600
    s_waitcnt lgkmcnt(4)
    v_mfma_f32_16x16x32_bf16 v[32:35], a[36:39], v[8:11], v[32:35]
    v_mfma_f32_16x16x32_bf16 v[36:39], a[36:39], v[12:15], v[36:39]
    v_mfma_f32_16x16x32_bf16 v[40:43], a[116:119], v[8:11], v[40:43]
    buffer_load_dwordx4 v2, s[12:15], s23 offen offset:1152  lds
    v_mfma_f32_16x16x32_bf16 v[44:47], a[116:119], v[12:15], v[44:47]
    v_mfma_f32_16x16x32_bf16 v[48:51], a[196:199], v[8:11], v[48:51]
    v_mfma_f32_16x16x32_bf16 v[52:55], a[196:199], v[12:15], v[52:55]
    ds_read_b128 v[8:11], v94 offset:6144
    ds_read_b128 v[12:15], v94 offset:26624
    s_waitcnt lgkmcnt(4)
    v_mfma_f32_16x16x32_bf16 v[32:35], a[40:43], v[16:19], v[32:35]
    v_mfma_f32_16x16x32_bf16 v[36:39], a[40:43], v[20:23], v[36:39]
    v_mfma_f32_16x16x32_bf16 v[40:43], a[120:123], v[16:19], v[40:43]
    v_mfma_f32_16x16x32_bf16 v[44:47], a[120:123], v[20:23], v[44:47]
    v_mfma_f32_16x16x32_bf16 v[48:51], a[200:203], v[16:19], v[48:51]
    v_mfma_f32_16x16x32_bf16 v[52:55], a[200:203], v[20:23], v[52:55]
    ds_read_b128 v[16:19], v95 offset:6144
    ds_read_b128 v[20:23], v95 offset:26624
    s_waitcnt lgkmcnt(4)
    v_mfma_f32_16x16x32_bf16 v[32:35], a[44:47], v[24:27], v[32:35]
    v_mfma_f32_16x16x32_bf16 v[36:39], a[44:47], v[28:31], v[36:39]
    v_mfma_f32_16x16x32_bf16 v[40:43], a[124:127], v[24:27], v[40:43]
    s_mov_b64 exec, 0xffff
    buffer_load_dword v97, v96, s[12:15], s23 offen
    s_mov_b64 exec, -1
    v_mfma_f32_16x16x32_bf16 v[44:47], a[124:127], v[28:31], v[44:47]
    v_mfma_f32_16x16x32_bf16 v[48:51], a[204:207], v[24:27], v[48:51]
    v_mfma_f32_16x16x32_bf16 v[52:55], a[204:207], v[28:31], v[52:55]
    ds_read_b128 v[24:27], v94 offset:7168
    ds_read_b128 v[28:31], v94 offset:27648
    s_waitcnt lgkmcnt(4)
    v_mfma_f32_16x16x32_bf16 v[32:35], a[48:51], v[8:11], v[32:35]
    v_mfma_f32_16x16x32_bf16 v[36:39], a[48:51], v[12:15], v[36:39]
    v_mfma_f32_16x16x32_bf16 v[40:43], a[128:131], v[8:11], v[40:43]
    v_mfma_f32_16x16x32_bf16 v[44:47], a[128:131], v[12:15], v[44:47]
    v_mfma_f32_16x16x32_bf16 v[48:51], a[208:211], v[8:11], v[48:51]
    v_mfma_f32_16x16x32_bf16 v[52:55], a[208:211], v[12:15], v[52:55]
    ds_read_b128 v[8:11], v95 offset:7168
    ds_read_b128 v[12:15], v95 offset:27648
    s_waitcnt lgkmcnt(4)
    v_mfma_f32_16x16x32_bf16 v[32:35], a[52:55], v[16:19], v[32:35]
    v_mfma_f32_16x16x32_bf16 v[36:39], a[52:55], v[20:23], v[36:39]
    v_mfma_f32_16x16x32_bf16 v[40:43], a[132:135], v[16:19], v[40:43]
    v_mfma_f32_16x16x32_bf16 v[44:47], a[132:135], v[20:23], v[44:47]
    v_mfma_f32_16x16x32_bf16 v[48:51], a[212:215], v[16:19], v[48:51]
    v_mfma_f32_16x16x32_bf16 v[52:55], a[212:215], v[20:23], v[52:55]
    ds_read_b128 v[16:19], v94 offset:8192
    ds_read_b128 v[20:23], v94 offset:28672
    s_waitcnt lgkmcnt(4)
    v_mfma_f32_16x16x32_bf16 v[32:35], a[56:59], v[24:27], v[32:35]
    v_mfma_f32_16x16x32_bf16 v[36:39], a[56:59], v[28:31], v[36:39]
    v_mfma_f32_16x16x32_bf16 v[40:43], a[136:139], v[24:27], v[40:43]
    v_mfma_f32_16x16x32_bf16 v[44:47], a[136:139], v[28:31], v[44:47]
    v_mfma_f32_16x16x32_bf16 v[48:51], a[216:219], v[24:27], v[48:51]
    v_mfma_f32_16x16x32_bf16 v[52:55], a[216:219], v[28:31], v[52:55]
    ds_read_b128 v[24:27], v95 offset:8192
    ds_read_b128 v[28:31], v95 offset:28672
    s_waitcnt lgkmcnt(4)
    v_mfma_f32_16x16x32_bf16 v[32:35], a[60:63], v[8:11], v[32:35]
    v_mfma_f32_16x16x32_bf16 v[36:39], a[60:63], v[12:15], v[36:39]
    v_mfma_f32_16x16x32_bf16 v[40:43], a[140:143], v[8:11], v[40:43]
    v_mfma_f32_16x16x32_bf16 v[44:47], a[140:143], v[12:15], v[44:47]
    v_mfma_f32_16x16x32_bf16 v[48:51], a[220:223], v[8:11], v[48:51]
    v_mfma_f32_16x16x32_bf16 v[52:55], a[220:223], v[12:15], v[52:55]
    ds_read_b128 v[8:11], v94 offset:9216
    ds_read_b128 v[12:15], v94 offset:29696
    s_waitcnt lgkmcnt(4)
    v_mfma_f32_16x16x32_bf16 v[32:35], a[64:67], v[16:19], v[32:35]
    v_mfma_f32_16x16x32_bf16 v[36:39], a[64:67], v[20:23], v[36:39]
    v_mfma_f32_16x16x32_bf16 v[40:43], a[144:147], v[16:19], v[40:43]
    v_mfma_f32_16x16x32_bf16 v[44:47], a[144:147], v[20:23], v[44:47]
    v_mfma_f32_16x16x32_bf16 v[48:51], a[224:227], v[16:19], v[48:51]
    v_mfma_f32_16x16x32_bf16 v[52:55], a[224:227], v[20:23], v[52:55]
    ds_read_b128 v[16:19], v95 offset:9216
    ds_read_b128 v[20:23], v95 offset:29696
    s_waitcnt lgkmcnt(4)
    v_mfma_f32_16x16x32_bf16 v[32:35], a[68:71], v[24:27], v[32:35]
    v_mfma_f32_16x16x32_bf16 v[36:39], a[68:71], v[28:31], v[36:39]
    v_mfma_f32_16x16x32_bf16 v[40:43], a[148:151], v[24:27], v[40:43]
    v_mfma_f32_16x16x32_bf16 v[44:47], a[148:151], v[28:31], v[44:47]
    v_mfma_f32_16x16x32_bf16 v[48:51], a[228:231], v[24:27], v[48:51]
    v_mfma_f32_16x16x32_bf16 v[52:55], a[228:231], v[28:31], v[52:55]
    s_waitcnt lgkmcnt(2)
    v_mfma_f32_16x16x32_bf16 v[32:35], a[72:75], v[8:11], v[32:35]
    v_mfma_f32_16x16x32_bf16 v[36:39], a[72:75], v[12:15], v[36:39]
    v_mfma_f32_16x16x32_bf16 v[40:43], a[152:155], v[8:11], v[40:43]
    v_mfma_f32_16x16x32_bf16 v[44:47], a[152:155], v[12:15], v[44:47]
    v_mfma_f32_16x16x32_bf16 v[48:51], a[232:235], v[8:11], v[48:51]
    v_mfma_f32_16x16x32_bf16 v[52:55], a[232:235], v[12:15], v[52:55]
    s_waitcnt lgkmcnt(0)
    v_mfma_f32_16x16x32_bf16 v[32:35], a[76:79], v[16:19], v[32:35]
    v_mfma_f32_16x16x32_bf16 v[36:39], a[76:79], v[20:23], v[36:39]
    v_mfma_f32_16x16x32_bf16 v[40:43], a[156:159], v[16:19], v[40:43]
    v_mfma_f32_16x16x32_bf16 v[44:47], a[156:159], v[20:23], v[44:47]
    v_mfma_f32_16x16x32_bf16 v[48:51], a[236:239], v[16:19], v[48:51]
    v_mfma_f32_16x16x32_bf16 v[52:55], a[236:239], v[20:23], v[52:55]
    s_cmp_lg_u32 s20, 3
    s_cbranch_scc1 Q_nom_301
fw_lp_303:
    v_cmp_gt_u32 vcc, s35, v220
    s_cbranch_vccz fw_ok_302
    s_cmp_eq_u32 s100, 0
    s_cbranch_scc1 fw_ok_302
    s_sub_u32 s100, s100, 1
    s_sleep 2
    buffer_load_dword v220, v221, s[4:7], s38 offen sc1
    s_waitcnt vmcnt(0)
    s_branch fw_lp_303
fw_ok_302:
    s_mov_b32 m0, 94208
    s_nop 0
    buffer_load_dwordx4 v214, s[4:7], s31 offen offset:0 sc1 lds
    buffer_load_dwordx4 v214, s[4:7], s31 offen offset:1024 sc1 lds
    buffer_load_dwordx4 v214, s[4:7], s31 offen offset:2048 sc1 lds
Q_nom_301:
    s_nop 7
    v_cvt_pk_bf16_f32 v80, v32, v33
    v_cvt_pk_bf16_f32 v81, v34, v35
    v_cvt_pk_bf16_f32 v82, v40, v41
    v_cvt_pk_bf16_f32 v83, v42, v43
    v_cvt_pk_bf16_f32 v84, v36, v37
    v_cvt_pk_bf16_f32 v85, v38, v39
    v_cvt_pk_bf16_f32 v86, v44, v45
    v_cvt_pk_bf16_f32 v87, v46, v47
    v_cvt_pk_bf16_f32 v88, v48, v49
    v_cvt_pk_bf16_f32 v89, v50, v51
    v_cvt_pk_bf16_f32 v90, v52, v53
    v_cvt_pk_bf16_f32 v91, v54, v55
    ds_write_b128 v215, v[80:83]
    ds_write_b128 v215, v[84:87] offset:6144
    v_permlane16_swap_b32 v88, v90
    v_permlane16_swap_b32 v89, v91
    ds_write_b128 v217, v[88:91]
    s_cmp_lg_u32 s20, 3
    s_cbranch_scc1 Q_w3_304
    s_waitcnt vmcnt(0)
Q_w3_304:
    s_waitcnt vmcnt(11) lgkmcnt(0)
    s_barrier
    s_cmp_ge_u32 s20, 2
    s_cbranch_scc1 Q_done_306
    s_cmp_eq_u32 s20, 0
    s_cbranch_scc1 Q_a0_305
    ds_read_b128 v[148:151], v218 offset:0
    ds_read_b128 v[152:155], v218 offset:1024
    ds_read_b128 v[156:159], v218 offset:2048
    ds_read_b128 v[160:163], v218 offset:3072
    ds_read_b128 v[164:167], v218 offset:4096
    ds_read_b128 v[168:171], v218 offset:5120
    ds_read_b64_tr_b16 v[172:173], v212 offset:0
    ds_read_b64_tr_b16 v[174:175], v212 offset:256
    ds_read_b64_tr_b16 v[176:177], v212 offset:768
    ds_read_b64_tr_b16 v[178:179], v212 offset:1024
    ds_read_b64_tr_b16 v[180:181], v212 offset:1536
    ds_read_b64_tr_b16 v[182:183], v212 offset:1792
    ds_read_b64_tr_b16 v[184:185], v212 offset:2304
    ds_read_b64_tr_b16 v[186:187], v212 offset:2560
    s_waitcnt lgkmcnt(8)
    ds_read_b64_tr_b16 v[188:189], v213 offset:512
    ds_read_b64_tr_b16 v[190:191], v213 offset:576
    ds_read_b64_tr_b16 v[192:193], v213 offset:2048
    ds_read_b64_tr_b16 v[194:195], v213 offset:2112
    v_mfma_f32_16x16x32_bf16 v[200:203], v[100:103], v[148:151], 0
    v_mfma_f32_16x16x32_bf16 v[204:207], v[124:127], v[148:151], v[208:211]
    v_mfma_f32_16x16x32_bf16 v[200:203], v[104:107], v[152:155], v[200:203]
    v_mfma_f32_16x16x32_bf16 v[204:207], v[128:131], v[152:155], v[204:207]
    v_mfma_f32_16x16x32_bf16 v[200:203], v[108:111], v[156:159], v[200:203]
    v_mfma_f32_16x16x32_bf16 v[204:207], v[132:135], v[156:159], v[204:207]
    v_mfma_f32_16x16x32_bf16 v[200:203], v[112:115], v[160:163], v[200:203]
    v_mfma_f32_16x16x32_bf16 v[204:207], v[136:139], v[160:163], v[204:207]
    v_mfma_f32_16x16x32_bf16 v[200:203], v[116:119], v[164:167], v[200:203]
    v_mfma_f32_16x16x32_bf16 v[204:207], v[140:143], v[164:167], v[204:207]
    v_mfma_f32_16x16x32_bf16 v[200:203], v[120:123], v[168:171], v[200:203]
    v_mfma_f32_16x16x32_bf16 v[204:207], v[144:147], v[168:171], v[204:207]
    s_waitcnt lgkmcnt(0)
    v_mfma_f32_16x16x32_bf16 v[196:199], v[172:175], v[148:151], 0
    v_mfma_f32_16x16x32_bf16 v[196:199], v[176:179], v[152:155], v[196:199]
    v_mfma_f32_16x16x32_bf16 v[196:199], v[180:183], v[156:159], v[196:199]
    v_mfma_f32_16x16x32_bf16 v[196:199], v[184:187], v[160:163], v[196:199]
    v_mfma_f32_16x16x32_bf16 v[196:199], v[188:191], v[164:167], v[196:199]
    v_mfma_f32_16x16x32_bf16 v[196:199], v[192:195], v[168:171], v[196:199]
    v_max3_f32 v224, v200, v201, v202
    v_max3_f32 v224, v224, v204, v205
    v_max3_f32 v224, v224, v206, v207
    s_nop 6
    v_max3_f32 v224, v224, v203, v196
    v_max3_f32 v225, v197, v198, v199
    v_max_f32 v224, v224, v225
    v_mov_b32 v225, v224
    s_nop 1
    v_permlane16_swap_b32 v224, v225
    v_max_f32 v224, v224, v225
    v_mov_b32 v225, v224
    s_nop 1
    v_permlane32_swap_b32 v224, v225
    v_max_f32 v224, v224, v225
    v_mul_f32 v224, s34, v224
    v_fma_f32 v196, v196, s34, -v224
    v_fma_f32 v197, v197, s34, -v224
    v_fma_f32 v198, v198, s34, -v224
    v_fma_f32 v199, v199, s34, -v224
    v_fma_f32 v200, v200, s34, -v224
    v_fma_f32 v201, v201, s34, -v224
    v_fma_f32 v202, v202, s34, -v224
    v_fma_f32 v203, v203, s34, -v224
    v_fma_f32 v204, v204, s34, -v224
    v_fma_f32 v205, v205, s34, -v224
    v_fma_f32 v206, v206, s34, -v224
    v_fma_f32 v207, v207, s34, -v224
    v_exp_f32 v196, v196
    v_exp_f32 v197, v197
    v_exp_f32 v198, v198
    v_exp_f32 v199, v199
    v_exp_f32 v200, v200
    v_exp_f32 v201, v201
    v_exp_f32 v202, v202
    v_exp_f32 v203, v203
    v_exp_f32 v204, v204
    v_exp_f32 v205, v205
    v_exp_f32 v206, v206
    v_exp_f32 v207, v207
    v_add_f32 v226, v196, v197
    v_add_f32 v225, v198, v199
    v_add_f32 v226, v226, v225
    v_mul_f32 v226, 0.5, v226
    v_add_f32 v226, v226, v200
    v_add_f32 v226, v226, v201
    v_add_f32 v226, v226, v202
    v_add_f32 v226, v226, v203
    v_add_f32 v226, v226, v204
    v_add_f32 v226, v226, v205
    v_add_f32 v226, v226, v206
    v_add_f32 v226, v226, v207
    v_mov_b32 v225, v226
    s_nop 1
    v_permlane16_swap_b32 v226, v225
    v_add_f32 v226, v226, v225
    v_mov_b32 v225, v226
    s_nop 1
    v_permlane32_swap_b32 v226, v225
    v_add_f32 v226, v226, v225
    v_rcp_f32 v226, v226
    s_nop 0
    v_mul_f32 v196, v196, v226
    v_mul_f32 v197, v197, v226
    v_mul_f32 v198, v198, v226
    v_mul_f32 v199, v199, v226
    v_mul_f32 v200, v200, v226
    v_mul_f32 v201, v201, v226
    v_mul_f32 v202, v202, v226
    v_mul_f32 v203, v203, v226
    v_mul_f32 v204, v204, v226
    v_mul_f32 v205, v205, v226
    v_mul_f32 v206, v206, v226
    v_mul_f32 v207, v207, v226
    v_cvt_pk_bf16_f32 v232, v196, v197
    v_cvt_pk_bf16_f32 v233, v198, v199
    v_cvt_pk_bf16_f32 v228, v200, v201
    v_cvt_pk_bf16_f32 v229, v202, v203
    v_cvt_pk_bf16_f32 v230, v204, v205
    v_cvt_pk_bf16_f32 v231, v206, v207
    buffer_store_dwordx4 v[228:231], v214, s[4:7], s32 offen sc0 sc1
    s_mov_b64 exec, s[50:51]
    buffer_store_dwordx2 v[232:233], v219, s[4:7], s33 offen sc0 sc1
    s_mov_b64 exec, -1
    s_branch Q_done_306
Q_a0_305:
    ds_read_b128 v[148:151], v218 offset:0
    ds_read_b128 v[152:155], v218 offset:1024
    ds_read_b128 v[156:159], v218 offset:2048
    ds_read_b128 v[160:163], v218 offset:3072
    ds_read_b128 v[164:167], v218 offset:4096
    ds_read_b128 v[168:171], v218 offset:5120
    ds_read_b64_tr_b16 v[172:173], v212 offset:0
    ds_read_b64_tr_b16 v[174:175], v212 offset:256
    ds_read_b64_tr_b16 v[176:177], v212 offset:768
    ds_read_b64_tr_b16 v[178:179], v212 offset:1024
    ds_read_b64_tr_b16 v[180:181], v212 offset:1536
    ds_read_b64_tr_b16 v[182:183], v212 offset:1792
    ds_read_b64_tr_b16 v[184:185], v212 offset:2304
    ds_read_b64_tr_b16 v[186:187], v212 offset:2560
    s_waitcnt lgkmcnt(8)
    ds_read_b64_tr_b16 v[188:189], v213 offset:512
    ds_read_b64_tr_b16 v[190:191], v213 offset:576
    ds_read_b64_tr_b16 v[192:193], v213 offset:2048
    ds_read_b64_tr_b16 v[194:195], v213 offset:2112
    v_mfma_f32_16x16x32_bf16 v[200:203], v[100:103], v[148:151], v[208:211]
    v_mfma_f32_16x16x32_bf16 v[200:203], v[104:107], v[152:155], v[200:203]
    v_mfma_f32_16x16x32_bf16 v[200:203], v[108:111], v[156:159], v[200:203]
    v_mfma_f32_16x16x32_bf16 v[200:203], v[112:115], v[160:163], v[200:203]
    v_mfma_f32_16x16x32_bf16 v[200:203], v[116:119], v[164:167], v[200:203]
    v_mfma_f32_16x16x32_bf16 v[200:203], v[120:123], v[168:171], v[200:203]
    s_waitcnt lgkmcnt(0)
    v_mfma_f32_16x16x32_bf16 v[196:199], v[172:175], v[148:151], 0
    v_mfma_f32_16x16x32_bf16 v[196:199], v[176:179], v[152:155], v[196:199]
    v_mfma_f32_16x16x32_bf16 v[196:199], v[180:183], v[156:159], v[196:199]
    v_mfma_f32_16x16x32_bf16 v[196:199], v[184:187], v[160:163], v[196:199]
    v_mfma_f32_16x16x32_bf16 v[196:199], v[188:191], v[164:167], v[196:199]
    v_mfma_f32_16x16x32_bf16 v[196:199], v[192:195], v[168:171], v[196:199]
    v_max3_f32 v224, v200, v201, v202
    s_nop 6
    v_max3_f32 v224, v224, v203, v196
    v_max3_f32 v225, v197, v198, v199
    v_max_f32 v224, v224, v225
    v_mov_b32 v225, v224
    s_nop 1
    v_permlane16_swap_b32 v224, v225
    v_max_f32 v224, v224, v225
    v_mov_b32 v225, v224
    s_nop 1
    v_permlane32_swap_b32 v224, v225
    v_max_f32 v224, v224, v225
    v_mul_f32 v224, s34, v224
    v_fma_f32 v196, v196, s34, -v224
    v_fma_f32 v197, v197, s34, -v224
    v_fma_f32 v198, v198, s34, -v224
    v_fma_f32 v199, v199, s34, -v224
    v_fma_f32 v200, v200, s34, -v224
    v_fma_f32 v201, v201, s34, -v224
    v_fma_f32 v202, v202, s34, -v224
    v_fma_f32 v203, v203, s34, -v224
    v_exp_f32 v196, v196
    v_exp_f32 v197, v197
    v_exp_f32 v198, v198
    v_exp_f32 v199, v199
    v_exp_f32 v200, v200
    v_exp_f32 v201, v201
    v_exp_f32 v202, v202
    v_exp_f32 v203, v203
    v_add_f32 v226, v196, v197
    v_add_f32 v225, v198, v199
    v_add_f32 v226, v226, v225
    v_mul_f32 v226, 0.5, v226
    v_add_f32 v226, v226, v200
    v_add_f32 v226, v226, v201
    v_add_f32 v226, v226, v202
    v_add_f32 v226, v226, v203
    v_mov_b32 v225, v226
    s_nop 1
    v_permlane16_swap_b32 v226, v225
    v_add_f32 v226, v226, v225
    v_mov_b32 v225, v226
    s_nop 1
    v_permlane32_swap_b32 v226, v225
    v_add_f32 v226, v226, v225
    v_rcp_f32 v226, v226
    s_nop 0
    v_mul_f32 v196, v196, v226
    v_mul_f32 v197, v197, v226
    v_mul_f32 v198, v198, v226
    v_mul_f32 v199, v199, v226
    v_mul_f32 v200, v200, v226
    v_mul_f32 v201, v201, v226
    v_mul_f32 v202, v202, v226
    v_mul_f32 v203, v203, v226
    v_cvt_pk_bf16_f32 v232, v196, v197
    v_cvt_pk_bf16_f32 v233, v198, v199
    v_cvt_pk_bf16_f32 v228, v200, v201
    v_cvt_pk_bf16_f32 v229, v202, v203
    v_mov_b64 v[230:231], 0
    buffer_store_dwordx4 v[228:231], v214, s[4:7], s32 offen sc0 sc1
    s_mov_b64 exec, s[50:51]
    buffer_store_dwordx2 v[232:233], v219, s[4:7], s33 offen sc0 sc1
    s_mov_b64 exec, -1
Q_done_306:
    s_add_u32 s30, s30, 393216
    s_add_u32 s31, s31, 98304
    s_add_u32 s32, s32, 81920
    s_add_u32 s33, s33, 81920
    s_add_u32 s22, s22, 1
    s_cmp_lt_u32 s22, 64
    s_cbranch_scc1 Q_loop_284
    s_waitcnt vmcnt(0)
    s_barrier
    s_cmp_lg_u32 s20, 0
    s_cbranch_scc1 al_307
    v_mov_b32 v224, 1
    v_mov_b32 v225, 0
    v_mov_b32 v226, 8192
    s_mov_b64 exec, 1
    buffer_atomic_add v224, v225, s[4:7], s37 offen sc0 sc1
    s_waitcnt vmcnt(0)
    v_cmp_eq_u32 vcc, 31, v224
    s_cbranch_vccz al_307_x
    buffer_store_dword v224, v226, s[4:7], s37 offen sc0 sc1
al_307_x:
    s_mov_b64 exec, -1
al_307:
    s_branch L_end
L_notq:
    s_cmp_ge_u32 s25, 160
    s_cbranch_scc1 L_notb
    v_mov_b32 v251, 0
    global_load_dword v250, v251, s[98:99] sc1
    s_waitcnt vmcnt(0)
iw_lp_309:
    v_cmp_gt_u32 vcc, 27, v250
    s_cbranch_vccz iw_ok_308
    s_cmp_eq_u32 s100, 0
    s_cbranch_scc1 iw_ok_308
    s_sub_u32 s100, s100, 1
    s_sleep 2
    global_load_dword v250, v251, s[98:99] sc1
    s_waitcnt vmcnt(0)
    s_branch iw_lp_309
iw_ok_308:
    s_lshl_b32 s88, s21, 7
    s_add_u32 s88, s88, 167829504
    s_mov_b32 s89, 4
    v_mov_b32 v250, 0
fw_lp_311:
    v_cmp_gt_u32 vcc, s89, v250
    s_cbranch_vccz fw_ok_310
    s_cmp_eq_u32 s100, 0
    s_cbranch_scc1 fw_ok_310
    s_sub_u32 s100, s100, 1
    s_sleep 16
    buffer_load_dword v250, v251, s[4:7], s88 offen sc1
    s_waitcnt vmcnt(0)
    s_branch fw_lp_311
fw_ok_310:
    s_load_dwordx2 s[8:9], s[0:1], 64
    s_load_dwordx2 s[12:13], s[0:1], 56
    v_and_b32 v234, 31, v1
    v_lshlrev_b32 v235, 2, v234
    v_mov_b32 v10, 0x7ffffff0
    v_add_u32 v11, 2464, v235
    v_mov_b32 v12, v10
    v_cmp_gt_u32 vcc, 24, v234
    s_nop 1
    v_cndmask_b32 v11, v11, v12, vcc
    v_add_u32 v12, 2512, v235
    v_cmp_gt_u32 vcc, 22, v234
    s_nop 1
    v_cndmask_b32 v11, v11, v12, vcc
    v_add_u32 v12, 1240, v235
    v_cmp_gt_u32 vcc, 20, v234
    s_nop 1
    v_cndmask_b32 v11, v11, v12, vcc
    v_add_u32 v12, 4294967264, v235
    v_cmp_gt_u32 vcc, 18, v234
    s_nop 1
    v_cndmask_b32 v11, v11, v12, vcc
    v_add_u32 v12, 1248, v235
    v_cmp_gt_u32 vcc, 16, v234
    s_nop 1
    v_cndmask_b32 v11, v11, v12, vcc
    v_add_u32 v12, 0, v235
    v_cmp_gt_u32 vcc, 8, v234
    s_nop 1
    v_cndmask_b32 v11, v11, v12, vcc
    v_lshrrev_b32 v12, 5, v1
    v_mul_u32_u24 v12, 3840, v12
    v_add_u32 v11, v11, v12
    s_mul_i32 s30, s21, 40
    s_mul_i32 s31, s20, 614400
    s_add_u32 s30, s30, s31
    s_mul_i32 s31, s20, 20480
    s_waitcnt lgkmcnt(0)
    s_and_b32 s9, s9, 0xffff
    s_mov_b32 s10, 2457600
    s_mov_b32 s11, 0x20000
    s_and_b32 s13, s13, 0xffff
    s_mov_b32 s14, 2621440
    s_mov_b32 s15, 0x20000
    s_mov_b32 s32, 0
B_wl_312:
    s_add_u32 m0, s31, 0
    s_add_u32 s33, s30, 0
    buffer_load_dword v11, s[8:11], s33 offen lds
    s_add_u32 m0, s31, 256
    s_add_u32 s33, s30, 7680
    buffer_load_dword v11, s[8:11], s33 offen lds
    s_add_u32 m0, s31, 512
    s_add_u32 s33, s30, 15360
    buffer_load_dword v11, s[8:11], s33 offen lds
    s_add_u32 m0, s31, 768
    s_add_u32 s33, s30, 23040
    buffer_load_dword v11, s[8:11], s33 offen lds
    s_add_u32 m0, s31, 1024
    s_add_u32 s33, s30, 30720
    buffer_load_dword v11, s[8:11], s33 offen lds
    s_add_u32 m0, s31, 1280
    s_add_u32 s33, s30, 38400
    buffer_load_dword v11, s[8:11], s33 offen lds
    s_add_u32 m0, s31, 1536
    s_add_u32 s33, s30, 46080
    buffer_load_dword v11, s[8:11], s33 offen lds
    s_add_u32 m0, s31, 1792
    s_add_u32 s33, s30, 53760
    buffer_load_dword v11, s[8:11], s33 offen lds
    s_waitcnt vmcnt(40)
    s_add_u32 s31, s31, 2048
    s_add_u32 s30, s30, 61440
    s_add_u32 s32, s32, 1
    s_cmp_lt_u32 s32, 10
    s_cbranch_scc1 B_wl_312
    v_and_b32 v232, 15, v1
    v_lshrrev_b32 v233, 4, v1
    v_bfe_u32 v234, v1, 2, 2
    v_lshl_add_u32 v234, v233, 3, v234
    v_and_b32 v235, 3, v1
    v_lshlrev_b32 v235, 3, v235
    v_lshl_add_u32 v10, v234, 7, v235
    s_lshl_b32 s26, s20, 5
    v_add_u32 v10, s26, v10
    v_add_u32 v12, 40960, v10
    s_waitcnt vmcnt(0)
    s_barrier
    ds_read_b64_tr_b16 a[0:1], v10 offset:0
    ds_read_b64_tr_b16 a[2:3], v10 offset:512
    ds_read_b64_tr_b16 a[4:5], v10 offset:4096
    ds_read_b64_tr_b16 a[6:7], v10 offset:4608
    ds_read_b64_tr_b16 a[8:9], v10 offset:8192
    ds_read_b64_tr_b16 a[10:11], v10 offset:8704
    ds_read_b64_tr_b16 a[12:13], v10 offset:12288
    ds_read_b64_tr_b16 a[14:15], v10 offset:12800
    ds_read_b64_tr_b16 a[16:17], v10 offset:16384
    ds_read_b64_tr_b16 a[18:19], v10 offset:16896
    ds_read_b64_tr_b16 a[20:21], v10 offset:20480
    ds_read_b64_tr_b16 a[22:23], v10 offset:20992
    s_waitcnt lgkmcnt(0)
    ds_read_b64_tr_b16 a[24:25], v10 offset:24576
    ds_read_b64_tr_b16 a[26:27], v10 offset:25088
    ds_read_b64_tr_b16 a[28:29], v10 offset:28672
    ds_read_b64_tr_b16 a[30:31], v10 offset:29184
    ds_read_b64_tr_b16 a[32:33], v10 offset:32768
    ds_read_b64_tr_b16 a[34:35], v10 offset:33280
    ds_read_b64_tr_b16 a[36:37], v10 offset:36864
    ds_read_b64_tr_b16 a[38:39], v10 offset:37376
    ds_read_b64_tr_b16 a[40:41], v12 offset:0
    ds_read_b64_tr_b16 a[42:43], v12 offset:512
    ds_read_b64_tr_b16 a[44:45], v12 offset:4096
    ds_read_b64_tr_b16 a[46:47], v12 offset:4608
    s_waitcnt lgkmcnt(0)
    ds_read_b64_tr_b16 a[48:49], v12 offset:8192
    ds_read_b64_tr_b16 a[50:51], v12 offset:8704
    ds_read_b64_tr_b16 a[52:53], v12 offset:12288
    ds_read_b64_tr_b16 a[54:55], v12 offset:12800
    ds_read_b64_tr_b16 a[56:57], v12 offset:16384
    ds_read_b64_tr_b16 a[58:59], v12 offset:16896
    ds_read_b64_tr_b16 a[60:61], v12 offset:20480
    ds_read_b64_tr_b16 a[62:63], v12 offset:20992
    ds_read_b64_tr_b16 a[64:65], v12 offset:24576
    ds_read_b64_tr_b16 a[66:67], v12 offset:25088
    ds_read_b64_tr_b16 a[68:69], v12 offset:28672
    ds_read_b64_tr_b16 a[70:71], v12 offset:29184
    s_waitcnt lgkmcnt(0)
    ds_read_b64_tr_b16 a[72:73], v12 offset:32768
    ds_read_b64_tr_b16 a[74:75], v12 offset:33280
    ds_read_b64_tr_b16 a[76:77], v12 offset:36864
    ds_read_b64_tr_b16 a[78:79], v12 offset:37376
    s_waitcnt lgkmcnt(0)
    s_barrier
    v_lshrrev_b32 v6, 3, v1
    s_and_b32 s26, s20, 1
    s_lshl_b32 s26, s26, 2
    v_lshrrev_b32 v7, 4, v1
    v_add_u32 v7, s26, v7
    v_and_b32 v2, 7, v1
    v_xor_b32 v7, v7, v2
    v_mul_u32_u24 v6, 1280, v6
    v_lshl_add_u32 v6, v7, 4, v6
    s_mul_i32 s26, s20, 10240
    v_add_u32 v2, s26, v6
    s_mul_i32 s25, s20, 10240
    v_and_b32 v6, 15, v1
    v_lshrrev_b32 v7, 1, v6
    v_lshrrev_b32 v3, 4, v1
    v_xor_b32 v7, v7, v3
    v_lshlrev_b32 v7, 4, v7
    v_lshrrev_b32 v3, 3, v6
    v_mul_u32_u24 v3, 10240, v3
    v_and_b32 v6, 7, v6
    v_lshl_add_u32 v6, v6, 7, v7
    v_add_u32 v3, v3, v6
    v_xor_b32 v93, 64, v3
    v_mov_b32 v92, v3
    v_add_u32 v94, 40960, v92
    v_add_u32 v95, 40960, v93
    s_mov_b32 s23, 0
    s_mul_i32 s26, s21, 13108
    s_lshr_b32 s26, s26, 16
    s_mul_i32 s26, s26, 5
    s_sub_u32 s26, s21, s26
    s_lshl_b32 s26, s26, 2
    s_add_u32 s26, s26, s20
    s_lshl_b32 s26, s26, 11
    s_add_u32 s26, s26, 122880
    v_lshl_add_u32 v96, v1, 7, s26
    s_add_u32 m0, s25, 0
    s_nop 0
    buffer_load_dwordx4 v2, s[12:15], s23 offen offset:0  lds
    s_add_u32 m0, s25, 896
    s_nop 0
    buffer_load_dwordx4 v2, s[12:15], s23 offen offset:128  lds
    s_add_u32 m0, s25, 1792
    s_nop 0
    buffer_load_dwordx4 v2, s[12:15], s23 offen offset:256  lds
    s_add_u32 m0, s25, 2688
    s_nop 0
    buffer_load_dwordx4 v2, s[12:15], s23 offen offset:384  lds
    s_add_u32 m0, s25, 3584
    s_nop 0
    buffer_load_dwordx4 v2, s[12:15], s23 offen offset:512  lds
    s_add_u32 m0, s25, 4480
    s_nop 0
    buffer_load_dwordx4 v2, s[12:15], s23 offen offset:640  lds
    s_add_u32 m0, s25, 5376
    s_nop 0
    buffer_load_dwordx4 v2, s[12:15], s23 offen offset:768  lds
    s_add_u32 m0, s25, 6272
    s_nop 0
    buffer_load_dwordx4 v2, s[12:15], s23 offen offset:896  lds
    s_add_u32 m0, s25, 7168
    s_nop 0
    buffer_load_dwordx4 v2, s[12:15], s23 offen offset:1024  lds
    s_add_u32 m0, s25, 8064
    s_nop 0
    buffer_load_dwordx4 v2, s[12:15], s23 offen offset:1152  lds
    v_subrev_u32 v96, 81920, v96
    s_mov_b64 exec, 0xffff
    buffer_load_dword v97, v96, s[12:15], s23 offen
    s_mov_b64 exec, -1
    v_add_u32 v96, 40960, v96
    s_mov_b64 exec, 0xffff
    buffer_load_dword v97, v96, s[12:15], s23 offen
    s_mov_b64 exec, -1
    v_add_u32 v96, 40960, v96
    s_mov_b64 exec, 0xffff
    buffer_load_dword v97, v96, s[12:15], s23 offen
    s_mov_b64 exec, -1
    v_lshlrev_b32 v216, 4, v1
    v_mov_b32 v100, 0
    v_mov_b32 v101, 0
    v_mov_b32 v102, 0
    v_mov_b32 v103, 0
    v_mov_b32 v104, 0
    v_mov_b32 v105, 0
    v_mov_b32 v106, 0
    v_mov_b32 v107, 0
    v_mov_b32 v108, 0
    v_mov_b32 v109, 0
    v_mov_b32 v110, 0
    v_mov_b32 v111, 0
    v_cmp_eq_u32 vcc, 1, v233
    v_mov_b32 v234, 0xf149
    v_mov_b32 v235, 0x3f80
    v_cndmask_b32 v102, 0, v234, vcc
    v_cndmask_b32 v114, 0, v235, vcc
    v_mov_b32 v112, 0
    v_mov_b32 v113, 0
    v_mov_b32 v115, 0
    v_and_b32 v234, 3, v232
    v_cmp_eq_u32 vcc, 0, v234
    v_cmp_lt_u32 s[50:51], 3, v232
    v_mov_b32 v235, 0x3f803f80
    s_and_b64 vcc, vcc, s[50:51]
    s_nop 1
    v_cndmask_b32 v108, 0, v235, vcc
    v_cndmask_b32 v109, 0, v235, vcc
    v_cndmask_b32 v110, 0, v235, vcc
    v_cndmask_b32 v111, 0, v235, vcc
    s_mul_i32 s26, s20, 12288
    s_add_u32 s26, s26, 81920
    v_add_u32 v234, s26, v216
    ds_write_b128 v234, v[100:103] offset:0
    ds_write_b128 v234, v[100:103] offset:1024
    ds_write_b128 v234, v[104:107] offset:2048
    ds_write_b128 v234, v[108:111] offset:3072
    ds_write_b128 v234, v[100:103] offset:4096
    ds_write_b128 v234, v[100:103] offset:5120
    ds_write_b128 v234, v[104:107] offset:6144
    ds_write_b128 v234, v[108:111] offset:7168
    ds_write_b128 v234, v[100:103] offset:8192
    ds_write_b128 v234, v[100:103] offset:9216
    ds_write_b128 v234, v[104:107] offset:10240
    ds_write_b128 v234, v[108:111] offset:11264
    s_lshl_b32 s26, s20, 10
    s_add_u32 s26, s26, 131072
    v_add_u32 v230, s26, v216
    ds_write_b128 v230, v[112:115]
    v_add_u32 v229, 81920, v216
    s_mov_b64 s[50:51], 0xffff
    s_mov_b32 s52, 0
    s_mov_b32 s53, 0xffff
    s_mov_b32 s54, -1
    s_mov_b32 s55, 0xffff0000
    v_lshlrev_b32 v234, 2, v233
    v_mov_b32 v235, 4048155338
    v_add_u32 v10, 0, v234
    v_cmp_gt_u32 vcc, v10, v232
    s_nop 1
    v_cndmask_b32 v208, 0, v235, vcc
    v_cndmask_b32 v212, v235, v104, vcc
    v_add_u32 v10, 1, v234
    v_cmp_gt_u32 vcc, v10, v232
    s_nop 1
    v_cndmask_b32 v209, 0, v235, vcc
    v_cndmask_b32 v213, v235, v104, vcc
    v_add_u32 v10, 2, v234
    v_cmp_gt_u32 vcc, v10, v232
    s_nop 1
    v_cndmask_b32 v210, 0, v235, vcc
    v_cndmask_b32 v214, v235, v104, vcc
    v_add_u32 v10, 3, v234
    v_cmp_gt_u32 vcc, v10, v232
    s_nop 1
    v_cndmask_b32 v211, 0, v235, vcc
    v_cndmask_b32 v215, v235, v104, vcc
    v_lshlrev_b32 v10, 4, v232
    v_lshrrev_b32 v11, 1, v233
    v_lshl_add_u32 v10, v11, 8, v10
    v_add_u32 v10, 8, v10
    s_mov_b32 s26, 131072
    s_cmp_eq_u32 s20, 1
    s_cselect_b32 s26, 0, s26
    s_cmp_eq_u32 s20, 3
    s_cselect_b32 s26, 2048, s26
    v_add_u32 v217, s26, v216
    s_cmp_eq_u32 s20, 2
    s_cselect_b64 vcc, -1, 0
    v_cndmask_b32 v217, v217, v10, vcc
    v_lshrrev_b32 v10, 2, v232
    v_lshlrev_b32 v10, 8, v10
    v_and_b32 v11, 3, v232
    v_lshl_add_u32 v10, v11, 1, v10
    v_add_u32 v218, 3072, v10
    s_lshl_b32 s26, s20, 4
    v_add_u32 v10, s26, v232
    v_mul_u32_u24 v10, 1280, v10
    v_lshl_add_u32 v219, v233, 3, v10
    s_mul_i32 s34, s21, 40
    s_add_u32 s34, s34, 167882752
    s_mov_b32 s32, 1051011932
    s_mov_b32 s33, 167874560
    s_mov_b32 s30, 81920
    s_lshr_b32 s31, s20, 1
    s_add_u32 s31, s31, 4
    s_mov_b32 s36, 0
    s_waitcnt lgkmcnt(0)
B_loop_313:
    s_waitcnt vmcnt(0)
    s_barrier
    ds_read_b128 v[8:11], v92 offset:0
    ds_read_b128 v[12:15], v92 offset:20480
    ds_read_b128 v[16:19], v93 offset:0
    ds_read_b128 v[20:23], v93 offset:20480
    s_cmp_eq_u32 s36, 0
    s_cbranch_scc1 B_s0_314
    s_cmp_lg_u32 s20, 0
    s_cbranch_scc1 al_315
    v_mov_b32 v232, 1
    v_mov_b32 v233, 0
    v_mov_b32 v234, 4096
    s_mov_b64 exec, 1
    buffer_atomic_add v232, v233, s[4:7], s33 offen sc0 sc1
    s_waitcnt vmcnt(0)
    v_cmp_eq_u32 vcc, 31, v232
    s_cbranch_vccz al_315_x
    buffer_store_dword v232, v234, s[4:7], s33 offen sc0 sc1
al_315_x:
    s_mov_b64 exec, -1
al_315:
    s_add_u32 s33, s33, 128
B_s0_314:
    s_add_u32 s23, s23, 40960
    s_cmp_eq_u32 s20, 3
    s_cbranch_scc1 B_g3_316
    s_add_u32 m0, s25, 40960
    ds_read_b128 v[24:27], v92 offset:1024
    ds_read_b128 v[28:31], v92 offset:21504
    s_waitcnt lgkmcnt(4)
    v_mfma_f32_16x16x32_bf16 v[32:35], a[0:3], v[8:11], 0
    buffer_load_dwordx4 v2, s[12:15], s23 offen offset:0 lds
    v_mfma_f32_16x16x32_bf16 v[36:39], a[0:3], v[12:15], 0
    s_add_u32 m0, s25, 41856
    ds_read_b128 v[8:11], v93 offset:1024
    ds_read_b128 v[12:15], v93 offset:21504
    s_waitcnt lgkmcnt(4)
    v_mfma_f32_16x16x32_bf16 v[32:35], a[4:7], v[16:19], v[32:35]
    buffer_load_dwordx4 v2, s[12:15], s23 offen offset:128 lds
    v_mfma_f32_16x16x32_bf16 v[36:39], a[4:7], v[20:23], v[36:39]
    s_add_u32 m0, s25, 42752
    ds_read_b128 v[16:19], v92 offset:2048
    ds_read_b128 v[20:23], v92 offset:22528
    s_waitcnt lgkmcnt(4)
    v_mfma_f32_16x16x32_bf16 v[32:35], a[8:11], v[24:27], v[32:35]
    buffer_load_dwordx4 v2, s[12:15], s23 offen offset:256 lds
    v_mfma_f32_16x16x32_bf16 v[36:39], a[8:11], v[28:31], v[36:39]
    s_add_u32 m0, s25, 43648
    ds_read_b128 v[24:27], v93 offset:2048
    ds_read_b128 v[28:31], v93 offset:22528
    s_waitcnt lgkmcnt(4)
    v_mfma_f32_16x16x32_bf16 v[32:35], a[12:15], v[8:11], v[32:35]
    buffer_load_dwordx4 v2, s[12:15], s23 offen offset:384 lds
    v_mfma_f32_16x16x32_bf16 v[36:39], a[12:15], v[12:15], v[36:39]
    s_add_u32 m0, s25, 44544
    ds_read_b128 v[8:11], v92 offset:3072
    ds_read_b128 v[12:15], v92 offset:23552
    s_waitcnt lgkmcnt(4)
    v_mfma_f32_16x16x32_bf16 v[32:35], a[16:19], v[16:19], v[32:35]
    buffer_load_dwordx4 v2, s[12:15], s23 offen offset:512 lds
    v_mfma_f32_16x16x32_bf16 v[36:39], a[16:19], v[20:23], v[36:39]
    s_add_u32 m0, s25, 45440
    ds_read_b128 v[16:19], v93 offset:3072
    ds_read_b128 v[20:23], v93 offset:23552
    s_waitcnt lgkmcnt(4)
    v_mfma_f32_16x16x32_bf16 v[32:35], a[20:23], v[24:27], v[32:35]
    buffer_load_dwordx4 v2, s[12:15], s23 offen offset:640 lds
    v_mfma_f32_16x16x32_bf16 v[36:39], a[20:23], v[28:31], v[36:39]
    s_add_u32 m0, s25, 46336
    ds_read_b128 v[24:27], v92 offset:4096
    ds_read_b128 v[28:31], v92 offset:24576
    s_waitcnt lgkmcnt(4)
    v_mfma_f32_16x16x32_bf16 v[32:35], a[24:27], v[8:11], v[32:35]
    buffer_load_dwordx4 v2, s[12:15], s23 offen offset:768 lds
    v_mfma_f32_16x16x32_bf16 v[36:39], a[24:27], v[12:15], v[36:39]
    s_add_u32 m0, s25, 47232
    ds_read_b128 v[8:11], v93 offset:4096
    ds_read_b128 v[12:15], v93 offset:24576
    s_waitcnt lgkmcnt(4)
    v_mfma_f32_16x16x32_bf16 v[32:35], a[28:31], v[16:19], v[32:35]
    buffer_load_dwordx4 v2, s[12:15], s23 offen offset:896 lds
    v_mfma_f32_16x16x32_bf16 v[36:39], a[28:31], v[20:23], v[36:39]
    s_add_u32 m0, s25, 48128
    ds_read_b128 v[16:19], v92 offset:5120
    ds_read_b128 v[20:23], v92 offset:25600
    s_waitcnt lgkmcnt(4)
    v_mfma_f32_16x16x32_bf16 v[32:35], a[32:35], v[24:27], v[32:35]
    buffer_load_dwordx4 v2, s[12:15], s23 offen offset:1024 lds
    v_mfma_f32_16x16x32_bf16 v[36:39], a[32:35], v[28:31], v[36:39]
    s_add_u32 m0, s25, 49024
    ds_read_b128 v[24:27], v93 offset:5120
    ds_read_b128 v[28:31], v93 offset:25600
    s_waitcnt lgkmcnt(4)
    v_mfma_f32_16x16x32_bf16 v[32:35], a[36:39], v[8:11], v[32:35]
    buffer_load_dwordx4 v2, s[12:15], s23 offen offset:1152 lds
    v_mfma_f32_16x16x32_bf16 v[36:39], a[36:39], v[12:15], v[36:39]
    ds_read_b128 v[8:11], v92 offset:6144
    ds_read_b128 v[12:15], v92 offset:26624
    s_waitcnt lgkmcnt(4)
    v_mfma_f32_16x16x32_bf16 v[32:35], a[40:43], v[16:19], v[32:35]
    v_mfma_f32_16x16x32_bf16 v[36:39], a[40:43], v[20:23], v[36:39]
    ds_read_b128 v[16:19], v93 offset:6144
    ds_read_b128 v[20:23], v93 offset:26624
    s_waitcnt lgkmcnt(4)
    v_mfma_f32_16x16x32_bf16 v[32:35], a[44:47], v[24:27], v[32:35]
    s_mov_b64 exec, 0xffff
    buffer_load_dword v97, v96, s[12:15], s23 offen
    s_mov_b64 exec, -1
    v_mfma_f32_16x16x32_bf16 v[36:39], a[44:47], v[28:31], v[36:39]
    ds_read_b128 v[24:27], v92 offset:7168
    ds_read_b128 v[28:31], v92 offset:27648
    s_waitcnt lgkmcnt(4)
    v_mfma_f32_16x16x32_bf16 v[32:35], a[48:51], v[8:11], v[32:35]
    v_mfma_f32_16x16x32_bf16 v[36:39], a[48:51], v[12:15], v[36:39]
    ds_read_b128 v[8:11], v93 offset:7168
    ds_read_b128 v[12:15], v93 offset:27648
    s_waitcnt lgkmcnt(4)
    v_mfma_f32_16x16x32_bf16 v[32:35], a[52:55], v[16:19], v[32:35]
    v_mfma_f32_16x16x32_bf16 v[36:39], a[52:55], v[20:23], v[36:39]
    ds_read_b128 v[16:19], v92 offset:8192
    ds_read_b128 v[20:23], v92 offset:28672
    s_waitcnt lgkmcnt(4)
    v_mfma_f32_16x16x32_bf16 v[32:35], a[56:59], v[24:27], v[32:35]
    v_mfma_f32_16x16x32_bf16 v[36:39], a[56:59], v[28:31], v[36:39]
    ds_read_b128 v[24:27], v93 offset:8192
    ds_read_b128 v[28:31], v93 offset:28672
    s_waitcnt lgkmcnt(4)
    v_mfma_f32_16x16x32_bf16 v[32:35], a[60:63], v[8:11], v[32:35]
    v_mfma_f32_16x16x32_bf16 v[36:39], a[60:63], v[12:15], v[36:39]
    ds_read_b128 v[8:11], v92 offset:9216
    ds_read_b128 v[12:15], v92 offset:29696
    s_waitcnt lgkmcnt(4)
    v_mfma_f32_16x16x32_bf16 v[32:35], a[64:67], v[16:19], v[32:35]
    v_mfma_f32_16x16x32_bf16 v[36:39], a[64:67], v[20:23], v[36:39]
    ds_read_b128 v[16:19], v93 offset:9216
    ds_read_b128 v[20:23], v93 offset:29696
    s_waitcnt lgkmcnt(4)
    v_mfma_f32_16x16x32_bf16 v[32:35], a[68:71], v[24:27], v[32:35]
    v_mfma_f32_16x16x32_bf16 v[36:39], a[68:71], v[28:31], v[36:39]
    s_waitcnt lgkmcnt(2)
    v_mfma_f32_16x16x32_bf16 v[32:35], a[72:75], v[8:11], v[32:35]
    v_mfma_f32_16x16x32_bf16 v[36:39], a[72:75], v[12:15], v[36:39]
    s_waitcnt lgkmcnt(0)
    v_mfma_f32_16x16x32_bf16 v[32:35], a[76:79], v[16:19], v[32:35]
    v_mfma_f32_16x16x32_bf16 v[36:39], a[76:79], v[20:23], v[36:39]
    s_nop 5
    s_cmp_eq_u32 s20, 2
    s_cbranch_scc1 B_e2_317
    s_cmp_eq_u32 s20, 1
    s_cbranch_scc1 B_e1_318
    v_cvt_pk_bf16_f32 v232, v32, v33
    v_cvt_pk_bf16_f32 v233, v34, v35
    v_cvt_pk_bf16_f32 v234, v36, v37
    v_cvt_pk_bf16_f32 v235, v38, v39
    ds_write_b64 v217, v[232:233] offset:0
    ds_write_b64 v217, v[234:235] offset:1024
    s_branch B_ee_319
B_e1_318:
    v_cvt_pk_bf16_f32 v232, v32, v33
    v_cvt_pk_bf16_f32 v233, v34, v35
    v_cvt_pk_bf16_f32 v234, v36, v37
    v_cvt_pk_bf16_f32 v235, v38, v39
    v_add_u32 v236, s30, v217
    ds_write_b64 v236, v[232:233] offset:0
    ds_write_b64 v236, v[234:235] offset:1024
    s_branch B_ee_319
B_e2_317:
    v_cvt_pk_bf16_f32 v232, v32, v33
    v_cvt_pk_bf16_f32 v233, v34, v35
    v_cvt_pk_bf16_f32 v234, v36, v37
    v_cvt_pk_bf16_f32 v235, v38, v39
    v_mov_b32 v236, s30
    v_mov_b32 v237, 131072
    v_cndmask_b32 v237, v236, v237, s[50:51]
    v_add_u32 v237, v237, v217
    v_add_u32 v236, v236, v218
    s_mov_b64 exec, s[54:55]
    ds_write_b64 v237, v[232:233] offset:0
    ds_write_b64 v237, v[234:235] offset:1024
    s_mov_b64 exec, s[52:53]
    ds_write_b16 v236, v232 offset:0
    ds_write_b16_d16_hi v236, v232 offset:16
    ds_write_b16 v236, v233 offset:32
    ds_write_b16_d16_hi v236, v233 offset:48
    ds_write_b16 v236, v234 offset:8
    ds_write_b16_d16_hi v236, v234 offset:24
    ds_write_b16 v236, v235 offset:40
    ds_write_b16_d16_hi v236, v235 offset:56
    s_mov_b64 exec, -1
    s_branch B_ee_319
B_g3_316:
    s_add_u32 m0, s25, 40960
    ds_read_b128 v[24:27], v92 offset:1024
    ds_read_b128 v[28:31], v92 offset:21504
    s_waitcnt lgkmcnt(4)
    v_mfma_f32_16x16x32_bf16 v[32:35], v[8:11], a[0:3], 0
    buffer_load_dwordx4 v2, s[12:15], s23 offen offset:0 lds
    v_mfma_f32_16x16x32_bf16 v[36:39], v[12:15], a[0:3], 0
    s_add_u32 m0, s25, 41856
    ds_read_b128 v[8:11], v93 offset:1024
    ds_read_b128 v[12:15], v93 offset:21504
    s_waitcnt lgkmcnt(4)
    v_mfma_f32_16x16x32_bf16 v[32:35], v[16:19], a[4:7], v[32:35]
    buffer_load_dwordx4 v2, s[12:15], s23 offen offset:128 lds
    v_mfma_f32_16x16x32_bf16 v[36:39], v[20:23], a[4:7], v[36:39]
    s_add_u32 m0, s25, 42752
    ds_read_b128 v[16:19], v92 offset:2048
    ds_read_b128 v[20:23], v92 offset:22528
    s_waitcnt lgkmcnt(4)
    v_mfma_f32_16x16x32_bf16 v[32:35], v[24:27], a[8:11], v[32:35]
    buffer_load_dwordx4 v2, s[12:15], s23 offen offset:256 lds
    v_mfma_f32_16x16x32_bf16 v[36:39], v[28:31], a[8:11], v[36:39]
    s_add_u32 m0, s25, 43648
    ds_read_b128 v[24:27], v93 offset:2048
    ds_read_b128 v[28:31], v93 offset:22528
    s_waitcnt lgkmcnt(4)
    v_mfma_f32_16x16x32_bf16 v[32:35], v[8:11], a[12:15], v[32:35]
    buffer_load_dwordx4 v2, s[12:15], s23 offen offset:384 lds
    v_mfma_f32_16x16x32_bf16 v[36:39], v[12:15], a[12:15], v[36:39]
    s_add_u32 m0, s25, 44544
    ds_read_b128 v[8:11], v92 offset:3072
    ds_read_b128 v[12:15], v92 offset:23552
    s_waitcnt lgkmcnt(4)
    v_mfma_f32_16x16x32_bf16 v[32:35], v[16:19], a[16:19], v[32:35]
    buffer_load_dwordx4 v2, s[12:15], s23 offen offset:512 lds
    v_mfma_f32_16x16x32_bf16 v[36:39], v[20:23], a[16:19], v[36:39]
    s_add_u32 m0, s25, 45440
    ds_read_b128 v[16:19], v93 offset:3072
    ds_read_b128 v[20:23], v93 offset:23552
    s_waitcnt lgkmcnt(4)
    v_mfma_f32_16x16x32_bf16 v[32:35], v[24:27], a[20:23], v[32:35]
    buffer_load_dwordx4 v2, s[12:15], s23 offen offset:640 lds
    v_mfma_f32_16x16x32_bf16 v[36:39], v[28:31], a[20:23], v[36:39]
    s_add_u32 m0, s25, 46336
    ds_read_b128 v[24:27], v92 offset:4096
    ds_read_b128 v[28:31], v92 offset:24576
    s_waitcnt lgkmcnt(4)
    v_mfma_f32_16x16x32_bf16 v[32:35], v[8:11], a[24:27], v[32:35]
    buffer_load_dwordx4 v2, s[12:15], s23 offen offset:768 lds
    v_mfma_f32_16x16x32_bf16 v[36:39], v[12:15], a[24:27], v[36:39]
    s_add_u32 m0, s25, 47232
    ds_read_b128 v[8:11], v93 offset:4096
    ds_read_b128 v[12:15], v93 offset:24576
    s_waitcnt lgkmcnt(4)
    v_mfma_f32_16x16x32_bf16 v[32:35], v[16:19], a[28:31], v[32:35]
    buffer_load_dwordx4 v2, s[12:15], s23 offen offset:896 lds
    v_mfma_f32_16x16x32_bf16 v[36:39], v[20:23], a[28:31], v[36:39]
    s_add_u32 m0, s25, 48128
    ds_read_b128 v[16:19], v92 offset:5120
    ds_read_b128 v[20:23], v92 offset:25600
    s_waitcnt lgkmcnt(4)
    v_mfma_f32_16x16x32_bf16 v[32:35], v[24:27], a[32:35], v[32:35]
    buffer_load_dwordx4 v2, s[12:15], s23 offen offset:1024 lds
    v_mfma_f32_16x16x32_bf16 v[36:39], v[28:31], a[32:35], v[36:39]
    s_add_u32 m0, s25, 49024
    ds_read_b128 v[24:27], v93 offset:5120
    ds_read_b128 v[28:31], v93 offset:25600
    s_waitcnt lgkmcnt(4)
    v_mfma_f32_16x16x32_bf16 v[32:35], v[8:11], a[36:39], v[32:35]
    buffer_load_dwordx4 v2, s[12:15], s23 offen offset:1152 lds
    v_mfma_f32_16x16x32_bf16 v[36:39], v[12:15], a[36:39], v[36:39]
    ds_read_b128 v[8:11], v92 offset:6144
    ds_read_b128 v[12:15], v92 offset:26624
    s_waitcnt lgkmcnt(4)
    v_mfma_f32_16x16x32_bf16 v[32:35], v[16:19], a[40:43], v[32:35]
    v_mfma_f32_16x16x32_bf16 v[36:39], v[20:23], a[40:43], v[36:39]
    ds_read_b128 v[16:19], v93 offset:6144
    ds_read_b128 v[20:23], v93 offset:26624
    s_waitcnt lgkmcnt(4)
    v_mfma_f32_16x16x32_bf16 v[32:35], v[24:27], a[44:47], v[32:35]
    s_mov_b64 exec, 0xffff
    buffer_load_dword v97, v96, s[12:15], s23 offen
    s_mov_b64 exec, -1
    v_mfma_f32_16x16x32_bf16 v[36:39], v[28:31], a[44:47], v[36:39]
    ds_read_b128 v[24:27], v92 offset:7168
    ds_read_b128 v[28:31], v92 offset:27648
    s_waitcnt lgkmcnt(4)
    v_mfma_f32_16x16x32_bf16 v[32:35], v[8:11], a[48:51], v[32:35]
    v_mfma_f32_16x16x32_bf16 v[36:39], v[12:15], a[48:51], v[36:39]
    ds_read_b128 v[8:11], v93 offset:7168
    ds_read_b128 v[12:15], v93 offset:27648
    s_waitcnt lgkmcnt(4)
    v_mfma_f32_16x16x32_bf16 v[32:35], v[16:19], a[52:55], v[32:35]
    v_mfma_f32_16x16x32_bf16 v[36:39], v[20:23], a[52:55], v[36:39]
    ds_read_b128 v[16:19], v92 offset:8192
    ds_read_b128 v[20:23], v92 offset:28672
    s_waitcnt lgkmcnt(4)
    v_mfma_f32_16x16x32_bf16 v[32:35], v[24:27], a[56:59], v[32:35]
    v_mfma_f32_16x16x32_bf16 v[36:39], v[28:31], a[56:59], v[36:39]
    ds_read_b128 v[24:27], v93 offset:8192
    ds_read_b128 v[28:31], v93 offset:28672
    s_waitcnt lgkmcnt(4)
    v_mfma_f32_16x16x32_bf16 v[32:35], v[8:11], a[60:63], v[32:35]
    v_mfma_f32_16x16x32_bf16 v[36:39], v[12:15], a[60:63], v[36:39]
    ds_read_b128 v[8:11], v92 offset:9216
    ds_read_b128 v[12:15], v92 offset:29696
    s_waitcnt lgkmcnt(4)
    v_mfma_f32_16x16x32_bf16 v[32:35], v[16:19], a[64:67], v[32:35]
    v_mfma_f32_16x16x32_bf16 v[36:39], v[20:23], a[64:67], v[36:39]
    ds_read_b128 v[16:19], v93 offset:9216
    ds_read_b128 v[20:23], v93 offset:29696
    s_waitcnt lgkmcnt(4)
    v_mfma_f32_16x16x32_bf16 v[32:35], v[24:27], a[68:71], v[32:35]
    v_mfma_f32_16x16x32_bf16 v[36:39], v[28:31], a[68:71], v[36:39]
    s_waitcnt lgkmcnt(2)
    v_mfma_f32_16x16x32_bf16 v[32:35], v[8:11], a[72:75], v[32:35]
    v_mfma_f32_16x16x32_bf16 v[36:39], v[12:15], a[72:75], v[36:39]
    s_waitcnt lgkmcnt(0)
    v_mfma_f32_16x16x32_bf16 v[32:35], v[16:19], a[76:79], v[32:35]
    v_mfma_f32_16x16x32_bf16 v[36:39], v[20:23], a[76:79], v[36:39]
    s_nop 7
    v_cvt_pk_bf16_f32 v232, v32, v33
    v_cvt_pk_bf16_f32 v233, v34, v35
    v_cvt_pk_bf16_f32 v234, v36, v37
    v_cvt_pk_bf16_f32 v235, v38, v39
    v_add_u32 v236, s30, v217
    ds_write_b64 v236, v[232:233] offset:0
    ds_write_b64 v236, v[234:235] offset:8
B_ee_319:
    s_add_u32 s30, s30, 4096
    s_waitcnt vmcnt(1)
    s_barrier
    ds_read_b128 v[8:11], v94 offset:0
    ds_read_b128 v[12:15], v94 offset:20480
    ds_read_b128 v[16:19], v95 offset:0
    ds_read_b128 v[20:23], v95 offset:20480
    s_add_u32 s23, s23, 40960
    s_cmp_eq_u32 s20, 3
    s_cbranch_scc1 B_g3_320
    s_add_u32 m0, s25, 0
    ds_read_b128 v[24:27], v94 offset:1024
    ds_read_b128 v[28:31], v94 offset:21504
    s_waitcnt lgkmcnt(4)
    v_mfma_f32_16x16x32_bf16 v[32:35], a[0:3], v[8:11], 0
    buffer_load_dwordx4 v2, s[12:15], s23 offen offset:0 lds
    v_mfma_f32_16x16x32_bf16 v[36:39], a[0:3], v[12:15], 0
    s_add_u32 m0, s25, 896
    ds_read_b128 v[8:11], v95 offset:1024
    ds_read_b128 v[12:15], v95 offset:21504
    s_waitcnt lgkmcnt(4)
    v_mfma_f32_16x16x32_bf16 v[32:35], a[4:7], v[16:19], v[32:35]
    buffer_load_dwordx4 v2, s[12:15], s23 offen offset:128 lds
    v_mfma_f32_16x16x32_bf16 v[36:39], a[4:7], v[20:23], v[36:39]
    s_add_u32 m0, s25, 1792
    ds_read_b128 v[16:19], v94 offset:2048
    ds_read_b128 v[20:23], v94 offset:22528
    s_waitcnt lgkmcnt(4)
    v_mfma_f32_16x16x32_bf16 v[32:35], a[8:11], v[24:27], v[32:35]
    buffer_load_dwordx4 v2, s[12:15], s23 offen offset:256 lds
    v_mfma_f32_16x16x32_bf16 v[36:39], a[8:11], v[28:31], v[36:39]
    s_add_u32 m0, s25, 2688
    ds_read_b128 v[24:27], v95 offset:2048
    ds_read_b128 v[28:31], v95 offset:22528
    s_waitcnt lgkmcnt(4)
    v_mfma_f32_16x16x32_bf16 v[32:35], a[12:15], v[8:11], v[32:35]
    buffer_load_dwordx4 v2, s[12:15], s23 offen offset:384 lds
    v_mfma_f32_16x16x32_bf16 v[36:39], a[12:15], v[12:15], v[36:39]
    s_add_u32 m0, s25, 3584
    ds_read_b128 v[8:11], v94 offset:3072
    ds_read_b128 v[12:15], v94 offset:23552
    s_waitcnt lgkmcnt(4)
    v_mfma_f32_16x16x32_bf16 v[32:35], a[16:19], v[16:19], v[32:35]
    buffer_load_dwordx4 v2, s[12:15], s23 offen offset:512 lds
    v_mfma_f32_16x16x32_bf16 v[36:39], a[16:19], v[20:23], v[36:39]
    s_add_u32 m0, s25, 4480
    ds_read_b128 v[16:19], v95 offset:3072
    ds_read_b128 v[20:23], v95 offset:23552
    s_waitcnt lgkmcnt(4)
    v_mfma_f32_16x16x32_bf16 v[32:35], a[20:23], v[24:27], v[32:35]
    buffer_load_dwordx4 v2, s[12:15], s23 offen offset:640 lds
    v_mfma_f32_16x16x32_bf16 v[36:39], a[20:23], v[28:31], v[36:39]
    s_add_u32 m0, s25, 5376
    ds_read_b128 v[24:27], v94 offset:4096
    ds_read_b128 v[28:31], v94 offset:24576
    s_waitcnt lgkmcnt(4)
    v_mfma_f32_16x16x32_bf16 v[32:35], a[24:27], v[8:11], v[32:35]
    buffer_load_dwordx4 v2, s[12:15], s23 offen offset:768 lds
    v_mfma_f32_16x16x32_bf16 v[36:39], a[24:27], v[12:15], v[36:39]
    s_add_u32 m0, s25, 6272
    ds_read_b128 v[8:11], v95 offset:4096
    ds_read_b128 v[12:15], v95 offset:24576
    s_waitcnt lgkmcnt(4)
    v_mfma_f32_16x16x32_bf16 v[32:35], a[28:31], v[16:19], v[32:35]
    buffer_load_dwordx4 v2, s[12:15], s23 offen offset:896 lds
    v_mfma_f32_16x16x32_bf16 v[36:39], a[28:31], v[20:23], v[36:39]
    s_add_u32 m0, s25, 7168
    ds_read_b128 v[16:19], v94 offset:5120
    ds_read_b128 v[20:23], v94 offset:25600
    s_waitcnt lgkmcnt(4)
    v_mfma_f32_16x16x32_bf16 v[32:35], a[32:35], v[24:27], v[32:35]
    buffer_load_dwordx4 v2, s[12:15], s23 offen offset:1024 lds
    v_mfma_f32_16x16x32_bf16 v[36:39], a[32:35], v[28:31], v[36:39]
    s_add_u32 m0, s25, 8064
    ds_read_b128 v[24:27], v95 offset:5120
    ds_read_b128 v[28:31], v95 offset:25600
    s_waitcnt lgkmcnt(4)
    v_mfma_f32_16x16x32_bf16 v[32:35], a[36:39], v[8:11], v[32:35]
    buffer_load_dwordx4 v2, s[12:15], s23 offen offset:1152 lds
    v_mfma_f32_16x16x32_bf16 v[36:39], a[36:39], v[12:15], v[36:39]
    ds_read_b128 v[8:11], v94 offset:6144
    ds_read_b128 v[12:15], v94 offset:26624
    s_waitcnt lgkmcnt(4)
    v_mfma_f32_16x16x32_bf16 v[32:35], a[40:43], v[16:19], v[32:35]
    v_mfma_f32_16x16x32_bf16 v[36:39], a[40:43], v[20:23], v[36:39]
    ds_read_b128 v[16:19], v95 offset:6144
    ds_read_b128 v[20:23], v95 offset:26624
    s_waitcnt lgkmcnt(4)
    v_mfma_f32_16x16x32_bf16 v[32:35], a[44:47], v[24:27], v[32:35]
    s_mov_b64 exec, 0xffff
    buffer_load_dword v97, v96, s[12:15], s23 offen
    s_mov_b64 exec, -1
    v_mfma_f32_16x16x32_bf16 v[36:39], a[44:47], v[28:31], v[36:39]
    ds_read_b128 v[24:27], v94 offset:7168
    ds_read_b128 v[28:31], v94 offset:27648
    s_waitcnt lgkmcnt(4)
    v_mfma_f32_16x16x32_bf16 v[32:35], a[48:51], v[8:11], v[32:35]
    v_mfma_f32_16x16x32_bf16 v[36:39], a[48:51], v[12:15], v[36:39]
    ds_read_b128 v[8:11], v95 offset:7168
    ds_read_b128 v[12:15], v95 offset:27648
    s_waitcnt lgkmcnt(4)
    v_mfma_f32_16x16x32_bf16 v[32:35], a[52:55], v[16:19], v[32:35]
    v_mfma_f32_16x16x32_bf16 v[36:39], a[52:55], v[20:23], v[36:39]
    ds_read_b128 v[16:19], v94 offset:8192
    ds_read_b128 v[20:23], v94 offset:28672
    s_waitcnt lgkmcnt(4)
    v_mfma_f32_16x16x32_bf16 v[32:35], a[56:59], v[24:27], v[32:35]
    v_mfma_f32_16x16x32_bf16 v[36:39], a[56:59], v[28:31], v[36:39]
    ds_read_b128 v[24:27], v95 offset:8192
    ds_read_b128 v[28:31], v95 offset:28672
    s_waitcnt lgkmcnt(4)
    v_mfma_f32_16x16x32_bf16 v[32:35], a[60:63], v[8:11], v[32:35]
    v_mfma_f32_16x16x32_bf16 v[36:39], a[60:63], v[12:15], v[36:39]
    ds_read_b128 v[8:11], v94 offset:9216
    ds_read_b128 v[12:15], v94 offset:29696
    s_waitcnt lgkmcnt(4)
    v_mfma_f32_16x16x32_bf16 v[32:35], a[64:67], v[16:19], v[32:35]
    v_mfma_f32_16x16x32_bf16 v[36:39], a[64:67], v[20:23], v[36:39]
    ds_read_b128 v[16:19], v95 offset:9216
    ds_read_b128 v[20:23], v95 offset:29696
    s_waitcnt lgkmcnt(4)
    v_mfma_f32_16x16x32_bf16 v[32:35], a[68:71], v[24:27], v[32:35]
    v_mfma_f32_16x16x32_bf16 v[36:39], a[68:71], v[28:31], v[36:39]
    s_waitcnt lgkmcnt(2)
    v_mfma_f32_16x16x32_bf16 v[32:35], a[72:75], v[8:11], v[32:35]
    v_mfma_f32_16x16x32_bf16 v[36:39], a[72:75], v[12:15], v[36:39]
    s_waitcnt lgkmcnt(0)
    v_mfma_f32_16x16x32_bf16 v[32:35], a[76:79], v[16:19], v[32:35]
    v_mfma_f32_16x16x32_bf16 v[36:39], a[76:79], v[20:23], v[36:39]
    s_nop 5
    s_cmp_eq_u32 s20, 2
    s_cbranch_scc1 B_e2_321
    s_cmp_eq_u32 s20, 1
    s_cbranch_scc1 B_e1_322
    v_cvt_pk_bf16_f32 v232, v32, v33
    v_cvt_pk_bf16_f32 v233, v34, v35
    v_cvt_pk_bf16_f32 v234, v36, v37
    v_cvt_pk_bf16_f32 v235, v38, v39
    ds_write_b64 v217, v[232:233] offset:2048
    ds_write_b64 v217, v[234:235] offset:3072
    s_branch B_ee_323
B_e1_322:
    v_cvt_pk_bf16_f32 v232, v32, v33
    v_cvt_pk_bf16_f32 v233, v34, v35
    v_cvt_pk_bf16_f32 v234, v36, v37
    v_cvt_pk_bf16_f32 v235, v38, v39
    v_add_u32 v236, s30, v217
    ds_write_b64 v236, v[232:233] offset:0
    ds_write_b64 v236, v[234:235] offset:1024
    s_branch B_ee_323
B_e2_321:
    v_cvt_pk_bf16_f32 v232, v32, v33
    v_cvt_pk_bf16_f32 v233, v34, v35
    v_cvt_pk_bf16_f32 v234, v36, v37
    v_cvt_pk_bf16_f32 v235, v38, v39
    v_mov_b32 v236, s30
    v_mov_b32 v237, 133120
    v_cndmask_b32 v237, v236, v237, s[50:51]
    v_add_u32 v237, v237, v217
    v_add_u32 v236, v236, v218
    s_mov_b64 exec, s[54:55]
    ds_write_b64 v237, v[232:233] offset:0
    ds_write_b64 v237, v[234:235] offset:1024
    s_mov_b64 exec, s[52:53]
    ds_write_b16 v236, v232 offset:0
    ds_write_b16_d16_hi v236, v232 offset:16
    ds_write_b16 v236, v233 offset:32
    ds_write_b16_d16_hi v236, v233 offset:48
    ds_write_b16 v236, v234 offset:8
    ds_write_b16_d16_hi v236, v234 offset:24
    ds_write_b16 v236, v235 offset:40
    ds_write_b16_d16_hi v236, v235 offset:56
    s_mov_b64 exec, -1
    s_branch B_ee_323
B_g3_320:
    s_add_u32 m0, s25, 0
    ds_read_b128 v[24:27], v94 offset:1024
    ds_read_b128 v[28:31], v94 offset:21504
    s_waitcnt lgkmcnt(4)
    v_mfma_f32_16x16x32_bf16 v[32:35], v[8:11], a[0:3], 0
    buffer_load_dwordx4 v2, s[12:15], s23 offen offset:0 lds
    v_mfma_f32_16x16x32_bf16 v[36:39], v[12:15], a[0:3], 0
    s_add_u32 m0, s25, 896
    ds_read_b128 v[8:11], v95 offset:1024
    ds_read_b128 v[12:15], v95 offset:21504
    s_waitcnt lgkmcnt(4)
    v_mfma_f32_16x16x32_bf16 v[32:35], v[16:19], a[4:7], v[32:35]
    buffer_load_dwordx4 v2, s[12:15], s23 offen offset:128 lds
    v_mfma_f32_16x16x32_bf16 v[36:39], v[20:23], a[4:7], v[36:39]
    s_add_u32 m0, s25, 1792
    ds_read_b128 v[16:19], v94 offset:2048
    ds_read_b128 v[20:23], v94 offset:22528
    s_waitcnt lgkmcnt(4)
    v_mfma_f32_16x16x32_bf16 v[32:35], v[24:27], a[8:11], v[32:35]
    buffer_load_dwordx4 v2, s[12:15], s23 offen offset:256 lds
    v_mfma_f32_16x16x32_bf16 v[36:39], v[28:31], a[8:11], v[36:39]
    s_add_u32 m0, s25, 2688
    ds_read_b128 v[24:27], v95 offset:2048
    ds_read_b128 v[28:31], v95 offset:22528
    s_waitcnt lgkmcnt(4)
    v_mfma_f32_16x16x32_bf16 v[32:35], v[8:11], a[12:15], v[32:35]
    buffer_load_dwordx4 v2, s[12:15], s23 offen offset:384 lds
    v_mfma_f32_16x16x32_bf16 v[36:39], v[12:15], a[12:15], v[36:39]
    s_add_u32 m0, s25, 3584
    ds_read_b128 v[8:11], v94 offset:3072
    ds_read_b128 v[12:15], v94 offset:23552
    s_waitcnt lgkmcnt(4)
    v_mfma_f32_16x16x32_bf16 v[32:35], v[16:19], a[16:19], v[32:35]
    buffer_load_dwordx4 v2, s[12:15], s23 offen offset:512 lds
    v_mfma_f32_16x16x32_bf16 v[36:39], v[20:23], a[16:19], v[36:39]
    s_add_u32 m0, s25, 4480
    ds_read_b128 v[16:19], v95 offset:3072
    ds_read_b128 v[20:23], v95 offset:23552
    s_waitcnt lgkmcnt(4)
    v_mfma_f32_16x16x32_bf16 v[32:35], v[24:27], a[20:23], v[32:35]
    buffer_load_dwordx4 v2, s[12:15], s23 offen offset:640 lds
    v_mfma_f32_16x16x32_bf16 v[36:39], v[28:31], a[20:23], v[36:39]
    s_add_u32 m0, s25, 5376
    ds_read_b128 v[24:27], v94 offset:4096
    ds_read_b128 v[28:31], v94 offset:24576
    s_waitcnt lgkmcnt(4)
    v_mfma_f32_16x16x32_bf16 v[32:35], v[8:11], a[24:27], v[32:35]
    buffer_load_dwordx4 v2, s[12:15], s23 offen offset:768 lds
    v_mfma_f32_16x16x32_bf16 v[36:39], v[12:15], a[24:27], v[36:39]
    s_add_u32 m0, s25, 6272
    ds_read_b128 v[8:11], v95 offset:4096
    ds_read_b128 v[12:15], v95 offset:24576
    s_waitcnt lgkmcnt(4)
    v_mfma_f32_16x16x32_bf16 v[32:35], v[16:19], a[28:31], v[32:35]
    buffer_load_dwordx4 v2, s[12:15], s23 offen offset:896 lds
    v_mfma_f32_16x16x32_bf16 v[36:39], v[20:23], a[28:31], v[36:39]
    s_add_u32 m0, s25, 7168
    ds_read_b128 v[16:19], v94 offset:5120
    ds_read_b128 v[20:23], v94 offset:25600
    s_waitcnt lgkmcnt(4)
    v_mfma_f32_16x16x32_bf16 v[32:35], v[24:27], a[32:35], v[32:35]
    buffer_load_dwordx4 v2, s[12:15], s23 offen offset:1024 lds
    v_mfma_f32_16x16x32_bf16 v[36:39], v[28:31], a[32:35], v[36:39]
    s_add_u32 m0, s25, 8064
    ds_read_b128 v[24:27], v95 offset:5120
    ds_read_b128 v[28:31], v95 offset:25600
    s_waitcnt lgkmcnt(4)
    v_mfma_f32_16x16x32_bf16 v[32:35], v[8:11], a[36:39], v[32:35]
    buffer_load_dwordx4 v2, s[12:15], s23 offen offset:1152 lds
    v_mfma_f32_16x16x32_bf16 v[36:39], v[12:15], a[36:39], v[36:39]
    ds_read_b128 v[8:11], v94 offset:6144
    ds_read_b128 v[12:15], v94 offset:26624
    s_waitcnt lgkmcnt(4)
    v_mfma_f32_16x16x32_bf16 v[32:35], v[16:19], a[40:43], v[32:35]
    v_mfma_f32_16x16x32_bf16 v[36:39], v[20:23], a[40:43], v[36:39]
    ds_read_b128 v[16:19], v95 offset:6144
    ds_read_b128 v[20:23], v95 offset:26624
    s_waitcnt lgkmcnt(4)
    v_mfma_f32_16x16x32_bf16 v[32:35], v[24:27], a[44:47], v[32:35]
    s_mov_b64 exec, 0xffff
    buffer_load_dword v97, v96, s[12:15], s23 offen
    s_mov_b64 exec, -1
    v_mfma_f32_16x16x32_bf16 v[36:39], v[28:31], a[44:47], v[36:39]
    ds_read_b128 v[24:27], v94 offset:7168
    ds_read_b128 v[28:31], v94 offset:27648
    s_waitcnt lgkmcnt(4)
    v_mfma_f32_16x16x32_bf16 v[32:35], v[8:11], a[48:51], v[32:35]
    v_mfma_f32_16x16x32_bf16 v[36:39], v[12:15], a[48:51], v[36:39]
    ds_read_b128 v[8:11], v95 offset:7168
    ds_read_b128 v[12:15], v95 offset:27648
    s_waitcnt lgkmcnt(4)
    v_mfma_f32_16x16x32_bf16 v[32:35], v[16:19], a[52:55], v[32:35]
    v_mfma_f32_16x16x32_bf16 v[36:39], v[20:23], a[52:55], v[36:39]
    ds_read_b128 v[16:19], v94 offset:8192
    ds_read_b128 v[20:23], v94 offset:28672
    s_waitcnt lgkmcnt(4)
    v_mfma_f32_16x16x32_bf16 v[32:35], v[24:27], a[56:59], v[32:35]
    v_mfma_f32_16x16x32_bf16 v[36:39], v[28:31], a[56:59], v[36:39]
    ds_read_b128 v[24:27], v95 offset:8192
    ds_read_b128 v[28:31], v95 offset:28672
    s_waitcnt lgkmcnt(4)
    v_mfma_f32_16x16x32_bf16 v[32:35], v[8:11], a[60:63], v[32:35]
    v_mfma_f32_16x16x32_bf16 v[36:39], v[12:15], a[60:63], v[36:39]
    ds_read_b128 v[8:11], v94 offset:9216
    ds_read_b128 v[12:15], v94 offset:29696
    s_waitcnt lgkmcnt(4)
    v_mfma_f32_16x16x32_bf16 v[32:35], v[16:19], a[64:67], v[32:35]
    v_mfma_f32_16x16x32_bf16 v[36:39], v[20:23], a[64:67], v[36:39]
    ds_read_b128 v[16:19], v95 offset:9216
    ds_read_b128 v[20:23], v95 offset:29696
    s_waitcnt lgkmcnt(4)
    v_mfma_f32_16x16x32_bf16 v[32:35], v[24:27], a[68:71], v[32:35]
    v_mfma_f32_16x16x32_bf16 v[36:39], v[28:31], a[68:71], v[36:39]
    s_waitcnt lgkmcnt(2)
    v_mfma_f32_16x16x32_bf16 v[32:35], v[8:11], a[72:75], v[32:35]
    v_mfma_f32_16x16x32_bf16 v[36:39], v[12:15], a[72:75], v[36:39]
    s_waitcnt lgkmcnt(0)
    v_mfma_f32_16x16x32_bf16 v[32:35], v[16:19], a[76:79], v[32:35]
    v_mfma_f32_16x16x32_bf16 v[36:39], v[20:23], a[76:79], v[36:39]
    s_nop 7
    v_cvt_pk_bf16_f32 v232, v32, v33
    v_cvt_pk_bf16_f32 v233, v34, v35
    v_cvt_pk_bf16_f32 v234, v36, v37
    v_cvt_pk_bf16_f32 v235, v38, v39
    v_add_u32 v236, s30, v217
    ds_write_b64 v236, v[232:233] offset:0
    ds_write_b64 v236, v[234:235] offset:8
B_ee_323:
    s_add_u32 s30, s30, 4096
    s_cmp_eq_u32 s30, 131072
    s_cselect_b32 s30, 81920, s30
    s_waitcnt lgkmcnt(0)
    s_barrier
    s_mov_b32 s35, s31
    s_bitcmp1_b32 s20, 0
    s_cbranch_scc1 B_odd_324
    s_lshl_b32 s26, s35, 12
    v_add_u32 v220, s26, v229
    s_add_u32 s35, s35, 1
    s_cmp_eq_u32 s35, 12
    s_cselect_b32 s35, 0, s35
    s_lshl_b32 s26, s35, 12
    v_add_u32 v221, s26, v229
    s_add_u32 s35, s35, 1
    s_cmp_eq_u32 s35, 12
    s_cselect_b32 s35, 0, s35
    s_lshl_b32 s26, s35, 12
    v_add_u32 v222, s26, v229
    s_add_u32 s35, s35, 1
    s_cmp_eq_u32 s35, 12
    s_cselect_b32 s35, 0, s35
    s_lshl_b32 s26, s35, 12
    v_add_u32 v223, s26, v229
    s_add_u32 s35, s35, 1
    s_cmp_eq_u32 s35, 12
    s_cselect_b32 s35, 0, s35
    s_lshl_b32 s26, s35, 12
    v_add_u32 v224, s26, v229
    s_add_u32 s35, s35, 1
    s_cmp_eq_u32 s35, 12
    s_cselect_b32 s35, 0, s35
    s_lshl_b32 s26, s35, 12
    v_add_u32 v225, s26, v229
    s_add_u32 s35, s35, 1
    s_cmp_eq_u32 s35, 12
    s_cselect_b32 s35, 0, s35
    s_lshl_b32 s26, s35, 12
    v_add_u32 v226, s26, v229
    s_add_u32 s35, s35, 1
    s_cmp_eq_u32 s35, 12
    s_cselect_b32 s35, 0, s35
    s_lshl_b32 s26, s35, 12
    v_add_u32 v227, s26, v229
    s_add_u32 s35, s35, 1
    s_cmp_eq_u32 s35, 12
    s_cselect_b32 s35, 0, s35
    s_lshl_b32 s26, s35, 12
    v_add_u32 v228, s26, v229
    s_add_u32 s35, s35, 1
    s_cmp_eq_u32 s35, 12
    s_cselect_b32 s35, 0, s35
    ds_read_b128 v[196:199], v230
    ds_read_b128 v[172:175], v220 offset:0
    ds_read_b128 v[176:179], v220 offset:1024
    ds_read_b128 v[180:183], v221 offset:0
    ds_read_b128 v[184:187], v221 offset:1024
    ds_read_b128 v[188:191], v222 offset:0
    ds_read_b128 v[192:195], v222 offset:1024
    s_waitcnt lgkmcnt(5)
    v_mfma_f32_16x16x32_bf16 v[100:103], v[172:175], v[196:199], v[212:215]
    ds_read_b128 v[172:175], v223 offset:0
    s_waitcnt lgkmcnt(5)
    v_mfma_f32_16x16x32_bf16 v[104:107], v[176:179], v[196:199], 0
    ds_read_b128 v[176:179], v223 offset:1024
    s_waitcnt lgkmcnt(5)
    v_mfma_f32_16x16x32_bf16 v[108:111], v[180:183], v[196:199], 0
    ds_read_b128 v[180:183], v224 offset:0
    s_waitcnt lgkmcnt(5)
    v_mfma_f32_16x16x32_bf16 v[112:115], v[184:187], v[196:199], 0
    v_max3_f32 v232, v100, v101, v102
    v_mov_b32 v233, v103
    ds_read_b128 v[184:187], v224 offset:1024
    s_waitcnt lgkmcnt(5)
    v_mfma_f32_16x16x32_bf16 v[116:119], v[188:191], v[196:199], 0
    v_max3_f32 v232, v232, v104, v105
    v_max3_f32 v233, v233, v106, v107
    ds_read_b128 v[188:191], v225 offset:0
    s_waitcnt lgkmcnt(5)
    v_mfma_f32_16x16x32_bf16 v[120:123], v[192:195], v[196:199], 0
    v_max3_f32 v232, v232, v108, v109
    v_max3_f32 v233, v233, v110, v111
    ds_read_b128 v[192:195], v225 offset:1024
    s_waitcnt lgkmcnt(5)
    v_mfma_f32_16x16x32_bf16 v[124:127], v[172:175], v[196:199], 0
    v_max3_f32 v232, v232, v112, v113
    v_max3_f32 v233, v233, v114, v115
    ds_read_b128 v[172:175], v226 offset:0
    s_waitcnt lgkmcnt(5)
    v_mfma_f32_16x16x32_bf16 v[128:131], v[176:179], v[196:199], 0
    v_max3_f32 v232, v232, v116, v117
    v_max3_f32 v233, v233, v118, v119
    ds_read_b128 v[176:179], v226 offset:1024
    s_waitcnt lgkmcnt(5)
    v_mfma_f32_16x16x32_bf16 v[132:135], v[180:183], v[196:199], 0
    v_max3_f32 v232, v232, v120, v121
    v_max3_f32 v233, v233, v122, v123
    ds_read_b128 v[180:183], v227 offset:0
    s_waitcnt lgkmcnt(5)
    v_mfma_f32_16x16x32_bf16 v[136:139], v[184:187], v[196:199], 0
    v_max3_f32 v232, v232, v124, v125
    v_max3_f32 v233, v233, v126, v127
    ds_read_b128 v[184:187], v227 offset:1024
    s_waitcnt lgkmcnt(5)
    v_mfma_f32_16x16x32_bf16 v[140:143], v[188:191], v[196:199], 0
    v_max3_f32 v232, v232, v128, v129
    v_max3_f32 v233, v233, v130, v131
    ds_read_b128 v[188:191], v228 offset:0
    s_waitcnt lgkmcnt(5)
    v_mfma_f32_16x16x32_bf16 v[144:147], v[192:195], v[196:199], 0
    v_max3_f32 v232, v232, v132, v133
    v_max3_f32 v233, v233, v134, v135
    s_waitcnt lgkmcnt(4)
    v_mfma_f32_16x16x32_bf16 v[148:151], v[172:175], v[196:199], 0
    v_max3_f32 v232, v232, v136, v137
    v_max3_f32 v233, v233, v138, v139
    s_waitcnt lgkmcnt(3)
    v_mfma_f32_16x16x32_bf16 v[152:155], v[176:179], v[196:199], 0
    v_max3_f32 v232, v232, v140, v141
    v_max3_f32 v233, v233, v142, v143
    s_waitcnt lgkmcnt(2)
    v_mfma_f32_16x16x32_bf16 v[156:159], v[180:183], v[196:199], 0
    v_max3_f32 v232, v232, v144, v145
    v_max3_f32 v233, v233, v146, v147
    s_waitcnt lgkmcnt(1)
    v_mfma_f32_16x16x32_bf16 v[160:163], v[184:187], v[196:199], 0
    v_max3_f32 v232, v232, v148, v149
    v_max3_f32 v233, v233, v150, v151
    s_waitcnt lgkmcnt(0)
    v_mfma_f32_16x16x32_bf16 v[164:167], v[188:191], v[196:199], v[208:211]
    v_max3_f32 v232, v232, v152, v153
    v_max3_f32 v233, v233, v154, v155
    ds_read_b128 v[172:175], v220 offset:2048
    ds_read_b128 v[176:179], v220 offset:3072
    ds_read_b128 v[180:183], v221 offset:2048
    ds_read_b128 v[184:187], v221 offset:3072
    ds_read_b128 v[188:191], v222 offset:2048
    ds_read_b128 v[192:195], v222 offset:3072
    v_max3_f32 v232, v232, v156, v157
    v_max3_f32 v233, v233, v158, v159
    v_max3_f32 v232, v232, v160, v161
    v_max3_f32 v233, v233, v162, v163
    s_nop 1
    v_max3_f32 v232, v232, v164, v165
    v_max3_f32 v233, v233, v166, v167
    v_max_f32 v232, v232, v233
    v_mov_b32 v233, v232
    s_nop 1
    v_permlane16_swap_b32 v232, v233
    v_max_f32 v232, v232, v233
    v_mov_b32 v233, v232
    s_nop 1
    v_permlane32_swap_b32 v232, v233
    v_max_f32 v232, v232, v233
    v_mul_f32 v232, s32, v232
    v_fma_f32 v100, v100, s32, -v232
    v_fma_f32 v101, v101, s32, -v232
    v_fma_f32 v102, v102, s32, -v232
    v_fma_f32 v103, v103, s32, -v232
    v_fma_f32 v104, v104, s32, -v232
    v_fma_f32 v105, v105, s32, -v232
    v_fma_f32 v106, v106, s32, -v232
    v_fma_f32 v107, v107, s32, -v232
    v_exp_f32 v100, v100
    v_exp_f32 v101, v101
    v_exp_f32 v102, v102
    v_exp_f32 v103, v103
    v_exp_f32 v104, v104
    v_exp_f32 v105, v105
    v_exp_f32 v106, v106
    v_exp_f32 v107, v107
    v_cvt_pk_bf16_f32 v100, v100, v101
    v_cvt_pk_bf16_f32 v101, v102, v103
    v_cvt_pk_bf16_f32 v102, v104, v105
    v_cvt_pk_bf16_f32 v103, v106, v107
    v_fma_f32 v108, v108, s32, -v232
    v_fma_f32 v109, v109, s32, -v232
    v_fma_f32 v110, v110, s32, -v232
    v_fma_f32 v111, v111, s32, -v232
    v_fma_f32 v112, v112, s32, -v232
    v_fma_f32 v113, v113, s32, -v232
    v_fma_f32 v114, v114, s32, -v232
    v_fma_f32 v115, v115, s32, -v232
    s_waitcnt lgkmcnt(4)
    v_mfma_f32_16x16x32_bf16 v[200:203], v[172:175], v[100:103], 0
    v_mfma_f32_16x16x32_bf16 v[204:207], v[176:179], v[100:103], 0
    ds_read_b128 v[172:175], v223 offset:2048
    ds_read_b128 v[176:179], v223 offset:3072
    v_exp_f32 v108, v108
    v_exp_f32 v109, v109
    v_exp_f32 v110, v110
    v_exp_f32 v111, v111
    v_exp_f32 v112, v112
    v_exp_f32 v113, v113
    v_exp_f32 v114, v114
    v_exp_f32 v115, v115
    v_cvt_pk_bf16_f32 v108, v108, v109
    v_cvt_pk_bf16_f32 v109, v110, v111
    v_cvt_pk_bf16_f32 v110, v112, v113
    v_cvt_pk_bf16_f32 v111, v114, v115
    v_fma_f32 v116, v116, s32, -v232
    v_fma_f32 v117, v117, s32, -v232
    v_fma_f32 v118, v118, s32, -v232
    v_fma_f32 v119, v119, s32, -v232
    v_fma_f32 v120, v120, s32, -v232
    v_fma_f32 v121, v121, s32, -v232
    v_fma_f32 v122, v122, s32, -v232
    v_fma_f32 v123, v123, s32, -v232
    s_waitcnt lgkmcnt(4)
    v_mfma_f32_16x16x32_bf16 v[200:203], v[180:183], v[108:111], v[200:203]
    v_mfma_f32_16x16x32_bf16 v[204:207], v[184:187], v[108:111], v[204:207]
    ds_read_b128 v[180:183], v224 offset:2048
    ds_read_b128 v[184:187], v224 offset:3072
    v_exp_f32 v116, v116
    v_exp_f32 v117, v117
    v_exp_f32 v118, v118
    v_exp_f32 v119, v119
    v_exp_f32 v120, v120
    v_exp_f32 v121, v121
    v_exp_f32 v122, v122
    v_exp_f32 v123, v123
    v_cvt_pk_bf16_f32 v116, v116, v117
    v_cvt_pk_bf16_f32 v117, v118, v119
    v_cvt_pk_bf16_f32 v118, v120, v121
    v_cvt_pk_bf16_f32 v119, v122, v123
    v_fma_f32 v124, v124, s32, -v232
    v_fma_f32 v125, v125, s32, -v232
    v_fma_f32 v126, v126, s32, -v232
    v_fma_f32 v127, v127, s32, -v232
    v_fma_f32 v128, v128, s32, -v232
    v_fma_f32 v129, v129, s32, -v232
    v_fma_f32 v130, v130, s32, -v232
    v_fma_f32 v131, v131, s32, -v232
    s_waitcnt lgkmcnt(4)
    v_mfma_f32_16x16x32_bf16 v[200:203], v[188:191], v[116:119], v[200:203]
    v_mfma_f32_16x16x32_bf16 v[204:207], v[192:195], v[116:119], v[204:207]
    ds_read_b128 v[188:191], v225 offset:2048
    ds_read_b128 v[192:195], v225 offset:3072
    v_exp_f32 v124, v124
    v_exp_f32 v125, v125
    v_exp_f32 v126, v126
    v_exp_f32 v127, v127
    v_exp_f32 v128, v128
    v_exp_f32 v129, v129
    v_exp_f32 v130, v130
    v_exp_f32 v131, v131
    v_cvt_pk_bf16_f32 v124, v124, v125
    v_cvt_pk_bf16_f32 v125, v126, v127
    v_cvt_pk_bf16_f32 v126, v128, v129
    v_cvt_pk_bf16_f32 v127, v130, v131
    v_fma_f32 v132, v132, s32, -v232
    v_fma_f32 v133, v133, s32, -v232
    v_fma_f32 v134, v134, s32, -v232
    v_fma_f32 v135, v135, s32, -v232
    v_fma_f32 v136, v136, s32, -v232
    v_fma_f32 v137, v137, s32, -v232
    v_fma_f32 v138, v138, s32, -v232
    v_fma_f32 v139, v139, s32, -v232
    s_waitcnt lgkmcnt(4)
    v_mfma_f32_16x16x32_bf16 v[200:203], v[172:175], v[124:127], v[200:203]
    v_mfma_f32_16x16x32_bf16 v[204:207], v[176:179], v[124:127], v[204:207]
    ds_read_b128 v[172:175], v226 offset:2048
    ds_read_b128 v[176:179], v226 offset:3072
    v_exp_f32 v132, v132
    v_exp_f32 v133, v133
    v_exp_f32 v134, v134
    v_exp_f32 v135, v135
    v_exp_f32 v136, v136
    v_exp_f32 v137, v137
    v_exp_f32 v138, v138
    v_exp_f32 v139, v139
    v_cvt_pk_bf16_f32 v132, v132, v133
    v_cvt_pk_bf16_f32 v133, v134, v135
    v_cvt_pk_bf16_f32 v134, v136, v137
    v_cvt_pk_bf16_f32 v135, v138, v139
    v_fma_f32 v140, v140, s32, -v232
    v_fma_f32 v141, v141, s32, -v232
    v_fma_f32 v142, v142, s32, -v232
    v_fma_f32 v143, v143, s32, -v232
    v_fma_f32 v144, v144, s32, -v232
    v_fma_f32 v145, v145, s32, -v232
    v_fma_f32 v146, v146, s32, -v232
    v_fma_f32 v147, v147, s32, -v232
    s_waitcnt lgkmcnt(4)
    v_mfma_f32_16x16x32_bf16 v[200:203], v[180:183], v[132:135], v[200:203]
    v_mfma_f32_16x16x32_bf16 v[204:207], v[184:187], v[132:135], v[204:207]
    ds_read_b128 v[180:183], v227 offset:2048
    ds_read_b128 v[184:187], v227 offset:3072
    v_exp_f32 v140, v140
    v_exp_f32 v141, v141
    v_exp_f32 v142, v142
    v_exp_f32 v143, v143
    v_exp_f32 v144, v144
    v_exp_f32 v145, v145
    v_exp_f32 v146, v146
    v_exp_f32 v147, v147
    v_cvt_pk_bf16_f32 v140, v140, v141
    v_cvt_pk_bf16_f32 v141, v142, v143
    v_cvt_pk_bf16_f32 v142, v144, v145
    v_cvt_pk_bf16_f32 v143, v146, v147
    v_fma_f32 v148, v148, s32, -v232
    v_fma_f32 v149, v149, s32, -v232
    v_fma_f32 v150, v150, s32, -v232
    v_fma_f32 v151, v151, s32, -v232
    v_fma_f32 v152, v152, s32, -v232
    v_fma_f32 v153, v153, s32, -v232
    v_fma_f32 v154, v154, s32, -v232
    v_fma_f32 v155, v155, s32, -v232
    s_waitcnt lgkmcnt(4)
    v_mfma_f32_16x16x32_bf16 v[200:203], v[188:191], v[140:143], v[200:203]
    v_mfma_f32_16x16x32_bf16 v[204:207], v[192:195], v[140:143], v[204:207]
    ds_read_b128 v[188:191], v228 offset:2048
    ds_read_b128 v[192:195], v228 offset:3072
    v_exp_f32 v148, v148
    v_exp_f32 v149, v149
    v_exp_f32 v150, v150
    v_exp_f32 v151, v151
    v_exp_f32 v152, v152
    v_exp_f32 v153, v153
    v_exp_f32 v154, v154
    v_exp_f32 v155, v155
    v_cvt_pk_bf16_f32 v148, v148, v149
    v_cvt_pk_bf16_f32 v149, v150, v151
    v_cvt_pk_bf16_f32 v150, v152, v153
    v_cvt_pk_bf16_f32 v151, v154, v155
    v_fma_f32 v156, v156, s32, -v232
    v_fma_f32 v157, v157, s32, -v232
    v_fma_f32 v158, v158, s32, -v232
    v_fma_f32 v159, v159, s32, -v232
    v_fma_f32 v160, v160, s32, -v232
    v_fma_f32 v161, v161, s32, -v232
    v_fma_f32 v162, v162, s32, -v232
    v_fma_f32 v163, v163, s32, -v232
    s_waitcnt lgkmcnt(4)
    v_mfma_f32_16x16x32_bf16 v[200:203], v[172:175], v[148:151], v[200:203]
    v_mfma_f32_16x16x32_bf16 v[204:207], v[176:179], v[148:151], v[204:207]
    v_exp_f32 v156, v156
    v_exp_f32 v157, v157
    v_exp_f32 v158, v158
    v_exp_f32 v159, v159
    v_exp_f32 v160, v160
    v_exp_f32 v161, v161
    v_exp_f32 v162, v162
    v_exp_f32 v163, v163
    v_cvt_pk_bf16_f32 v156, v156, v157
    v_cvt_pk_bf16_f32 v157, v158, v159
    v_cvt_pk_bf16_f32 v158, v160, v161
    v_cvt_pk_bf16_f32 v159, v162, v163
    v_fma_f32 v164, v164, s32, -v232
    v_fma_f32 v165, v165, s32, -v232
    v_fma_f32 v166, v166, s32, -v232
    v_fma_f32 v167, v167, s32, -v232
    s_waitcnt lgkmcnt(2)
    v_mfma_f32_16x16x32_bf16 v[200:203], v[180:183], v[156:159], v[200:203]
    v_mfma_f32_16x16x32_bf16 v[204:207], v[184:187], v[156:159], v[204:207]
    v_exp_f32 v164, v164
    v_exp_f32 v165, v165
    v_exp_f32 v166, v166
    v_exp_f32 v167, v167
    s_nop 0
    v_cvt_pk_bf16_f32 v164, v164, v165
    v_cvt_pk_bf16_f32 v165, v166, v167
    v_mov_b32 v166, 0
    v_mov_b32 v167, 0
    s_nop 1
    s_waitcnt lgkmcnt(0)
    v_mfma_f32_16x16x32_bf16 v[200:203], v[188:191], v[164:167], v[200:203]
    v_mfma_f32_16x16x32_bf16 v[204:207], v[192:195], v[164:167], v[204:207]
    s_nop 7
    v_mov_b32 v232, v204
    v_mov_b32 v233, v204
    s_nop 1
    v_permlane16_swap_b32 v232, v233
    v_rcp_f32 v233, v233
    s_nop 0
    v_mul_f32 v200, v200, v233
    v_mul_f32 v201, v201, v233
    v_mul_f32 v202, v202, v233
    v_mul_f32 v203, v203, v233
    v_mul_f32 v204, v204, v233
    v_mul_f32 v205, v205, v233
    v_mul_f32 v206, v206, v233
    v_mul_f32 v207, v207, v233
    v_cvt_pk_bf16_f32 v200, v200, v201
    v_cvt_pk_bf16_f32 v201, v202, v203
    v_cvt_pk_bf16_f32 v202, v204, v205
    v_cvt_pk_bf16_f32 v203, v206, v207
    buffer_store_dwordx2 v[200:201], v219, s[4:7], s34 offen sc0 sc1
    s_mov_b64 exec, s[50:51]
    buffer_store_dwordx2 v[202:203], v219, s[4:7], s34 offen offset:32 sc0 sc1
    s_mov_b64 exec, -1
    s_branch B_ad_325
B_odd_324:
    s_lshl_b32 s26, s35, 12
    v_add_u32 v220, s26, v229
    s_add_u32 s35, s35, 1
    s_cmp_eq_u32 s35, 12
    s_cselect_b32 s35, 0, s35
    s_lshl_b32 s26, s35, 12
    v_add_u32 v221, s26, v229
    s_add_u32 s35, s35, 1
    s_cmp_eq_u32 s35, 12
    s_cselect_b32 s35, 0, s35
    s_lshl_b32 s26, s35, 12
    v_add_u32 v222, s26, v229
    s_add_u32 s35, s35, 1
    s_cmp_eq_u32 s35, 12
    s_cselect_b32 s35, 0, s35
    s_lshl_b32 s26, s35, 12
    v_add_u32 v223, s26, v229
    s_add_u32 s35, s35, 1
    s_cmp_eq_u32 s35, 12
    s_cselect_b32 s35, 0, s35
    s_lshl_b32 s26, s35, 12
    v_add_u32 v224, s26, v229
    s_add_u32 s35, s35, 1
    s_cmp_eq_u32 s35, 12
    s_cselect_b32 s35, 0, s35
    s_lshl_b32 s26, s35, 12
    v_add_u32 v225, s26, v229
    s_add_u32 s35, s35, 1
    s_cmp_eq_u32 s35, 12
    s_cselect_b32 s35, 0, s35
    s_lshl_b32 s26, s35, 12
    v_add_u32 v226, s26, v229
    s_add_u32 s35, s35, 1
    s_cmp_eq_u32 s35, 12
    s_cselect_b32 s35, 0, s35
    s_lshl_b32 s26, s35, 12
    v_add_u32 v227, s26, v229
    s_add_u32 s35, s35, 1
    s_cmp_eq_u32 s35, 12
    s_cselect_b32 s35, 0, s35
    s_lshl_b32 s26, s35, 12
    v_add_u32 v228, s26, v229
    s_add_u32 s35, s35, 1
    s_cmp_eq_u32 s35, 12
    s_cselect_b32 s35, 0, s35
    ds_read_b128 v[196:199], v230
    ds_read_b128 v[172:175], v220 offset:1024
    ds_read_b128 v[176:179], v221 offset:0
    ds_read_b128 v[180:183], v221 offset:1024
    ds_read_b128 v[184:187], v222 offset:0
    ds_read_b128 v[188:191], v222 offset:1024
    ds_read_b128 v[192:195], v223 offset:0
    s_waitcnt lgkmcnt(5)
    v_mfma_f32_16x16x32_bf16 v[104:107], v[172:175], v[196:199], v[212:215]
    ds_read_b128 v[172:175], v223 offset:1024
    s_waitcnt lgkmcnt(5)
    v_mfma_f32_16x16x32_bf16 v[108:111], v[176:179], v[196:199], 0
    ds_read_b128 v[176:179], v224 offset:0
    s_waitcnt lgkmcnt(5)
    v_mfma_f32_16x16x32_bf16 v[112:115], v[180:183], v[196:199], 0
    ds_read_b128 v[180:183], v224 offset:1024
    s_waitcnt lgkmcnt(5)
    v_mfma_f32_16x16x32_bf16 v[116:119], v[184:187], v[196:199], 0
    v_max3_f32 v232, v104, v105, v106
    v_mov_b32 v233, v107
    ds_read_b128 v[184:187], v225 offset:0
    s_waitcnt lgkmcnt(5)
    v_mfma_f32_16x16x32_bf16 v[120:123], v[188:191], v[196:199], 0
    v_max3_f32 v232, v232, v108, v109
    v_max3_f32 v233, v233, v110, v111
    ds_read_b128 v[188:191], v225 offset:1024
    s_waitcnt lgkmcnt(5)
    v_mfma_f32_16x16x32_bf16 v[124:127], v[192:195], v[196:199], 0
    v_max3_f32 v232, v232, v112, v113
    v_max3_f32 v233, v233, v114, v115
    ds_read_b128 v[192:195], v226 offset:0
    s_waitcnt lgkmcnt(5)
    v_mfma_f32_16x16x32_bf16 v[128:131], v[172:175], v[196:199], 0
    v_max3_f32 v232, v232, v116, v117
    v_max3_f32 v233, v233, v118, v119
    ds_read_b128 v[172:175], v226 offset:1024
    s_waitcnt lgkmcnt(5)
    v_mfma_f32_16x16x32_bf16 v[132:135], v[176:179], v[196:199], 0
    v_max3_f32 v232, v232, v120, v121
    v_max3_f32 v233, v233, v122, v123
    ds_read_b128 v[176:179], v227 offset:0
    s_waitcnt lgkmcnt(5)
    v_mfma_f32_16x16x32_bf16 v[136:139], v[180:183], v[196:199], 0
    v_max3_f32 v232, v232, v124, v125
    v_max3_f32 v233, v233, v126, v127
    ds_read_b128 v[180:183], v227 offset:1024
    s_waitcnt lgkmcnt(5)
    v_mfma_f32_16x16x32_bf16 v[140:143], v[184:187], v[196:199], 0
    v_max3_f32 v232, v232, v128, v129
    v_max3_f32 v233, v233, v130, v131
    ds_read_b128 v[184:187], v228 offset:0
    s_waitcnt lgkmcnt(5)
    v_mfma_f32_16x16x32_bf16 v[144:147], v[188:191], v[196:199], 0
    v_max3_f32 v232, v232, v132, v133
    v_max3_f32 v233, v233, v134, v135
    ds_read_b128 v[188:191], v228 offset:1024
    s_waitcnt lgkmcnt(5)
    v_mfma_f32_16x16x32_bf16 v[148:151], v[192:195], v[196:199], 0
    v_max3_f32 v232, v232, v136, v137
    v_max3_f32 v233, v233, v138, v139
    s_waitcnt lgkmcnt(4)
    v_mfma_f32_16x16x32_bf16 v[152:155], v[172:175], v[196:199], 0
    v_max3_f32 v232, v232, v140, v141
    v_max3_f32 v233, v233, v142, v143
    s_waitcnt lgkmcnt(3)
    v_mfma_f32_16x16x32_bf16 v[156:159], v[176:179], v[196:199], 0
    v_max3_f32 v232, v232, v144, v145
    v_max3_f32 v233, v233, v146, v147
    s_waitcnt lgkmcnt(2)
    v_mfma_f32_16x16x32_bf16 v[160:163], v[180:183], v[196:199], 0
    v_max3_f32 v232, v232, v148, v149
    v_max3_f32 v233, v233, v150, v151
    s_waitcnt lgkmcnt(1)
    v_mfma_f32_16x16x32_bf16 v[164:167], v[184:187], v[196:199], 0
    v_max3_f32 v232, v232, v152, v153
    v_max3_f32 v233, v233, v154, v155
    s_waitcnt lgkmcnt(0)
    v_mfma_f32_16x16x32_bf16 v[168:171], v[188:191], v[196:199], v[208:211]
    v_max3_f32 v232, v232, v156, v157
    v_max3_f32 v233, v233, v158, v159
    ds_read_b128 v[172:175], v220 offset:2048
    ds_read_b128 v[176:179], v220 offset:3072
    ds_read_b128 v[180:183], v221 offset:2048
    ds_read_b128 v[184:187], v221 offset:3072
    ds_read_b128 v[188:191], v222 offset:2048
    ds_read_b128 v[192:195], v222 offset:3072
    v_max3_f32 v232, v232, v160, v161
    v_max3_f32 v233, v233, v162, v163
    v_max3_f32 v232, v232, v164, v165
    v_max3_f32 v233, v233, v166, v167
    s_nop 1
    v_max3_f32 v232, v232, v168, v169
    v_max3_f32 v233, v233, v170, v171
    v_max_f32 v232, v232, v233
    v_mov_b32 v233, v232
    s_nop 1
    v_permlane16_swap_b32 v232, v233
    v_max_f32 v232, v232, v233
    v_mov_b32 v233, v232
    s_nop 1
    v_permlane32_swap_b32 v232, v233
    v_max_f32 v232, v232, v233
    v_mul_f32 v232, s32, v232
    v_fma_f32 v104, v104, s32, -v232
    v_fma_f32 v105, v105, s32, -v232
    v_fma_f32 v106, v106, s32, -v232
    v_fma_f32 v107, v107, s32, -v232
    v_exp_f32 v104, v104
    v_exp_f32 v105, v105
    v_exp_f32 v106, v106
    v_exp_f32 v107, v107
    s_nop 0
    v_mov_b32 v100, 0
    v_mov_b32 v101, 0
    v_cvt_pk_bf16_f32 v102, v104, v105
    v_cvt_pk_bf16_f32 v103, v106, v107
    v_fma_f32 v108, v108, s32, -v232
    v_fma_f32 v109, v109, s32, -v232
    v_fma_f32 v110, v110, s32, -v232
    v_fma_f32 v111, v111, s32, -v232
    v_fma_f32 v112, v112, s32, -v232
    v_fma_f32 v113, v113, s32, -v232
    v_fma_f32 v114, v114, s32, -v232
    v_fma_f32 v115, v115, s32, -v232
    s_waitcnt lgkmcnt(4)
    v_mfma_f32_16x16x32_bf16 v[200:203], v[172:175], v[100:103], 0
    v_mfma_f32_16x16x32_bf16 v[204:207], v[176:179], v[100:103], 0
    ds_read_b128 v[172:175], v223 offset:2048
    ds_read_b128 v[176:179], v223 offset:3072
    v_exp_f32 v108, v108
    v_exp_f32 v109, v109
    v_exp_f32 v110, v110
    v_exp_f32 v111, v111
    v_exp_f32 v112, v112
    v_exp_f32 v113, v113
    v_exp_f32 v114, v114
    v_exp_f32 v115, v115
    v_cvt_pk_bf16_f32 v108, v108, v109
    v_cvt_pk_bf16_f32 v109, v110, v111
    v_cvt_pk_bf16_f32 v110, v112, v113
    v_cvt_pk_bf16_f32 v111, v114, v115
    v_fma_f32 v116, v116, s32, -v232
    v_fma_f32 v117, v117, s32, -v232
    v_fma_f32 v118, v118, s32, -v232
    v_fma_f32 v119, v119, s32, -v232
    v_fma_f32 v120, v120, s32, -v232
    v_fma_f32 v121, v121, s32, -v232
    v_fma_f32 v122, v122, s32, -v232
    v_fma_f32 v123, v123, s32, -v232
    s_waitcnt lgkmcnt(4)
    v_mfma_f32_16x16x32_bf16 v[200:203], v[180:183], v[108:111], v[200:203]
    v_mfma_f32_16x16x32_bf16 v[204:207], v[184:187], v[108:111], v[204:207]
    ds_read_b128 v[180:183], v224 offset:2048
    ds_read_b128 v[184:187], v224 offset:3072
    v_exp_f32 v116, v116
    v_exp_f32 v117, v117
    v_exp_f32 v118, v118
    v_exp_f32 v119, v119
    v_exp_f32 v120, v120
    v_exp_f32 v121, v121
    v_exp_f32 v122, v122
    v_exp_f32 v123, v123
    v_cvt_pk_bf16_f32 v116, v116, v117
    v_cvt_pk_bf16_f32 v117, v118, v119
    v_cvt_pk_bf16_f32 v118, v120, v121
    v_cvt_pk_bf16_f32 v119, v122, v123
    v_fma_f32 v124, v124, s32, -v232
    v_fma_f32 v125, v125, s32, -v232
    v_fma_f32 v126, v126, s32, -v232
    v_fma_f32 v127, v127, s32, -v232
    v_fma_f32 v128, v128, s32, -v232
    v_fma_f32 v129, v129, s32, -v232
    v_fma_f32 v130, v130, s32, -v232
    v_fma_f32 v131, v131, s32, -v232
    s_waitcnt lgkmcnt(4)
    v_mfma_f32_16x16x32_bf16 v[200:203], v[188:191], v[116:119], v[200:203]
    v_mfma_f32_16x16x32_bf16 v[204:207], v[192:195], v[116:119], v[204:207]
    ds_read_b128 v[188:191], v225 offset:2048
    ds_read_b128 v[192:195], v225 offset:3072
    v_exp_f32 v124, v124
    v_exp_f32 v125, v125
    v_exp_f32 v126, v126
    v_exp_f32 v127, v127
    v_exp_f32 v128, v128
    v_exp_f32 v129, v129
    v_exp_f32 v130, v130
    v_exp_f32 v131, v131
    v_cvt_pk_bf16_f32 v124, v124, v125
    v_cvt_pk_bf16_f32 v125, v126, v127
    v_cvt_pk_bf16_f32 v126, v128, v129
    v_cvt_pk_bf16_f32 v127, v130, v131
    v_fma_f32 v132, v132, s32, -v232
    v_fma_f32 v133, v133, s32, -v232
    v_fma_f32 v134, v134, s32, -v232
    v_fma_f32 v135, v135, s32, -v232
    v_fma_f32 v136, v136, s32, -v232
    v_fma_f32 v137, v137, s32, -v232
    v_fma_f32 v138, v138, s32, -v232
    v_fma_f32 v139, v139, s32, -v232
    s_waitcnt lgkmcnt(4)
    v_mfma_f32_16x16x32_bf16 v[200:203], v[172:175], v[124:127], v[200:203]
    v_mfma_f32_16x16x32_bf16 v[204:207], v[176:179], v[124:127], v[204:207]
    ds_read_b128 v[172:175], v226 offset:2048
    ds_read_b128 v[176:179], v226 offset:3072
    v_exp_f32 v132, v132
    v_exp_f32 v133, v133
    v_exp_f32 v134, v134
    v_exp_f32 v135, v135
    v_exp_f32 v136, v136
    v_exp_f32 v137, v137
    v_exp_f32 v138, v138
    v_exp_f32 v139, v139
    v_cvt_pk_bf16_f32 v132, v132, v133
    v_cvt_pk_bf16_f32 v133, v134, v135
    v_cvt_pk_bf16_f32 v134, v136, v137
    v_cvt_pk_bf16_f32 v135, v138, v139
    v_fma_f32 v140, v140, s32, -v232
    v_fma_f32 v141, v141, s32, -v232
    v_fma_f32 v142, v142, s32, -v232
    v_fma_f32 v143, v143, s32, -v232
    v_fma_f32 v144, v144, s32, -v232
    v_fma_f32 v145, v145, s32, -v232
    v_fma_f32 v146, v146, s32, -v232
    v_fma_f32 v147, v147, s32, -v232
    s_waitcnt lgkmcnt(4)
    v_mfma_f32_16x16x32_bf16 v[200:203], v[180:183], v[132:135], v[200:203]
    v_mfma_f32_16x16x32_bf16 v[204:207], v[184:187], v[132:135], v[204:207]
    ds_read_b128 v[180:183], v227 offset:2048
    ds_read_b128 v[184:187], v227 offset:3072
    v_exp_f32 v140, v140
    v_exp_f32 v141, v141
    v_exp_f32 v142, v142
    v_exp_f32 v143, v143
    v_exp_f32 v144, v144
    v_exp_f32 v145, v145
    v_exp_f32 v146, v146
    v_exp_f32 v147, v147
    v_cvt_pk_bf16_f32 v140, v140, v141
    v_cvt_pk_bf16_f32 v141, v142, v143
    v_cvt_pk_bf16_f32 v142, v144, v145
    v_cvt_pk_bf16_f32 v143, v146, v147
    v_fma_f32 v148, v148, s32, -v232
    v_fma_f32 v149, v149, s32, -v232
    v_fma_f32 v150, v150, s32, -v232
    v_fma_f32 v151, v151, s32, -v232
    v_fma_f32 v152, v152, s32, -v232
    v_fma_f32 v153, v153, s32, -v232
    v_fma_f32 v154, v154, s32, -v232
    v_fma_f32 v155, v155, s32, -v232
    s_waitcnt lgkmcnt(4)
    v_mfma_f32_16x16x32_bf16 v[200:203], v[188:191], v[140:143], v[200:203]
    v_mfma_f32_16x16x32_bf16 v[204:207], v[192:195], v[140:143], v[204:207]
    ds_read_b128 v[188:191], v228 offset:2048
    ds_read_b128 v[192:195], v228 offset:3072
    v_exp_f32 v148, v148
    v_exp_f32 v149, v149
    v_exp_f32 v150, v150
    v_exp_f32 v151, v151
    v_exp_f32 v152, v152
    v_exp_f32 v153, v153
    v_exp_f32 v154, v154
    v_exp_f32 v155, v155
    v_cvt_pk_bf16_f32 v148, v148, v149
    v_cvt_pk_bf16_f32 v149, v150, v151
    v_cvt_pk_bf16_f32 v150, v152, v153
    v_cvt_pk_bf16_f32 v151, v154, v155
    v_fma_f32 v156, v156, s32, -v232
    v_fma_f32 v157, v157, s32, -v232
    v_fma_f32 v158, v158, s32, -v232
    v_fma_f32 v159, v159, s32, -v232
    v_fma_f32 v160, v160, s32, -v232
    v_fma_f32 v161, v161, s32, -v232
    v_fma_f32 v162, v162, s32, -v232
    v_fma_f32 v163, v163, s32, -v232
    s_waitcnt lgkmcnt(4)
    v_mfma_f32_16x16x32_bf16 v[200:203], v[172:175], v[148:151], v[200:203]
    v_mfma_f32_16x16x32_bf16 v[204:207], v[176:179], v[148:151], v[204:207]
    v_exp_f32 v156, v156
    v_exp_f32 v157, v157
    v_exp_f32 v158, v158
    v_exp_f32 v159, v159
    v_exp_f32 v160, v160
    v_exp_f32 v161, v161
    v_exp_f32 v162, v162
    v_exp_f32 v163, v163
    v_cvt_pk_bf16_f32 v156, v156, v157
    v_cvt_pk_bf16_f32 v157, v158, v159
    v_cvt_pk_bf16_f32 v158, v160, v161
    v_cvt_pk_bf16_f32 v159, v162, v163
    v_fma_f32 v164, v164, s32, -v232
    v_fma_f32 v165, v165, s32, -v232
    v_fma_f32 v166, v166, s32, -v232
    v_fma_f32 v167, v167, s32, -v232
    v_fma_f32 v168, v168, s32, -v232
    v_fma_f32 v169, v169, s32, -v232
    v_fma_f32 v170, v170, s32, -v232
    v_fma_f32 v171, v171, s32, -v232
    s_waitcnt lgkmcnt(2)
    v_mfma_f32_16x16x32_bf16 v[200:203], v[180:183], v[156:159], v[200:203]
    v_mfma_f32_16x16x32_bf16 v[204:207], v[184:187], v[156:159], v[204:207]
    v_exp_f32 v164, v164
    v_exp_f32 v165, v165
    v_exp_f32 v166, v166
    v_exp_f32 v167, v167
    v_exp_f32 v168, v168
    v_exp_f32 v169, v169
    v_exp_f32 v170, v170
    v_exp_f32 v171, v171
    v_cvt_pk_bf16_f32 v164, v164, v165
    v_cvt_pk_bf16_f32 v165, v166, v167
    v_cvt_pk_bf16_f32 v166, v168, v169
    v_cvt_pk_bf16_f32 v167, v170, v171
    s_nop 1
    s_waitcnt lgkmcnt(0)
    v_mfma_f32_16x16x32_bf16 v[200:203], v[188:191], v[164:167], v[200:203]
    v_mfma_f32_16x16x32_bf16 v[204:207], v[192:195], v[164:167], v[204:207]
    s_nop 7
    v_mov_b32 v232, v204
    v_mov_b32 v233, v204
    s_nop 1
    v_permlane16_swap_b32 v232, v233
    v_rcp_f32 v233, v233
    s_nop 0
    v_mul_f32 v200, v200, v233
    v_mul_f32 v201, v201, v233
    v_mul_f32 v202, v202, v233
    v_mul_f32 v203, v203, v233
    v_mul_f32 v204, v204, v233
    v_mul_f32 v205, v205, v233
    v_mul_f32 v206, v206, v233
    v_mul_f32 v207, v207, v233
    v_cvt_pk_bf16_f32 v200, v200, v201
    v_cvt_pk_bf16_f32 v201, v202, v203
    v_cvt_pk_bf16_f32 v202, v204, v205
    v_cvt_pk_bf16_f32 v203, v206, v207
    buffer_store_dwordx2 v[200:201], v219, s[4:7], s34 offen sc0 sc1
    s_mov_b64 exec, s[50:51]
    buffer_store_dwordx2 v[202:203], v219, s[4:7], s34 offen offset:32 sc0 sc1
    s_mov_b64 exec, -1
B_ad_325:
    s_add_u32 s31, s31, 2
    s_cmp_ge_u32 s31, 12
    s_cselect_b32 s26, 12, 0
    s_sub_u32 s31, s31, s26
    s_add_u32 s34, s34, 81920
    s_add_u32 s36, s36, 1
    s_cmp_lt_u32 s36, 32
    s_cbranch_scc1 B_loop_313
    s_waitcnt vmcnt(0)
    s_barrier
    s_cmp_lg_u32 s20, 0
    s_cbranch_scc1 al_326
    v_mov_b32 v232, 1
    v_mov_b32 v233, 0
    v_mov_b32 v234, 4096
    s_mov_b64 exec, 1
    buffer_atomic_add v232, v233, s[4:7], s33 offen sc0 sc1
    s_waitcnt vmcnt(0)
    v_cmp_eq_u32 vcc, 31, v232
    s_cbranch_vccz al_326_x
    buffer_store_dword v232, v234, s[4:7], s33 offen sc0 sc1
al_326_x:
    s_mov_b64 exec, -1
al_326:
    s_branch L_end
L_notb:
    s_cmp_ge_u32 s25, 165
    s_cbranch_scc1 L_f
    s_sub_u32 s30, s25, 160
    v_mov_b32 v251, 0
    global_load_dword v250, v251, s[98:99] sc1
    s_waitcnt vmcnt(0)
iw_lp_328:
    v_cmp_gt_u32 vcc, 27, v250
    s_cbranch_vccz iw_ok_327
    s_cmp_eq_u32 s100, 0
    s_cbranch_scc1 iw_ok_327
    s_sub_u32 s100, s100, 1
    s_sleep 2
    global_load_dword v250, v251, s[98:99] sc1
    s_waitcnt vmcnt(0)
    s_branch iw_lp_328
iw_ok_327:
    s_lshl_b32 s88, s30, 7
    s_add_u32 s88, s88, 167829504
    s_mov_b32 s89, 4
    v_mov_b32 v250, 0
fw_lp_330:
    v_cmp_gt_u32 vcc, s89, v250
    s_cbranch_vccz fw_ok_329
    s_cmp_eq_u32 s100, 0
    s_cbranch_scc1 fw_ok_329
    s_sub_u32 s100, s100, 1
    s_sleep 16
    buffer_load_dword v250, v251, s[4:7], s88 offen sc1
    s_waitcnt vmcnt(0)
    s_branch fw_lp_330
fw_ok_329:
    s_load_dwordx2 s[8:9], s[0:1], 72
    s_load_dwordx2 s[16:17], s[0:1], 80
    v_lshrrev_b32 v10, 4, v1
    v_mul_u32_u24 v11, 1280, v10
    v_and_b32 v12, 15, v1
    v_lshl_add_u32 v11, v12, 4, v11
    s_lshl_b32 s35, s30, 8
    s_mul_i32 s36, s20, 204800
    s_add_u32 s35, s35, s36
    s_mul_i32 s36, s20, 40960
    s_waitcnt lgkmcnt(0)
    s_and_b32 s9, s9, 0xffff
    s_mov_b32 s10, 819200
    s_mov_b32 s11, 0x20000
    s_and_b32 s17, s17, 0xffff
    s_mov_b32 s18, 5242880
    s_mov_b32 s19, 0x20000
    s_add_u32 m0, s36, 0
    s_add_u32 s37, s35, 0
    buffer_load_dwordx4 v11, s[8:11], s37 offen lds
    s_add_u32 m0, s36, 1024
    s_add_u32 s37, s35, 5120
    buffer_load_dwordx4 v11, s[8:11], s37 offen lds
    s_add_u32 m0, s36, 2048
    s_add_u32 s37, s35, 10240
    buffer_load_dwordx4 v11, s[8:11], s37 offen lds
    s_add_u32 m0, s36, 3072
    s_add_u32 s37, s35, 15360
    buffer_load_dwordx4 v11, s[8:11], s37 offen lds
    s_add_u32 m0, s36, 4096
    s_add_u32 s37, s35, 20480
    buffer_load_dwordx4 v11, s[8:11], s37 offen lds
    s_add_u32 m0, s36, 5120
    s_add_u32 s37, s35, 25600
    buffer_load_dwordx4 v11, s[8:11], s37 offen lds
    s_add_u32 m0, s36, 6144
    s_add_u32 s37, s35, 30720
    buffer_load_dwordx4 v11, s[8:11], s37 offen lds
    s_add_u32 m0, s36, 7168
    s_add_u32 s37, s35, 35840
    buffer_load_dwordx4 v11, s[8:11], s37 offen lds
    s_add_u32 m0, s36, 8192
    s_add_u32 s37, s35, 40960
    buffer_load_dwordx4 v11, s[8:11], s37 offen lds
    s_add_u32 m0, s36, 9216
    s_add_u32 s37, s35, 46080
    buffer_load_dwordx4 v11, s[8:11], s37 offen lds
    s_add_u32 m0, s36, 10240
    s_add_u32 s37, s35, 51200
    buffer_load_dwordx4 v11, s[8:11], s37 offen lds
    s_add_u32 m0, s36, 11264
    s_add_u32 s37, s35, 56320
    buffer_load_dwordx4 v11, s[8:11], s37 offen lds
    s_add_u32 m0, s36, 12288
    s_add_u32 s37, s35, 61440
    buffer_load_dwordx4 v11, s[8:11], s37 offen lds
    s_add_u32 m0, s36, 13312
    s_add_u32 s37, s35, 66560
    buffer_load_dwordx4 v11, s[8:11], s37 offen lds
    s_add_u32 m0, s36, 14336
    s_add_u32 s37, s35, 71680
    buffer_load_dwordx4 v11, s[8:11], s37 offen lds
    s_add_u32 m0, s36, 15360
    s_add_u32 s37, s35, 76800
    buffer_load_dwordx4 v11, s[8:11], s37 offen lds
    s_add_u32 m0, s36, 16384
    s_add_u32 s37, s35, 81920
    buffer_load_dwordx4 v11, s[8:11], s37 offen lds
    s_add_u32 m0, s36, 17408
    s_add_u32 s37, s35, 87040
    buffer_load_dwordx4 v11, s[8:11], s37 offen lds
    s_add_u32 m0, s36, 18432
    s_add_u32 s37, s35, 92160
    buffer_load_dwordx4 v11, s[8:11], s37 offen lds
    s_add_u32 m0, s36, 19456
    s_add_u32 s37, s35, 97280
    buffer_load_dwordx4 v11, s[8:11], s37 offen lds
    s_add_u32 m0, s36, 20480
    s_add_u32 s37, s35, 102400
    buffer_load_dwordx4 v11, s[8:11], s37 offen lds
    s_add_u32 m0, s36, 21504
    s_add_u32 s37, s35, 107520
    buffer_load_dwordx4 v11, s[8:11], s37 offen lds
    s_add_u32 m0, s36, 22528
    s_add_u32 s37, s35, 112640
    buffer_load_dwordx4 v11, s[8:11], s37 offen lds
    s_add_u32 m0, s36, 23552
    s_add_u32 s37, s35, 117760
    buffer_load_dwordx4 v11, s[8:11], s37 offen lds
    s_add_u32 m0, s36, 24576
    s_add_u32 s37, s35, 122880
    buffer_load_dwordx4 v11, s[8:11], s37 offen lds
    s_add_u32 m0, s36, 25600
    s_add_u32 s37, s35, 128000
    buffer_load_dwordx4 v11, s[8:11], s37 offen lds
    s_add_u32 m0, s36, 26624
    s_add_u32 s37, s35, 133120
    buffer_load_dwordx4 v11, s[8:11], s37 offen lds
    s_add_u32 m0, s36, 27648
    s_add_u32 s37, s35, 138240
    buffer_load_dwordx4 v11, s[8:11], s37 offen lds
    s_add_u32 m0, s36, 28672
    s_add_u32 s37, s35, 143360
    buffer_load_dwordx4 v11, s[8:11], s37 offen lds
    s_add_u32 m0, s36, 29696
    s_add_u32 s37, s35, 148480
    buffer_load_dwordx4 v11, s[8:11], s37 offen lds
    s_add_u32 m0, s36, 30720
    s_add_u32 s37, s35, 153600
    buffer_load_dwordx4 v11, s[8:11], s37 offen lds
    s_add_u32 m0, s36, 31744
    s_add_u32 s37, s35, 158720
    buffer_load_dwordx4 v11, s[8:11], s37 offen lds
    s_add_u32 m0, s36, 32768
    s_add_u32 s37, s35, 163840
    buffer_load_dwordx4 v11, s[8:11], s37 offen lds
    s_add_u32 m0, s36, 33792
    s_add_u32 s37, s35, 168960
    buffer_load_dwordx4 v11, s[8:11], s37 offen lds
    s_add_u32 m0, s36, 34816
    s_add_u32 s37, s35, 174080
    buffer_load_dwordx4 v11, s[8:11], s37 offen lds
    s_add_u32 m0, s36, 35840
    s_add_u32 s37, s35, 179200
    buffer_load_dwordx4 v11, s[8:11], s37 offen lds
    s_add_u32 m0, s36, 36864
    s_add_u32 s37, s35, 184320
    buffer_load_dwordx4 v11, s[8:11], s37 offen lds
    s_add_u32 m0, s36, 37888
    s_add_u32 s37, s35, 189440
    buffer_load_dwordx4 v11, s[8:11], s37 offen lds
    s_add_u32 m0, s36, 38912
    s_add_u32 s37, s35, 194560
    buffer_load_dwordx4 v11, s[8:11], s37 offen lds
    s_add_u32 m0, s36, 39936
    s_add_u32 s37, s35, 199680
    buffer_load_dwordx4 v11, s[8:11], s37 offen lds
    v_bfe_u32 v13, v1, 2, 2
    v_lshl_add_u32 v13, v10, 3, v13
    v_and_b32 v14, 3, v1
    v_lshlrev_b32 v14, 3, v14
    v_lshl_add_u32 v13, v13, 8, v14
    s_lshl_b32 s26, s20, 6
    v_add_u32 v13, s26, v13
    s_waitcnt vmcnt(0)
    s_barrier
    ds_read_b64_tr_b16 a[0:1], v13 offset:0
    ds_read_b64_tr_b16 a[2:3], v13 offset:1024
    ds_read_b64_tr_b16 a[80:81], v13 offset:32
    ds_read_b64_tr_b16 a[82:83], v13 offset:1056
    ds_read_b64_tr_b16 a[4:5], v13 offset:8192
    ds_read_b64_tr_b16 a[6:7], v13 offset:9216
    ds_read_b64_tr_b16 a[84:85], v13 offset:8224
    ds_read_b64_tr_b16 a[86:87], v13 offset:9248
    ds_read_b64_tr_b16 a[8:9], v13 offset:16384
    ds_read_b64_tr_b16 a[10:11], v13 offset:17408
    ds_read_b64_tr_b16 a[88:89], v13 offset:16416
    ds_read_b64_tr_b16 a[90:91], v13 offset:17440
    s_waitcnt lgkmcnt(0)
    ds_read_b64_tr_b16 a[12:13], v13 offset:24576
    ds_read_b64_tr_b16 a[14:15], v13 offset:25600
    ds_read_b64_tr_b16 a[92:93], v13 offset:24608
    ds_read_b64_tr_b16 a[94:95], v13 offset:25632
    ds_read_b64_tr_b16 a[16:17], v13 offset:32768
    ds_read_b64_tr_b16 a[18:19], v13 offset:33792
    ds_read_b64_tr_b16 a[96:97], v13 offset:32800
    ds_read_b64_tr_b16 a[98:99], v13 offset:33824
    ds_read_b64_tr_b16 a[20:21], v13 offset:40960
    ds_read_b64_tr_b16 a[22:23], v13 offset:41984
    ds_read_b64_tr_b16 a[100:101], v13 offset:40992
    ds_read_b64_tr_b16 a[102:103], v13 offset:42016
    s_waitcnt lgkmcnt(0)
    ds_read_b64_tr_b16 a[24:25], v13 offset:49152
    ds_read_b64_tr_b16 a[26:27], v13 offset:50176
    ds_read_b64_tr_b16 a[104:105], v13 offset:49184
    ds_read_b64_tr_b16 a[106:107], v13 offset:50208
    v_add_u32 v13, 57344, v13
    ds_read_b64_tr_b16 a[28:29], v13 offset:0
    ds_read_b64_tr_b16 a[30:31], v13 offset:1024
    ds_read_b64_tr_b16 a[108:109], v13 offset:32
    ds_read_b64_tr_b16 a[110:111], v13 offset:1056
    ds_read_b64_tr_b16 a[32:33], v13 offset:8192
    ds_read_b64_tr_b16 a[34:35], v13 offset:9216
    ds_read_b64_tr_b16 a[112:113], v13 offset:8224
    ds_read_b64_tr_b16 a[114:115], v13 offset:9248
    s_waitcnt lgkmcnt(0)
    ds_read_b64_tr_b16 a[36:37], v13 offset:16384
    ds_read_b64_tr_b16 a[38:39], v13 offset:17408
    ds_read_b64_tr_b16 a[116:117], v13 offset:16416
    ds_read_b64_tr_b16 a[118:119], v13 offset:17440
    ds_read_b64_tr_b16 a[40:41], v13 offset:24576
    ds_read_b64_tr_b16 a[42:43], v13 offset:25600
    ds_read_b64_tr_b16 a[120:121], v13 offset:24608
    ds_read_b64_tr_b16 a[122:123], v13 offset:25632
    ds_read_b64_tr_b16 a[44:45], v13 offset:32768
    ds_read_b64_tr_b16 a[46:47], v13 offset:33792
    ds_read_b64_tr_b16 a[124:125], v13 offset:32800
    ds_read_b64_tr_b16 a[126:127], v13 offset:33824
    s_waitcnt lgkmcnt(0)
    ds_read_b64_tr_b16 a[48:49], v13 offset:40960
    ds_read_b64_tr_b16 a[50:51], v13 offset:41984
    ds_read_b64_tr_b16 a[128:129], v13 offset:40992
    ds_read_b64_tr_b16 a[130:131], v13 offset:42016
    ds_read_b64_tr_b16 a[52:53], v13 offset:49152
    ds_read_b64_tr_b16 a[54:55], v13 offset:50176
    ds_read_b64_tr_b16 a[132:133], v13 offset:49184
    ds_read_b64_tr_b16 a[134:135], v13 offset:50208
    v_add_u32 v13, 57344, v13
    ds_read_b64_tr_b16 a[56:57], v13 offset:0
    ds_read_b64_tr_b16 a[58:59], v13 offset:1024
    ds_read_b64_tr_b16 a[136:137], v13 offset:32
    ds_read_b64_tr_b16 a[138:139], v13 offset:1056
    s_waitcnt lgkmcnt(0)
    ds_read_b64_tr_b16 a[60:61], v13 offset:8192
    ds_read_b64_tr_b16 a[62:63], v13 offset:9216
    ds_read_b64_tr_b16 a[140:141], v13 offset:8224
    ds_read_b64_tr_b16 a[142:143], v13 offset:9248
    ds_read_b64_tr_b16 a[64:65], v13 offset:16384
    ds_read_b64_tr_b16 a[66:67], v13 offset:17408
    ds_read_b64_tr_b16 a[144:145], v13 offset:16416
    ds_read_b64_tr_b16 a[146:147], v13 offset:17440
    ds_read_b64_tr_b16 a[68:69], v13 offset:24576
    ds_read_b64_tr_b16 a[70:71], v13 offset:25600
    ds_read_b64_tr_b16 a[148:149], v13 offset:24608
    ds_read_b64_tr_b16 a[150:151], v13 offset:25632
    s_waitcnt lgkmcnt(0)
    ds_read_b64_tr_b16 a[72:73], v13 offset:32768
    ds_read_b64_tr_b16 a[74:75], v13 offset:33792
    ds_read_b64_tr_b16 a[152:153], v13 offset:32800
    ds_read_b64_tr_b16 a[154:155], v13 offset:33824
    ds_read_b64_tr_b16 a[76:77], v13 offset:40960
    ds_read_b64_tr_b16 a[78:79], v13 offset:41984
    ds_read_b64_tr_b16 a[156:157], v13 offset:40992
    ds_read_b64_tr_b16 a[158:159], v13 offset:42016
    s_waitcnt lgkmcnt(0)
    s_barrier
    v_lshrrev_b32 v6, 3, v1
    s_and_b32 s26, s20, 1
    s_lshl_b32 s26, s26, 2
    v_lshrrev_b32 v7, 4, v1
    v_add_u32 v7, s26, v7
    v_and_b32 v2, 7, v1
    v_xor_b32 v7, v7, v2
    v_mul_u32_u24 v6, 1280, v6
    v_lshl_add_u32 v6, v7, 4, v6
    s_mul_i32 s26, s20, 10240
    v_add_u32 v2, s26, v6
    s_mul_i32 s25, s20, 10240
    v_and_b32 v6, 15, v1
    v_lshrrev_b32 v7, 1, v6
    v_lshrrev_b32 v3, 4, v1
    v_xor_b32 v7, v7, v3
    v_lshlrev_b32 v7, 4, v7
    v_lshrrev_b32 v3, 3, v6
    v_mul_u32_u24 v3, 10240, v3
    v_and_b32 v6, 7, v6
    v_lshl_add_u32 v6, v6, 7, v7
    v_add_u32 v3, v3, v6
    v_xor_b32 v93, 64, v3
    v_mov_b32 v92, v3
    v_add_u32 v94, 40960, v92
    v_add_u32 v95, 40960, v93
    v_mul_u32_u24 v102, 2560, v12
    v_and_b32 v13, 1, v10
    v_lshl_add_u32 v102, v13, 5, v102
    v_lshrrev_b32 v13, 1, v10
    v_lshl_add_u32 v102, v13, 4, v102
    s_lshl_b32 s31, s30, 8
    s_lshl_b32 s26, s20, 6
    s_add_u32 s31, s31, s26
    s_add_u32 s31, s31, 1280
    v_mov_b32 v100, 0
    s_mov_b32 s34, 167878656
    s_mov_b32 s23, 167882752
    s_mov_b32 s22, 0
    s_mov_b32 s32, 1
    v_mov_b32 v101, 0
fw_lp_332:
    v_cmp_gt_u32 vcc, s32, v101
    s_cbranch_vccz fw_ok_331
    s_cmp_eq_u32 s100, 0
    s_cbranch_scc1 fw_ok_331
    s_sub_u32 s100, s100, 1
    s_sleep 8
    buffer_load_dword v101, v100, s[4:7], s34 offen sc1
    s_waitcnt vmcnt(0)
    s_branch fw_lp_332
fw_ok_331:
    s_add_u32 m0, s25, 0
    s_nop 0
    buffer_load_dwordx4 v2, s[4:7], s23 offen offset:0 sc1 lds
    s_add_u32 m0, s25, 896
    s_nop 0
    buffer_load_dwordx4 v2, s[4:7], s23 offen offset:128 sc1 lds
    s_add_u32 m0, s25, 1792
    s_nop 0
    buffer_load_dwordx4 v2, s[4:7], s23 offen offset:256 sc1 lds
    s_add_u32 m0, s25, 2688
    s_nop 0
    buffer_load_dwordx4 v2, s[4:7], s23 offen offset:384 sc1 lds
    s_add_u32 m0, s25, 3584
    s_nop 0
    buffer_load_dwordx4 v2, s[4:7], s23 offen offset:512 sc1 lds
    s_add_u32 m0, s25, 4480
    s_nop 0
    buffer_load_dwordx4 v2, s[4:7], s23 offen offset:640 sc1 lds
    s_add_u32 m0, s25, 5376
    s_nop 0
    buffer_load_dwordx4 v2, s[4:7], s23 offen offset:768 sc1 lds
    s_add_u32 m0, s25, 6272
    s_nop 0
    buffer_load_dwordx4 v2, s[4:7], s23 offen offset:896 sc1 lds
    s_add_u32 m0, s25, 7168
    s_nop 0
    buffer_load_dwordx4 v2, s[4:7], s23 offen offset:1024 sc1 lds
    s_add_u32 m0, s25, 8064
    s_nop 0
    buffer_load_dwordx4 v2, s[4:7], s23 offen offset:1152 sc1 lds
B3_loop_333:
    s_waitcnt vmcnt(0)
    s_barrier
    ds_read_b128 v[8:11], v92 offset:0
    ds_read_b128 v[12:15], v92 offset:20480
    ds_read_b128 v[16:19], v93 offset:0
    ds_read_b128 v[20:23], v93 offset:20480
    s_add_u32 s23, s23, 40960
    s_add_u32 m0, s25, 40960
    ds_read_b128 v[24:27], v92 offset:1024
    ds_read_b128 v[28:31], v92 offset:21504
    s_waitcnt lgkmcnt(4)
    v_mfma_f32_16x16x32_bf16 v[32:35], a[0:3], v[8:11], 0
    v_mfma_f32_16x16x32_bf16 v[40:43], a[0:3], v[12:15], 0
    buffer_load_dwordx4 v2, s[4:7], s23 offen offset:0 sc1 lds
    v_mfma_f32_16x16x32_bf16 v[36:39], a[80:83], v[8:11], 0
    v_mfma_f32_16x16x32_bf16 v[44:47], a[80:83], v[12:15], 0
    s_add_u32 m0, s25, 41856
    ds_read_b128 v[8:11], v93 offset:1024
    ds_read_b128 v[12:15], v93 offset:21504
    s_waitcnt lgkmcnt(4)
    v_mfma_f32_16x16x32_bf16 v[32:35], a[4:7], v[16:19], v[32:35]
    v_mfma_f32_16x16x32_bf16 v[40:43], a[4:7], v[20:23], v[40:43]
    buffer_load_dwordx4 v2, s[4:7], s23 offen offset:128 sc1 lds
    v_mfma_f32_16x16x32_bf16 v[36:39], a[84:87], v[16:19], v[36:39]
    v_mfma_f32_16x16x32_bf16 v[44:47], a[84:87], v[20:23], v[44:47]
    s_add_u32 m0, s25, 42752
    ds_read_b128 v[16:19], v92 offset:2048
    ds_read_b128 v[20:23], v92 offset:22528
    s_waitcnt lgkmcnt(4)
    v_mfma_f32_16x16x32_bf16 v[32:35], a[8:11], v[24:27], v[32:35]
    v_mfma_f32_16x16x32_bf16 v[40:43], a[8:11], v[28:31], v[40:43]
    buffer_load_dwordx4 v2, s[4:7], s23 offen offset:256 sc1 lds
    v_mfma_f32_16x16x32_bf16 v[36:39], a[88:91], v[24:27], v[36:39]
    v_mfma_f32_16x16x32_bf16 v[44:47], a[88:91], v[28:31], v[44:47]
    s_add_u32 m0, s25, 43648
    ds_read_b128 v[24:27], v93 offset:2048
    ds_read_b128 v[28:31], v93 offset:22528
    s_waitcnt lgkmcnt(4)
    v_mfma_f32_16x16x32_bf16 v[32:35], a[12:15], v[8:11], v[32:35]
    v_mfma_f32_16x16x32_bf16 v[40:43], a[12:15], v[12:15], v[40:43]
    buffer_load_dwordx4 v2, s[4:7], s23 offen offset:384 sc1 lds
    v_mfma_f32_16x16x32_bf16 v[36:39], a[92:95], v[8:11], v[36:39]
    v_mfma_f32_16x16x32_bf16 v[44:47], a[92:95], v[12:15], v[44:47]
    s_add_u32 m0, s25, 44544
    ds_read_b128 v[8:11], v92 offset:3072
    ds_read_b128 v[12:15], v92 offset:23552
    s_waitcnt lgkmcnt(4)
    v_mfma_f32_16x16x32_bf16 v[32:35], a[16:19], v[16:19], v[32:35]
    v_mfma_f32_16x16x32_bf16 v[40:43], a[16:19], v[20:23], v[40:43]
    buffer_load_dwordx4 v2, s[4:7], s23 offen offset:512 sc1 lds
    v_mfma_f32_16x16x32_bf16 v[36:39], a[96:99], v[16:19], v[36:39]
    v_mfma_f32_16x16x32_bf16 v[44:47], a[96:99], v[20:23], v[44:47]
    s_add_u32 m0, s25, 45440
    ds_read_b128 v[16:19], v93 offset:3072
    ds_read_b128 v[20:23], v93 offset:23552
    s_waitcnt lgkmcnt(4)
    v_mfma_f32_16x16x32_bf16 v[32:35], a[20:23], v[24:27], v[32:35]
    v_mfma_f32_16x16x32_bf16 v[40:43], a[20:23], v[28:31], v[40:43]
    buffer_load_dwordx4 v2, s[4:7], s23 offen offset:640 sc1 lds
    v_mfma_f32_16x16x32_bf16 v[36:39], a[100:103], v[24:27], v[36:39]
    v_mfma_f32_16x16x32_bf16 v[44:47], a[100:103], v[28:31], v[44:47]
    s_add_u32 m0, s25, 46336
    ds_read_b128 v[24:27], v92 offset:4096
    ds_read_b128 v[28:31], v92 offset:24576
    s_waitcnt lgkmcnt(4)
    v_mfma_f32_16x16x32_bf16 v[32:35], a[24:27], v[8:11], v[32:35]
    v_mfma_f32_16x16x32_bf16 v[40:43], a[24:27], v[12:15], v[40:43]
    buffer_load_dwordx4 v2, s[4:7], s23 offen offset:768 sc1 lds
    v_mfma_f32_16x16x32_bf16 v[36:39], a[104:107], v[8:11], v[36:39]
    v_mfma_f32_16x16x32_bf16 v[44:47], a[104:107], v[12:15], v[44:47]
    s_add_u32 m0, s25, 47232
    ds_read_b128 v[8:11], v93 offset:4096
    ds_read_b128 v[12:15], v93 offset:24576
    s_waitcnt lgkmcnt(4)
    v_mfma_f32_16x16x32_bf16 v[32:35], a[28:31], v[16:19], v[32:35]
    v_mfma_f32_16x16x32_bf16 v[40:43], a[28:31], v[20:23], v[40:43]
    buffer_load_dwordx4 v2, s[4:7], s23 offen offset:896 sc1 lds
    v_mfma_f32_16x16x32_bf16 v[36:39], a[108:111], v[16:19], v[36:39]
    v_mfma_f32_16x16x32_bf16 v[44:47], a[108:111], v[20:23], v[44:47]
    s_add_u32 m0, s25, 48128
    ds_read_b128 v[16:19], v92 offset:5120
    ds_read_b128 v[20:23], v92 offset:25600
    s_waitcnt lgkmcnt(4)
    v_mfma_f32_16x16x32_bf16 v[32:35], a[32:35], v[24:27], v[32:35]
    v_mfma_f32_16x16x32_bf16 v[40:43], a[32:35], v[28:31], v[40:43]
    buffer_load_dwordx4 v2, s[4:7], s23 offen offset:1024 sc1 lds
    v_mfma_f32_16x16x32_bf16 v[36:39], a[112:115], v[24:27], v[36:39]
    v_mfma_f32_16x16x32_bf16 v[44:47], a[112:115], v[28:31], v[44:47]
    s_add_u32 m0, s25, 49024
    ds_read_b128 v[24:27], v93 offset:5120
    ds_read_b128 v[28:31], v93 offset:25600
    s_waitcnt lgkmcnt(4)
    v_mfma_f32_16x16x32_bf16 v[32:35], a[36:39], v[8:11], v[32:35]
    v_mfma_f32_16x16x32_bf16 v[40:43], a[36:39], v[12:15], v[40:43]
    buffer_load_dwordx4 v2, s[4:7], s23 offen offset:1152 sc1 lds
    v_mfma_f32_16x16x32_bf16 v[36:39], a[116:119], v[8:11], v[36:39]
    v_mfma_f32_16x16x32_bf16 v[44:47], a[116:119], v[12:15], v[44:47]
    ds_read_b128 v[8:11], v92 offset:6144
    ds_read_b128 v[12:15], v92 offset:26624
    s_waitcnt lgkmcnt(4)
    v_mfma_f32_16x16x32_bf16 v[32:35], a[40:43], v[16:19], v[32:35]
    v_mfma_f32_16x16x32_bf16 v[40:43], a[40:43], v[20:23], v[40:43]
    v_mfma_f32_16x16x32_bf16 v[36:39], a[120:123], v[16:19], v[36:39]
    v_mfma_f32_16x16x32_bf16 v[44:47], a[120:123], v[20:23], v[44:47]
    ds_read_b128 v[16:19], v93 offset:6144
    ds_read_b128 v[20:23], v93 offset:26624
    s_waitcnt lgkmcnt(4)
    v_mfma_f32_16x16x32_bf16 v[32:35], a[44:47], v[24:27], v[32:35]
    v_mfma_f32_16x16x32_bf16 v[40:43], a[44:47], v[28:31], v[40:43]
    v_mfma_f32_16x16x32_bf16 v[36:39], a[124:127], v[24:27], v[36:39]
    v_mfma_f32_16x16x32_bf16 v[44:47], a[124:127], v[28:31], v[44:47]
    ds_read_b128 v[24:27], v92 offset:7168
    ds_read_b128 v[28:31], v92 offset:27648
    s_waitcnt lgkmcnt(4)
    v_mfma_f32_16x16x32_bf16 v[32:35], a[48:51], v[8:11], v[32:35]
    v_mfma_f32_16x16x32_bf16 v[40:43], a[48:51], v[12:15], v[40:43]
    v_mfma_f32_16x16x32_bf16 v[36:39], a[128:131], v[8:11], v[36:39]
    v_mfma_f32_16x16x32_bf16 v[44:47], a[128:131], v[12:15], v[44:47]
    ds_read_b128 v[8:11], v93 offset:7168
    ds_read_b128 v[12:15], v93 offset:27648
    s_waitcnt lgkmcnt(4)
    v_mfma_f32_16x16x32_bf16 v[32:35], a[52:55], v[16:19], v[32:35]
    v_mfma_f32_16x16x32_bf16 v[40:43], a[52:55], v[20:23], v[40:43]
    v_mfma_f32_16x16x32_bf16 v[36:39], a[132:135], v[16:19], v[36:39]
    v_mfma_f32_16x16x32_bf16 v[44:47], a[132:135], v[20:23], v[44:47]
    ds_read_b128 v[16:19], v92 offset:8192
    ds_read_b128 v[20:23], v92 offset:28672
    s_waitcnt lgkmcnt(4)
    v_mfma_f32_16x16x32_bf16 v[32:35], a[56:59], v[24:27], v[32:35]
    v_mfma_f32_16x16x32_bf16 v[40:43], a[56:59], v[28:31], v[40:43]
    v_mfma_f32_16x16x32_bf16 v[36:39], a[136:139], v[24:27], v[36:39]
    v_mfma_f32_16x16x32_bf16 v[44:47], a[136:139], v[28:31], v[44:47]
    ds_read_b128 v[24:27], v93 offset:8192
    ds_read_b128 v[28:31], v93 offset:28672
    s_waitcnt lgkmcnt(4)
    v_mfma_f32_16x16x32_bf16 v[32:35], a[60:63], v[8:11], v[32:35]
    v_mfma_f32_16x16x32_bf16 v[40:43], a[60:63], v[12:15], v[40:43]
    v_mfma_f32_16x16x32_bf16 v[36:39], a[140:143], v[8:11], v[36:39]
    v_mfma_f32_16x16x32_bf16 v[44:47], a[140:143], v[12:15], v[44:47]
    ds_read_b128 v[8:11], v92 offset:9216
    ds_read_b128 v[12:15], v92 offset:29696
    s_waitcnt lgkmcnt(4)
    v_mfma_f32_16x16x32_bf16 v[32:35], a[64:67], v[16:19], v[32:35]
    v_mfma_f32_16x16x32_bf16 v[40:43], a[64:67], v[20:23], v[40:43]
    v_mfma_f32_16x16x32_bf16 v[36:39], a[144:147], v[16:19], v[36:39]
    v_mfma_f32_16x16x32_bf16 v[44:47], a[144:147], v[20:23], v[44:47]
    ds_read_b128 v[16:19], v93 offset:9216
    ds_read_b128 v[20:23], v93 offset:29696
    s_waitcnt lgkmcnt(4)
    v_mfma_f32_16x16x32_bf16 v[32:35], a[68:71], v[24:27], v[32:35]
    v_mfma_f32_16x16x32_bf16 v[40:43], a[68:71], v[28:31], v[40:43]
    v_mfma_f32_16x16x32_bf16 v[36:39], a[148:151], v[24:27], v[36:39]
    v_mfma_f32_16x16x32_bf16 v[44:47], a[148:151], v[28:31], v[44:47]
    s_waitcnt lgkmcnt(2)
    v_mfma_f32_16x16x32_bf16 v[32:35], a[72:75], v[8:11], v[32:35]
    v_mfma_f32_16x16x32_bf16 v[40:43], a[72:75], v[12:15], v[40:43]
    v_mfma_f32_16x16x32_bf16 v[36:39], a[152:155], v[8:11], v[36:39]
    v_mfma_f32_16x16x32_bf16 v[44:47], a[152:155], v[12:15], v[44:47]
    s_waitcnt lgkmcnt(0)
    v_mfma_f32_16x16x32_bf16 v[32:35], a[76:79], v[16:19], v[32:35]
    v_mfma_f32_16x16x32_bf16 v[40:43], a[76:79], v[20:23], v[40:43]
    v_mfma_f32_16x16x32_bf16 v[36:39], a[156:159], v[16:19], v[36:39]
    v_mfma_f32_16x16x32_bf16 v[44:47], a[156:159], v[20:23], v[44:47]
    s_nop 4
    v_cvt_pk_bf16_f32 v104, v32, v33
    v_cvt_pk_bf16_f32 v105, v34, v35
    v_cvt_pk_bf16_f32 v106, v36, v37
    v_cvt_pk_bf16_f32 v107, v38, v39
    v_cvt_pk_bf16_f32 v108, v40, v41
    v_cvt_pk_bf16_f32 v109, v42, v43
    v_cvt_pk_bf16_f32 v110, v44, v45
    v_cvt_pk_bf16_f32 v111, v46, v47
    s_add_u32 s26, s31, 40960
    v_permlane16_swap_b32 v104, v106
    v_permlane16_swap_b32 v105, v107
    buffer_store_dwordx4 v[104:107], v102, s[16:19], s31 offen nt
    v_permlane16_swap_b32 v108, v110
    v_permlane16_swap_b32 v109, v111
    buffer_store_dwordx4 v[108:111], v102, s[16:19], s26 offen nt
    s_add_u32 s31, s31, 81920
    s_add_u32 s22, s22, 1
    s_waitcnt vmcnt(0)
    s_barrier
    ds_read_b128 v[8:11], v94 offset:0
    ds_read_b128 v[12:15], v94 offset:20480
    ds_read_b128 v[16:19], v95 offset:0
    ds_read_b128 v[20:23], v95 offset:20480
    s_add_u32 s23, s23, 40960
    s_add_u32 s34, s34, 128
    s_min_u32 s34, s34, 167882624
    v_mov_b32 v101, 0
fw_lp_335:
    v_cmp_gt_u32 vcc, s32, v101
    s_cbranch_vccz fw_ok_334
    s_cmp_eq_u32 s100, 0
    s_cbranch_scc1 fw_ok_334
    s_sub_u32 s100, s100, 1
    s_sleep 8
    buffer_load_dword v101, v100, s[4:7], s34 offen sc1
    s_waitcnt vmcnt(0)
    s_branch fw_lp_335
fw_ok_334:
    s_add_u32 m0, s25, 0
    ds_read_b128 v[24:27], v94 offset:1024
    ds_read_b128 v[28:31], v94 offset:21504
    s_waitcnt lgkmcnt(4)
    v_mfma_f32_16x16x32_bf16 v[32:35], a[0:3], v[8:11], 0
    v_mfma_f32_16x16x32_bf16 v[40:43], a[0:3], v[12:15], 0
    buffer_load_dwordx4 v2, s[4:7], s23 offen offset:0 sc1 lds
    v_mfma_f32_16x16x32_bf16 v[36:39], a[80:83], v[8:11], 0
    v_mfma_f32_16x16x32_bf16 v[44:47], a[80:83], v[12:15], 0
    s_add_u32 m0, s25, 896
    ds_read_b128 v[8:11], v95 offset:1024
    ds_read_b128 v[12:15], v95 offset:21504
    s_waitcnt lgkmcnt(4)
    v_mfma_f32_16x16x32_bf16 v[32:35], a[4:7], v[16:19], v[32:35]
    v_mfma_f32_16x16x32_bf16 v[40:43], a[4:7], v[20:23], v[40:43]
    buffer_load_dwordx4 v2, s[4:7], s23 offen offset:128 sc1 lds
    v_mfma_f32_16x16x32_bf16 v[36:39], a[84:87], v[16:19], v[36:39]
    v_mfma_f32_16x16x32_bf16 v[44:47], a[84:87], v[20:23], v[44:47]
    s_add_u32 m0, s25, 1792
    ds_read_b128 v[16:19], v94 offset:2048
    ds_read_b128 v[20:23], v94 offset:22528
    s_waitcnt lgkmcnt(4)
    v_mfma_f32_16x16x32_bf16 v[32:35], a[8:11], v[24:27], v[32:35]
    v_mfma_f32_16x16x32_bf16 v[40:43], a[8:11], v[28:31], v[40:43]
    buffer_load_dwordx4 v2, s[4:7], s23 offen offset:256 sc1 lds
    v_mfma_f32_16x16x32_bf16 v[36:39], a[88:91], v[24:27], v[36:39]
    v_mfma_f32_16x16x32_bf16 v[44:47], a[88:91], v[28:31], v[44:47]
    s_add_u32 m0, s25, 2688
    ds_read_b128 v[24:27], v95 offset:2048
    ds_read_b128 v[28:31], v95 offset:22528
    s_waitcnt lgkmcnt(4)
    v_mfma_f32_16x16x32_bf16 v[32:35], a[12:15], v[8:11], v[32:35]
    v_mfma_f32_16x16x32_bf16 v[40:43], a[12:15], v[12:15], v[40:43]
    buffer_load_dwordx4 v2, s[4:7], s23 offen offset:384 sc1 lds
    v_mfma_f32_16x16x32_bf16 v[36:39], a[92:95], v[8:11], v[36:39]
    v_mfma_f32_16x16x32_bf16 v[44:47], a[92:95], v[12:15], v[44:47]
    s_add_u32 m0, s25, 3584
    ds_read_b128 v[8:11], v94 offset:3072
    ds_read_b128 v[12:15], v94 offset:23552
    s_waitcnt lgkmcnt(4)
    v_mfma_f32_16x16x32_bf16 v[32:35], a[16:19], v[16:19], v[32:35]
    v_mfma_f32_16x16x32_bf16 v[40:43], a[16:19], v[20:23], v[40:43]
    buffer_load_dwordx4 v2, s[4:7], s23 offen offset:512 sc1 lds
    v_mfma_f32_16x16x32_bf16 v[36:39], a[96:99], v[16:19], v[36:39]
    v_mfma_f32_16x16x32_bf16 v[44:47], a[96:99], v[20:23], v[44:47]
    s_add_u32 m0, s25, 4480
    ds_read_b128 v[16:19], v95 offset:3072
    ds_read_b128 v[20:23], v95 offset:23552
    s_waitcnt lgkmcnt(4)
    v_mfma_f32_16x16x32_bf16 v[32:35], a[20:23], v[24:27], v[32:35]
    v_mfma_f32_16x16x32_bf16 v[40:43], a[20:23], v[28:31], v[40:43]
    buffer_load_dwordx4 v2, s[4:7], s23 offen offset:640 sc1 lds
    v_mfma_f32_16x16x32_bf16 v[36:39], a[100:103], v[24:27], v[36:39]
    v_mfma_f32_16x16x32_bf16 v[44:47], a[100:103], v[28:31], v[44:47]
    s_add_u32 m0, s25, 5376
    ds_read_b128 v[24:27], v94 offset:4096
    ds_read_b128 v[28:31], v94 offset:24576
    s_waitcnt lgkmcnt(4)
    v_mfma_f32_16x16x32_bf16 v[32:35], a[24:27], v[8:11], v[32:35]
    v_mfma_f32_16x16x32_bf16 v[40:43], a[24:27], v[12:15], v[40:43]
    buffer_load_dwordx4 v2, s[4:7], s23 offen offset:768 sc1 lds
    v_mfma_f32_16x16x32_bf16 v[36:39], a[104:107], v[8:11], v[36:39]
    v_mfma_f32_16x16x32_bf16 v[44:47], a[104:107], v[12:15], v[44:47]
    s_add_u32 m0, s25, 6272
    ds_read_b128 v[8:11], v95 offset:4096
    ds_read_b128 v[12:15], v95 offset:24576
    s_waitcnt lgkmcnt(4)
    v_mfma_f32_16x16x32_bf16 v[32:35], a[28:31], v[16:19], v[32:35]
    v_mfma_f32_16x16x32_bf16 v[40:43], a[28:31], v[20:23], v[40:43]
    buffer_load_dwordx4 v2, s[4:7], s23 offen offset:896 sc1 lds
    v_mfma_f32_16x16x32_bf16 v[36:39], a[108:111], v[16:19], v[36:39]
    v_mfma_f32_16x16x32_bf16 v[44:47], a[108:111], v[20:23], v[44:47]
    s_add_u32 m0, s25, 7168
    ds_read_b128 v[16:19], v94 offset:5120
    ds_read_b128 v[20:23], v94 offset:25600
    s_waitcnt lgkmcnt(4)
    v_mfma_f32_16x16x32_bf16 v[32:35], a[32:35], v[24:27], v[32:35]
    v_mfma_f32_16x16x32_bf16 v[40:43], a[32:35], v[28:31], v[40:43]
    buffer_load_dwordx4 v2, s[4:7], s23 offen offset:1024 sc1 lds
    v_mfma_f32_16x16x32_bf16 v[36:39], a[112:115], v[24:27], v[36:39]
    v_mfma_f32_16x16x32_bf16 v[44:47], a[112:115], v[28:31], v[44:47]
    s_add_u32 m0, s25, 8064
    ds_read_b128 v[24:27], v95 offset:5120
    ds_read_b128 v[28:31], v95 offset:25600
    s_waitcnt lgkmcnt(4)
    v_mfma_f32_16x16x32_bf16 v[32:35], a[36:39], v[8:11], v[32:35]
    v_mfma_f32_16x16x32_bf16 v[40:43], a[36:39], v[12:15], v[40:43]
    buffer_load_dwordx4 v2, s[4:7], s23 offen offset:1152 sc1 lds
    v_mfma_f32_16x16x32_bf16 v[36:39], a[116:119], v[8:11], v[36:39]
    v_mfma_f32_16x16x32_bf16 v[44:47], a[116:119], v[12:15], v[44:47]
    ds_read_b128 v[8:11], v94 offset:6144
    ds_read_b128 v[12:15], v94 offset:26624
    s_waitcnt lgkmcnt(4)
    v_mfma_f32_16x16x32_bf16 v[32:35], a[40:43], v[16:19], v[32:35]
    v_mfma_f32_16x16x32_bf16 v[40:43], a[40:43], v[20:23], v[40:43]
    v_mfma_f32_16x16x32_bf16 v[36:39], a[120:123], v[16:19], v[36:39]
    v_mfma_f32_16x16x32_bf16 v[44:47], a[120:123], v[20:23], v[44:47]
    ds_read_b128 v[16:19], v95 offset:6144
    ds_read_b128 v[20:23], v95 offset:26624
    s_waitcnt lgkmcnt(4)
    v_mfma_f32_16x16x32_bf16 v[32:35], a[44:47], v[24:27], v[32:35]
    v_mfma_f32_16x16x32_bf16 v[40:43], a[44:47], v[28:31], v[40:43]
    v_mfma_f32_16x16x32_bf16 v[36:39], a[124:127], v[24:27], v[36:39]
    v_mfma_f32_16x16x32_bf16 v[44:47], a[124:127], v[28:31], v[44:47]
    ds_read_b128 v[24:27], v94 offset:7168
    ds_read_b128 v[28:31], v94 offset:27648
    s_waitcnt lgkmcnt(4)
    v_mfma_f32_16x16x32_bf16 v[32:35], a[48:51], v[8:11], v[32:35]
    v_mfma_f32_16x16x32_bf16 v[40:43], a[48:51], v[12:15], v[40:43]
    v_mfma_f32_16x16x32_bf16 v[36:39], a[128:131], v[8:11], v[36:39]
    v_mfma_f32_16x16x32_bf16 v[44:47], a[128:131], v[12:15], v[44:47]
    ds_read_b128 v[8:11], v95 offset:7168
    ds_read_b128 v[12:15], v95 offset:27648
    s_waitcnt lgkmcnt(4)
    v_mfma_f32_16x16x32_bf16 v[32:35], a[52:55], v[16:19], v[32:35]
    v_mfma_f32_16x16x32_bf16 v[40:43], a[52:55], v[20:23], v[40:43]
    v_mfma_f32_16x16x32_bf16 v[36:39], a[132:135], v[16:19], v[36:39]
    v_mfma_f32_16x16x32_bf16 v[44:47], a[132:135], v[20:23], v[44:47]
    ds_read_b128 v[16:19], v94 offset:8192
    ds_read_b128 v[20:23], v94 offset:28672
    s_waitcnt lgkmcnt(4)
    v_mfma_f32_16x16x32_bf16 v[32:35], a[56:59], v[24:27], v[32:35]
    v_mfma_f32_16x16x32_bf16 v[40:43], a[56:59], v[28:31], v[40:43]
    v_mfma_f32_16x16x32_bf16 v[36:39], a[136:139], v[24:27], v[36:39]
    v_mfma_f32_16x16x32_bf16 v[44:47], a[136:139], v[28:31], v[44:47]
    ds_read_b128 v[24:27], v95 offset:8192
    ds_read_b128 v[28:31], v95 offset:28672
    s_waitcnt lgkmcnt(4)
    v_mfma_f32_16x16x32_bf16 v[32:35], a[60:63], v[8:11], v[32:35]
    v_mfma_f32_16x16x32_bf16 v[40:43], a[60:63], v[12:15], v[40:43]
    v_mfma_f32_16x16x32_bf16 v[36:39], a[140:143], v[8:11], v[36:39]
    v_mfma_f32_16x16x32_bf16 v[44:47], a[140:143], v[12:15], v[44:47]
    ds_read_b128 v[8:11], v94 offset:9216
    ds_read_b128 v[12:15], v94 offset:29696
    s_waitcnt lgkmcnt(4)
    v_mfma_f32_16x16x32_bf16 v[32:35], a[64:67], v[16:19], v[32:35]
    v_mfma_f32_16x16x32_bf16 v[40:43], a[64:67], v[20:23], v[40:43]
    v_mfma_f32_16x16x32_bf16 v[36:39], a[144:147], v[16:19], v[36:39]
    v_mfma_f32_16x16x32_bf16 v[44:47], a[144:147], v[20:23], v[44:47]
    ds_read_b128 v[16:19], v95 offset:9216
    ds_read_b128 v[20:23], v95 offset:29696
    s_waitcnt lgkmcnt(4)
    v_mfma_f32_16x16x32_bf16 v[32:35], a[68:71], v[24:27], v[32:35]
    v_mfma_f32_16x16x32_bf16 v[40:43], a[68:71], v[28:31], v[40:43]
    v_mfma_f32_16x16x32_bf16 v[36:39], a[148:151], v[24:27], v[36:39]
    v_mfma_f32_16x16x32_bf16 v[44:47], a[148:151], v[28:31], v[44:47]
    s_waitcnt lgkmcnt(2)
    v_mfma_f32_16x16x32_bf16 v[32:35], a[72:75], v[8:11], v[32:35]
    v_mfma_f32_16x16x32_bf16 v[40:43], a[72:75], v[12:15], v[40:43]
    v_mfma_f32_16x16x32_bf16 v[36:39], a[152:155], v[8:11], v[36:39]
    v_mfma_f32_16x16x32_bf16 v[44:47], a[152:155], v[12:15], v[44:47]
    s_waitcnt lgkmcnt(0)
    v_mfma_f32_16x16x32_bf16 v[32:35], a[76:79], v[16:19], v[32:35]
    v_mfma_f32_16x16x32_bf16 v[40:43], a[76:79], v[20:23], v[40:43]
    v_mfma_f32_16x16x32_bf16 v[36:39], a[156:159], v[16:19], v[36:39]
    v_mfma_f32_16x16x32_bf16 v[44:47], a[156:159], v[20:23], v[44:47]
    s_nop 4
    v_cvt_pk_bf16_f32 v104, v32, v33
    v_cvt_pk_bf16_f32 v105, v34, v35
    v_cvt_pk_bf16_f32 v106, v36, v37
    v_cvt_pk_bf16_f32 v107, v38, v39
    v_cvt_pk_bf16_f32 v108, v40, v41
    v_cvt_pk_bf16_f32 v109, v42, v43
    v_cvt_pk_bf16_f32 v110, v44, v45
    v_cvt_pk_bf16_f32 v111, v46, v47
    s_add_u32 s26, s31, 40960
    v_permlane16_swap_b32 v104, v106
    v_permlane16_swap_b32 v105, v107
    buffer_store_dwordx4 v[104:107], v102, s[16:19], s31 offen nt
    v_permlane16_swap_b32 v108, v110
    v_permlane16_swap_b32 v109, v111
    buffer_store_dwordx4 v[108:111], v102, s[16:19], s26 offen nt
    s_add_u32 s31, s31, 81920
    s_add_u32 s22, s22, 1
    s_cmp_lt_u32 s22, 64
    s_cbranch_scc1 B3_loop_333
    s_waitcnt vmcnt(0)
    s_branch L_end
L_f:
    s_sub_u32 s22, s25, 165
    s_mov_b32 s36, 27
    s_load_dwordx2 s[16:17], s[0:1], 80
    v_lshlrev_b32 v2, 4, v1
    v_add_u32 v8, 40960, v2
    v_and_b32 v9, 31, v1
    v_mul_u32_u24 v9, 2560, v9
    v_lshrrev_b32 v10, 5, v1
    v_lshl_add_u32 v3, v10, 4, v9
    v_mov_b32 v4, 0
    s_mov_b32 s37, 0
    s_mov_b32 s38, 0
    s_mov_b32 s39, 0
    s_mul_i32 s34, s20, 20480
    s_waitcnt lgkmcnt(0)
    s_and_b32 s17, s17, 0xffff
    s_mov_b32 s18, 5242880
    s_mov_b32 s19, 0x20000
    s_cmp_eq_u32 s22, 0
    s_cbranch_scc1 F_nw_336
    s_load_dwordx2 s[12:13], s[0:1], 0
    s_load_dwordx2 s[8:9], s[0:1], 56
    s_sub_u32 s26, s22, 1
    s_lshl_b32 s26, s26, 2
    s_add_u32 s26, s26, s20
    s_lshl_b32 s26, s26, 13
    v_lshlrev_b32 v28, 7, v1
    s_waitcnt lgkmcnt(0)
    s_and_b32 s13, s13, 0xffff
    s_mov_b32 s14, 2621440
    s_mov_b32 s15, 0x20000
    s_and_b32 s9, s9, 0xffff
    s_mov_b32 s10, 2621440
    s_mov_b32 s11, 0x20000
    buffer_load_dword v29, v28, s[12:15], s26 offen
    s_add_u32 s26, s26, 884736
F_nw_336:
    v_mov_b32 v12, -1
    v_mov_b32 v13, -1
    v_mov_b32 v14, -1
    v_mov_b32 v15, -1
    s_lshl_b32 s26, s20, 10
    v_add_u32 v16, s26, v2
    s_sub_u32 s33, s22, 1
    s_cbranch_scc1 F_skip_337
    s_lshl_b32 s26, s33, 12
    s_add_u32 s26, s26, 166723584
F_po_338:
    buffer_store_dwordx4 v[12:15], v16, s[4:7], s26 offen sc0 sc1
    s_add_u32 s26, s26, 106496
    s_cmp_lt_u32 s26, 167829504
    s_cbranch_scc1 F_po_338
    s_mov_b32 s27, s33
F_pr_339:
    s_mul_i32 s30, s27, 6554
    s_lshr_b32 s30, s30, 16
    s_mul_i32 s31, s30, 10
    s_sub_u32 s31, s27, s31
    s_cmp_eq_u32 s31, 9
    s_cselect_b32 s31, 10, s31
    s_lshl_b32 s31, s31, 12
    s_mul_i32 s26, s30, 49152
    s_cmp_ge_u32 s30, 42
    s_cselect_b32 s30, 32768, 0
    s_add_u32 s26, s26, s30
    s_add_u32 s26, s26, s31
    s_add_u32 s26, s26, 171966464
    buffer_store_dwordx4 v[12:15], v16, s[4:7], s26 offen sc0 sc1
    s_cmp_ge_u32 s31, 32768
    s_cselect_b32 exec_lo, 0xffff, 0
    s_mov_b32 exec_hi, 0
    s_add_u32 s26, s26, 4096
    buffer_store_dwordx4 v[12:15], v2, s[4:7], s26 offen sc0 sc1
    s_mov_b64 exec, -1
    s_add_u32 s27, s27, 26
    s_cmp_lt_u32 s27, 630
    s_cbranch_scc1 F_pr_339
    s_cmp_ge_u32 s33, 13
    s_cbranch_scc1 F_nz_340
    v_mov_b32 v20, 0
    v_mov_b32 v21, 0
    v_mov_b32 v22, 0
    v_mov_b32 v23, 0
    s_lshl_b32 s26, s33, 12
    s_add_u32 s26, s26, 167829504
    buffer_store_dwordx4 v[20:23], v16, s[4:7], s26 offen sc0 sc1
F_nz_340:
F_skip_337:
    s_waitcnt vmcnt(0)
    s_or_b32 s26, s22, s20
    s_cbranch_scc1 F_np_341
    s_mov_b32 s44, 174030848
    s_mov_b32 s45, 174034944
    s_mov_b32 s46, 174039040
    s_mov_b32 s47, 174043136
    s_mov_b32 s48, 174047232
    s_mov_b32 s49, 174051328
    s_mov_b32 s50, 174055424
    s_mov_b32 s51, 174059520
    s_mov_b64 exec, 0xffff
    buffer_store_dwordx4 v[12:15], v2, s[4:7], s44 offen sc0 sc1
    buffer_store_dwordx4 v[12:15], v2, s[4:7], s45 offen sc0 sc1
    buffer_store_dwordx4 v[12:15], v2, s[4:7], s46 offen sc0 sc1
    buffer_store_dwordx4 v[12:15], v2, s[4:7], s47 offen sc0 sc1
    buffer_store_dwordx4 v[12:15], v2, s[4:7], s48 offen sc0 sc1
    buffer_store_dwordx4 v[12:15], v2, s[4:7], s49 offen sc0 sc1
    buffer_store_dwordx4 v[12:15], v2, s[4:7], s50 offen sc0 sc1
    buffer_store_dwordx4 v[12:15], v2, s[4:7], s51 offen sc0 sc1
    s_mov_b64 exec, 1
    s_waitcnt vmcnt(0)
    s_mov_b32 s30, -1
    s_mov_b32 s31, -1
    s_memtime s[40:41]
    s_waitcnt lgkmcnt(0)
    buffer_load_dword v25, v4, s[4:7], s44 offen offset:0 sc1
    s_waitcnt vmcnt(0)
    s_memtime s[42:43]
    s_waitcnt lgkmcnt(0)
    s_sub_u32 s42, s42, s40
    s_min_u32 s30, s30, s42
    s_memtime s[40:41]
    s_waitcnt lgkmcnt(0)
    buffer_load_dword v25, v4, s[4:7], s46 offen offset:0 sc1
    s_waitcnt vmcnt(0)
    s_memtime s[42:43]
    s_waitcnt lgkmcnt(0)
    s_sub_u32 s42, s42, s40
    s_min_u32 s31, s31, s42
    s_memtime s[40:41]
    s_waitcnt lgkmcnt(0)
    buffer_load_dword v25, v4, s[4:7], s45 offen offset:0 sc1
    s_waitcnt vmcnt(0)
    s_memtime s[42:43]
    s_waitcnt lgkmcnt(0)
    s_sub_u32 s42, s42, s40
    s_min_u32 s30, s30, s42
    s_memtime s[40:41]
    s_waitcnt lgkmcnt(0)
    buffer_load_dword v25, v4, s[4:7], s47 offen offset:0 sc1
    s_waitcnt vmcnt(0)
    s_memtime s[42:43]
    s_waitcnt lgkmcnt(0)
    s_sub_u32 s42, s42, s40
    s_min_u32 s31, s31, s42
    s_memtime s[40:41]
    s_waitcnt lgkmcnt(0)
    buffer_load_dword v25, v4, s[4:7], s48 offen offset:0 sc1
    s_waitcnt vmcnt(0)
    s_memtime s[42:43]
    s_waitcnt lgkmcnt(0)
    s_sub_u32 s42, s42, s40
    s_min_u32 s30, s30, s42
    s_memtime s[40:41]
    s_waitcnt lgkmcnt(0)
    buffer_load_dword v25, v4, s[4:7], s50 offen offset:0 sc1
    s_waitcnt vmcnt(0)
    s_memtime s[42:43]
    s_waitcnt lgkmcnt(0)
    s_sub_u32 s42, s42, s40
    s_min_u32 s31, s31, s42
    s_memtime s[40:41]
    s_waitcnt lgkmcnt(0)
    buffer_load_dword v25, v4, s[4:7], s49 offen offset:0 sc1
    s_waitcnt vmcnt(0)
    s_memtime s[42:43]
    s_waitcnt lgkmcnt(0)
    s_sub_u32 s42, s42, s40
    s_min_u32 s30, s30, s42
    s_memtime s[40:41]
    s_waitcnt lgkmcnt(0)
    buffer_load_dword v25, v4, s[4:7], s51 offen offset:0 sc1
    s_waitcnt vmcnt(0)
    s_memtime s[42:43]
    s_waitcnt lgkmcnt(0)
    s_sub_u32 s42, s42, s40
    s_min_u32 s31, s31, s42
    s_memtime s[40:41]
    s_waitcnt lgkmcnt(0)
    buffer_load_dword v25, v4, s[4:7], s44 offen offset:128 sc1
    s_waitcnt vmcnt(0)
    s_memtime s[42:43]
    s_waitcnt lgkmcnt(0)
    s_sub_u32 s42, s42, s40
    s_min_u32 s30, s30, s42
    s_memtime s[40:41]
    s_waitcnt lgkmcnt(0)
    buffer_load_dword v25, v4, s[4:7], s46 offen offset:128 sc1
    s_waitcnt vmcnt(0)
    s_memtime s[42:43]
    s_waitcnt lgkmcnt(0)
    s_sub_u32 s42, s42, s40
    s_min_u32 s31, s31, s42
    s_memtime s[40:41]
    s_waitcnt lgkmcnt(0)
    buffer_load_dword v25, v4, s[4:7], s45 offen offset:128 sc1
    s_waitcnt vmcnt(0)
    s_memtime s[42:43]
    s_waitcnt lgkmcnt(0)
    s_sub_u32 s42, s42, s40
    s_min_u32 s30, s30, s42
    s_memtime s[40:41]
    s_waitcnt lgkmcnt(0)
    buffer_load_dword v25, v4, s[4:7], s47 offen offset:128 sc1
    s_waitcnt vmcnt(0)
    s_memtime s[42:43]
    s_waitcnt lgkmcnt(0)
    s_sub_u32 s42, s42, s40
    s_min_u32 s31, s31, s42
    s_memtime s[40:41]
    s_waitcnt lgkmcnt(0)
    buffer_load_dword v25, v4, s[4:7], s48 offen offset:128 sc1
    s_waitcnt vmcnt(0)
    s_memtime s[42:43]
    s_waitcnt lgkmcnt(0)
    s_sub_u32 s42, s42, s40
    s_min_u32 s30, s30, s42
    s_memtime s[40:41]
    s_waitcnt lgkmcnt(0)
    buffer_load_dword v25, v4, s[4:7], s50 offen offset:128 sc1
    s_waitcnt vmcnt(0)
    s_memtime s[42:43]
    s_waitcnt lgkmcnt(0)
    s_sub_u32 s42, s42, s40
    s_min_u32 s31, s31, s42
    s_memtime s[40:41]
    s_waitcnt lgkmcnt(0)
    buffer_load_dword v25, v4, s[4:7], s49 offen offset:128 sc1
    s_waitcnt vmcnt(0)
    s_memtime s[42:43]
    s_waitcnt lgkmcnt(0)
    s_sub_u32 s42, s42, s40
    s_min_u32 s30, s30, s42
    s_memtime s[40:41]
    s_waitcnt lgkmcnt(0)
    buffer_load_dword v25, v4, s[4:7], s51 offen offset:128 sc1
    s_waitcnt vmcnt(0)
    s_memtime s[42:43]
    s_waitcnt lgkmcnt(0)
    s_sub_u32 s42, s42, s40
    s_min_u32 s31, s31, s42
    s_getreg_b32 s27, hwreg(HW_REG_XCC_ID, 2, 1)
    s_mul_i32 s27, s27, 3
    s_cmp_gt_u32 s30, s31
    s_cselect_b32 s26, 1, 2
    s_xor_b32 s26, s26, s27
    v_mov_b32 v24, s26
    global_store_dword v4, v24, s[98:99] offset:4 sc0 sc1
    s_mov_b64 exec, -1
    s_waitcnt vmcnt(0)
F_np_341:
    s_barrier
    s_cmp_lg_u32 s20, 0
    s_cbranch_scc1 F_na_342
    v_mov_b32 v12, 1
    s_mov_b64 exec, 1
    global_atomic_add v4, v12, s[98:99] sc1
    s_mov_b64 exec, -1
F_na_342:
    v_mov_b32 v18, 0
    global_load_dword v17, v18, s[98:99] sc1
    s_waitcnt vmcnt(0)
iw_lp_344:
    v_cmp_gt_u32 vcc, 27, v17
    s_cbranch_vccz iw_ok_343
    s_cmp_eq_u32 s100, 0
    s_cbranch_scc1 iw_ok_343
    s_sub_u32 s100, s100, 1
    s_sleep 2
    global_load_dword v17, v18, s[98:99] sc1
    s_waitcnt vmcnt(0)
    s_branch iw_lp_344
iw_ok_343:
    s_mov_b32 s27, s22
    s_mul_i32 s23, s27, 6554
    s_lshr_b32 s23, s23, 16
    s_mul_i32 s26, s23, 10
    s_sub_u32 s24, s27, s26
    s_lshl_b32 s24, s24, 2
    s_add_u32 s24, s24, s20
    s_cmp_lt_u32 s23, s37
    s_cbranch_scc1 F_kn_345
    s_lshl_b32 s35, s23, 7
    s_add_u32 s35, s35, 167841792
    s_mov_b32 s28, 32
    v_mov_b32 v6, 0
fw_lp_347:
    v_cmp_gt_u32 vcc, s28, v6
    s_cbranch_vccz fw_ok_346
    s_cmp_eq_u32 s100, 0
    s_cbranch_scc1 fw_ok_346
    s_sub_u32 s100, s100, 1
    s_sleep 6
    buffer_load_dword v6, v4, s[4:7], s35 offen sc1
    s_waitcnt vmcnt(0)
    s_branch fw_lp_347
fw_ok_346:
    s_add_u32 s37, s23, 1
F_kn_345:
    s_mul_i32 s30, s23, 1310720
    s_lshl_b32 s26, s24, 10
    s_add_u32 s30, s30, s26
    s_add_u32 s30, s30, 50331648
    buffer_load_dwordx4 a[0:3], v2, s[4:7], s30 offen sc1
    s_add_u32 s30, s30, 40960
    buffer_load_dwordx4 a[4:7], v2, s[4:7], s30 offen sc1
    s_add_u32 s30, s30, 40960
    buffer_load_dwordx4 a[8:11], v2, s[4:7], s30 offen sc1
    s_add_u32 s30, s30, 40960
    buffer_load_dwordx4 a[12:15], v2, s[4:7], s30 offen sc1
    s_add_u32 s30, s30, 40960
    buffer_load_dwordx4 a[16:19], v2, s[4:7], s30 offen sc1
    s_add_u32 s30, s30, 40960
    buffer_load_dwordx4 a[20:23], v2, s[4:7], s30 offen sc1
    s_add_u32 s30, s30, 40960
    buffer_load_dwordx4 a[24:27], v2, s[4:7], s30 offen sc1
    s_add_u32 s30, s30, 40960
    buffer_load_dwordx4 a[28:31], v2, s[4:7], s30 offen sc1
    s_add_u32 s30, s30, 40960
    buffer_load_dwordx4 a[32:35], v2, s[4:7], s30 offen sc1
    s_add_u32 s30, s30, 40960
    buffer_load_dwordx4 a[36:39], v2, s[4:7], s30 offen sc1
    s_add_u32 s30, s30, 40960
    buffer_load_dwordx4 a[40:43], v2, s[4:7], s30 offen sc1
    s_add_u32 s30, s30, 40960
    buffer_load_dwordx4 a[44:47], v2, s[4:7], s30 offen sc1
    s_add_u32 s30, s30, 40960
    buffer_load_dwordx4 a[48:51], v2, s[4:7], s30 offen sc1
    s_add_u32 s30, s30, 40960
    buffer_load_dwordx4 a[52:55], v2, s[4:7], s30 offen sc1
    s_add_u32 s30, s30, 40960
    buffer_load_dwordx4 a[56:59], v2, s[4:7], s30 offen sc1
    s_add_u32 s30, s30, 40960
    buffer_load_dwordx4 a[60:63], v2, s[4:7], s30 offen sc1
    s_add_u32 s30, s30, 40960
    buffer_load_dwordx4 a[64:67], v2, s[4:7], s30 offen sc1
    s_add_u32 s30, s30, 40960
    buffer_load_dwordx4 a[68:71], v2, s[4:7], s30 offen sc1
    s_add_u32 s30, s30, 40960
    buffer_load_dwordx4 a[72:75], v2, s[4:7], s30 offen sc1
    s_add_u32 s30, s30, 40960
    buffer_load_dwordx4 a[76:79], v2, s[4:7], s30 offen sc1
    s_add_u32 s30, s30, 40960
    buffer_load_dwordx4 a[80:83], v2, s[4:7], s30 offen sc1
    s_add_u32 s30, s30, 40960
    buffer_load_dwordx4 a[84:87], v2, s[4:7], s30 offen sc1
    s_add_u32 s30, s30, 40960
    buffer_load_dwordx4 a[88:91], v2, s[4:7], s30 offen sc1
    s_add_u32 s30, s30, 40960
    buffer_load_dwordx4 a[92:95], v2, s[4:7], s30 offen sc1
    s_add_u32 s30, s30, 40960
    buffer_load_dwordx4 a[96:99], v2, s[4:7], s30 offen sc1
    s_add_u32 s30, s30, 40960
    buffer_load_dwordx4 a[100:103], v2, s[4:7], s30 offen sc1
    s_add_u32 s30, s30, 40960
    buffer_load_dwordx4 a[104:107], v2, s[4:7], s30 offen sc1
    s_add_u32 s30, s30, 40960
    buffer_load_dwordx4 a[108:111], v2, s[4:7], s30 offen sc1
    s_add_u32 s30, s30, 40960
    buffer_load_dwordx4 a[112:115], v2, s[4:7], s30 offen sc1
    s_add_u32 s30, s30, 40960
    buffer_load_dwordx4 a[116:119], v2, s[4:7], s30 offen sc1
    s_add_u32 s30, s30, 40960
    buffer_load_dwordx4 a[120:123], v2, s[4:7], s30 offen sc1
    s_add_u32 s30, s30, 40960
    buffer_load_dwordx4 a[124:127], v2, s[4:7], s30 offen sc1
F_loop_348:
    s_mov_b32 s27, s22
    s_mul_i32 s23, s27, 6554
    s_lshr_b32 s23, s23, 16
    s_mul_i32 s26, s23, 10
    s_sub_u32 s24, s27, s26
    s_lshl_b32 s24, s24, 2
    s_add_u32 s24, s24, s20
    s_mul_i32 s31, s23, 81920
    s_add_u32 s31, s31, s34
    s_add_u32 s31, s31, 155189248
    s_mul_i32 s32, s23, 327680
    s_lshl_b32 s26, s24, 13
    s_add_u32 s32, s32, s26
    s_add_u32 s32, s32, 134217728
    s_mul_i32 s33, s23, 81920
    s_lshl_b32 s26, s24, 5
    s_add_u32 s33, s33, s26
    s_cmp_lt_u32 s23, s38
    s_cbranch_scc1 F_kn_350
    s_lshl_b32 s35, s23, 7
    s_add_u32 s35, s35, 167866368
    s_mov_b32 s28, 1
    v_mov_b32 v6, 0
fw_lp_352:
    v_cmp_gt_u32 vcc, s28, v6
    s_cbranch_vccz fw_ok_351
    s_cmp_eq_u32 s100, 0
    s_cbranch_scc1 fw_ok_351
    s_sub_u32 s100, s100, 1
    s_sleep 3
    buffer_load_dword v6, v4, s[4:7], s35 offen sc1
    s_waitcnt vmcnt(0)
    s_branch fw_lp_352
fw_ok_351:
    s_add_u32 s38, s23, 1
F_kn_350:
    s_lshl_b32 s35, s23, 7
    s_add_u32 s35, s35, 167849984
    buffer_load_dword v7, v4, s[4:7], s35 offen sc1
    s_barrier
    s_add_u32 m0, s34, 0
    s_add_u32 s26, s31, 0
    buffer_load_dwordx4 v2, s[4:7], s26 offen offset:0 sc1 lds
    buffer_load_dwordx4 v2, s[4:7], s26 offen offset:1024 sc1 lds
    buffer_load_dwordx4 v2, s[4:7], s26 offen offset:2048 sc1 lds
    buffer_load_dwordx4 v2, s[4:7], s26 offen offset:3072 sc1 lds
    s_add_u32 m0, s34, 4096
    s_add_u32 s26, s31, 4096
    buffer_load_dwordx4 v2, s[4:7], s26 offen offset:0 sc1 lds
    buffer_load_dwordx4 v2, s[4:7], s26 offen offset:1024 sc1 lds
    buffer_load_dwordx4 v2, s[4:7], s26 offen offset:2048 sc1 lds
    buffer_load_dwordx4 v2, s[4:7], s26 offen offset:3072 sc1 lds
    s_add_u32 m0, s34, 8192
    s_add_u32 s26, s31, 8192
    buffer_load_dwordx4 v2, s[4:7], s26 offen offset:0 sc1 lds
    buffer_load_dwordx4 v2, s[4:7], s26 offen offset:1024 sc1 lds
    buffer_load_dwordx4 v2, s[4:7], s26 offen offset:2048 sc1 lds
    buffer_load_dwordx4 v2, s[4:7], s26 offen offset:3072 sc1 lds
    s_add_u32 m0, s34, 12288
    s_add_u32 s26, s31, 12288
    buffer_load_dwordx4 v2, s[4:7], s26 offen offset:0 sc1 lds
    buffer_load_dwordx4 v2, s[4:7], s26 offen offset:1024 sc1 lds
    buffer_load_dwordx4 v2, s[4:7], s26 offen offset:2048 sc1 lds
    buffer_load_dwordx4 v2, s[4:7], s26 offen offset:3072 sc1 lds
    s_add_u32 m0, s34, 16384
    s_add_u32 s26, s31, 16384
    buffer_load_dwordx4 v2, s[4:7], s26 offen offset:0 sc1 lds
    buffer_load_dwordx4 v2, s[4:7], s26 offen offset:1024 sc1 lds
    buffer_load_dwordx4 v2, s[4:7], s26 offen offset:2048 sc1 lds
    buffer_load_dwordx4 v2, s[4:7], s26 offen offset:3072 sc1 lds
    s_waitcnt vmcnt(20)
    s_mov_b32 s28, 64
fw_lp_354:
    v_cmp_gt_u32 vcc, s28, v7
    s_cbranch_vccz fw_ok_353
    s_cmp_eq_u32 s100, 0
    s_cbranch_scc1 fw_ok_353
    s_sub_u32 s100, s100, 1
    s_sleep 3
    buffer_load_dword v7, v4, s[4:7], s35 offen sc1
    s_waitcnt vmcnt(0)
    s_branch fw_lp_354
fw_ok_353:
    buffer_load_dwordx4 v[44:47], v2, s[4:7], s32 offen offset:0 sc1
    buffer_load_dwordx4 v[48:51], v2, s[4:7], s32 offen offset:1024 sc1
    buffer_load_dwordx4 v[52:55], v2, s[4:7], s32 offen offset:2048 sc1
    buffer_load_dwordx4 v[56:59], v2, s[4:7], s32 offen offset:3072 sc1
    s_add_u32 s32, s32, 4096
    buffer_load_dwordx4 v[60:63], v2, s[4:7], s32 offen offset:0 sc1
    buffer_load_dwordx4 v[64:67], v2, s[4:7], s32 offen offset:1024 sc1
    buffer_load_dwordx4 v[68:71], v2, s[4:7], s32 offen offset:2048 sc1
    buffer_load_dwordx4 v[72:75], v2, s[4:7], s32 offen offset:3072 sc1
    s_add_u32 s27, s22, s36
    s_min_u32 s27, s27, 639
    s_mul_i32 s23, s27, 6554
    s_lshr_b32 s23, s23, 16
    s_mul_i32 s26, s23, 10
    s_sub_u32 s24, s27, s26
    s_lshl_b32 s24, s24, 2
    s_add_u32 s24, s24, s20
    s_cmp_lt_u32 s23, s37
    s_cbranch_scc1 F_kn_355
    s_lshl_b32 s35, s23, 7
    s_add_u32 s35, s35, 167841792
    s_mov_b32 s28, 32
    v_mov_b32 v6, 0
fw_lp_357:
    v_cmp_gt_u32 vcc, s28, v6
    s_cbranch_vccz fw_ok_356
    s_cmp_eq_u32 s100, 0
    s_cbranch_scc1 fw_ok_356
    s_sub_u32 s100, s100, 1
    s_sleep 6
    buffer_load_dword v6, v4, s[4:7], s35 offen sc1
    s_waitcnt vmcnt(0)
    s_branch fw_lp_357
fw_ok_356:
    s_add_u32 s37, s23, 1
F_kn_355:
    s_mul_i32 s30, s23, 1310720
    s_lshl_b32 s26, s24, 10
    s_add_u32 s30, s30, s26
    s_add_u32 s30, s30, 50331648
    buffer_load_dwordx4 a[128:131], v2, s[4:7], s30 offen sc1
    s_add_u32 s30, s30, 40960
    buffer_load_dwordx4 a[132:135], v2, s[4:7], s30 offen sc1
    s_add_u32 s30, s30, 40960
    buffer_load_dwordx4 a[136:139], v2, s[4:7], s30 offen sc1
    s_add_u32 s30, s30, 40960
    buffer_load_dwordx4 a[140:143], v2, s[4:7], s30 offen sc1
    s_add_u32 s30, s30, 40960
    buffer_load_dwordx4 a[144:147], v2, s[4:7], s30 offen sc1
    s_add_u32 s30, s30, 40960
    buffer_load_dwordx4 a[148:151], v2, s[4:7], s30 offen sc1
    s_add_u32 s30, s30, 40960
    buffer_load_dwordx4 a[152:155], v2, s[4:7], s30 offen sc1
    s_add_u32 s30, s30, 40960
    buffer_load_dwordx4 a[156:159], v2, s[4:7], s30 offen sc1
    s_add_u32 s30, s30, 40960
    buffer_load_dwordx4 a[160:163], v2, s[4:7], s30 offen sc1
    s_add_u32 s30, s30, 40960
    buffer_load_dwordx4 a[164:167], v2, s[4:7], s30 offen sc1
    s_add_u32 s30, s30, 40960
    buffer_load_dwordx4 a[168:171], v2, s[4:7], s30 offen sc1
    s_add_u32 s30, s30, 40960
    buffer_load_dwordx4 a[172:175], v2, s[4:7], s30 offen sc1
    s_add_u32 s30, s30, 40960
    buffer_load_dwordx4 a[176:179], v2, s[4:7], s30 offen sc1
    s_add_u32 s30, s30, 40960
    buffer_load_dwordx4 a[180:183], v2, s[4:7], s30 offen sc1
    s_add_u32 s30, s30, 40960
    buffer_load_dwordx4 a[184:187], v2, s[4:7], s30 offen sc1
    s_add_u32 s30, s30, 40960
    buffer_load_dwordx4 a[188:191], v2, s[4:7], s30 offen sc1
    s_add_u32 s30, s30, 40960
    buffer_load_dwordx4 a[192:195], v2, s[4:7], s30 offen sc1
    s_add_u32 s30, s30, 40960
    buffer_load_dwordx4 a[196:199], v2, s[4:7], s30 offen sc1
    s_add_u32 s30, s30, 40960
    buffer_load_dwordx4 a[200:203], v2, s[4:7], s30 offen sc1
    s_add_u32 s30, s30, 40960
    buffer_load_dwordx4 a[204:207], v2, s[4:7], s30 offen sc1
    s_add_u32 s30, s30, 40960
    buffer_load_dwordx4 a[208:211], v2, s[4:7], s30 offen sc1
    s_add_u32 s30, s30, 40960
    buffer_load_dwordx4 a[212:215], v2, s[4:7], s30 offen sc1
    s_add_u32 s30, s30, 40960
    buffer_load_dwordx4 a[216:219], v2, s[4:7], s30 offen sc1
    s_add_u32 s30, s30, 40960
    buffer_load_dwordx4 a[220:223], v2, s[4:7], s30 offen sc1
    s_add_u32 s30, s30, 40960
    buffer_load_dwordx4 a[224:227], v2, s[4:7], s30 offen sc1
    s_add_u32 s30, s30, 40960
    buffer_load_dwordx4 a[228:231], v2, s[4:7], s30 offen sc1
    s_add_u32 s30, s30, 40960
    buffer_load_dwordx4 a[232:235], v2, s[4:7], s30 offen sc1
    s_add_u32 s30, s30, 40960
    buffer_load_dwordx4 a[236:239], v2, s[4:7], s30 offen sc1
    s_add_u32 s30, s30, 40960
    buffer_load_dwordx4 a[240:243], v2, s[4:7], s30 offen sc1
    s_add_u32 s30, s30, 40960
    buffer_load_dwordx4 a[244:247], v2, s[4:7], s30 offen sc1
    s_add_u32 s30, s30, 40960
    buffer_load_dwordx4 a[248:251], v2, s[4:7], s30 offen sc1
    s_add_u32 s30, s30, 40960
    buffer_load_dwordx4 a[252:255], v2, s[4:7], s30 offen sc1
    s_waitcnt vmcnt(32)
    s_barrier
    ds_read_b128 v[12:15], v2 offset:0
    ds_read_b128 v[16:19], v8 offset:0
    ds_read_b128 v[20:23], v2 offset:1024
    ds_read_b128 v[24:27], v8 offset:1024
    ds_read_b128 v[28:31], v2 offset:2048
    ds_read_b128 v[32:35], v8 offset:2048
    ds_read_b128 v[36:39], v2 offset:3072
    ds_read_b128 v[40:43], v8 offset:3072
    s_waitcnt lgkmcnt(6)
    v_mfma_f32_16x16x32_bf16 v[76:79], a[0:3], v[12:15], 0
    v_mfma_f32_16x16x32_bf16 v[80:83], a[0:3], v[16:19], 0
    ds_read_b128 v[12:15], v2 offset:4096
    ds_read_b128 v[16:19], v8 offset:4096
    s_waitcnt lgkmcnt(6)
    v_mfma_f32_16x16x32_bf16 v[76:79], a[4:7], v[20:23], v[76:79]
    v_mfma_f32_16x16x32_bf16 v[80:83], a[4:7], v[24:27], v[80:83]
    ds_read_b128 v[20:23], v2 offset:5120
    ds_read_b128 v[24:27], v8 offset:5120
    s_waitcnt lgkmcnt(6)
    v_mfma_f32_16x16x32_bf16 v[76:79], a[8:11], v[28:31], v[76:79]
    v_mfma_f32_16x16x32_bf16 v[80:83], a[8:11], v[32:35], v[80:83]
    ds_read_b128 v[28:31], v2 offset:6144
    ds_read_b128 v[32:35], v8 offset:6144
    s_waitcnt lgkmcnt(6)
    v_mfma_f32_16x16x32_bf16 v[76:79], a[12:15], v[36:39], v[76:79]
    v_mfma_f32_16x16x32_bf16 v[80:83], a[12:15], v[40:43], v[80:83]
    ds_read_b128 v[36:39], v2 offset:7168
    ds_read_b128 v[40:43], v8 offset:7168
    s_waitcnt lgkmcnt(6)
    v_mfma_f32_16x16x32_bf16 v[76:79], a[16:19], v[12:15], v[76:79]
    v_mfma_f32_16x16x32_bf16 v[80:83], a[16:19], v[16:19], v[80:83]
    ds_read_b128 v[12:15], v2 offset:8192
    ds_read_b128 v[16:19], v8 offset:8192
    s_waitcnt lgkmcnt(6)
    v_mfma_f32_16x16x32_bf16 v[76:79], a[20:23], v[20:23], v[76:79]
    v_mfma_f32_16x16x32_bf16 v[80:83], a[20:23], v[24:27], v[80:83]
    ds_read_b128 v[20:23], v2 offset:9216
    ds_read_b128 v[24:27], v8 offset:9216
    s_waitcnt lgkmcnt(6)
    v_mfma_f32_16x16x32_bf16 v[76:79], a[24:27], v[28:31], v[76:79]
    v_mfma_f32_16x16x32_bf16 v[80:83], a[24:27], v[32:35], v[80:83]
    ds_read_b128 v[28:31], v2 offset:10240
    ds_read_b128 v[32:35], v8 offset:10240
    s_waitcnt lgkmcnt(6)
    v_mfma_f32_16x16x32_bf16 v[76:79], a[28:31], v[36:39], v[76:79]
    v_mfma_f32_16x16x32_bf16 v[80:83], a[28:31], v[40:43], v[80:83]
    ds_read_b128 v[36:39], v2 offset:11264
    ds_read_b128 v[40:43], v8 offset:11264
    s_waitcnt lgkmcnt(6)
    v_mfma_f32_16x16x32_bf16 v[76:79], a[32:35], v[12:15], v[76:79]
    v_mfma_f32_16x16x32_bf16 v[80:83], a[32:35], v[16:19], v[80:83]
    ds_read_b128 v[12:15], v2 offset:12288
    ds_read_b128 v[16:19], v8 offset:12288
    s_waitcnt lgkmcnt(6)
    v_mfma_f32_16x16x32_bf16 v[76:79], a[36:39], v[20:23], v[76:79]
    v_mfma_f32_16x16x32_bf16 v[80:83], a[36:39], v[24:27], v[80:83]
    ds_read_b128 v[20:23], v2 offset:13312
    ds_read_b128 v[24:27], v8 offset:13312
    s_waitcnt lgkmcnt(6)
    v_mfma_f32_16x16x32_bf16 v[76:79], a[40:43], v[28:31], v[76:79]
    v_mfma_f32_16x16x32_bf16 v[80:83], a[40:43], v[32:35], v[80:83]
    ds_read_b128 v[28:31], v2 offset:14336
    ds_read_b128 v[32:35], v8 offset:14336
    s_waitcnt lgkmcnt(6)
    v_mfma_f32_16x16x32_bf16 v[76:79], a[44:47], v[36:39], v[76:79]
    v_mfma_f32_16x16x32_bf16 v[80:83], a[44:47], v[40:43], v[80:83]
    ds_read_b128 v[36:39], v2 offset:15360
    ds_read_b128 v[40:43], v8 offset:15360
    s_waitcnt lgkmcnt(6)
    v_mfma_f32_16x16x32_bf16 v[76:79], a[48:51], v[12:15], v[76:79]
    v_mfma_f32_16x16x32_bf16 v[80:83], a[48:51], v[16:19], v[80:83]
    ds_read_b128 v[12:15], v2 offset:16384
    ds_read_b128 v[16:19], v8 offset:16384
    s_waitcnt lgkmcnt(6)
    v_mfma_f32_16x16x32_bf16 v[76:79], a[52:55], v[20:23], v[76:79]
    v_mfma_f32_16x16x32_bf16 v[80:83], a[52:55], v[24:27], v[80:83]
    ds_read_b128 v[20:23], v2 offset:17408
    ds_read_b128 v[24:27], v8 offset:17408
    s_waitcnt lgkmcnt(6)
    v_mfma_f32_16x16x32_bf16 v[76:79], a[56:59], v[28:31], v[76:79]
    v_mfma_f32_16x16x32_bf16 v[80:83], a[56:59], v[32:35], v[80:83]
    ds_read_b128 v[28:31], v2 offset:18432
    ds_read_b128 v[32:35], v8 offset:18432
    s_waitcnt lgkmcnt(6)
    v_mfma_f32_16x16x32_bf16 v[76:79], a[60:63], v[36:39], v[76:79]
    v_mfma_f32_16x16x32_bf16 v[80:83], a[60:63], v[40:43], v[80:83]
    ds_read_b128 v[36:39], v2 offset:19456
    ds_read_b128 v[40:43], v8 offset:19456
    s_waitcnt lgkmcnt(6)
    v_mfma_f32_16x16x32_bf16 v[76:79], a[64:67], v[12:15], v[76:79]
    v_mfma_f32_16x16x32_bf16 v[80:83], a[64:67], v[16:19], v[80:83]
    ds_read_b128 v[12:15], v2 offset:20480
    ds_read_b128 v[16:19], v8 offset:20480
    s_waitcnt lgkmcnt(6)
    v_mfma_f32_16x16x32_bf16 v[76:79], a[68:71], v[20:23], v[76:79]
    v_mfma_f32_16x16x32_bf16 v[80:83], a[68:71], v[24:27], v[80:83]
    ds_read_b128 v[20:23], v2 offset:21504
    ds_read_b128 v[24:27], v8 offset:21504
    s_waitcnt lgkmcnt(6)
    v_mfma_f32_16x16x32_bf16 v[76:79], a[72:75], v[28:31], v[76:79]
    v_mfma_f32_16x16x32_bf16 v[80:83], a[72:75], v[32:35], v[80:83]
    ds_read_b128 v[28:31], v2 offset:22528
    ds_read_b128 v[32:35], v8 offset:22528
    s_waitcnt lgkmcnt(6)
    v_mfma_f32_16x16x32_bf16 v[76:79], a[76:79], v[36:39], v[76:79]
    v_mfma_f32_16x16x32_bf16 v[80:83], a[76:79], v[40:43], v[80:83]
    ds_read_b128 v[36:39], v2 offset:23552
    ds_read_b128 v[40:43], v8 offset:23552
    s_waitcnt lgkmcnt(6)
    v_mfma_f32_16x16x32_bf16 v[76:79], a[80:83], v[12:15], v[76:79]
    v_mfma_f32_16x16x32_bf16 v[80:83], a[80:83], v[16:19], v[80:83]
    ds_read_b128 v[12:15], v2 offset:24576
    ds_read_b128 v[16:19], v8 offset:24576
    s_waitcnt lgkmcnt(6)
    v_mfma_f32_16x16x32_bf16 v[76:79], a[84:87], v[20:23], v[76:79]
    v_mfma_f32_16x16x32_bf16 v[80:83], a[84:87], v[24:27], v[80:83]
    ds_read_b128 v[20:23], v2 offset:25600
    ds_read_b128 v[24:27], v8 offset:25600
    s_waitcnt lgkmcnt(6)
    v_mfma_f32_16x16x32_bf16 v[76:79], a[88:91], v[28:31], v[76:79]
    v_mfma_f32_16x16x32_bf16 v[80:83], a[88:91], v[32:35], v[80:83]
    ds_read_b128 v[28:31], v2 offset:26624
    ds_read_b128 v[32:35], v8 offset:26624
    s_waitcnt lgkmcnt(6)
    v_mfma_f32_16x16x32_bf16 v[76:79], a[92:95], v[36:39], v[76:79]
    v_mfma_f32_16x16x32_bf16 v[80:83], a[92:95], v[40:43], v[80:83]
    ds_read_b128 v[36:39], v2 offset:27648
    ds_read_b128 v[40:43], v8 offset:27648
    s_waitcnt lgkmcnt(6)
    v_mfma_f32_16x16x32_bf16 v[76:79], a[96:99], v[12:15], v[76:79]
    v_mfma_f32_16x16x32_bf16 v[80:83], a[96:99], v[16:19], v[80:83]
    ds_read_b128 v[12:15], v2 offset:28672
    ds_read_b128 v[16:19], v8 offset:28672
    s_waitcnt lgkmcnt(6)
    v_mfma_f32_16x16x32_bf16 v[76:79], a[100:103], v[20:23], v[76:79]
    v_mfma_f32_16x16x32_bf16 v[80:83], a[100:103], v[24:27], v[80:83]
    ds_read_b128 v[20:23], v2 offset:29696
    ds_read_b128 v[24:27], v8 offset:29696
    s_waitcnt lgkmcnt(6)
    v_mfma_f32_16x16x32_bf16 v[76:79], a[104:107], v[28:31], v[76:79]
    v_mfma_f32_16x16x32_bf16 v[80:83], a[104:107], v[32:35], v[80:83]
    ds_read_b128 v[28:31], v2 offset:30720
    ds_read_b128 v[32:35], v8 offset:30720
    s_waitcnt lgkmcnt(6)
    v_mfma_f32_16x16x32_bf16 v[76:79], a[108:111], v[36:39], v[76:79]
    v_mfma_f32_16x16x32_bf16 v[80:83], a[108:111], v[40:43], v[80:83]
    ds_read_b128 v[36:39], v2 offset:31744
    ds_read_b128 v[40:43], v8 offset:31744
    s_waitcnt lgkmcnt(6)
    v_mfma_f32_16x16x32_bf16 v[76:79], a[112:115], v[12:15], v[76:79]
    v_mfma_f32_16x16x32_bf16 v[80:83], a[112:115], v[16:19], v[80:83]
    ds_read_b128 v[12:15], v2 offset:32768
    ds_read_b128 v[16:19], v8 offset:32768
    s_waitcnt lgkmcnt(6)
    v_mfma_f32_16x16x32_bf16 v[76:79], a[116:119], v[20:23], v[76:79]
    v_mfma_f32_16x16x32_bf16 v[80:83], a[116:119], v[24:27], v[80:83]
    ds_read_b128 v[20:23], v2 offset:33792
    ds_read_b128 v[24:27], v8 offset:33792
    s_waitcnt lgkmcnt(6)
    v_mfma_f32_16x16x32_bf16 v[76:79], a[120:123], v[28:31], v[76:79]
    v_mfma_f32_16x16x32_bf16 v[80:83], a[120:123], v[32:35], v[80:83]
    ds_read_b128 v[28:31], v2 offset:34816
    ds_read_b128 v[32:35], v8 offset:34816
    s_waitcnt lgkmcnt(6)
    v_mfma_f32_16x16x32_bf16 v[76:79], a[124:127], v[36:39], v[76:79]
    v_mfma_f32_16x16x32_bf16 v[80:83], a[124:127], v[40:43], v[80:83]
    ds_read_b128 v[36:39], v2 offset:35840
    ds_read_b128 v[40:43], v8 offset:35840
    s_waitcnt lgkmcnt(6)
    v_mfma_f32_16x16x32_bf16 v[76:79], v[44:47], v[12:15], v[76:79]
    v_mfma_f32_16x16x32_bf16 v[80:83], v[44:47], v[16:19], v[80:83]
    ds_read_b128 v[12:15], v2 offset:36864
    ds_read_b128 v[16:19], v8 offset:36864
    s_waitcnt lgkmcnt(6)
    v_mfma_f32_16x16x32_bf16 v[76:79], v[48:51], v[20:23], v[76:79]
    v_mfma_f32_16x16x32_bf16 v[80:83], v[48:51], v[24:27], v[80:83]
    ds_read_b128 v[20:23], v2 offset:37888
    ds_read_b128 v[24:27], v8 offset:37888
    s_waitcnt lgkmcnt(6)
    v_mfma_f32_16x16x32_bf16 v[76:79], v[52:55], v[28:31], v[76:79]
    v_mfma_f32_16x16x32_bf16 v[80:83], v[52:55], v[32:35], v[80:83]
    ds_read_b128 v[28:31], v2 offset:38912
    ds_read_b128 v[32:35], v8 offset:38912
    s_waitcnt lgkmcnt(6)
    v_mfma_f32_16x16x32_bf16 v[76:79], v[56:59], v[36:39], v[76:79]
    v_mfma_f32_16x16x32_bf16 v[80:83], v[56:59], v[40:43], v[80:83]
    ds_read_b128 v[36:39], v2 offset:39936
    ds_read_b128 v[40:43], v8 offset:39936
    s_waitcnt lgkmcnt(6)
    v_mfma_f32_16x16x32_bf16 v[76:79], v[60:63], v[12:15], v[76:79]
    v_mfma_f32_16x16x32_bf16 v[80:83], v[60:63], v[16:19], v[80:83]
    s_waitcnt lgkmcnt(4)
    v_mfma_f32_16x16x32_bf16 v[76:79], v[64:67], v[20:23], v[76:79]
    v_mfma_f32_16x16x32_bf16 v[80:83], v[64:67], v[24:27], v[80:83]
    s_waitcnt lgkmcnt(2)
    v_mfma_f32_16x16x32_bf16 v[76:79], v[68:71], v[28:31], v[76:79]
    v_mfma_f32_16x16x32_bf16 v[80:83], v[68:71], v[32:35], v[80:83]
    s_waitcnt lgkmcnt(0)
    v_mfma_f32_16x16x32_bf16 v[76:79], v[72:75], v[36:39], v[76:79]
    v_mfma_f32_16x16x32_bf16 v[80:83], v[72:75], v[40:43], v[80:83]
    s_nop 7
    v_cvt_pk_bf16_f32 v84, v76, v77
    v_cvt_pk_bf16_f32 v85, v78, v79
    v_cvt_pk_bf16_f32 v86, v80, v81
    v_cvt_pk_bf16_f32 v87, v82, v83
    s_nop 1
    v_permlane16_swap_b32 v84, v86
    v_permlane16_swap_b32 v85, v87
    buffer_store_dwordx4 v[84:87], v3, s[16:19], s33 offen nt
    s_add_u32 s22, s22, s36
    s_cmp_ge_u32 s22, 640
    s_cbranch_scc1 F_done_349
    s_mov_b32 s27, s22
    s_mul_i32 s23, s27, 6554
    s_lshr_b32 s23, s23, 16
    s_mul_i32 s26, s23, 10
    s_sub_u32 s24, s27, s26
    s_lshl_b32 s24, s24, 2
    s_add_u32 s24, s24, s20
    s_mul_i32 s31, s23, 81920
    s_add_u32 s31, s31, s34
    s_add_u32 s31, s31, 155189248
    s_mul_i32 s32, s23, 327680
    s_lshl_b32 s26, s24, 13
    s_add_u32 s32, s32, s26
    s_add_u32 s32, s32, 134217728
    s_mul_i32 s33, s23, 81920
    s_lshl_b32 s26, s24, 5
    s_add_u32 s33, s33, s26
    s_cmp_lt_u32 s23, s38
    s_cbranch_scc1 F_kn_358
    s_lshl_b32 s35, s23, 7
    s_add_u32 s35, s35, 167866368
    s_mov_b32 s28, 1
    v_mov_b32 v6, 0
fw_lp_360:
    v_cmp_gt_u32 vcc, s28, v6
    s_cbranch_vccz fw_ok_359
    s_cmp_eq_u32 s100, 0
    s_cbranch_scc1 fw_ok_359
    s_sub_u32 s100, s100, 1
    s_sleep 3
    buffer_load_dword v6, v4, s[4:7], s35 offen sc1
    s_waitcnt vmcnt(0)
    s_branch fw_lp_360
fw_ok_359:
    s_add_u32 s38, s23, 1
F_kn_358:
    s_lshl_b32 s35, s23, 7
    s_add_u32 s35, s35, 167849984
    buffer_load_dword v7, v4, s[4:7], s35 offen sc1
    s_barrier
    s_add_u32 m0, s34, 0
    s_add_u32 s26, s31, 0
    buffer_load_dwordx4 v2, s[4:7], s26 offen offset:0 sc1 lds
    buffer_load_dwordx4 v2, s[4:7], s26 offen offset:1024 sc1 lds
    buffer_load_dwordx4 v2, s[4:7], s26 offen offset:2048 sc1 lds
    buffer_load_dwordx4 v2, s[4:7], s26 offen offset:3072 sc1 lds
    s_add_u32 m0, s34, 4096
    s_add_u32 s26, s31, 4096
    buffer_load_dwordx4 v2, s[4:7], s26 offen offset:0 sc1 lds
    buffer_load_dwordx4 v2, s[4:7], s26 offen offset:1024 sc1 lds
    buffer_load_dwordx4 v2, s[4:7], s26 offen offset:2048 sc1 lds
    buffer_load_dwordx4 v2, s[4:7], s26 offen offset:3072 sc1 lds
    s_add_u32 m0, s34, 8192
    s_add_u32 s26, s31, 8192
    buffer_load_dwordx4 v2, s[4:7], s26 offen offset:0 sc1 lds
    buffer_load_dwordx4 v2, s[4:7], s26 offen offset:1024 sc1 lds
    buffer_load_dwordx4 v2, s[4:7], s26 offen offset:2048 sc1 lds
    buffer_load_dwordx4 v2, s[4:7], s26 offen offset:3072 sc1 lds
    s_add_u32 m0, s34, 12288
    s_add_u32 s26, s31, 12288
    buffer_load_dwordx4 v2, s[4:7], s26 offen offset:0 sc1 lds
    buffer_load_dwordx4 v2, s[4:7], s26 offen offset:1024 sc1 lds
    buffer_load_dwordx4 v2, s[4:7], s26 offen offset:2048 sc1 lds
    buffer_load_dwordx4 v2, s[4:7], s26 offen offset:3072 sc1 lds
    s_add_u32 m0, s34, 16384
    s_add_u32 s26, s31, 16384
    buffer_load_dwordx4 v2, s[4:7], s26 offen offset:0 sc1 lds
    buffer_load_dwordx4 v2, s[4:7], s26 offen offset:1024 sc1 lds
    buffer_load_dwordx4 v2, s[4:7], s26 offen offset:2048 sc1 lds
    buffer_load_dwordx4 v2, s[4:7], s26 offen offset:3072 sc1 lds
    s_waitcnt vmcnt(20)
    s_mov_b32 s28, 64
fw_lp_362:
    v_cmp_gt_u32 vcc, s28, v7
    s_cbranch_vccz fw_ok_361
    s_cmp_eq_u32 s100, 0
    s_cbranch_scc1 fw_ok_361
    s_sub_u32 s100, s100, 1
    s_sleep 3
    buffer_load_dword v7, v4, s[4:7], s35 offen sc1
    s_waitcnt vmcnt(0)
    s_branch fw_lp_362
fw_ok_361:
    buffer_load_dwordx4 v[44:47], v2, s[4:7], s32 offen offset:0 sc1
    buffer_load_dwordx4 v[48:51], v2, s[4:7], s32 offen offset:1024 sc1
    buffer_load_dwordx4 v[52:55], v2, s[4:7], s32 offen offset:2048 sc1
    buffer_load_dwordx4 v[56:59], v2, s[4:7], s32 offen offset:3072 sc1
    s_add_u32 s32, s32, 4096
    buffer_load_dwordx4 v[60:63], v2, s[4:7], s32 offen offset:0 sc1
    buffer_load_dwordx4 v[64:67], v2, s[4:7], s32 offen offset:1024 sc1
    buffer_load_dwordx4 v[68:71], v2, s[4:7], s32 offen offset:2048 sc1
    buffer_load_dwordx4 v[72:75], v2, s[4:7], s32 offen offset:3072 sc1
    s_add_u32 s27, s22, s36
    s_min_u32 s27, s27, 639
    s_mul_i32 s23, s27, 6554
    s_lshr_b32 s23, s23, 16
    s_mul_i32 s26, s23, 10
    s_sub_u32 s24, s27, s26
    s_lshl_b32 s24, s24, 2
    s_add_u32 s24, s24, s20
    s_cmp_lt_u32 s23, s37
    s_cbranch_scc1 F_kn_363
    s_lshl_b32 s35, s23, 7
    s_add_u32 s35, s35, 167841792
    s_mov_b32 s28, 32
    v_mov_b32 v6, 0
fw_lp_365:
    v_cmp_gt_u32 vcc, s28, v6
    s_cbranch_vccz fw_ok_364
    s_cmp_eq_u32 s100, 0
    s_cbranch_scc1 fw_ok_364
    s_sub_u32 s100, s100, 1
    s_sleep 6
    buffer_load_dword v6, v4, s[4:7], s35 offen sc1
    s_waitcnt vmcnt(0)
    s_branch fw_lp_365
fw_ok_364:
    s_add_u32 s37, s23, 1
F_kn_363:
    s_mul_i32 s30, s23, 1310720
    s_lshl_b32 s26, s24, 10
    s_add_u32 s30, s30, s26
    s_add_u32 s30, s30, 50331648
    buffer_load_dwordx4 a[0:3], v2, s[4:7], s30 offen sc1
    s_add_u32 s30, s30, 40960
    buffer_load_dwordx4 a[4:7], v2, s[4:7], s30 offen sc1
    s_add_u32 s30, s30, 40960
    buffer_load_dwordx4 a[8:11], v2, s[4:7], s30 offen sc1
    s_add_u32 s30, s30, 40960
    buffer_load_dwordx4 a[12:15], v2, s[4:7], s30 offen sc1
    s_add_u32 s30, s30, 40960
    buffer_load_dwordx4 a[16:19], v2, s[4:7], s30 offen sc1
    s_add_u32 s30, s30, 40960
    buffer_load_dwordx4 a[20:23], v2, s[4:7], s30 offen sc1
    s_add_u32 s30, s30, 40960
    buffer_load_dwordx4 a[24:27], v2, s[4:7], s30 offen sc1
    s_add_u32 s30, s30, 40960
    buffer_load_dwordx4 a[28:31], v2, s[4:7], s30 offen sc1
    s_add_u32 s30, s30, 40960
    buffer_load_dwordx4 a[32:35], v2, s[4:7], s30 offen sc1
    s_add_u32 s30, s30, 40960
    buffer_load_dwordx4 a[36:39], v2, s[4:7], s30 offen sc1
    s_add_u32 s30, s30, 40960
    buffer_load_dwordx4 a[40:43], v2, s[4:7], s30 offen sc1
    s_add_u32 s30, s30, 40960
    buffer_load_dwordx4 a[44:47], v2, s[4:7], s30 offen sc1
    s_add_u32 s30, s30, 40960
    buffer_load_dwordx4 a[48:51], v2, s[4:7], s30 offen sc1
    s_add_u32 s30, s30, 40960
    buffer_load_dwordx4 a[52:55], v2, s[4:7], s30 offen sc1
    s_add_u32 s30, s30, 40960
    buffer_load_dwordx4 a[56:59], v2, s[4:7], s30 offen sc1
    s_add_u32 s30, s30, 40960
    buffer_load_dwordx4 a[60:63], v2, s[4:7], s30 offen sc1
    s_add_u32 s30, s30, 40960
    buffer_load_dwordx4 a[64:67], v2, s[4:7], s30 offen sc1
    s_add_u32 s30, s30, 40960
    buffer_load_dwordx4 a[68:71], v2, s[4:7], s30 offen sc1
    s_add_u32 s30, s30, 40960
    buffer_load_dwordx4 a[72:75], v2, s[4:7], s30 offen sc1
    s_add_u32 s30, s30, 40960
    buffer_load_dwordx4 a[76:79], v2, s[4:7], s30 offen sc1
    s_add_u32 s30, s30, 40960
    buffer_load_dwordx4 a[80:83], v2, s[4:7], s30 offen sc1
    s_add_u32 s30, s30, 40960
    buffer_load_dwordx4 a[84:87], v2, s[4:7], s30 offen sc1
    s_add_u32 s30, s30, 40960
    buffer_load_dwordx4 a[88:91], v2, s[4:7], s30 offen sc1
    s_add_u32 s30, s30, 40960
    buffer_load_dwordx4 a[92:95], v2, s[4:7], s30 offen sc1
    s_add_u32 s30, s30, 40960
    buffer_load_dwordx4 a[96:99], v2, s[4:7], s30 offen sc1
    s_add_u32 s30, s30, 40960
    buffer_load_dwordx4 a[100:103], v2, s[4:7], s30 offen sc1
    s_add_u32 s30, s30, 40960
    buffer_load_dwordx4 a[104:107], v2, s[4:7], s30 offen sc1
    s_add_u32 s30, s30, 40960
    buffer_load_dwordx4 a[108:111], v2, s[4:7], s30 offen sc1
    s_add_u32 s30, s30, 40960
    buffer_load_dwordx4 a[112:115], v2, s[4:7], s30 offen sc1
    s_add_u32 s30, s30, 40960
    buffer_load_dwordx4 a[116:119], v2, s[4:7], s30 offen sc1
    s_add_u32 s30, s30, 40960
    buffer_load_dwordx4 a[120:123], v2, s[4:7], s30 offen sc1
    s_add_u32 s30, s30, 40960
    buffer_load_dwordx4 a[124:127], v2, s[4:7], s30 offen sc1
    s_waitcnt vmcnt(32)
    s_barrier
    ds_read_b128 v[12:15], v2 offset:0
    ds_read_b128 v[16:19], v8 offset:0
    ds_read_b128 v[20:23], v2 offset:1024
    ds_read_b128 v[24:27], v8 offset:1024
    ds_read_b128 v[28:31], v2 offset:2048
    ds_read_b128 v[32:35], v8 offset:2048
    ds_read_b128 v[36:39], v2 offset:3072
    ds_read_b128 v[40:43], v8 offset:3072
    s_waitcnt lgkmcnt(6)
    v_mfma_f32_16x16x32_bf16 v[76:79], a[128:131], v[12:15], 0
    v_mfma_f32_16x16x32_bf16 v[80:83], a[128:131], v[16:19], 0
    ds_read_b128 v[12:15], v2 offset:4096
    ds_read_b128 v[16:19], v8 offset:4096
    s_waitcnt lgkmcnt(6)
    v_mfma_f32_16x16x32_bf16 v[76:79], a[132:135], v[20:23], v[76:79]
    v_mfma_f32_16x16x32_bf16 v[80:83], a[132:135], v[24:27], v[80:83]
    ds_read_b128 v[20:23], v2 offset:5120
    ds_read_b128 v[24:27], v8 offset:5120
    s_waitcnt lgkmcnt(6)
    v_mfma_f32_16x16x32_bf16 v[76:79], a[136:139], v[28:31], v[76:79]
    v_mfma_f32_16x16x32_bf16 v[80:83], a[136:139], v[32:35], v[80:83]
    ds_read_b128 v[28:31], v2 offset:6144
    ds_read_b128 v[32:35], v8 offset:6144
    s_waitcnt lgkmcnt(6)
    v_mfma_f32_16x16x32_bf16 v[76:79], a[140:143], v[36:39], v[76:79]
    v_mfma_f32_16x16x32_bf16 v[80:83], a[140:143], v[40:43], v[80:83]
    ds_read_b128 v[36:39], v2 offset:7168
    ds_read_b128 v[40:43], v8 offset:7168
    s_waitcnt lgkmcnt(6)
    v_mfma_f32_16x16x32_bf16 v[76:79], a[144:147], v[12:15], v[76:79]
    v_mfma_f32_16x16x32_bf16 v[80:83], a[144:147], v[16:19], v[80:83]
    ds_read_b128 v[12:15], v2 offset:8192
    ds_read_b128 v[16:19], v8 offset:8192
    s_waitcnt lgkmcnt(6)
    v_mfma_f32_16x16x32_bf16 v[76:79], a[148:151], v[20:23], v[76:79]
    v_mfma_f32_16x16x32_bf16 v[80:83], a[148:151], v[24:27], v[80:83]
    ds_read_b128 v[20:23], v2 offset:9216
    ds_read_b128 v[24:27], v8 offset:9216
    s_waitcnt lgkmcnt(6)
    v_mfma_f32_16x16x32_bf16 v[76:79], a[152:155], v[28:31], v[76:79]
    v_mfma_f32_16x16x32_bf16 v[80:83], a[152:155], v[32:35], v[80:83]
    ds_read_b128 v[28:31], v2 offset:10240
    ds_read_b128 v[32:35], v8 offset:10240
    s_waitcnt lgkmcnt(6)
    v_mfma_f32_16x16x32_bf16 v[76:79], a[156:159], v[36:39], v[76:79]
    v_mfma_f32_16x16x32_bf16 v[80:83], a[156:159], v[40:43], v[80:83]
    ds_read_b128 v[36:39], v2 offset:11264
    ds_read_b128 v[40:43], v8 offset:11264
    s_waitcnt lgkmcnt(6)
    v_mfma_f32_16x16x32_bf16 v[76:79], a[160:163], v[12:15], v[76:79]
    v_mfma_f32_16x16x32_bf16 v[80:83], a[160:163], v[16:19], v[80:83]
    ds_read_b128 v[12:15], v2 offset:12288
    ds_read_b128 v[16:19], v8 offset:12288
    s_waitcnt lgkmcnt(6)
    v_mfma_f32_16x16x32_bf16 v[76:79], a[164:167], v[20:23], v[76:79]
    v_mfma_f32_16x16x32_bf16 v[80:83], a[164:167], v[24:27], v[80:83]
    ds_read_b128 v[20:23], v2 offset:13312
    ds_read_b128 v[24:27], v8 offset:13312
    s_waitcnt lgkmcnt(6)
    v_mfma_f32_16x16x32_bf16 v[76:79], a[168:171], v[28:31], v[76:79]
    v_mfma_f32_16x16x32_bf16 v[80:83], a[168:171], v[32:35], v[80:83]
    ds_read_b128 v[28:31], v2 offset:14336
    ds_read_b128 v[32:35], v8 offset:14336
    s_waitcnt lgkmcnt(6)
    v_mfma_f32_16x16x32_bf16 v[76:79], a[172:175], v[36:39], v[76:79]
    v_mfma_f32_16x16x32_bf16 v[80:83], a[172:175], v[40:43], v[80:83]
    ds_read_b128 v[36:39], v2 offset:15360
    ds_read_b128 v[40:43], v8 offset:15360
    s_waitcnt lgkmcnt(6)
    v_mfma_f32_16x16x32_bf16 v[76:79], a[176:179], v[12:15], v[76:79]
    v_mfma_f32_16x16x32_bf16 v[80:83], a[176:179], v[16:19], v[80:83]
    ds_read_b128 v[12:15], v2 offset:16384
    ds_read_b128 v[16:19], v8 offset:16384
    s_waitcnt lgkmcnt(6)
    v_mfma_f32_16x16x32_bf16 v[76:79], a[180:183], v[20:23], v[76:79]
    v_mfma_f32_16x16x32_bf16 v[80:83], a[180:183], v[24:27], v[80:83]
    ds_read_b128 v[20:23], v2 offset:17408
    ds_read_b128 v[24:27], v8 offset:17408
    s_waitcnt lgkmcnt(6)
    v_mfma_f32_16x16x32_bf16 v[76:79], a[184:187], v[28:31], v[76:79]
    v_mfma_f32_16x16x32_bf16 v[80:83], a[184:187], v[32:35], v[80:83]
    ds_read_b128 v[28:31], v2 offset:18432
    ds_read_b128 v[32:35], v8 offset:18432
    s_waitcnt lgkmcnt(6)
    v_mfma_f32_16x16x32_bf16 v[76:79], a[188:191], v[36:39], v[76:79]
    v_mfma_f32_16x16x32_bf16 v[80:83], a[188:191], v[40:43], v[80:83]
    ds_read_b128 v[36:39], v2 offset:19456
    ds_read_b128 v[40:43], v8 offset:19456
    s_waitcnt lgkmcnt(6)
    v_mfma_f32_16x16x32_bf16 v[76:79], a[192:195], v[12:15], v[76:79]
    v_mfma_f32_16x16x32_bf16 v[80:83], a[192:195], v[16:19], v[80:83]
    ds_read_b128 v[12:15], v2 offset:20480
    ds_read_b128 v[16:19], v8 offset:20480
    s_waitcnt lgkmcnt(6)
    v_mfma_f32_16x16x32_bf16 v[76:79], a[196:199], v[20:23], v[76:79]
    v_mfma_f32_16x16x32_bf16 v[80:83], a[196:199], v[24:27], v[80:83]
    ds_read_b128 v[20:23], v2 offset:21504
    ds_read_b128 v[24:27], v8 offset:21504
    s_waitcnt lgkmcnt(6)
    v_mfma_f32_16x16x32_bf16 v[76:79], a[200:203], v[28:31], v[76:79]
    v_mfma_f32_16x16x32_bf16 v[80:83], a[200:203], v[32:35], v[80:83]
    ds_read_b128 v[28:31], v2 offset:22528
    ds_read_b128 v[32:35], v8 offset:22528
    s_waitcnt lgkmcnt(6)
    v_mfma_f32_16x16x32_bf16 v[76:79], a[204:207], v[36:39], v[76:79]
    v_mfma_f32_16x16x32_bf16 v[80:83], a[204:207], v[40:43], v[80:83]
    ds_read_b128 v[36:39], v2 offset:23552
    ds_read_b128 v[40:43], v8 offset:23552
    s_waitcnt lgkmcnt(6)
    v_mfma_f32_16x16x32_bf16 v[76:79], a[208:211], v[12:15], v[76:79]
    v_mfma_f32_16x16x32_bf16 v[80:83], a[208:211], v[16:19], v[80:83]
    ds_read_b128 v[12:15], v2 offset:24576
    ds_read_b128 v[16:19], v8 offset:24576
    s_waitcnt lgkmcnt(6)
    v_mfma_f32_16x16x32_bf16 v[76:79], a[212:215], v[20:23], v[76:79]
    v_mfma_f32_16x16x32_bf16 v[80:83], a[212:215], v[24:27], v[80:83]
    ds_read_b128 v[20:23], v2 offset:25600
    ds_read_b128 v[24:27], v8 offset:25600
    s_waitcnt lgkmcnt(6)
    v_mfma_f32_16x16x32_bf16 v[76:79], a[216:219], v[28:31], v[76:79]
    v_mfma_f32_16x16x32_bf16 v[80:83], a[216:219], v[32:35], v[80:83]
    ds_read_b128 v[28:31], v2 offset:26624
    ds_read_b128 v[32:35], v8 offset:26624
    s_waitcnt lgkmcnt(6)
    v_mfma_f32_16x16x32_bf16 v[76:79], a[220:223], v[36:39], v[76:79]
    v_mfma_f32_16x16x32_bf16 v[80:83], a[220:223], v[40:43], v[80:83]
    ds_read_b128 v[36:39], v2 offset:27648
    ds_read_b128 v[40:43], v8 offset:27648
    s_waitcnt lgkmcnt(6)
    v_mfma_f32_16x16x32_bf16 v[76:79], a[224:227], v[12:15], v[76:79]
    v_mfma_f32_16x16x32_bf16 v[80:83], a[224:227], v[16:19], v[80:83]
    ds_read_b128 v[12:15], v2 offset:28672
    ds_read_b128 v[16:19], v8 offset:28672
    s_waitcnt lgkmcnt(6)
    v_mfma_f32_16x16x32_bf16 v[76:79], a[228:231], v[20:23], v[76:79]
    v_mfma_f32_16x16x32_bf16 v[80:83], a[228:231], v[24:27], v[80:83]
    ds_read_b128 v[20:23], v2 offset:29696
    ds_read_b128 v[24:27], v8 offset:29696
    s_waitcnt lgkmcnt(6)
    v_mfma_f32_16x16x32_bf16 v[76:79], a[232:235], v[28:31], v[76:79]
    v_mfma_f32_16x16x32_bf16 v[80:83], a[232:235], v[32:35], v[80:83]
    ds_read_b128 v[28:31], v2 offset:30720
    ds_read_b128 v[32:35], v8 offset:30720
    s_waitcnt lgkmcnt(6)
    v_mfma_f32_16x16x32_bf16 v[76:79], a[236:239], v[36:39], v[76:79]
    v_mfma_f32_16x16x32_bf16 v[80:83], a[236:239], v[40:43], v[80:83]
    ds_read_b128 v[36:39], v2 offset:31744
    ds_read_b128 v[40:43], v8 offset:31744
    s_waitcnt lgkmcnt(6)
    v_mfma_f32_16x16x32_bf16 v[76:79], a[240:243], v[12:15], v[76:79]
    v_mfma_f32_16x16x32_bf16 v[80:83], a[240:243], v[16:19], v[80:83]
    ds_read_b128 v[12:15], v2 offset:32768
    ds_read_b128 v[16:19], v8 offset:32768
    s_waitcnt lgkmcnt(6)
    v_mfma_f32_16x16x32_bf16 v[76:79], a[244:247], v[20:23], v[76:79]
    v_mfma_f32_16x16x32_bf16 v[80:83], a[244:247], v[24:27], v[80:83]
    ds_read_b128 v[20:23], v2 offset:33792
    ds_read_b128 v[24:27], v8 offset:33792
    s_waitcnt lgkmcnt(6)
    v_mfma_f32_16x16x32_bf16 v[76:79], a[248:251], v[28:31], v[76:79]
    v_mfma_f32_16x16x32_bf16 v[80:83], a[248:251], v[32:35], v[80:83]
    ds_read_b128 v[28:31], v2 offset:34816
    ds_read_b128 v[32:35], v8 offset:34816
    s_waitcnt lgkmcnt(6)
    v_mfma_f32_16x16x32_bf16 v[76:79], a[252:255], v[36:39], v[76:79]
    v_mfma_f32_16x16x32_bf16 v[80:83], a[252:255], v[40:43], v[80:83]
    ds_read_b128 v[36:39], v2 offset:35840
    ds_read_b128 v[40:43], v8 offset:35840
    s_waitcnt lgkmcnt(6)
    v_mfma_f32_16x16x32_bf16 v[76:79], v[44:47], v[12:15], v[76:79]
    v_mfma_f32_16x16x32_bf16 v[80:83], v[44:47], v[16:19], v[80:83]
    ds_read_b128 v[12:15], v2 offset:36864
    ds_read_b128 v[16:19], v8 offset:36864
    s_waitcnt lgkmcnt(6)
    v_mfma_f32_16x16x32_bf16 v[76:79], v[48:51], v[20:23], v[76:79]
    v_mfma_f32_16x16x32_bf16 v[80:83], v[48:51], v[24:27], v[80:83]
    ds_read_b128 v[20:23], v2 offset:37888
    ds_read_b128 v[24:27], v8 offset:37888
    s_waitcnt lgkmcnt(6)
    v_mfma_f32_16x16x32_bf16 v[76:79], v[52:55], v[28:31], v[76:79]
    v_mfma_f32_16x16x32_bf16 v[80:83], v[52:55], v[32:35], v[80:83]
    ds_read_b128 v[28:31], v2 offset:38912
    ds_read_b128 v[32:35], v8 offset:38912
    s_waitcnt lgkmcnt(6)
    v_mfma_f32_16x16x32_bf16 v[76:79], v[56:59], v[36:39], v[76:79]
    v_mfma_f32_16x16x32_bf16 v[80:83], v[56:59], v[40:43], v[80:83]
    ds_read_b128 v[36:39], v2 offset:39936
    ds_read_b128 v[40:43], v8 offset:39936
    s_waitcnt lgkmcnt(6)
    v_mfma_f32_16x16x32_bf16 v[76:79], v[60:63], v[12:15], v[76:79]
    v_mfma_f32_16x16x32_bf16 v[80:83], v[60:63], v[16:19], v[80:83]
    s_waitcnt lgkmcnt(4)
    v_mfma_f32_16x16x32_bf16 v[76:79], v[64:67], v[20:23], v[76:79]
    v_mfma_f32_16x16x32_bf16 v[80:83], v[64:67], v[24:27], v[80:83]
    s_waitcnt lgkmcnt(2)
    v_mfma_f32_16x16x32_bf16 v[76:79], v[68:71], v[28:31], v[76:79]
    v_mfma_f32_16x16x32_bf16 v[80:83], v[68:71], v[32:35], v[80:83]
    s_waitcnt lgkmcnt(0)
    v_mfma_f32_16x16x32_bf16 v[76:79], v[72:75], v[36:39], v[76:79]
    v_mfma_f32_16x16x32_bf16 v[80:83], v[72:75], v[40:43], v[80:83]
    s_nop 7
    v_cvt_pk_bf16_f32 v84, v76, v77
    v_cvt_pk_bf16_f32 v85, v78, v79
    v_cvt_pk_bf16_f32 v86, v80, v81
    v_cvt_pk_bf16_f32 v87, v82, v83
    s_nop 1
    v_permlane16_swap_b32 v84, v86
    v_permlane16_swap_b32 v85, v87
    buffer_store_dwordx4 v[84:87], v3, s[16:19], s33 offen nt
    s_add_u32 s22, s22, s36
    s_cmp_ge_u32 s22, 640
    s_cbranch_scc1 F_done_349
    s_branch F_loop_348
F_done_349:
    s_waitcnt vmcnt(0)
L_end:
    s_endpgm
.section .rodata,"a"
.p2align 6
.amdhsa_kernel concat_heads__memory_aug_recurrent_mem_tr__sliding_block__prompt_kernel
  .amdhsa_next_free_vgpr 512
  .amdhsa_next_free_sgpr 102
  .amdhsa_accum_offset 256
  .amdhsa_group_segment_fixed_size 0
  .amdhsa_kernarg_size 104
  .amdhsa_user_sgpr_count 2
  .amdhsa_user_sgpr_kernarg_segment_ptr 1
  .amdhsa_system_sgpr_workgroup_id_x 1
  .amdhsa_float_denorm_mode_32 3
.end_amdhsa_kernel
```
